```python
import torch

def _softmax(x, axis=-1):
    return torch.softmax(x, dim=axis)
def _gelu(x):
    return torch.nn.functional.gelu(x, approximate="tanh")
def _silu(x):
    return torch.nn.functional.silu(x)
def _sigmoid(x):
    return torch.sigmoid(x)
def _layernorm(x, axis=-1, eps=1e-5):
    m = x.mean(dim=axis, keepdim=True)
    v = x.var(dim=axis, keepdim=True, unbiased=False)
    return (x - m) / torch.sqrt(v + eps)
def _scatter_add(tgt, idx, src, axis=0):
    return tgt.clone().index_add_(axis, idx, src)
def _segment_sum(src, seg, n):
    out = torch.zeros((n,) + src.shape[1:], dtype=src.dtype)
    return out.index_add_(0, seg, src)
def _pad(x, pw):
    flat = tuple(v for pair in reversed(pw) for v in pair)
    return torch.nn.functional.pad(x, flat)

kernel_name = 'sequential_preLN__linear_kernel_hedgehog__dense_activation_relu__prompt'

def setup_inputs():

    _w = (lambda a: (lambda t: t.to(torch.bfloat16) if t.is_floating_point() else t)(torch.as_tensor(a)))
    def _A_setup():
        B, S, D, H = 1, 2048, 576, 32
        Dh = D // H
        return {
            "x": _w((lambda *s: torch.randn(*s, dtype=torch.bfloat16) * 0.05)(B, S, D)),
            "wqkv": _w((lambda *s: torch.randn(*s, dtype=torch.bfloat16) * 0.2)(D, 3 * D)),
            "w_phi": _w((lambda *s: torch.randn(*s, dtype=torch.bfloat16) * 0.2)(H, Dh, Dh) * (Dh ** -0.5)),
            "wo": _w((lambda *s: torch.randn(*s, dtype=torch.bfloat16) * 0.05)(D, D)),
        }
    _A_in = _A_setup()

    def _B_setup():
        B, S, D, Dff = 1, 2048, 576, 4608
        return {
            "x": _w((lambda *s: torch.randn(*s, dtype=torch.bfloat16) * 0.05)(B, S, D)),
            "w1": _w((lambda *s: torch.randn(*s, dtype=torch.bfloat16) * 0.05)(D, Dff)),
            "w2": _w((lambda *s: torch.randn(*s, dtype=torch.bfloat16) * 0.05)(Dff, D)),
        }
    _B_in = _B_setup()

    return {
        "A_x": _A_in["x"],
        "A_wqkv": _A_in["wqkv"],
        "A_w_phi": _A_in["w_phi"],
        "A_wo": _A_in["wo"],
        "B_x": _B_in["x"],
        "B_w1": _B_in["w1"],
        "B_w2": _B_in["w2"],
    }

def reference(A_x, A_wqkv, A_w_phi, A_wo, B_x, B_w1, B_w2):
    def _A_ref(x, wqkv, w_phi, wo):
        B, S, D = x.shape
        H = 32; Dh = D // H
        qkv = (lambda x, *d: x.permute(*d))((x @ wqkv).reshape(B, S, 3, H, Dh), 2, 0, 3, 1, 4)
        q, k, v = qkv[0], qkv[1], qkv[2]
        pq = torch.einsum("bhsd,hdf->bhsf", q, w_phi)
        pk = torch.einsum("bhsd,hdf->bhsf", k, w_phi)
        phi_q = torch.concatenate([_softmax(pq, axis=-1), _softmax(-pq, axis=-1)], axis=-1)
        phi_k = torch.concatenate([_softmax(pk, axis=-1), _softmax(-pk, axis=-1)], axis=-1)
        kv = torch.einsum("bhsf,bhsd->bhfd", phi_k, v)
        z  = torch.einsum("bhsf->bhf", phi_k)
        num = torch.einsum("bhqf,bhfd->bhqd", phi_q, kv)
        den = torch.einsum("bhqf,bhf->bhq", phi_q, z)[..., None] + 1e-6
        o = num / den
        return (lambda x, *d: x.permute(*d))(o, 0, 2, 1, 3).reshape(B, S, D) @ wo

    def _B_ref(x, w1, w2):
        h = torch.einsum("bsd,df->bsf", x, w1)
        zero = torch.zeros_like(h)
        h = torch.maximum(h, zero)
        return torch.einsum("bsf,fd->bsd", h, w2)

    x = A_x
    h = x + _A_ref(_layernorm(x, axis=-1), A_wqkv, A_w_phi, A_wo)
    h2 = h + _B_ref(_layernorm(h, axis=-1), B_w1, B_w2)
    return h2
```

```asm
; @launch grid=(256,1,1) block=(512,1,1) lds=163840
.amdgcn_target "amdgcn-amd-amdhsa--gfx950"
.text
.globl sequential_preLN__linear_kernel_hedgehog__dense_activation_relu__prompt_kernel
.p2align 8
.type sequential_preLN__linear_kernel_hedgehog__dense_activation_relu__prompt_kernel,@function
sequential_preLN__linear_kernel_hedgehog__dense_activation_relu__prompt_kernel:
    s_cmp_ge_u32 s2, 256
    s_cbranch_scc1 L_done
    s_load_dwordx8 s[4:11], s[0:1], 0
    s_load_dwordx8 s[12:19], s[0:1], 40
    s_load_dwordx2 s[20:21], s[0:1], 72
    v_lshrrev_b32 v2, 6, v0
    v_and_b32 v1, 63, v0
    v_readfirstlane_b32 s22, v2
    s_and_b32 s23, s2, 7
    s_lshr_b32 s24, s2, 3
    s_cmp_eq_u32 s22, 4
    s_cbranch_scc1 L_r4
    s_cmp_eq_u32 s22, 5
    s_cbranch_scc1 L_r5
    s_cmp_eq_u32 s22, 6
    s_cbranch_scc1 L_r6
    s_cmp_eq_u32 s22, 7
    s_cbranch_scc1 L_r7
    s_lshr_b32 s25, s23, 2
    s_lshl_b32 s25, s25, 3
    s_lshr_b32 s44, s24, 2
    s_add_u32 s25, s25, s44
    s_and_b32 s26, s23, 3
    s_lshl_b32 s26, s26, 2
    s_and_b32 s45, s24, 3
    s_add_u32 s26, s26, s45
    s_lshl_b32 s45, s45, 1
    s_add_u32 s27, s44, s45
    s_cmp_ge_u32 s27, 9
    s_cselect_b32 s44, 9, 0
    s_sub_u32 s27, s27, s44
    s_lshl_b32 s46, s22, 12
    v_mov_b32 v172, 0x3f803f80
    v_mov_b32 v173, 0x3f803f80
    v_mov_b32 v174, 0x3f803f80
    v_mov_b32 v175, 0x3f803f80
    v_and_b32 v20, 3, v1
    v_lshlrev_b32 v20, 2, v20
    v_add_u32 v20, 15, v20
    v_and_b32 v20, 15, v20
    v_lshlrev_b32 v20, 4, v20
    v_lshl_add_u32 v20, v1, 8, v20
    s_lshl_b32 s44, s22, 15
    s_add_u32 s44, s44, 16384
    v_add_u32 v20, s44, v20
    ds_write_b128 v20, v[172:175]
    v_mov_b32 v28, 0
    v_mov_b32 v29, 0
    v_mov_b32 v30, 0
    v_mov_b32 v31, 0
    v_min_u32 v20, 207, v0
    v_lshlrev_b32 v20, 4, v20
    v_add_u32 v8, 134656, v20
    ds_write_b128 v8, v[28:31]
    v_lshrrev_b32 v19, 5, v1
    v_bfe_u32 v20, v1, 4, 1
    v_bfe_u32 v21, v1, 2, 2
    v_and_b32 v22, 1, v1
    v_bfe_u32 v23, v1, 1, 1
    v_and_b32 v24, 31, v1
    v_bfe_u32 v25, v24, 1, 3
    v_xor_b32 v25, v25, v19
    v_lshlrev_b32 v25, 4, v25
    v_lshl_add_u32 v25, v24, 7, v25
    v_add_u32 v10, s46, v25
    v_xor_b32 v11, 32, v10
    v_xor_b32 v12, 64, v10
    v_xor_b32 v13, 96, v10
    v_lshl_add_u32 v24, v19, 3, v21
    v_lshlrev_b32 v24, 8, v24
    v_add_u32 v24, 16384, v24
    v_lshl_add_u32 v25, v22, 1, v20
    v_lshl_add_u32 v25, v21, 2, v25
    v_add_u32 v26, 0, v25
    v_and_b32 v26, 15, v26
    v_lshl_add_u32 v26, v26, 4, v24
    v_lshl_add_u32 v14, v23, 3, v26
    v_add_u32 v26, 5, v25
    v_and_b32 v26, 15, v26
    v_lshl_add_u32 v26, v26, 4, v24
    v_lshl_add_u32 v15, v23, 3, v26
    v_add_u32 v26, 10, v25
    v_and_b32 v26, 15, v26
    v_lshl_add_u32 v26, v26, 4, v24
    v_lshl_add_u32 v16, v23, 3, v26
    v_lshl_add_u32 v25, v20, 1, v23
    v_mul_u32_u24 v26, 5, v25
    v_lshl_add_u32 v26, v22, 1, v26
    v_add_u32 v26, 2, v26
    v_mov_b32 v28, 15
    v_cmp_eq_u32 vcc, 3, v25
    s_nop 1
    v_cndmask_b32 v26, v26, v28, vcc
    v_lshl_add_u32 v26, v21, 2, v26
    v_and_b32 v26, 15, v26
    v_lshl_add_u32 v17, v26, 4, v24
    v_lshl_add_u32 v17, v22, 3, v17
    v_mov_b32 v18, v14
    s_cmp_eq_u32 s22, 1
    s_cselect_b64 s[60:61], -1, 0
    v_cndmask_b32 v18, v18, v15, s[60:61]
    s_cmp_eq_u32 s22, 2
    s_cselect_b64 s[60:61], -1, 0
    v_cndmask_b32 v18, v18, v16, s[60:61]
    s_cmp_eq_u32 s22, 3
    s_cselect_b64 s[60:61], -1, 0
    v_cndmask_b32 v18, v18, v17, s[60:61]
    v_mul_u32_u24 v24, 18, v19
    v_add_u32 v24, v24, v21
    v_mul_u32_u24 v24, 40, v24
    v_add_u32 v24, 131072, v24
    v_mul_u32_u24 v28, 40, v21
    v_add_u32 v28, 132592, v28
    v_lshl_add_u32 v29, v25, 3, v24
    v_cmp_eq_u32 vcc, v22, v19
    s_nop 1
    v_cndmask_b32 v232, v28, v29, vcc
    v_add_u32 v29, 32, v24
    v_and_b32 v30, 19, v1
    v_cmp_eq_u32 vcc, v30, v19
    s_nop 1
    v_cndmask_b32 v233, v28, v29, vcc
    s_mov_b32 s76, 0x3fb8aa3b
    s_mov_b32 s77, 0xbfb8aa3b
    v_mov_b32 v27, 2146435072
    v_and_b32 v2, 31, v1
    s_lshl_b32 s44, s22, 5
    v_add_u32 v2, s44, v2
    v_mul_u32_u24 v2, 112, v2
    v_mul_u32_u24 v21, 14336, v19
    v_add_u32 v2, v2, v21
    v_add_u32 v2, 98304, v2
    v_lshrrev_b32 v21, 4, v1
    v_bfe_u32 v22, v1, 2, 2
    v_and_b32 v23, 3, v1
    v_lshl_add_u32 v3, v21, 2, v22
    v_mul_u32_u24 v3, 112, v3
    v_lshl_add_u32 v3, v23, 3, v3
    s_lshr_b32 s44, s22, 1
    s_mul_i32 s45, s44, 14336
    s_add_u32 s45, s45, 98304
    v_add_u32 v3, s45, v3
    s_and_b32 s47, s22, 1
    s_lshl_b32 s45, s47, 5
    s_add_u32 s45, s45, 72
    v_add_u32 v4, s45, v3
    v_and_b32 v26, 15, v1
    s_lshl_b32 s45, s47, 4
    v_add_u32 v26, s45, v26
    s_mul_i32 s45, s44, 1824
    s_add_u32 s45, s45, 137984
    v_mul_u32_u24 v5, 96, v26
    v_add_u32 v5, s45, v5
    v_mov_b32 v28, 141632
    v_cmp_gt_u32 s[62:63], 19, v26
    v_cmp_eq_u32 vcc, 0, v21
    s_nop 0
    s_and_b64 s[64:65], s[62:63], vcc
    v_lshlrev_b32 v29, 2, v21
    v_add_u32 v29, 0, v29
    v_mul_u32_u24 v30, 43, v29
    v_lshrrev_b32 v30, 8, v30
    v_mul_u32_u24 v31, 6, v30
    v_sub_u32 v31, v29, v31
    v_lshlrev_b32 v31, 1, v31
    v_lshl_add_u32 v31, v30, 4, v31
    v_add_u32 v31, v31, v5
    v_cndmask_b32 v176, v28, v31, s[62:63]
    v_lshlrev_b32 v29, 2, v21
    v_add_u32 v29, 2, v29
    v_mul_u32_u24 v30, 43, v29
    v_lshrrev_b32 v30, 8, v30
    v_mul_u32_u24 v31, 6, v30
    v_sub_u32 v31, v29, v31
    v_lshlrev_b32 v31, 1, v31
    v_lshl_add_u32 v31, v30, 4, v31
    v_add_u32 v31, v31, v5
    v_cndmask_b32 v177, v28, v31, s[62:63]
    v_lshlrev_b32 v29, 2, v21
    v_add_u32 v29, 16, v29
    v_mul_u32_u24 v30, 43, v29
    v_lshrrev_b32 v30, 8, v30
    v_mul_u32_u24 v31, 6, v30
    v_sub_u32 v31, v29, v31
    v_lshlrev_b32 v31, 1, v31
    v_lshl_add_u32 v31, v30, 4, v31
    v_add_u32 v31, v31, v5
    v_cndmask_b32 v178, v28, v31, s[62:63]
    v_lshlrev_b32 v29, 2, v21
    v_add_u32 v29, 18, v29
    v_mul_u32_u24 v30, 43, v29
    v_lshrrev_b32 v30, 8, v30
    v_mul_u32_u24 v31, 6, v30
    v_sub_u32 v31, v29, v31
    v_lshlrev_b32 v31, 1, v31
    v_lshl_add_u32 v31, v30, 4, v31
    v_add_u32 v31, v31, v5
    v_cndmask_b32 v179, v28, v31, s[62:63]
    v_lshlrev_b32 v29, 2, v21
    v_add_u32 v29, 32, v29
    v_mul_u32_u24 v30, 43, v29
    v_lshrrev_b32 v30, 8, v30
    v_mul_u32_u24 v31, 6, v30
    v_sub_u32 v31, v29, v31
    v_lshlrev_b32 v31, 1, v31
    v_lshl_add_u32 v31, v30, 4, v31
    v_add_u32 v31, v31, v5
    v_cndmask_b32 v180, v28, v31, s[64:65]
    v_lshlrev_b32 v29, 2, v21
    v_add_u32 v29, 34, v29
    v_mul_u32_u24 v30, 43, v29
    v_lshrrev_b32 v30, 8, v30
    v_mul_u32_u24 v31, 6, v30
    v_sub_u32 v31, v29, v31
    v_lshlrev_b32 v31, 1, v31
    v_lshl_add_u32 v31, v30, 4, v31
    v_add_u32 v31, v31, v5
    v_cndmask_b32 v181, v28, v31, s[64:65]
    v_lshlrev_b32 v8, 4, v0
    v_cmp_gt_u32 vcc, 228, v0
    s_nop 1
    v_cndmask_b32 v255, v27, v8, vcc
    s_mov_b64 s[74:75], vcc
    v_min_u32 v8, 3632, v8
    v_add_u32 v8, 137984, v8
    v_min_u32 v29, 227, v0
    v_mul_u32_u24 v30, 171, v29
    v_lshrrev_b32 v30, 10, v30
    v_mul_u32_u24 v31, 6, v30
    v_sub_u32 v31, v29, v31
    v_mul_u32_u24 v31, 12, v31
    v_cmp_le_u32 vcc, 19, v30
    s_nop 1
    v_addc_co_u32 v30, vcc, 0, v30, vcc
    v_mul_u32_u24 v30, 80, v30
    v_add_u32 v5, v30, v31
    v_add_u32 v5, 134656, v5
    v_cndmask_b32 v5, v28, v5, s[74:75]
    s_mul_i32 s49, s26, 59392
    s_add_u32 s49, s49, 4980736
    s_mul_i32 s48, s25, 3712
    s_add_u32 s48, s48, s49
    v_bfe_u32 v26, v1, 2, 1
    v_bfe_u32 v28, v1, 3, 2
    v_and_b32 v29, 3, v1
    v_mul_u32_u24 v30, 1600, v19
    v_add_u32 v30, 134656, v30
    v_mov_b32 v31, 137856
    v_lshl_add_u32 v250, v28, 2, v29
    v_mul_u32_u24 v250, 80, v250
    v_add_u32 v250, v250, v30
    v_cmp_eq_u32 vcc, v26, v19
    s_nop 1
    v_cndmask_b32 v250, v31, v250, vcc
    v_mul_u32_u24 v251, 80, v29
    v_add_u32 v251, 1280, v251
    v_add_u32 v251, v251, v30
    v_bfe_u32 v26, v1, 2, 3
    v_cmp_eq_u32 vcc, v26, v19
    s_nop 1
    v_cndmask_b32 v251, v31, v251, vcc
    s_mul_i32 s44, s22, 2304
    s_add_u32 s45, s44, 141696
    v_and_b32 v252, 31, v1
    v_mul_u32_u24 v252, 72, v252
    v_mul_u32_u24 v28, 36, v19
    v_add3_u32 v252, v252, v28, s45
    v_lshlrev_b32 v244, 4, v1
    v_add_u32 v245, s45, v244
    v_cmp_gt_u32 vcc, 16, v1
    s_nop 1
    v_cndmask_b32 v9, v27, v244, vcc
    s_lshl_b32 s50, s25, 4
    s_add_u32 s50, s50, s26
    s_mul_i32 s50, s50, 9216
    s_add_u32 s50, s50, s44
    s_add_u32 s50, s50, 0
    s_lshl_b32 s44, s22, 7
    s_add_u32 s44, s44, 134144
    v_lshlrev_b32 v253, 6, v19
    v_add_u32 v254, s44, v253
    v_add_u32 v253, 134144, v253
    v_mov_b32 v20, v176
    v_mov_b32 v21, v177
    v_mov_b32 v22, v178
    v_mov_b32 v23, v179
    v_mov_b32 v24, v180
    v_mov_b32 v25, v181
    s_mov_b32 s60, 0xaaaaaaaa
    s_mov_b32 s61, 0xaaaaaaaa
    s_mov_b32 s62, 0xcccccccc
    s_mov_b32 s63, 0xcccccccc
    s_mov_b32 s64, 0xff00ff00
    s_mov_b32 s65, 0xff00ff00
    s_mov_b32 s66, 0xffff0000
    s_mov_b32 s67, 0xffff0000
    s_mov_b32 s68, 0xf0f0f0f
    s_mov_b32 s69, 0xf0f0f0f0
    s_mov_b32 s70, 0x0
    s_mov_b32 s71, 0xffffffff
    s_mov_b32 s72, 0x1
    s_mov_b32 s73, 0x1
    s_waitcnt lgkmcnt(0)
    s_mov_b32 s28, s20
    s_and_b32 s29, s21, 0xffff
    s_mov_b32 s30, 27262976
    s_mov_b32 s31, 0x20000
    s_barrier
    ds_read_b128 v[160:163], v10 offset:0
    ds_read_b64_tr_b16 v[128:129], v14 offset:0
    ds_read_b64_tr_b16 v[130:131], v14 offset:1024
    ds_read_b64_tr_b16 v[132:133], v15 offset:0
    ds_read_b64_tr_b16 v[134:135], v15 offset:1024
    ds_read_b64_tr_b16 v[136:137], v16 offset:0
    ds_read_b64_tr_b16 v[138:139], v16 offset:1024
    ds_read_b64_tr_b16 v[140:141], v17 offset:0
    ds_read_b64_tr_b16 v[142:143], v17 offset:1024
    ds_read_b64_tr_b16 v[144:145], v18 offset:0
    ds_read_b64_tr_b16 v[146:147], v18 offset:1024
    ds_read_b128 v[164:167], v11 offset:0
    ds_read_b64_tr_b16 v[148:149], v14 offset:4096
    ds_read_b64_tr_b16 v[150:151], v14 offset:5120
    s_waitcnt lgkmcnt(11)
    v_mfma_f32_32x32x16_bf16 v[32:47], v[128:131], v[160:163], 0
    ds_read_b64_tr_b16 v[152:153], v15 offset:4096
    ds_read_b64_tr_b16 v[154:155], v15 offset:5120
    s_waitcnt lgkmcnt(11)
    v_mfma_f32_32x32x16_bf16 v[48:63], v[132:135], v[160:163], 0
    v_mfma_f32_32x32x16_bf16 v[96:111], v[160:163], v[160:163], 0
    ds_read_b64_tr_b16 v[156:157], v16 offset:4096
    ds_read_b64_tr_b16 v[158:159], v16 offset:5120
    s_waitcnt lgkmcnt(11)
    v_mfma_f32_32x32x16_bf16 v[64:79], v[136:139], v[160:163], 0
    ds_read_b64_tr_b16 v[128:129], v17 offset:4096
    ds_read_b64_tr_b16 v[130:131], v17 offset:5120
    s_waitcnt lgkmcnt(11)
    v_mfma_f32_32x32x16_bf16 v[80:95], v[140:143], v[160:163], 0
    ds_read_b64_tr_b16 v[132:133], v18 offset:4096
    ds_read_b64_tr_b16 v[134:135], v18 offset:5120
    s_waitcnt lgkmcnt(11)
    v_mfma_f32_32x32x16_bf16 v[112:127], v[144:147], v[172:175], 0
    ds_read_b128 v[168:171], v12 offset:0
    ds_read_b64_tr_b16 v[136:137], v14 offset:8192
    ds_read_b64_tr_b16 v[138:139], v14 offset:9216
    s_waitcnt lgkmcnt(11)
    v_mfma_f32_32x32x16_bf16 v[32:47], v[148:151], v[164:167], v[32:47]
    ds_read_b64_tr_b16 v[140:141], v15 offset:8192
    ds_read_b64_tr_b16 v[142:143], v15 offset:9216
    s_waitcnt lgkmcnt(11)
    v_mfma_f32_32x32x16_bf16 v[48:63], v[152:155], v[164:167], v[48:63]
    v_mfma_f32_32x32x16_bf16 v[96:111], v[164:167], v[164:167], v[96:111]
    ds_read_b64_tr_b16 v[144:145], v16 offset:8192
    ds_read_b64_tr_b16 v[146:147], v16 offset:9216
    s_waitcnt lgkmcnt(11)
    v_mfma_f32_32x32x16_bf16 v[64:79], v[156:159], v[164:167], v[64:79]
    ds_read_b64_tr_b16 v[148:149], v17 offset:8192
    ds_read_b64_tr_b16 v[150:151], v17 offset:9216
    s_waitcnt lgkmcnt(11)
    v_mfma_f32_32x32x16_bf16 v[80:95], v[128:131], v[164:167], v[80:95]
    ds_read_b64_tr_b16 v[152:153], v18 offset:8192
    ds_read_b64_tr_b16 v[154:155], v18 offset:9216
    s_waitcnt lgkmcnt(11)
    v_mfma_f32_32x32x16_bf16 v[112:127], v[132:135], v[172:175], v[112:127]
    s_barrier
    ds_read_b128 v[160:163], v13 offset:0
    ds_read_b64_tr_b16 v[156:157], v14 offset:12288
    ds_read_b64_tr_b16 v[158:159], v14 offset:13312
    s_waitcnt lgkmcnt(11)
    v_mfma_f32_32x32x16_bf16 v[32:47], v[136:139], v[168:171], v[32:47]
    ds_read_b64_tr_b16 v[128:129], v15 offset:12288
    ds_read_b64_tr_b16 v[130:131], v15 offset:13312
    s_waitcnt lgkmcnt(11)
    v_mfma_f32_32x32x16_bf16 v[48:63], v[140:143], v[168:171], v[48:63]
    v_mfma_f32_32x32x16_bf16 v[96:111], v[168:171], v[168:171], v[96:111]
    ds_read_b64_tr_b16 v[132:133], v16 offset:12288
    ds_read_b64_tr_b16 v[134:135], v16 offset:13312
    s_waitcnt lgkmcnt(11)
    v_mfma_f32_32x32x16_bf16 v[64:79], v[144:147], v[168:171], v[64:79]
    ds_read_b64_tr_b16 v[136:137], v17 offset:12288
    ds_read_b64_tr_b16 v[138:139], v17 offset:13312
    s_waitcnt lgkmcnt(11)
    v_mfma_f32_32x32x16_bf16 v[80:95], v[148:151], v[168:171], v[80:95]
    ds_read_b64_tr_b16 v[140:141], v18 offset:12288
    ds_read_b64_tr_b16 v[142:143], v18 offset:13312
    s_waitcnt lgkmcnt(11)
    v_mfma_f32_32x32x16_bf16 v[112:127], v[152:155], v[172:175], v[112:127]
    ds_read_b128 v[164:167], v10 offset:32768
    ds_read_b64_tr_b16 v[144:145], v14 offset:32768
    ds_read_b64_tr_b16 v[146:147], v14 offset:33792
    s_waitcnt lgkmcnt(11)
    v_mfma_f32_32x32x16_bf16 v[32:47], v[156:159], v[160:163], v[32:47]
    ds_read_b64_tr_b16 v[148:149], v15 offset:32768
    ds_read_b64_tr_b16 v[150:151], v15 offset:33792
    s_waitcnt lgkmcnt(11)
    v_mfma_f32_32x32x16_bf16 v[48:63], v[128:131], v[160:163], v[48:63]
    v_mfma_f32_32x32x16_bf16 v[96:111], v[160:163], v[160:163], v[96:111]
    ds_read_b64_tr_b16 v[152:153], v16 offset:32768
    ds_read_b64_tr_b16 v[154:155], v16 offset:33792
    s_waitcnt lgkmcnt(11)
    v_mfma_f32_32x32x16_bf16 v[64:79], v[132:135], v[160:163], v[64:79]
    ds_read_b64_tr_b16 v[156:157], v17 offset:32768
    ds_read_b64_tr_b16 v[158:159], v17 offset:33792
    s_waitcnt lgkmcnt(11)
    v_mfma_f32_32x32x16_bf16 v[80:95], v[136:139], v[160:163], v[80:95]
    ds_read_b64_tr_b16 v[128:129], v18 offset:32768
    ds_read_b64_tr_b16 v[130:131], v18 offset:33792
    s_waitcnt lgkmcnt(11)
    v_mfma_f32_32x32x16_bf16 v[112:127], v[140:143], v[172:175], v[112:127]
    ds_read_b128 v[168:171], v11 offset:32768
    ds_read_b64_tr_b16 v[132:133], v14 offset:36864
    ds_read_b64_tr_b16 v[134:135], v14 offset:37888
    s_waitcnt lgkmcnt(11)
    v_mfma_f32_32x32x16_bf16 v[32:47], v[144:147], v[164:167], v[32:47]
    ds_read_b64_tr_b16 v[136:137], v15 offset:36864
    ds_read_b64_tr_b16 v[138:139], v15 offset:37888
    s_waitcnt lgkmcnt(11)
    v_mfma_f32_32x32x16_bf16 v[48:63], v[148:151], v[164:167], v[48:63]
    v_mfma_f32_32x32x16_bf16 v[96:111], v[164:167], v[164:167], v[96:111]
    ds_read_b64_tr_b16 v[140:141], v16 offset:36864
    ds_read_b64_tr_b16 v[142:143], v16 offset:37888
    s_waitcnt lgkmcnt(11)
    v_mfma_f32_32x32x16_bf16 v[64:79], v[152:155], v[164:167], v[64:79]
    ds_read_b64_tr_b16 v[144:145], v17 offset:36864
    ds_read_b64_tr_b16 v[146:147], v17 offset:37888
    s_waitcnt lgkmcnt(11)
    v_mfma_f32_32x32x16_bf16 v[80:95], v[156:159], v[164:167], v[80:95]
    ds_read_b64_tr_b16 v[148:149], v18 offset:36864
    ds_read_b64_tr_b16 v[150:151], v18 offset:37888
    s_waitcnt lgkmcnt(11)
    v_mfma_f32_32x32x16_bf16 v[112:127], v[128:131], v[172:175], v[112:127]
    ds_read_b128 v[160:163], v12 offset:32768
    ds_read_b64_tr_b16 v[152:153], v14 offset:40960
    ds_read_b64_tr_b16 v[154:155], v14 offset:41984
    s_waitcnt lgkmcnt(11)
    v_mfma_f32_32x32x16_bf16 v[32:47], v[132:135], v[168:171], v[32:47]
    ds_read_b64_tr_b16 v[156:157], v15 offset:40960
    ds_read_b64_tr_b16 v[158:159], v15 offset:41984
    s_waitcnt lgkmcnt(11)
    v_mfma_f32_32x32x16_bf16 v[48:63], v[136:139], v[168:171], v[48:63]
    v_mfma_f32_32x32x16_bf16 v[96:111], v[168:171], v[168:171], v[96:111]
    ds_read_b64_tr_b16 v[128:129], v16 offset:40960
    ds_read_b64_tr_b16 v[130:131], v16 offset:41984
    s_waitcnt lgkmcnt(11)
    v_mfma_f32_32x32x16_bf16 v[64:79], v[140:143], v[168:171], v[64:79]
    ds_read_b64_tr_b16 v[132:133], v17 offset:40960
    ds_read_b64_tr_b16 v[134:135], v17 offset:41984
    s_waitcnt lgkmcnt(11)
    v_mfma_f32_32x32x16_bf16 v[80:95], v[144:147], v[168:171], v[80:95]
    ds_read_b64_tr_b16 v[136:137], v18 offset:40960
    ds_read_b64_tr_b16 v[138:139], v18 offset:41984
    s_waitcnt lgkmcnt(11)
    v_mfma_f32_32x32x16_bf16 v[112:127], v[148:151], v[172:175], v[112:127]
    s_barrier
    ds_read_b64_tr_b16 v[212:213], v232 offset:0
    ds_read_b64_tr_b16 v[214:215], v232 offset:160
    ds_read_b64_tr_b16 v[216:217], v232 offset:320
    ds_read_b64_tr_b16 v[218:219], v232 offset:480
    ds_read_b64_tr_b16 v[220:221], v232 offset:640
    ds_read_b64_tr_b16 v[222:223], v233 offset:0
    ds_read_b64_tr_b16 v[224:225], v233 offset:160
    ds_read_b64_tr_b16 v[226:227], v233 offset:320
    ds_read_b64_tr_b16 v[228:229], v233 offset:480
    ds_read_b64_tr_b16 v[230:231], v233 offset:640
    ds_read_b128 v[164:167], v13 offset:32768
    ds_read_b64_tr_b16 v[140:141], v14 offset:45056
    ds_read_b64_tr_b16 v[142:143], v14 offset:46080
    s_waitcnt lgkmcnt(15)
    v_mfma_f32_32x32x16_bf16 v[32:47], v[152:155], v[160:163], v[32:47]
    ds_read_b64_tr_b16 v[144:145], v15 offset:45056
    ds_read_b64_tr_b16 v[146:147], v15 offset:46080
    v_mfma_f32_32x32x16_bf16 v[48:63], v[156:159], v[160:163], v[48:63]
    v_mfma_f32_32x32x16_bf16 v[96:111], v[160:163], v[160:163], v[96:111]
    ds_read_b64_tr_b16 v[148:149], v16 offset:45056
    ds_read_b64_tr_b16 v[150:151], v16 offset:46080
    v_mfma_f32_32x32x16_bf16 v[64:79], v[128:131], v[160:163], v[64:79]
    ds_read_b64_tr_b16 v[152:153], v17 offset:45056
    ds_read_b64_tr_b16 v[154:155], v17 offset:46080
    v_mfma_f32_32x32x16_bf16 v[80:95], v[132:135], v[160:163], v[80:95]
    ds_read_b64_tr_b16 v[156:157], v18 offset:45056
    ds_read_b64_tr_b16 v[158:159], v18 offset:46080
    s_waitcnt lgkmcnt(15)
    v_mfma_f32_32x32x16_bf16 v[112:127], v[136:139], v[172:175], v[112:127]
    v_xor_b32 v10, 0x10000, v10
    v_xor_b32 v11, 0x10000, v11
    v_xor_b32 v12, 0x10000, v12
    v_xor_b32 v13, 0x10000, v13
    v_xor_b32 v14, 0x10000, v14
    v_xor_b32 v15, 0x10000, v15
    v_xor_b32 v16, 0x10000, v16
    v_xor_b32 v17, 0x10000, v17
    v_xor_b32 v18, 0x10000, v18
    ds_read_b128 v[168:171], v10 offset:0
    ds_read_b64_tr_b16 v[128:129], v14 offset:0
    ds_read_b64_tr_b16 v[130:131], v14 offset:1024
    s_waitcnt lgkmcnt(11)
    v_mfma_f32_32x32x16_bf16 v[32:47], v[140:143], v[164:167], v[32:47]
    ds_read_b64_tr_b16 v[132:133], v15 offset:0
    ds_read_b64_tr_b16 v[134:135], v15 offset:1024
    s_waitcnt lgkmcnt(11)
    v_mfma_f32_32x32x16_bf16 v[48:63], v[144:147], v[164:167], v[48:63]
    v_mfma_f32_32x32x16_bf16 v[96:111], v[164:167], v[164:167], v[96:111]
    ds_read_b64_tr_b16 v[136:137], v16 offset:0
    ds_read_b64_tr_b16 v[138:139], v16 offset:1024
    s_waitcnt lgkmcnt(11)
    v_mfma_f32_32x32x16_bf16 v[64:79], v[148:151], v[164:167], v[64:79]
    ds_read_b64_tr_b16 v[140:141], v17 offset:0
    ds_read_b64_tr_b16 v[142:143], v17 offset:1024
    s_waitcnt lgkmcnt(11)
    v_mfma_f32_32x32x16_bf16 v[80:95], v[152:155], v[164:167], v[80:95]
    ds_read_b64_tr_b16 v[144:145], v18 offset:0
    ds_read_b64_tr_b16 v[146:147], v18 offset:1024
    s_waitcnt lgkmcnt(11)
    v_mfma_f32_32x32x16_bf16 v[112:127], v[156:159], v[172:175], v[112:127]
    ds_read_b128 v[160:163], v11 offset:0
    ds_read_b64_tr_b16 v[148:149], v14 offset:4096
    ds_read_b64_tr_b16 v[150:151], v14 offset:5120
    s_waitcnt lgkmcnt(11)
    v_mfma_f32_32x32x16_bf16 v[32:47], v[128:131], v[168:171], v[32:47]
    ds_read_b64_tr_b16 v[152:153], v15 offset:4096
    ds_read_b64_tr_b16 v[154:155], v15 offset:5120
    s_waitcnt lgkmcnt(11)
    v_mfma_f32_32x32x16_bf16 v[48:63], v[132:135], v[168:171], v[48:63]
    v_mfma_f32_32x32x16_bf16 v[96:111], v[168:171], v[168:171], v[96:111]
    ds_read_b64_tr_b16 v[156:157], v16 offset:4096
    ds_read_b64_tr_b16 v[158:159], v16 offset:5120
    s_waitcnt lgkmcnt(11)
    v_mfma_f32_32x32x16_bf16 v[64:79], v[136:139], v[168:171], v[64:79]
    ds_read_b64_tr_b16 v[128:129], v17 offset:4096
    ds_read_b64_tr_b16 v[130:131], v17 offset:5120
    s_waitcnt lgkmcnt(11)
    v_mfma_f32_32x32x16_bf16 v[80:95], v[140:143], v[168:171], v[80:95]
    ds_read_b64_tr_b16 v[132:133], v18 offset:4096
    ds_read_b64_tr_b16 v[134:135], v18 offset:5120
    s_waitcnt lgkmcnt(11)
    v_mfma_f32_32x32x16_bf16 v[112:127], v[144:147], v[172:175], v[112:127]
    ds_read_b128 v[164:167], v12 offset:0
    ds_read_b64_tr_b16 v[136:137], v14 offset:8192
    ds_read_b64_tr_b16 v[138:139], v14 offset:9216
    s_waitcnt lgkmcnt(11)
    v_mfma_f32_32x32x16_bf16 v[32:47], v[148:151], v[160:163], v[32:47]
    ds_read_b64_tr_b16 v[140:141], v15 offset:8192
    ds_read_b64_tr_b16 v[142:143], v15 offset:9216
    s_waitcnt lgkmcnt(11)
    v_mfma_f32_32x32x16_bf16 v[48:63], v[152:155], v[160:163], v[48:63]
    v_mfma_f32_32x32x16_bf16 v[96:111], v[160:163], v[160:163], v[96:111]
    ds_read_b64_tr_b16 v[144:145], v16 offset:8192
    ds_read_b64_tr_b16 v[146:147], v16 offset:9216
    s_waitcnt lgkmcnt(11)
    v_mfma_f32_32x32x16_bf16 v[64:79], v[156:159], v[160:163], v[64:79]
    ds_read_b64_tr_b16 v[148:149], v17 offset:8192
    ds_read_b64_tr_b16 v[150:151], v17 offset:9216
    s_waitcnt lgkmcnt(11)
    v_mfma_f32_32x32x16_bf16 v[80:95], v[128:131], v[160:163], v[80:95]
    ds_read_b64_tr_b16 v[152:153], v18 offset:8192
    ds_read_b64_tr_b16 v[154:155], v18 offset:9216
    s_waitcnt lgkmcnt(11)
    v_mfma_f32_32x32x16_bf16 v[112:127], v[132:135], v[172:175], v[112:127]
    s_barrier
    ds_read_b128 v[168:171], v13 offset:0
    ds_read_b64_tr_b16 v[156:157], v14 offset:12288
    ds_read_b64_tr_b16 v[158:159], v14 offset:13312
    s_waitcnt lgkmcnt(11)
    v_mfma_f32_32x32x16_bf16 v[32:47], v[136:139], v[164:167], v[32:47]
    ds_read_b64_tr_b16 v[128:129], v15 offset:12288
    ds_read_b64_tr_b16 v[130:131], v15 offset:13312
    s_waitcnt lgkmcnt(11)
    v_mfma_f32_32x32x16_bf16 v[48:63], v[140:143], v[164:167], v[48:63]
    v_mfma_f32_32x32x16_bf16 v[96:111], v[164:167], v[164:167], v[96:111]
    ds_read_b64_tr_b16 v[132:133], v16 offset:12288
    ds_read_b64_tr_b16 v[134:135], v16 offset:13312
    s_waitcnt lgkmcnt(11)
    v_mfma_f32_32x32x16_bf16 v[64:79], v[144:147], v[164:167], v[64:79]
    ds_read_b64_tr_b16 v[136:137], v17 offset:12288
    ds_read_b64_tr_b16 v[138:139], v17 offset:13312
    s_waitcnt lgkmcnt(11)
    v_mfma_f32_32x32x16_bf16 v[80:95], v[148:151], v[164:167], v[80:95]
    ds_read_b64_tr_b16 v[140:141], v18 offset:12288
    ds_read_b64_tr_b16 v[142:143], v18 offset:13312
    s_waitcnt lgkmcnt(11)
    v_mfma_f32_32x32x16_bf16 v[112:127], v[152:155], v[172:175], v[112:127]
    ds_read_b128 v[160:163], v10 offset:32768
    ds_read_b64_tr_b16 v[144:145], v14 offset:32768
    ds_read_b64_tr_b16 v[146:147], v14 offset:33792
    s_waitcnt lgkmcnt(11)
    v_mfma_f32_32x32x16_bf16 v[32:47], v[156:159], v[168:171], v[32:47]
    ds_read_b64_tr_b16 v[148:149], v15 offset:32768
    ds_read_b64_tr_b16 v[150:151], v15 offset:33792
    s_waitcnt lgkmcnt(11)
    v_mfma_f32_32x32x16_bf16 v[48:63], v[128:131], v[168:171], v[48:63]
    v_mfma_f32_32x32x16_bf16 v[96:111], v[168:171], v[168:171], v[96:111]
    ds_read_b64_tr_b16 v[152:153], v16 offset:32768
    ds_read_b64_tr_b16 v[154:155], v16 offset:33792
    s_waitcnt lgkmcnt(11)
    v_mfma_f32_32x32x16_bf16 v[64:79], v[132:135], v[168:171], v[64:79]
    ds_read_b64_tr_b16 v[156:157], v17 offset:32768
    ds_read_b64_tr_b16 v[158:159], v17 offset:33792
    s_waitcnt lgkmcnt(11)
    v_mfma_f32_32x32x16_bf16 v[80:95], v[136:139], v[168:171], v[80:95]
    ds_read_b64_tr_b16 v[128:129], v18 offset:32768
    ds_read_b64_tr_b16 v[130:131], v18 offset:33792
    s_waitcnt lgkmcnt(11)
    v_mfma_f32_32x32x16_bf16 v[112:127], v[140:143], v[172:175], v[112:127]
    ds_read_b128 v[164:167], v11 offset:32768
    ds_read_b64_tr_b16 v[132:133], v14 offset:36864
    ds_read_b64_tr_b16 v[134:135], v14 offset:37888
    s_waitcnt lgkmcnt(11)
    v_mfma_f32_32x32x16_bf16 v[32:47], v[144:147], v[160:163], v[32:47]
    ds_read_b64_tr_b16 v[136:137], v15 offset:36864
    ds_read_b64_tr_b16 v[138:139], v15 offset:37888
    s_waitcnt lgkmcnt(11)
    v_mfma_f32_32x32x16_bf16 v[48:63], v[148:151], v[160:163], v[48:63]
    v_mfma_f32_32x32x16_bf16 v[96:111], v[160:163], v[160:163], v[96:111]
    ds_read_b64_tr_b16 v[140:141], v16 offset:36864
    ds_read_b64_tr_b16 v[142:143], v16 offset:37888
    s_waitcnt lgkmcnt(11)
    v_mfma_f32_32x32x16_bf16 v[64:79], v[152:155], v[160:163], v[64:79]
    ds_read_b64_tr_b16 v[144:145], v17 offset:36864
    ds_read_b64_tr_b16 v[146:147], v17 offset:37888
    s_waitcnt lgkmcnt(11)
    v_mfma_f32_32x32x16_bf16 v[80:95], v[156:159], v[160:163], v[80:95]
    ds_read_b64_tr_b16 v[148:149], v18 offset:36864
    ds_read_b64_tr_b16 v[150:151], v18 offset:37888
    s_waitcnt lgkmcnt(11)
    v_mfma_f32_32x32x16_bf16 v[112:127], v[128:131], v[172:175], v[112:127]
    ds_read_b128 v[168:171], v12 offset:32768
    ds_read_b64_tr_b16 v[152:153], v14 offset:40960
    ds_read_b64_tr_b16 v[154:155], v14 offset:41984
    s_waitcnt lgkmcnt(11)
    v_mfma_f32_32x32x16_bf16 v[32:47], v[132:135], v[164:167], v[32:47]
    ds_read_b64_tr_b16 v[156:157], v15 offset:40960
    ds_read_b64_tr_b16 v[158:159], v15 offset:41984
    s_waitcnt lgkmcnt(11)
    v_mfma_f32_32x32x16_bf16 v[48:63], v[136:139], v[164:167], v[48:63]
    v_mfma_f32_32x32x16_bf16 v[96:111], v[164:167], v[164:167], v[96:111]
    ds_read_b64_tr_b16 v[128:129], v16 offset:40960
    ds_read_b64_tr_b16 v[130:131], v16 offset:41984
    s_waitcnt lgkmcnt(11)
    v_mfma_f32_32x32x16_bf16 v[64:79], v[140:143], v[164:167], v[64:79]
    ds_read_b64_tr_b16 v[132:133], v17 offset:40960
    ds_read_b64_tr_b16 v[134:135], v17 offset:41984
    s_waitcnt lgkmcnt(11)
    v_mfma_f32_32x32x16_bf16 v[80:95], v[144:147], v[164:167], v[80:95]
    ds_read_b64_tr_b16 v[136:137], v18 offset:40960
    ds_read_b64_tr_b16 v[138:139], v18 offset:41984
    s_waitcnt lgkmcnt(11)
    v_mfma_f32_32x32x16_bf16 v[112:127], v[148:151], v[172:175], v[112:127]
    s_barrier
    ds_read_b128 v[160:163], v13 offset:32768
    ds_read_b64_tr_b16 v[140:141], v14 offset:45056
    ds_read_b64_tr_b16 v[142:143], v14 offset:46080
    s_waitcnt lgkmcnt(11)
    v_mfma_f32_32x32x16_bf16 v[32:47], v[152:155], v[168:171], v[32:47]
    ds_read_b64_tr_b16 v[144:145], v15 offset:45056
    ds_read_b64_tr_b16 v[146:147], v15 offset:46080
    s_waitcnt lgkmcnt(11)
    v_mfma_f32_32x32x16_bf16 v[48:63], v[156:159], v[168:171], v[48:63]
    v_mfma_f32_32x32x16_bf16 v[96:111], v[168:171], v[168:171], v[96:111]
    ds_read_b64_tr_b16 v[148:149], v16 offset:45056
    ds_read_b64_tr_b16 v[150:151], v16 offset:46080
    s_waitcnt lgkmcnt(11)
    v_mfma_f32_32x32x16_bf16 v[64:79], v[128:131], v[168:171], v[64:79]
    ds_read_b64_tr_b16 v[152:153], v17 offset:45056
    ds_read_b64_tr_b16 v[154:155], v17 offset:46080
    s_waitcnt lgkmcnt(11)
    v_mfma_f32_32x32x16_bf16 v[80:95], v[132:135], v[168:171], v[80:95]
    ds_read_b64_tr_b16 v[156:157], v18 offset:45056
    ds_read_b64_tr_b16 v[158:159], v18 offset:46080
    s_waitcnt lgkmcnt(11)
    v_mfma_f32_32x32x16_bf16 v[112:127], v[136:139], v[172:175], v[112:127]
    v_xor_b32 v10, 0x10000, v10
    v_xor_b32 v11, 0x10000, v11
    v_xor_b32 v12, 0x10000, v12
    v_xor_b32 v13, 0x10000, v13
    v_xor_b32 v14, 0x10000, v14
    v_xor_b32 v15, 0x10000, v15
    v_xor_b32 v16, 0x10000, v16
    v_xor_b32 v17, 0x10000, v17
    v_xor_b32 v18, 0x10000, v18
    ds_read_b128 v[164:167], v10 offset:0
    ds_read_b64_tr_b16 v[128:129], v14 offset:0
    ds_read_b64_tr_b16 v[130:131], v14 offset:1024
    s_waitcnt lgkmcnt(11)
    v_mfma_f32_32x32x16_bf16 v[32:47], v[140:143], v[160:163], v[32:47]
    ds_read_b64_tr_b16 v[132:133], v15 offset:0
    ds_read_b64_tr_b16 v[134:135], v15 offset:1024
    s_waitcnt lgkmcnt(11)
    v_mfma_f32_32x32x16_bf16 v[48:63], v[144:147], v[160:163], v[48:63]
    v_mfma_f32_32x32x16_bf16 v[96:111], v[160:163], v[160:163], v[96:111]
    ds_read_b64_tr_b16 v[136:137], v16 offset:0
    ds_read_b64_tr_b16 v[138:139], v16 offset:1024
    s_waitcnt lgkmcnt(11)
    v_mfma_f32_32x32x16_bf16 v[64:79], v[148:151], v[160:163], v[64:79]
    ds_read_b64_tr_b16 v[140:141], v17 offset:0
    ds_read_b64_tr_b16 v[142:143], v17 offset:1024
    s_waitcnt lgkmcnt(11)
    v_mfma_f32_32x32x16_bf16 v[80:95], v[152:155], v[160:163], v[80:95]
    ds_read_b64_tr_b16 v[144:145], v18 offset:0
    ds_read_b64_tr_b16 v[146:147], v18 offset:1024
    s_waitcnt lgkmcnt(11)
    v_mfma_f32_32x32x16_bf16 v[112:127], v[156:159], v[172:175], v[112:127]
    ds_read_b128 v[168:171], v11 offset:0
    ds_read_b64_tr_b16 v[148:149], v14 offset:4096
    ds_read_b64_tr_b16 v[150:151], v14 offset:5120
    s_waitcnt lgkmcnt(11)
    v_mfma_f32_32x32x16_bf16 v[32:47], v[128:131], v[164:167], v[32:47]
    ds_read_b64_tr_b16 v[152:153], v15 offset:4096
    ds_read_b64_tr_b16 v[154:155], v15 offset:5120
    s_waitcnt lgkmcnt(11)
    v_mfma_f32_32x32x16_bf16 v[48:63], v[132:135], v[164:167], v[48:63]
    v_mfma_f32_32x32x16_bf16 v[96:111], v[164:167], v[164:167], v[96:111]
    ds_read_b64_tr_b16 v[156:157], v16 offset:4096
    ds_read_b64_tr_b16 v[158:159], v16 offset:5120
    s_waitcnt lgkmcnt(11)
    v_mfma_f32_32x32x16_bf16 v[64:79], v[136:139], v[164:167], v[64:79]
    ds_read_b64_tr_b16 v[128:129], v17 offset:4096
    ds_read_b64_tr_b16 v[130:131], v17 offset:5120
    s_waitcnt lgkmcnt(11)
    v_mfma_f32_32x32x16_bf16 v[80:95], v[140:143], v[164:167], v[80:95]
    ds_read_b64_tr_b16 v[132:133], v18 offset:4096
    ds_read_b64_tr_b16 v[134:135], v18 offset:5120
    s_waitcnt lgkmcnt(11)
    v_mfma_f32_32x32x16_bf16 v[112:127], v[144:147], v[172:175], v[112:127]
    ds_read_b128 v[160:163], v12 offset:0
    ds_read_b64_tr_b16 v[136:137], v14 offset:8192
    ds_read_b64_tr_b16 v[138:139], v14 offset:9216
    s_waitcnt lgkmcnt(11)
    v_mfma_f32_32x32x16_bf16 v[32:47], v[148:151], v[168:171], v[32:47]
    ds_read_b64_tr_b16 v[140:141], v15 offset:8192
    ds_read_b64_tr_b16 v[142:143], v15 offset:9216
    s_waitcnt lgkmcnt(11)
    v_mfma_f32_32x32x16_bf16 v[48:63], v[152:155], v[168:171], v[48:63]
    v_mfma_f32_32x32x16_bf16 v[96:111], v[168:171], v[168:171], v[96:111]
    ds_read_b64_tr_b16 v[144:145], v16 offset:8192
    ds_read_b64_tr_b16 v[146:147], v16 offset:9216
    s_waitcnt lgkmcnt(11)
    v_mfma_f32_32x32x16_bf16 v[64:79], v[156:159], v[168:171], v[64:79]
    ds_read_b64_tr_b16 v[148:149], v17 offset:8192
    ds_read_b64_tr_b16 v[150:151], v17 offset:9216
    s_waitcnt lgkmcnt(11)
    v_mfma_f32_32x32x16_bf16 v[80:95], v[128:131], v[168:171], v[80:95]
    ds_read_b64_tr_b16 v[152:153], v18 offset:8192
    ds_read_b64_tr_b16 v[154:155], v18 offset:9216
    s_waitcnt lgkmcnt(11)
    v_mfma_f32_32x32x16_bf16 v[112:127], v[132:135], v[172:175], v[112:127]
    s_barrier
    ds_read_b128 v[164:167], v13 offset:0
    ds_read_b64_tr_b16 v[156:157], v14 offset:12288
    ds_read_b64_tr_b16 v[158:159], v14 offset:13312
    s_waitcnt lgkmcnt(11)
    v_mfma_f32_32x32x16_bf16 v[32:47], v[136:139], v[160:163], v[32:47]
    ds_read_b64_tr_b16 v[128:129], v15 offset:12288
    ds_read_b64_tr_b16 v[130:131], v15 offset:13312
    s_waitcnt lgkmcnt(11)
    v_mfma_f32_32x32x16_bf16 v[48:63], v[140:143], v[160:163], v[48:63]
    v_mfma_f32_32x32x16_bf16 v[96:111], v[160:163], v[160:163], v[96:111]
    ds_read_b64_tr_b16 v[132:133], v16 offset:12288
    ds_read_b64_tr_b16 v[134:135], v16 offset:13312
    s_waitcnt lgkmcnt(11)
    v_mfma_f32_32x32x16_bf16 v[64:79], v[144:147], v[160:163], v[64:79]
    ds_read_b64_tr_b16 v[136:137], v17 offset:12288
    ds_read_b64_tr_b16 v[138:139], v17 offset:13312
    s_waitcnt lgkmcnt(11)
    v_mfma_f32_32x32x16_bf16 v[80:95], v[148:151], v[160:163], v[80:95]
    ds_read_b64_tr_b16 v[140:141], v18 offset:12288
    ds_read_b64_tr_b16 v[142:143], v18 offset:13312
    s_waitcnt lgkmcnt(11)
    v_mfma_f32_32x32x16_bf16 v[112:127], v[152:155], v[172:175], v[112:127]
    ds_read_b128 v[168:171], v10 offset:32768
    ds_read_b64_tr_b16 v[144:145], v14 offset:32768
    ds_read_b64_tr_b16 v[146:147], v14 offset:33792
    s_waitcnt lgkmcnt(11)
    v_mfma_f32_32x32x16_bf16 v[32:47], v[156:159], v[164:167], v[32:47]
    ds_read_b64_tr_b16 v[148:149], v15 offset:32768
    ds_read_b64_tr_b16 v[150:151], v15 offset:33792
    s_waitcnt lgkmcnt(11)
    v_mfma_f32_32x32x16_bf16 v[48:63], v[128:131], v[164:167], v[48:63]
    v_mfma_f32_32x32x16_bf16 v[96:111], v[164:167], v[164:167], v[96:111]
    ds_read_b64_tr_b16 v[152:153], v16 offset:32768
    ds_read_b64_tr_b16 v[154:155], v16 offset:33792
    s_waitcnt lgkmcnt(11)
    v_mfma_f32_32x32x16_bf16 v[64:79], v[132:135], v[164:167], v[64:79]
    ds_read_b64_tr_b16 v[156:157], v17 offset:32768
    ds_read_b64_tr_b16 v[158:159], v17 offset:33792
    s_waitcnt lgkmcnt(11)
    v_mfma_f32_32x32x16_bf16 v[80:95], v[136:139], v[164:167], v[80:95]
    ds_read_b64_tr_b16 v[128:129], v18 offset:32768
    ds_read_b64_tr_b16 v[130:131], v18 offset:33792
    s_waitcnt lgkmcnt(11)
    v_mfma_f32_32x32x16_bf16 v[112:127], v[140:143], v[172:175], v[112:127]
    ds_read_b128 v[160:163], v11 offset:32768
    ds_read_b64_tr_b16 v[132:133], v14 offset:36864
    ds_read_b64_tr_b16 v[134:135], v14 offset:37888
    s_waitcnt lgkmcnt(11)
    v_mfma_f32_32x32x16_bf16 v[32:47], v[144:147], v[168:171], v[32:47]
    ds_read_b64_tr_b16 v[136:137], v15 offset:36864
    ds_read_b64_tr_b16 v[138:139], v15 offset:37888
    s_waitcnt lgkmcnt(11)
    v_mfma_f32_32x32x16_bf16 v[48:63], v[148:151], v[168:171], v[48:63]
    v_mfma_f32_32x32x16_bf16 v[96:111], v[168:171], v[168:171], v[96:111]
    ds_read_b64_tr_b16 v[140:141], v16 offset:36864
    ds_read_b64_tr_b16 v[142:143], v16 offset:37888
    s_waitcnt lgkmcnt(11)
    v_mfma_f32_32x32x16_bf16 v[64:79], v[152:155], v[168:171], v[64:79]
    ds_read_b64_tr_b16 v[144:145], v17 offset:36864
    ds_read_b64_tr_b16 v[146:147], v17 offset:37888
    s_waitcnt lgkmcnt(11)
    v_mfma_f32_32x32x16_bf16 v[80:95], v[156:159], v[168:171], v[80:95]
    ds_read_b64_tr_b16 v[148:149], v18 offset:36864
    ds_read_b64_tr_b16 v[150:151], v18 offset:37888
    s_waitcnt lgkmcnt(11)
    v_mfma_f32_32x32x16_bf16 v[112:127], v[128:131], v[172:175], v[112:127]
    ds_read_b128 v[164:167], v12 offset:32768
    ds_read_b64_tr_b16 v[152:153], v14 offset:40960
    ds_read_b64_tr_b16 v[154:155], v14 offset:41984
    s_waitcnt lgkmcnt(11)
    v_mfma_f32_32x32x16_bf16 v[32:47], v[132:135], v[160:163], v[32:47]
    ds_read_b64_tr_b16 v[156:157], v15 offset:40960
    ds_read_b64_tr_b16 v[158:159], v15 offset:41984
    s_waitcnt lgkmcnt(11)
    v_mfma_f32_32x32x16_bf16 v[48:63], v[136:139], v[160:163], v[48:63]
    v_mfma_f32_32x32x16_bf16 v[96:111], v[160:163], v[160:163], v[96:111]
    ds_read_b64_tr_b16 v[128:129], v16 offset:40960
    ds_read_b64_tr_b16 v[130:131], v16 offset:41984
    s_waitcnt lgkmcnt(11)
    v_mfma_f32_32x32x16_bf16 v[64:79], v[140:143], v[160:163], v[64:79]
    ds_read_b64_tr_b16 v[132:133], v17 offset:40960
    ds_read_b64_tr_b16 v[134:135], v17 offset:41984
    s_waitcnt lgkmcnt(11)
    v_mfma_f32_32x32x16_bf16 v[80:95], v[144:147], v[160:163], v[80:95]
    ds_read_b64_tr_b16 v[136:137], v18 offset:40960
    ds_read_b64_tr_b16 v[138:139], v18 offset:41984
    s_waitcnt lgkmcnt(11)
    v_mfma_f32_32x32x16_bf16 v[112:127], v[148:151], v[172:175], v[112:127]
    s_barrier
    ds_read_b128 v[168:171], v13 offset:32768
    ds_read_b64_tr_b16 v[140:141], v14 offset:45056
    ds_read_b64_tr_b16 v[142:143], v14 offset:46080
    s_waitcnt lgkmcnt(11)
    v_mfma_f32_32x32x16_bf16 v[32:47], v[152:155], v[164:167], v[32:47]
    ds_read_b64_tr_b16 v[144:145], v15 offset:45056
    ds_read_b64_tr_b16 v[146:147], v15 offset:46080
    s_waitcnt lgkmcnt(11)
    v_mfma_f32_32x32x16_bf16 v[48:63], v[156:159], v[164:167], v[48:63]
    v_mfma_f32_32x32x16_bf16 v[96:111], v[164:167], v[164:167], v[96:111]
    ds_read_b64_tr_b16 v[148:149], v16 offset:45056
    ds_read_b64_tr_b16 v[150:151], v16 offset:46080
    s_waitcnt lgkmcnt(11)
    v_mfma_f32_32x32x16_bf16 v[64:79], v[128:131], v[164:167], v[64:79]
    ds_read_b64_tr_b16 v[152:153], v17 offset:45056
    ds_read_b64_tr_b16 v[154:155], v17 offset:46080
    s_waitcnt lgkmcnt(11)
    v_mfma_f32_32x32x16_bf16 v[80:95], v[132:135], v[164:167], v[80:95]
    ds_read_b64_tr_b16 v[156:157], v18 offset:45056
    ds_read_b64_tr_b16 v[158:159], v18 offset:46080
    s_waitcnt lgkmcnt(11)
    v_mfma_f32_32x32x16_bf16 v[112:127], v[136:139], v[172:175], v[112:127]
    v_xor_b32 v10, 0x10000, v10
    v_xor_b32 v11, 0x10000, v11
    v_xor_b32 v12, 0x10000, v12
    v_xor_b32 v13, 0x10000, v13
    v_xor_b32 v14, 0x10000, v14
    v_xor_b32 v15, 0x10000, v15
    v_xor_b32 v16, 0x10000, v16
    v_xor_b32 v17, 0x10000, v17
    v_xor_b32 v18, 0x10000, v18
    ds_read_b128 v[160:163], v10 offset:0
    ds_read_b64_tr_b16 v[128:129], v14 offset:0
    ds_read_b64_tr_b16 v[130:131], v14 offset:1024
    s_waitcnt lgkmcnt(11)
    v_mfma_f32_32x32x16_bf16 v[32:47], v[140:143], v[168:171], v[32:47]
    ds_read_b64_tr_b16 v[132:133], v15 offset:0
    ds_read_b64_tr_b16 v[134:135], v15 offset:1024
    s_waitcnt lgkmcnt(11)
    v_mfma_f32_32x32x16_bf16 v[48:63], v[144:147], v[168:171], v[48:63]
    v_mfma_f32_32x32x16_bf16 v[96:111], v[168:171], v[168:171], v[96:111]
    ds_read_b64_tr_b16 v[136:137], v16 offset:0
    ds_read_b64_tr_b16 v[138:139], v16 offset:1024
    s_waitcnt lgkmcnt(11)
    v_mfma_f32_32x32x16_bf16 v[64:79], v[148:151], v[168:171], v[64:79]
    ds_read_b64_tr_b16 v[140:141], v17 offset:0
    ds_read_b64_tr_b16 v[142:143], v17 offset:1024
    s_waitcnt lgkmcnt(11)
    v_mfma_f32_32x32x16_bf16 v[80:95], v[152:155], v[168:171], v[80:95]
    ds_read_b64_tr_b16 v[144:145], v18 offset:0
    ds_read_b64_tr_b16 v[146:147], v18 offset:1024
    s_waitcnt lgkmcnt(11)
    v_mfma_f32_32x32x16_bf16 v[112:127], v[156:159], v[172:175], v[112:127]
    ds_read_b128 v[164:167], v11 offset:0
    ds_read_b64_tr_b16 v[148:149], v14 offset:4096
    ds_read_b64_tr_b16 v[150:151], v14 offset:5120
    s_waitcnt lgkmcnt(11)
    v_mfma_f32_32x32x16_bf16 v[32:47], v[128:131], v[160:163], v[32:47]
    ds_read_b64_tr_b16 v[152:153], v15 offset:4096
    ds_read_b64_tr_b16 v[154:155], v15 offset:5120
    s_waitcnt lgkmcnt(11)
    v_mfma_f32_32x32x16_bf16 v[48:63], v[132:135], v[160:163], v[48:63]
    v_mfma_f32_32x32x16_bf16 v[96:111], v[160:163], v[160:163], v[96:111]
    ds_read_b64_tr_b16 v[156:157], v16 offset:4096
    ds_read_b64_tr_b16 v[158:159], v16 offset:5120
    s_waitcnt lgkmcnt(11)
    v_mfma_f32_32x32x16_bf16 v[64:79], v[136:139], v[160:163], v[64:79]
    ds_read_b64_tr_b16 v[128:129], v17 offset:4096
    ds_read_b64_tr_b16 v[130:131], v17 offset:5120
    s_waitcnt lgkmcnt(11)
    v_mfma_f32_32x32x16_bf16 v[80:95], v[140:143], v[160:163], v[80:95]
    ds_read_b64_tr_b16 v[132:133], v18 offset:4096
    ds_read_b64_tr_b16 v[134:135], v18 offset:5120
    s_waitcnt lgkmcnt(11)
    v_mfma_f32_32x32x16_bf16 v[112:127], v[144:147], v[172:175], v[112:127]
    ds_read_b128 v[168:171], v12 offset:0
    ds_read_b64_tr_b16 v[136:137], v14 offset:8192
    ds_read_b64_tr_b16 v[138:139], v14 offset:9216
    s_waitcnt lgkmcnt(11)
    v_mfma_f32_32x32x16_bf16 v[32:47], v[148:151], v[164:167], v[32:47]
    ds_read_b64_tr_b16 v[140:141], v15 offset:8192
    ds_read_b64_tr_b16 v[142:143], v15 offset:9216
    s_waitcnt lgkmcnt(11)
    v_mfma_f32_32x32x16_bf16 v[48:63], v[152:155], v[164:167], v[48:63]
    v_mfma_f32_32x32x16_bf16 v[96:111], v[164:167], v[164:167], v[96:111]
    ds_read_b64_tr_b16 v[144:145], v16 offset:8192
    ds_read_b64_tr_b16 v[146:147], v16 offset:9216
    s_waitcnt lgkmcnt(11)
    v_mfma_f32_32x32x16_bf16 v[64:79], v[156:159], v[164:167], v[64:79]
    ds_read_b64_tr_b16 v[148:149], v17 offset:8192
    ds_read_b64_tr_b16 v[150:151], v17 offset:9216
    s_waitcnt lgkmcnt(11)
    v_mfma_f32_32x32x16_bf16 v[80:95], v[128:131], v[164:167], v[80:95]
    ds_read_b64_tr_b16 v[152:153], v18 offset:8192
    ds_read_b64_tr_b16 v[154:155], v18 offset:9216
    s_waitcnt lgkmcnt(11)
    v_mfma_f32_32x32x16_bf16 v[112:127], v[132:135], v[172:175], v[112:127]
    s_barrier
    ds_read_b128 v[160:163], v13 offset:0
    ds_read_b64_tr_b16 v[156:157], v14 offset:12288
    ds_read_b64_tr_b16 v[158:159], v14 offset:13312
    s_waitcnt lgkmcnt(11)
    v_mfma_f32_32x32x16_bf16 v[32:47], v[136:139], v[168:171], v[32:47]
    ds_read_b64_tr_b16 v[128:129], v15 offset:12288
    ds_read_b64_tr_b16 v[130:131], v15 offset:13312
    s_waitcnt lgkmcnt(11)
    v_mfma_f32_32x32x16_bf16 v[48:63], v[140:143], v[168:171], v[48:63]
    v_mfma_f32_32x32x16_bf16 v[96:111], v[168:171], v[168:171], v[96:111]
    ds_read_b64_tr_b16 v[132:133], v16 offset:12288
    ds_read_b64_tr_b16 v[134:135], v16 offset:13312
    s_waitcnt lgkmcnt(11)
    v_mfma_f32_32x32x16_bf16 v[64:79], v[144:147], v[168:171], v[64:79]
    ds_read_b64_tr_b16 v[136:137], v17 offset:12288
    ds_read_b64_tr_b16 v[138:139], v17 offset:13312
    s_waitcnt lgkmcnt(11)
    v_mfma_f32_32x32x16_bf16 v[80:95], v[148:151], v[168:171], v[80:95]
    ds_read_b64_tr_b16 v[140:141], v18 offset:12288
    ds_read_b64_tr_b16 v[142:143], v18 offset:13312
    s_waitcnt lgkmcnt(11)
    v_mfma_f32_32x32x16_bf16 v[112:127], v[152:155], v[172:175], v[112:127]
    ds_read_b128 v[164:167], v10 offset:32768
    ds_read_b64_tr_b16 v[144:145], v14 offset:32768
    ds_read_b64_tr_b16 v[146:147], v14 offset:33792
    s_waitcnt lgkmcnt(11)
    v_mfma_f32_32x32x16_bf16 v[32:47], v[156:159], v[160:163], v[32:47]
    ds_read_b64_tr_b16 v[148:149], v15 offset:32768
    ds_read_b64_tr_b16 v[150:151], v15 offset:33792
    s_waitcnt lgkmcnt(11)
    v_mfma_f32_32x32x16_bf16 v[48:63], v[128:131], v[160:163], v[48:63]
    v_mfma_f32_32x32x16_bf16 v[96:111], v[160:163], v[160:163], v[96:111]
    ds_read_b64_tr_b16 v[152:153], v16 offset:32768
    ds_read_b64_tr_b16 v[154:155], v16 offset:33792
    s_waitcnt lgkmcnt(11)
    v_mfma_f32_32x32x16_bf16 v[64:79], v[132:135], v[160:163], v[64:79]
    ds_read_b64_tr_b16 v[156:157], v17 offset:32768
    ds_read_b64_tr_b16 v[158:159], v17 offset:33792
    s_waitcnt lgkmcnt(11)
    v_mfma_f32_32x32x16_bf16 v[80:95], v[136:139], v[160:163], v[80:95]
    ds_read_b64_tr_b16 v[128:129], v18 offset:32768
    ds_read_b64_tr_b16 v[130:131], v18 offset:33792
    s_waitcnt lgkmcnt(11)
    v_mfma_f32_32x32x16_bf16 v[112:127], v[140:143], v[172:175], v[112:127]
    ds_read_b128 v[168:171], v11 offset:32768
    ds_read_b64_tr_b16 v[132:133], v14 offset:36864
    ds_read_b64_tr_b16 v[134:135], v14 offset:37888
    s_waitcnt lgkmcnt(11)
    v_mfma_f32_32x32x16_bf16 v[32:47], v[144:147], v[164:167], v[32:47]
    ds_read_b64_tr_b16 v[136:137], v15 offset:36864
    ds_read_b64_tr_b16 v[138:139], v15 offset:37888
    s_waitcnt lgkmcnt(11)
    v_mfma_f32_32x32x16_bf16 v[48:63], v[148:151], v[164:167], v[48:63]
    v_mfma_f32_32x32x16_bf16 v[96:111], v[164:167], v[164:167], v[96:111]
    ds_read_b64_tr_b16 v[140:141], v16 offset:36864
    ds_read_b64_tr_b16 v[142:143], v16 offset:37888
    s_waitcnt lgkmcnt(11)
    v_mfma_f32_32x32x16_bf16 v[64:79], v[152:155], v[164:167], v[64:79]
    ds_read_b64_tr_b16 v[144:145], v17 offset:36864
    ds_read_b64_tr_b16 v[146:147], v17 offset:37888
    s_waitcnt lgkmcnt(11)
    v_mfma_f32_32x32x16_bf16 v[80:95], v[156:159], v[164:167], v[80:95]
    ds_read_b64_tr_b16 v[148:149], v18 offset:36864
    ds_read_b64_tr_b16 v[150:151], v18 offset:37888
    s_waitcnt lgkmcnt(11)
    v_mfma_f32_32x32x16_bf16 v[112:127], v[128:131], v[172:175], v[112:127]
    ds_read_b128 v[160:163], v12 offset:32768
    ds_read_b64_tr_b16 v[152:153], v14 offset:40960
    ds_read_b64_tr_b16 v[154:155], v14 offset:41984
    s_waitcnt lgkmcnt(11)
    v_mfma_f32_32x32x16_bf16 v[32:47], v[132:135], v[168:171], v[32:47]
    ds_read_b64_tr_b16 v[156:157], v15 offset:40960
    ds_read_b64_tr_b16 v[158:159], v15 offset:41984
    s_waitcnt lgkmcnt(11)
    v_mfma_f32_32x32x16_bf16 v[48:63], v[136:139], v[168:171], v[48:63]
    v_mfma_f32_32x32x16_bf16 v[96:111], v[168:171], v[168:171], v[96:111]
    ds_read_b64_tr_b16 v[128:129], v16 offset:40960
    ds_read_b64_tr_b16 v[130:131], v16 offset:41984
    s_waitcnt lgkmcnt(11)
    v_mfma_f32_32x32x16_bf16 v[64:79], v[140:143], v[168:171], v[64:79]
    ds_read_b64_tr_b16 v[132:133], v17 offset:40960
    ds_read_b64_tr_b16 v[134:135], v17 offset:41984
    s_waitcnt lgkmcnt(11)
    v_mfma_f32_32x32x16_bf16 v[80:95], v[144:147], v[168:171], v[80:95]
    ds_read_b64_tr_b16 v[136:137], v18 offset:40960
    ds_read_b64_tr_b16 v[138:139], v18 offset:41984
    s_waitcnt lgkmcnt(11)
    v_mfma_f32_32x32x16_bf16 v[112:127], v[148:151], v[172:175], v[112:127]
    s_barrier
    ds_read_b128 v[164:167], v13 offset:32768
    ds_read_b64_tr_b16 v[140:141], v14 offset:45056
    ds_read_b64_tr_b16 v[142:143], v14 offset:46080
    s_waitcnt lgkmcnt(11)
    v_mfma_f32_32x32x16_bf16 v[32:47], v[152:155], v[160:163], v[32:47]
    ds_read_b64_tr_b16 v[144:145], v15 offset:45056
    ds_read_b64_tr_b16 v[146:147], v15 offset:46080
    s_waitcnt lgkmcnt(11)
    v_mfma_f32_32x32x16_bf16 v[48:63], v[156:159], v[160:163], v[48:63]
    v_mfma_f32_32x32x16_bf16 v[96:111], v[160:163], v[160:163], v[96:111]
    ds_read_b64_tr_b16 v[148:149], v16 offset:45056
    ds_read_b64_tr_b16 v[150:151], v16 offset:46080
    s_waitcnt lgkmcnt(11)
    v_mfma_f32_32x32x16_bf16 v[64:79], v[128:131], v[160:163], v[64:79]
    ds_read_b64_tr_b16 v[152:153], v17 offset:45056
    ds_read_b64_tr_b16 v[154:155], v17 offset:46080
    s_waitcnt lgkmcnt(11)
    v_mfma_f32_32x32x16_bf16 v[80:95], v[132:135], v[160:163], v[80:95]
    ds_read_b64_tr_b16 v[156:157], v18 offset:45056
    ds_read_b64_tr_b16 v[158:159], v18 offset:46080
    s_waitcnt lgkmcnt(11)
    v_mfma_f32_32x32x16_bf16 v[112:127], v[136:139], v[172:175], v[112:127]
    v_xor_b32 v10, 0x10000, v10
    v_xor_b32 v11, 0x10000, v11
    v_xor_b32 v12, 0x10000, v12
    v_xor_b32 v13, 0x10000, v13
    v_xor_b32 v14, 0x10000, v14
    v_xor_b32 v15, 0x10000, v15
    v_xor_b32 v16, 0x10000, v16
    v_xor_b32 v17, 0x10000, v17
    v_xor_b32 v18, 0x10000, v18
    ds_read_b128 v[168:171], v10 offset:0
    ds_read_b64_tr_b16 v[128:129], v14 offset:0
    ds_read_b64_tr_b16 v[130:131], v14 offset:1024
    s_waitcnt lgkmcnt(11)
    v_mfma_f32_32x32x16_bf16 v[32:47], v[140:143], v[164:167], v[32:47]
    ds_read_b64_tr_b16 v[132:133], v15 offset:0
    ds_read_b64_tr_b16 v[134:135], v15 offset:1024
    s_waitcnt lgkmcnt(11)
    v_mfma_f32_32x32x16_bf16 v[48:63], v[144:147], v[164:167], v[48:63]
    v_mfma_f32_32x32x16_bf16 v[96:111], v[164:167], v[164:167], v[96:111]
    ds_read_b64_tr_b16 v[136:137], v16 offset:0
    ds_read_b64_tr_b16 v[138:139], v16 offset:1024
    s_waitcnt lgkmcnt(11)
    v_mfma_f32_32x32x16_bf16 v[64:79], v[148:151], v[164:167], v[64:79]
    ds_read_b64_tr_b16 v[140:141], v17 offset:0
    ds_read_b64_tr_b16 v[142:143], v17 offset:1024
    s_waitcnt lgkmcnt(11)
    v_mfma_f32_32x32x16_bf16 v[80:95], v[152:155], v[164:167], v[80:95]
    ds_read_b64_tr_b16 v[144:145], v18 offset:0
    ds_read_b64_tr_b16 v[146:147], v18 offset:1024
    s_waitcnt lgkmcnt(11)
    v_mfma_f32_32x32x16_bf16 v[112:127], v[156:159], v[172:175], v[112:127]
    ds_read_b128 v[160:163], v11 offset:0
    ds_read_b64_tr_b16 v[148:149], v14 offset:4096
    ds_read_b64_tr_b16 v[150:151], v14 offset:5120
    s_waitcnt lgkmcnt(11)
    v_mfma_f32_32x32x16_bf16 v[32:47], v[128:131], v[168:171], v[32:47]
    ds_read_b64_tr_b16 v[152:153], v15 offset:4096
    ds_read_b64_tr_b16 v[154:155], v15 offset:5120
    s_waitcnt lgkmcnt(11)
    v_mfma_f32_32x32x16_bf16 v[48:63], v[132:135], v[168:171], v[48:63]
    v_mfma_f32_32x32x16_bf16 v[96:111], v[168:171], v[168:171], v[96:111]
    ds_read_b64_tr_b16 v[156:157], v16 offset:4096
    ds_read_b64_tr_b16 v[158:159], v16 offset:5120
    s_waitcnt lgkmcnt(11)
    v_mfma_f32_32x32x16_bf16 v[64:79], v[136:139], v[168:171], v[64:79]
    ds_read_b64_tr_b16 v[128:129], v17 offset:4096
    ds_read_b64_tr_b16 v[130:131], v17 offset:5120
    s_waitcnt lgkmcnt(11)
    v_mfma_f32_32x32x16_bf16 v[80:95], v[140:143], v[168:171], v[80:95]
    ds_read_b64_tr_b16 v[132:133], v18 offset:4096
    ds_read_b64_tr_b16 v[134:135], v18 offset:5120
    s_waitcnt lgkmcnt(11)
    v_mfma_f32_32x32x16_bf16 v[112:127], v[144:147], v[172:175], v[112:127]
    ds_read_b128 v[164:167], v12 offset:0
    ds_read_b64_tr_b16 v[136:137], v14 offset:8192
    ds_read_b64_tr_b16 v[138:139], v14 offset:9216
    s_waitcnt lgkmcnt(11)
    v_mfma_f32_32x32x16_bf16 v[32:47], v[148:151], v[160:163], v[32:47]
    ds_read_b64_tr_b16 v[140:141], v15 offset:8192
    ds_read_b64_tr_b16 v[142:143], v15 offset:9216
    s_waitcnt lgkmcnt(11)
    v_mfma_f32_32x32x16_bf16 v[48:63], v[152:155], v[160:163], v[48:63]
    v_mfma_f32_32x32x16_bf16 v[96:111], v[160:163], v[160:163], v[96:111]
    ds_read_b64_tr_b16 v[144:145], v16 offset:8192
    ds_read_b64_tr_b16 v[146:147], v16 offset:9216
    s_waitcnt lgkmcnt(11)
    v_mfma_f32_32x32x16_bf16 v[64:79], v[156:159], v[160:163], v[64:79]
    ds_read_b64_tr_b16 v[148:149], v17 offset:8192
    ds_read_b64_tr_b16 v[150:151], v17 offset:9216
    s_waitcnt lgkmcnt(11)
    v_mfma_f32_32x32x16_bf16 v[80:95], v[128:131], v[160:163], v[80:95]
    ds_read_b64_tr_b16 v[152:153], v18 offset:8192
    ds_read_b64_tr_b16 v[154:155], v18 offset:9216
    s_waitcnt lgkmcnt(11)
    v_mfma_f32_32x32x16_bf16 v[112:127], v[132:135], v[172:175], v[112:127]
    ds_read_b128 v[168:171], v13 offset:0
    ds_read_b64_tr_b16 v[156:157], v14 offset:12288
    ds_read_b64_tr_b16 v[158:159], v14 offset:13312
    s_waitcnt lgkmcnt(11)
    v_mfma_f32_32x32x16_bf16 v[32:47], v[136:139], v[164:167], v[32:47]
    ds_read_b64_tr_b16 v[128:129], v15 offset:12288
    ds_read_b64_tr_b16 v[130:131], v15 offset:13312
    s_waitcnt lgkmcnt(11)
    v_mfma_f32_32x32x16_bf16 v[48:63], v[140:143], v[164:167], v[48:63]
    v_mfma_f32_32x32x16_bf16 v[96:111], v[164:167], v[164:167], v[96:111]
    ds_read_b64_tr_b16 v[132:133], v16 offset:12288
    ds_read_b64_tr_b16 v[134:135], v16 offset:13312
    s_waitcnt lgkmcnt(11)
    v_mfma_f32_32x32x16_bf16 v[64:79], v[144:147], v[164:167], v[64:79]
    ds_read_b64_tr_b16 v[136:137], v17 offset:12288
    ds_read_b64_tr_b16 v[138:139], v17 offset:13312
    s_waitcnt lgkmcnt(11)
    v_mfma_f32_32x32x16_bf16 v[80:95], v[148:151], v[164:167], v[80:95]
    ds_read_b64_tr_b16 v[140:141], v18 offset:12288
    ds_read_b64_tr_b16 v[142:143], v18 offset:13312
    s_waitcnt lgkmcnt(11)
    v_mfma_f32_32x32x16_bf16 v[112:127], v[152:155], v[172:175], v[112:127]
    s_waitcnt lgkmcnt(8)
    v_mfma_f32_32x32x16_bf16 v[32:47], v[156:159], v[168:171], v[32:47]
    s_waitcnt lgkmcnt(6)
    v_mfma_f32_32x32x16_bf16 v[48:63], v[128:131], v[168:171], v[48:63]
    v_mfma_f32_32x32x16_bf16 v[96:111], v[168:171], v[168:171], v[96:111]
    s_waitcnt lgkmcnt(4)
    v_mfma_f32_32x32x16_bf16 v[64:79], v[132:135], v[168:171], v[64:79]
    s_waitcnt lgkmcnt(2)
    v_mfma_f32_32x32x16_bf16 v[80:95], v[136:139], v[168:171], v[80:95]
    s_waitcnt lgkmcnt(0)
    v_mfma_f32_32x32x16_bf16 v[112:127], v[140:143], v[172:175], v[112:127]
    s_nop 5
    v_cndmask_b32 v96, v96, v97, s[60:61]
    v_cndmask_b32 v97, v98, v99, s[60:61]
    v_cndmask_b32 v98, v100, v101, s[60:61]
    v_cndmask_b32 v99, v102, v103, s[60:61]
    v_cndmask_b32 v100, v104, v105, s[60:61]
    v_cndmask_b32 v101, v106, v107, s[60:61]
    v_cndmask_b32 v102, v108, v109, s[60:61]
    v_cndmask_b32 v103, v110, v111, s[60:61]
    v_cndmask_b32 v96, v96, v97, s[62:63]
    v_cndmask_b32 v97, v98, v99, s[62:63]
    v_cndmask_b32 v98, v100, v101, s[62:63]
    v_cndmask_b32 v99, v102, v103, s[62:63]
    v_cndmask_b32 v96, v96, v97, s[64:65]
    v_cndmask_b32 v97, v98, v99, s[64:65]
    v_cndmask_b32 v96, v96, v97, s[66:67]
    v_cndmask_b32 v96, 0, v96, s[68:69]
    s_mov_b64 exec, s[72:73]
    ds_write_b128 v254, v[112:115] offset:0
    ds_write_b128 v254, v[116:119] offset:16
    ds_write_b128 v254, v[120:123] offset:32
    ds_write_b128 v254, v[124:127] offset:48
    s_mov_b64 exec, -1
    v_mov_b32 v97, v96
    s_nop 1
    v_permlane32_swap_b32 v96, v97
    v_add_f32 v96, v96, v97
    v_mul_f32 v246, -0.001736111111111111, v92
    v_mul_f32 v96, 0.001736111111111111, v96
    v_fma_f32 v96, -v246, v246, v96
    v_max_f32 v96, 0, v96
    v_add_f32 v96, 0x3727c5ac, v96
    v_rsq_f32 v248, v96
    v_mov_b32 v247, v246
    v_mov_b32 v249, v248
    s_waitcnt lgkmcnt(0)
    s_barrier
    ds_read_b128 v[128:131], v253 offset:128
    ds_read_b128 v[132:135], v253 offset:144
    ds_read_b128 v[136:139], v253 offset:160
    ds_read_b128 v[140:143], v253 offset:176
    ds_read_b128 v[144:147], v253 offset:400
    s_waitcnt lgkmcnt(4)
    v_pk_fma_f32 v[48:49], v[128:129], v[246:247], v[48:49]
    v_pk_fma_f32 v[50:51], v[130:131], v[246:247], v[50:51]
    v_pk_mul_f32 v[48:49], v[48:49], v[248:249]
    v_pk_mul_f32 v[50:51], v[50:51], v[248:249]
    v_cvt_pk_bf16_f32 v202, v48, v49
    v_cvt_pk_bf16_f32 v203, v50, v51
    s_waitcnt lgkmcnt(3)
    v_pk_fma_f32 v[52:53], v[132:133], v[246:247], v[52:53]
    v_pk_fma_f32 v[54:55], v[134:135], v[246:247], v[54:55]
    v_pk_mul_f32 v[52:53], v[52:53], v[248:249]
    v_pk_mul_f32 v[54:55], v[54:55], v[248:249]
    v_cvt_pk_bf16_f32 v204, v52, v53
    v_cvt_pk_bf16_f32 v205, v54, v55
    s_waitcnt lgkmcnt(2)
    v_pk_fma_f32 v[56:57], v[136:137], v[246:247], v[56:57]
    v_pk_fma_f32 v[58:59], v[138:139], v[246:247], v[58:59]
    v_pk_mul_f32 v[56:57], v[56:57], v[248:249]
    v_pk_mul_f32 v[58:59], v[58:59], v[248:249]
    v_cvt_pk_bf16_f32 v206, v56, v57
    v_cvt_pk_bf16_f32 v207, v58, v59
    s_waitcnt lgkmcnt(1)
    v_pk_fma_f32 v[60:61], v[140:141], v[246:247], v[60:61]
    v_pk_fma_f32 v[62:63], v[142:143], v[246:247], v[62:63]
    v_pk_mul_f32 v[60:61], v[60:61], v[248:249]
    v_pk_mul_f32 v[62:63], v[62:63], v[248:249]
    v_cvt_pk_bf16_f32 v208, v60, v61
    v_cvt_pk_bf16_f32 v209, v62, v63
    s_waitcnt lgkmcnt(0)
    v_pk_fma_f32 v[84:85], v[144:145], v[246:247], v[84:85]
    v_pk_fma_f32 v[86:87], v[146:147], v[246:247], v[86:87]
    v_pk_mul_f32 v[84:85], v[84:85], v[248:249]
    v_pk_mul_f32 v[86:87], v[86:87], v[248:249]
    v_cvt_pk_bf16_f32 v210, v84, v85
    v_cvt_pk_bf16_f32 v211, v86, v87
    v_mfma_f32_32x32x16_bf16 v[176:191], v[212:215], v[202:205], 0
    v_mfma_f32_32x32x16_bf16 v[96:111], v[222:225], v[202:205], 0
    v_mfma_f32_32x32x16_bf16 v[176:191], v[216:219], v[206:209], v[176:191]
    v_mfma_f32_32x32x16_bf16 v[96:111], v[226:229], v[206:209], v[96:111]
    ds_read_b128 v[148:151], v253 offset:256
    ds_read_b128 v[152:155], v253 offset:272
    ds_read_b128 v[156:159], v253 offset:288
    ds_read_b128 v[160:163], v253 offset:304
    ds_read_b128 v[164:167], v253 offset:416
    s_waitcnt lgkmcnt(4)
    v_pk_fma_f32 v[64:65], v[148:149], v[246:247], v[64:65]
    v_pk_fma_f32 v[66:67], v[150:151], v[246:247], v[66:67]
    v_pk_mul_f32 v[64:65], v[64:65], v[248:249]
    v_pk_mul_f32 v[66:67], v[66:67], v[248:249]
    v_cvt_pk_bf16_f32 v234, v64, v65
    v_cvt_pk_bf16_f32 v235, v66, v67
    s_waitcnt lgkmcnt(3)
    v_pk_fma_f32 v[68:69], v[152:153], v[246:247], v[68:69]
    v_pk_fma_f32 v[70:71], v[154:155], v[246:247], v[70:71]
    v_pk_mul_f32 v[68:69], v[68:69], v[248:249]
    v_pk_mul_f32 v[70:71], v[70:71], v[248:249]
    v_cvt_pk_bf16_f32 v236, v68, v69
    v_cvt_pk_bf16_f32 v237, v70, v71
    s_waitcnt lgkmcnt(2)
    v_pk_fma_f32 v[72:73], v[156:157], v[246:247], v[72:73]
    v_pk_fma_f32 v[74:75], v[158:159], v[246:247], v[74:75]
    v_pk_mul_f32 v[72:73], v[72:73], v[248:249]
    v_pk_mul_f32 v[74:75], v[74:75], v[248:249]
    v_cvt_pk_bf16_f32 v238, v72, v73
    v_cvt_pk_bf16_f32 v239, v74, v75
    s_waitcnt lgkmcnt(1)
    v_pk_fma_f32 v[76:77], v[160:161], v[246:247], v[76:77]
    v_pk_fma_f32 v[78:79], v[162:163], v[246:247], v[78:79]
    v_pk_mul_f32 v[76:77], v[76:77], v[248:249]
    v_pk_mul_f32 v[78:79], v[78:79], v[248:249]
    v_cvt_pk_bf16_f32 v240, v76, v77
    v_cvt_pk_bf16_f32 v241, v78, v79
    s_waitcnt lgkmcnt(0)
    v_pk_fma_f32 v[88:89], v[164:165], v[246:247], v[88:89]
    v_pk_fma_f32 v[90:91], v[166:167], v[246:247], v[90:91]
    v_pk_mul_f32 v[88:89], v[88:89], v[248:249]
    v_pk_mul_f32 v[90:91], v[90:91], v[248:249]
    v_cvt_pk_bf16_f32 v242, v88, v89
    v_cvt_pk_bf16_f32 v243, v90, v91
    v_mfma_f32_32x32x8_bf16 v[176:191], v[220:221], v[210:211], v[176:191]
    v_mfma_f32_32x32x8_bf16 v[96:111], v[230:231], v[210:211], v[96:111]
    v_cndmask_b32 v130, v234, v235, s[70:71]
    v_cndmask_b32 v131, v235, v236, s[70:71]
    v_cndmask_b32 v132, v236, v237, s[70:71]
    v_cndmask_b32 v133, v237, v238, s[70:71]
    v_cndmask_b32 v134, v238, v239, s[70:71]
    v_cndmask_b32 v135, v239, v240, s[70:71]
    v_cndmask_b32 v136, v240, v241, s[70:71]
    v_cndmask_b32 v137, v241, v242, s[70:71]
    v_cndmask_b32 v138, v242, v243, s[70:71]
    v_mov_b32 v139, 0x3f80
    s_nop 0
    v_max3_f32 v158, v176, v177, v178
    v_min3_f32 v160, v176, v177, v178
    v_mov_b32 v162, s76
    v_mov_b32 v163, s76
    v_mov_b32 v164, s77
    v_mov_b32 v165, s77
    v_max3_f32 v158, v158, v179, v180
    v_min3_f32 v160, v160, v179, v180
    v_max3_f32 v158, v158, v181, v182
    v_min3_f32 v160, v160, v181, v182
    v_max3_f32 v158, v158, v183, v184
    v_min3_f32 v160, v160, v183, v184
    v_max3_f32 v158, v158, v185, v186
    v_min3_f32 v160, v160, v185, v186
    v_max3_f32 v158, v158, v187, v188
    v_min3_f32 v160, v160, v187, v188
    v_max3_f32 v158, v158, v189, v190
    v_min3_f32 v160, v160, v189, v190
    v_max3_f32 v158, v158, v191, v96
    v_min3_f32 v160, v160, v191, v96
    v_max_f32 v158, v158, v97
    v_min_f32 v160, v160, v97
    v_mul_f32 v158, s77, v158
    v_mul_f32 v160, s76, v160
    v_mov_b32 v159, v158
    v_mov_b32 v161, v160
    v_pk_fma_f32 v[48:49], v[176:177], v[162:163], v[158:159]
    v_pk_fma_f32 v[140:141], v[176:177], v[164:165], v[160:161]
    v_pk_fma_f32 v[50:51], v[178:179], v[162:163], v[158:159]
    v_pk_fma_f32 v[142:143], v[178:179], v[164:165], v[160:161]
    v_pk_fma_f32 v[52:53], v[180:181], v[162:163], v[158:159]
    v_pk_fma_f32 v[144:145], v[180:181], v[164:165], v[160:161]
    v_pk_fma_f32 v[54:55], v[182:183], v[162:163], v[158:159]
    v_pk_fma_f32 v[146:147], v[182:183], v[164:165], v[160:161]
    v_pk_fma_f32 v[56:57], v[184:185], v[162:163], v[158:159]
    v_pk_fma_f32 v[148:149], v[184:185], v[164:165], v[160:161]
    v_pk_fma_f32 v[58:59], v[186:187], v[162:163], v[158:159]
    v_pk_fma_f32 v[150:151], v[186:187], v[164:165], v[160:161]
    v_pk_fma_f32 v[60:61], v[188:189], v[162:163], v[158:159]
    v_pk_fma_f32 v[152:153], v[188:189], v[164:165], v[160:161]
    v_pk_fma_f32 v[62:63], v[190:191], v[162:163], v[158:159]
    v_pk_fma_f32 v[154:155], v[190:191], v[164:165], v[160:161]
    v_pk_fma_f32 v[64:65], v[96:97], v[162:163], v[158:159]
    v_pk_fma_f32 v[156:157], v[96:97], v[164:165], v[160:161]
    v_exp_f32 v48, v48
    v_exp_f32 v140, v140
    v_exp_f32 v49, v49
    v_exp_f32 v141, v141
    v_exp_f32 v50, v50
    v_exp_f32 v142, v142
    v_exp_f32 v51, v51
    v_exp_f32 v143, v143
    v_exp_f32 v52, v52
    v_exp_f32 v144, v144
    v_exp_f32 v53, v53
    v_exp_f32 v145, v145
    v_exp_f32 v54, v54
    v_exp_f32 v146, v146
    v_exp_f32 v55, v55
    v_exp_f32 v147, v147
    v_exp_f32 v56, v56
    v_exp_f32 v148, v148
    v_exp_f32 v57, v57
    v_exp_f32 v149, v149
    v_exp_f32 v58, v58
    v_exp_f32 v150, v150
    v_exp_f32 v59, v59
    v_exp_f32 v151, v151
    v_exp_f32 v60, v60
    v_exp_f32 v152, v152
    v_exp_f32 v61, v61
    v_exp_f32 v153, v153
    v_exp_f32 v62, v62
    v_exp_f32 v154, v154
    v_exp_f32 v63, v63
    v_exp_f32 v155, v155
    v_exp_f32 v64, v64
    v_exp_f32 v156, v156
    v_exp_f32 v65, v65
    v_exp_f32 v157, v157
    v_pk_add_f32 v[166:167], v[48:49], v[50:51]
    v_pk_add_f32 v[168:169], v[140:141], v[142:143]
    v_pk_add_f32 v[166:167], v[166:167], v[52:53]
    v_pk_add_f32 v[168:169], v[168:169], v[144:145]
    v_pk_add_f32 v[166:167], v[166:167], v[54:55]
    v_pk_add_f32 v[168:169], v[168:169], v[146:147]
    v_pk_add_f32 v[166:167], v[166:167], v[56:57]
    v_pk_add_f32 v[168:169], v[168:169], v[148:149]
    v_pk_add_f32 v[166:167], v[166:167], v[58:59]
    v_pk_add_f32 v[168:169], v[168:169], v[150:151]
    v_pk_add_f32 v[166:167], v[166:167], v[60:61]
    v_pk_add_f32 v[168:169], v[168:169], v[152:153]
    v_pk_add_f32 v[166:167], v[166:167], v[62:63]
    v_pk_add_f32 v[168:169], v[168:169], v[154:155]
    v_pk_add_f32 v[166:167], v[166:167], v[64:65]
    v_pk_add_f32 v[168:169], v[168:169], v[156:157]
    v_add_f32 v166, v166, v167
    v_add_f32 v168, v168, v169
    v_rcp_f32 v166, v166
    v_rcp_f32 v168, v168
    v_mov_b32 v167, v166
    v_mov_b32 v169, v168
    v_pk_mul_f32 v[48:49], v[48:49], v[166:167]
    v_pk_mul_f32 v[140:141], v[140:141], v[168:169]
    v_pk_mul_f32 v[50:51], v[50:51], v[166:167]
    v_pk_mul_f32 v[142:143], v[142:143], v[168:169]
    v_pk_mul_f32 v[52:53], v[52:53], v[166:167]
    v_pk_mul_f32 v[144:145], v[144:145], v[168:169]
    v_pk_mul_f32 v[54:55], v[54:55], v[166:167]
    v_pk_mul_f32 v[146:147], v[146:147], v[168:169]
    v_pk_mul_f32 v[56:57], v[56:57], v[166:167]
    v_pk_mul_f32 v[148:149], v[148:149], v[168:169]
    v_pk_mul_f32 v[58:59], v[58:59], v[166:167]
    v_pk_mul_f32 v[150:151], v[150:151], v[168:169]
    v_pk_mul_f32 v[60:61], v[60:61], v[166:167]
    v_pk_mul_f32 v[152:153], v[152:153], v[168:169]
    v_pk_mul_f32 v[62:63], v[62:63], v[166:167]
    v_pk_mul_f32 v[154:155], v[154:155], v[168:169]
    v_pk_mul_f32 v[64:65], v[64:65], v[166:167]
    v_pk_mul_f32 v[156:157], v[156:157], v[168:169]
    v_cvt_pk_bf16_f32 v112, v48, v49
    v_cvt_pk_bf16_f32 v121, v140, v141
    v_cvt_pk_bf16_f32 v113, v50, v51
    v_cvt_pk_bf16_f32 v122, v142, v143
    v_cvt_pk_bf16_f32 v114, v52, v53
    v_cvt_pk_bf16_f32 v123, v144, v145
    v_cvt_pk_bf16_f32 v115, v54, v55
    v_cvt_pk_bf16_f32 v124, v146, v147
    v_cvt_pk_bf16_f32 v116, v56, v57
    v_cvt_pk_bf16_f32 v125, v148, v149
    v_cvt_pk_bf16_f32 v117, v58, v59
    v_cvt_pk_bf16_f32 v126, v150, v151
    v_cvt_pk_bf16_f32 v118, v60, v61
    v_cvt_pk_bf16_f32 v127, v152, v153
    v_cvt_pk_bf16_f32 v119, v62, v63
    v_cvt_pk_bf16_f32 v128, v154, v155
    v_cvt_pk_bf16_f32 v120, v64, v65
    v_cvt_pk_bf16_f32 v129, v156, v157
    ds_write_b128 v2, v[112:115] offset:0
    ds_write_b128 v2, v[116:119] offset:16
    ds_write_b128 v2, v[120:123] offset:32
    ds_write_b128 v2, v[124:127] offset:48
    ds_write_b128 v2, v[128:131] offset:64
    ds_write_b128 v2, v[132:135] offset:80
    ds_write_b128 v2, v[136:139] offset:96
    v_mov_b32 v197, 137968
    ds_read_b32 v196, v197
    s_waitcnt lgkmcnt(0)
    s_barrier
    ds_read_b64_tr_b16 v[128:129], v4 offset:0
    ds_read_b64_tr_b16 v[130:131], v4 offset:1792
    ds_read_b64_tr_b16 v[132:133], v3 offset:0
    ds_read_b64_tr_b16 v[134:135], v3 offset:1792
    ds_read_b64_tr_b16 v[136:137], v3 offset:32
    ds_read_b64_tr_b16 v[138:139], v3 offset:1824
    ds_read_b64_tr_b16 v[140:141], v3 offset:64
    ds_read_b64_tr_b16 v[142:143], v3 offset:1856
    ds_read_b64_tr_b16 v[144:145], v4 offset:3584
    ds_read_b64_tr_b16 v[146:147], v4 offset:5376
    ds_read_b64_tr_b16 v[148:149], v3 offset:3584
    ds_read_b64_tr_b16 v[150:151], v3 offset:5376
    ds_read_b64_tr_b16 v[152:153], v3 offset:3616
    ds_read_b64_tr_b16 v[154:155], v3 offset:5408
    ds_read_b64_tr_b16 v[156:157], v3 offset:3648
    ds_read_b64_tr_b16 v[158:159], v3 offset:5440
    s_waitcnt lgkmcnt(8)
    v_mfma_f32_16x16x32_bf16 v[200:203], v[132:135], v[128:131], 0
    v_mfma_f32_16x16x32_bf16 v[204:207], v[136:139], v[128:131], 0
    v_mfma_f32_16x16x32_bf16 v[208:211], v[140:143], v[128:131], 0
    ds_read_b64_tr_b16 v[160:161], v4 offset:7168
    ds_read_b64_tr_b16 v[162:163], v4 offset:8960
    ds_read_b64_tr_b16 v[164:165], v3 offset:7168
    ds_read_b64_tr_b16 v[166:167], v3 offset:8960
    ds_read_b64_tr_b16 v[168:169], v3 offset:7200
    ds_read_b64_tr_b16 v[170:171], v3 offset:8992
    ds_read_b64_tr_b16 v[172:173], v3 offset:7232
    ds_read_b64_tr_b16 v[174:175], v3 offset:9024
    s_waitcnt lgkmcnt(8)
    v_mfma_f32_16x16x32_bf16 v[200:203], v[148:151], v[144:147], v[200:203]
    v_mfma_f32_16x16x32_bf16 v[204:207], v[152:155], v[144:147], v[204:207]
    v_mfma_f32_16x16x32_bf16 v[208:211], v[156:159], v[144:147], v[208:211]
    ds_read_b64_tr_b16 v[176:177], v4 offset:10752
    ds_read_b64_tr_b16 v[178:179], v4 offset:12544
    ds_read_b64_tr_b16 v[180:181], v3 offset:10752
    ds_read_b64_tr_b16 v[182:183], v3 offset:12544
    ds_read_b64_tr_b16 v[184:185], v3 offset:10784
    ds_read_b64_tr_b16 v[186:187], v3 offset:12576
    ds_read_b64_tr_b16 v[188:189], v3 offset:10816
    ds_read_b64_tr_b16 v[190:191], v3 offset:12608
    s_waitcnt lgkmcnt(8)
    v_mfma_f32_16x16x32_bf16 v[200:203], v[164:167], v[160:163], v[200:203]
    v_mfma_f32_16x16x32_bf16 v[204:207], v[168:171], v[160:163], v[204:207]
    v_mfma_f32_16x16x32_bf16 v[208:211], v[172:175], v[160:163], v[208:211]
    s_waitcnt lgkmcnt(0)
    v_mfma_f32_16x16x32_bf16 v[200:203], v[180:183], v[176:179], v[200:203]
    v_mfma_f32_16x16x32_bf16 v[204:207], v[184:187], v[176:179], v[204:207]
    v_mfma_f32_16x16x32_bf16 v[208:211], v[188:191], v[176:179], v[208:211]
    s_nop 5
    v_cvt_pk_bf16_f32 v200, v200, v201
    v_cvt_pk_bf16_f32 v201, v202, v203
    ds_write_b32 v20, v200
    ds_write_b32 v21, v201
    v_cvt_pk_bf16_f32 v204, v204, v205
    v_cvt_pk_bf16_f32 v205, v206, v207
    ds_write_b32 v22, v204
    ds_write_b32 v23, v205
    v_cvt_pk_bf16_f32 v208, v208, v209
    v_cvt_pk_bf16_f32 v209, v210, v211
    ds_write_b32 v24, v208
    ds_write_b32 v25, v209
    s_waitcnt lgkmcnt(0)
    s_barrier
    ds_read_b128 v[192:195], v8
    s_waitcnt lgkmcnt(0)
    v_mov_b32 v195, v196
    buffer_store_dwordx4 v[192:195], v255, s[28:31], s48 offen sc1
    ds_read_b128 v[128:131], v253 offset:0
    ds_read_b128 v[132:135], v253 offset:16
    ds_read_b128 v[136:139], v253 offset:32
    ds_read_b128 v[140:143], v253 offset:48
    ds_read_b128 v[144:147], v253 offset:384
    s_waitcnt lgkmcnt(4)
    v_pk_fma_f32 v[32:33], v[128:129], v[246:247], v[32:33]
    v_pk_fma_f32 v[34:35], v[130:131], v[246:247], v[34:35]
    v_pk_mul_f32 v[32:33], v[32:33], v[248:249]
    v_pk_mul_f32 v[34:35], v[34:35], v[248:249]
    v_cvt_pk_bf16_f32 v168, v32, v33
    v_cvt_pk_bf16_f32 v169, v34, v35
    s_waitcnt lgkmcnt(3)
    v_pk_fma_f32 v[36:37], v[132:133], v[246:247], v[36:37]
    v_pk_fma_f32 v[38:39], v[134:135], v[246:247], v[38:39]
    v_pk_mul_f32 v[36:37], v[36:37], v[248:249]
    v_pk_mul_f32 v[38:39], v[38:39], v[248:249]
    v_cvt_pk_bf16_f32 v170, v36, v37
    v_cvt_pk_bf16_f32 v171, v38, v39
    s_waitcnt lgkmcnt(2)
    v_pk_fma_f32 v[40:41], v[136:137], v[246:247], v[40:41]
    v_pk_fma_f32 v[42:43], v[138:139], v[246:247], v[42:43]
    v_pk_mul_f32 v[40:41], v[40:41], v[248:249]
    v_pk_mul_f32 v[42:43], v[42:43], v[248:249]
    v_cvt_pk_bf16_f32 v172, v40, v41
    v_cvt_pk_bf16_f32 v173, v42, v43
    s_waitcnt lgkmcnt(1)
    v_pk_fma_f32 v[44:45], v[140:141], v[246:247], v[44:45]
    v_pk_fma_f32 v[46:47], v[142:143], v[246:247], v[46:47]
    v_pk_mul_f32 v[44:45], v[44:45], v[248:249]
    v_pk_mul_f32 v[46:47], v[46:47], v[248:249]
    v_cvt_pk_bf16_f32 v174, v44, v45
    v_cvt_pk_bf16_f32 v175, v46, v47
    s_waitcnt lgkmcnt(0)
    v_pk_fma_f32 v[80:81], v[144:145], v[246:247], v[80:81]
    v_pk_fma_f32 v[82:83], v[146:147], v[246:247], v[82:83]
    v_pk_mul_f32 v[80:81], v[80:81], v[248:249]
    v_pk_mul_f32 v[82:83], v[82:83], v[248:249]
    v_cvt_pk_bf16_f32 v176, v80, v81
    v_cvt_pk_bf16_f32 v177, v82, v83
    v_mfma_f32_32x32x16_bf16 v[48:63], v[212:215], v[168:171], 0
    v_mfma_f32_32x32x16_bf16 v[64:79], v[222:225], v[168:171], 0
    v_mfma_f32_32x32x16_bf16 v[48:63], v[216:219], v[172:175], v[48:63]
    v_mfma_f32_32x32x16_bf16 v[64:79], v[226:229], v[172:175], v[64:79]
    s_nop 8
    v_mfma_f32_32x32x8_bf16 v[48:63], v[220:221], v[176:177], v[48:63]
    v_mfma_f32_32x32x8_bf16 v[64:79], v[230:231], v[176:177], v[64:79]
    s_nop 10
    v_max3_f32 v164, v48, v49, v50
    v_min3_f32 v166, v48, v49, v50
    v_mov_b32 v168, s76
    v_mov_b32 v169, s76
    v_mov_b32 v170, s77
    v_mov_b32 v171, s77
    v_max3_f32 v164, v164, v51, v52
    v_min3_f32 v166, v166, v51, v52
    v_max3_f32 v164, v164, v53, v54
    v_min3_f32 v166, v166, v53, v54
    v_max3_f32 v164, v164, v55, v56
    v_min3_f32 v166, v166, v55, v56
    v_max3_f32 v164, v164, v57, v58
    v_min3_f32 v166, v166, v57, v58
    v_max3_f32 v164, v164, v59, v60
    v_min3_f32 v166, v166, v59, v60
    v_max3_f32 v164, v164, v61, v62
    v_min3_f32 v166, v166, v61, v62
    v_max3_f32 v164, v164, v63, v64
    v_min3_f32 v166, v166, v63, v64
    v_max_f32 v164, v164, v65
    v_min_f32 v166, v166, v65
    v_mul_f32 v164, s77, v164
    v_mul_f32 v166, s76, v166
    v_mov_b32 v165, v164
    v_mov_b32 v167, v166
    v_pk_fma_f32 v[128:129], v[48:49], v[168:169], v[164:165]
    v_pk_fma_f32 v[146:147], v[48:49], v[170:171], v[166:167]
    v_pk_fma_f32 v[130:131], v[50:51], v[168:169], v[164:165]
    v_pk_fma_f32 v[148:149], v[50:51], v[170:171], v[166:167]
    v_pk_fma_f32 v[132:133], v[52:53], v[168:169], v[164:165]
    v_pk_fma_f32 v[150:151], v[52:53], v[170:171], v[166:167]
    v_pk_fma_f32 v[134:135], v[54:55], v[168:169], v[164:165]
    v_pk_fma_f32 v[152:153], v[54:55], v[170:171], v[166:167]
    v_pk_fma_f32 v[136:137], v[56:57], v[168:169], v[164:165]
    v_pk_fma_f32 v[154:155], v[56:57], v[170:171], v[166:167]
    v_pk_fma_f32 v[138:139], v[58:59], v[168:169], v[164:165]
    v_pk_fma_f32 v[156:157], v[58:59], v[170:171], v[166:167]
    v_pk_fma_f32 v[140:141], v[60:61], v[168:169], v[164:165]
    v_pk_fma_f32 v[158:159], v[60:61], v[170:171], v[166:167]
    v_pk_fma_f32 v[142:143], v[62:63], v[168:169], v[164:165]
    v_pk_fma_f32 v[160:161], v[62:63], v[170:171], v[166:167]
    v_pk_fma_f32 v[144:145], v[64:65], v[168:169], v[164:165]
    v_pk_fma_f32 v[162:163], v[64:65], v[170:171], v[166:167]
    v_exp_f32 v128, v128
    v_exp_f32 v146, v146
    v_exp_f32 v129, v129
    v_exp_f32 v147, v147
    v_exp_f32 v130, v130
    v_exp_f32 v148, v148
    v_exp_f32 v131, v131
    v_exp_f32 v149, v149
    v_exp_f32 v132, v132
    v_exp_f32 v150, v150
    v_exp_f32 v133, v133
    v_exp_f32 v151, v151
    v_exp_f32 v134, v134
    v_exp_f32 v152, v152
    v_exp_f32 v135, v135
    v_exp_f32 v153, v153
    v_exp_f32 v136, v136
    v_exp_f32 v154, v154
    v_exp_f32 v137, v137
    v_exp_f32 v155, v155
    v_exp_f32 v138, v138
    v_exp_f32 v156, v156
    v_exp_f32 v139, v139
    v_exp_f32 v157, v157
    v_exp_f32 v140, v140
    v_exp_f32 v158, v158
    v_exp_f32 v141, v141
    v_exp_f32 v159, v159
    v_exp_f32 v142, v142
    v_exp_f32 v160, v160
    v_exp_f32 v143, v143
    v_exp_f32 v161, v161
    v_exp_f32 v144, v144
    v_exp_f32 v162, v162
    v_exp_f32 v145, v145
    v_exp_f32 v163, v163
    v_pk_add_f32 v[172:173], v[128:129], v[130:131]
    v_pk_add_f32 v[174:175], v[146:147], v[148:149]
    v_pk_add_f32 v[172:173], v[172:173], v[132:133]
    v_pk_add_f32 v[174:175], v[174:175], v[150:151]
    v_pk_add_f32 v[172:173], v[172:173], v[134:135]
    v_pk_add_f32 v[174:175], v[174:175], v[152:153]
    v_pk_add_f32 v[172:173], v[172:173], v[136:137]
    v_pk_add_f32 v[174:175], v[174:175], v[154:155]
    v_pk_add_f32 v[172:173], v[172:173], v[138:139]
    v_pk_add_f32 v[174:175], v[174:175], v[156:157]
    v_pk_add_f32 v[172:173], v[172:173], v[140:141]
    v_pk_add_f32 v[174:175], v[174:175], v[158:159]
    v_pk_add_f32 v[172:173], v[172:173], v[142:143]
    v_pk_add_f32 v[174:175], v[174:175], v[160:161]
    v_pk_add_f32 v[172:173], v[172:173], v[144:145]
    v_pk_add_f32 v[174:175], v[174:175], v[162:163]
    v_add_f32 v172, v172, v173
    v_add_f32 v174, v174, v175
    v_rcp_f32 v172, v172
    v_rcp_f32 v174, v174
    v_mov_b32 v173, v172
    v_mov_b32 v175, v174
    v_pk_mul_f32 v[128:129], v[128:129], v[172:173]
    v_pk_mul_f32 v[146:147], v[146:147], v[174:175]
    v_pk_mul_f32 v[130:131], v[130:131], v[172:173]
    v_pk_mul_f32 v[148:149], v[148:149], v[174:175]
    v_pk_mul_f32 v[132:133], v[132:133], v[172:173]
    v_pk_mul_f32 v[150:151], v[150:151], v[174:175]
    v_pk_mul_f32 v[134:135], v[134:135], v[172:173]
    v_pk_mul_f32 v[152:153], v[152:153], v[174:175]
    v_pk_mul_f32 v[136:137], v[136:137], v[172:173]
    v_pk_mul_f32 v[154:155], v[154:155], v[174:175]
    v_pk_mul_f32 v[138:139], v[138:139], v[172:173]
    v_pk_mul_f32 v[156:157], v[156:157], v[174:175]
    v_pk_mul_f32 v[140:141], v[140:141], v[172:173]
    v_pk_mul_f32 v[158:159], v[158:159], v[174:175]
    v_pk_mul_f32 v[142:143], v[142:143], v[172:173]
    v_pk_mul_f32 v[160:161], v[160:161], v[174:175]
    v_pk_mul_f32 v[144:145], v[144:145], v[172:173]
    v_pk_mul_f32 v[162:163], v[162:163], v[174:175]
    v_cvt_pk_bf16_f32 v96, v128, v129
    v_cvt_pk_bf16_f32 v105, v146, v147
    v_cvt_pk_bf16_f32 v97, v130, v131
    v_cvt_pk_bf16_f32 v106, v148, v149
    v_cvt_pk_bf16_f32 v98, v132, v133
    v_cvt_pk_bf16_f32 v107, v150, v151
    v_cvt_pk_bf16_f32 v99, v134, v135
    v_cvt_pk_bf16_f32 v108, v152, v153
    v_cvt_pk_bf16_f32 v100, v136, v137
    v_cvt_pk_bf16_f32 v109, v154, v155
    v_cvt_pk_bf16_f32 v101, v138, v139
    v_cvt_pk_bf16_f32 v110, v156, v157
    v_cvt_pk_bf16_f32 v102, v140, v141
    v_cvt_pk_bf16_f32 v111, v158, v159
    v_cvt_pk_bf16_f32 v103, v142, v143
    v_cvt_pk_bf16_f32 v112, v160, v161
    v_cvt_pk_bf16_f32 v104, v144, v145
    v_cvt_pk_bf16_f32 v113, v162, v163
    v_mov_b32 v114, 0
    v_mov_b32 v115, 0
    s_mov_b32 s53, 0
    s_mov_b32 s54, 0xffff
L_sequential_preLN__linear_kernel_hedgehog__dense_activation_relu__prompt_kernel_kvpoll_1:
    s_bitcmp1_b32 s54, 0
    s_cbranch_scc0 L_sequential_preLN__linear_kernel_hedgehog__dense_activation_relu__prompt_kernel_sk_3
    s_add_u32 s44, s49, 0
    buffer_load_dwordx4 v[128:131], v255, s[28:31], s44 offen sc1
L_sequential_preLN__linear_kernel_hedgehog__dense_activation_relu__prompt_kernel_sk_3:
    s_bitcmp1_b32 s54, 1
    s_cbranch_scc0 L_sequential_preLN__linear_kernel_hedgehog__dense_activation_relu__prompt_kernel_sk_4
    s_add_u32 s44, s49, 3712
    buffer_load_dwordx4 v[132:135], v255, s[28:31], s44 offen sc1
L_sequential_preLN__linear_kernel_hedgehog__dense_activation_relu__prompt_kernel_sk_4:
    s_bitcmp1_b32 s54, 2
    s_cbranch_scc0 L_sequential_preLN__linear_kernel_hedgehog__dense_activation_relu__prompt_kernel_sk_5
    s_add_u32 s44, s49, 7424
    buffer_load_dwordx4 v[136:139], v255, s[28:31], s44 offen sc1
L_sequential_preLN__linear_kernel_hedgehog__dense_activation_relu__prompt_kernel_sk_5:
    s_bitcmp1_b32 s54, 3
    s_cbranch_scc0 L_sequential_preLN__linear_kernel_hedgehog__dense_activation_relu__prompt_kernel_sk_6
    s_add_u32 s44, s49, 11136
    buffer_load_dwordx4 v[140:143], v255, s[28:31], s44 offen sc1
L_sequential_preLN__linear_kernel_hedgehog__dense_activation_relu__prompt_kernel_sk_6:
    s_bitcmp1_b32 s54, 4
    s_cbranch_scc0 L_sequential_preLN__linear_kernel_hedgehog__dense_activation_relu__prompt_kernel_sk_7
    s_add_u32 s44, s49, 14848
    buffer_load_dwordx4 v[144:147], v255, s[28:31], s44 offen sc1
L_sequential_preLN__linear_kernel_hedgehog__dense_activation_relu__prompt_kernel_sk_7:
    s_bitcmp1_b32 s54, 5
    s_cbranch_scc0 L_sequential_preLN__linear_kernel_hedgehog__dense_activation_relu__prompt_kernel_sk_8
    s_add_u32 s44, s49, 18560
    buffer_load_dwordx4 v[148:151], v255, s[28:31], s44 offen sc1
L_sequential_preLN__linear_kernel_hedgehog__dense_activation_relu__prompt_kernel_sk_8:
    s_bitcmp1_b32 s54, 6
    s_cbranch_scc0 L_sequential_preLN__linear_kernel_hedgehog__dense_activation_relu__prompt_kernel_sk_9
    s_add_u32 s44, s49, 22272
    buffer_load_dwordx4 v[152:155], v255, s[28:31], s44 offen sc1
L_sequential_preLN__linear_kernel_hedgehog__dense_activation_relu__prompt_kernel_sk_9:
    s_bitcmp1_b32 s54, 7
    s_cbranch_scc0 L_sequential_preLN__linear_kernel_hedgehog__dense_activation_relu__prompt_kernel_sk_10
    s_add_u32 s44, s49, 25984
    buffer_load_dwordx4 v[156:159], v255, s[28:31], s44 offen sc1
L_sequential_preLN__linear_kernel_hedgehog__dense_activation_relu__prompt_kernel_sk_10:
    s_bitcmp1_b32 s54, 8
    s_cbranch_scc0 L_sequential_preLN__linear_kernel_hedgehog__dense_activation_relu__prompt_kernel_sk_11
    s_add_u32 s44, s49, 29696
    buffer_load_dwordx4 v[160:163], v255, s[28:31], s44 offen sc1
L_sequential_preLN__linear_kernel_hedgehog__dense_activation_relu__prompt_kernel_sk_11:
    s_bitcmp1_b32 s54, 9
    s_cbranch_scc0 L_sequential_preLN__linear_kernel_hedgehog__dense_activation_relu__prompt_kernel_sk_12
    s_add_u32 s44, s49, 33408
    buffer_load_dwordx4 v[164:167], v255, s[28:31], s44 offen sc1
L_sequential_preLN__linear_kernel_hedgehog__dense_activation_relu__prompt_kernel_sk_12:
    s_bitcmp1_b32 s54, 10
    s_cbranch_scc0 L_sequential_preLN__linear_kernel_hedgehog__dense_activation_relu__prompt_kernel_sk_13
    s_add_u32 s44, s49, 37120
    buffer_load_dwordx4 v[168:171], v255, s[28:31], s44 offen sc1
L_sequential_preLN__linear_kernel_hedgehog__dense_activation_relu__prompt_kernel_sk_13:
    s_bitcmp1_b32 s54, 11
    s_cbranch_scc0 L_sequential_preLN__linear_kernel_hedgehog__dense_activation_relu__prompt_kernel_sk_14
    s_add_u32 s44, s49, 40832
    buffer_load_dwordx4 v[172:175], v255, s[28:31], s44 offen sc1
L_sequential_preLN__linear_kernel_hedgehog__dense_activation_relu__prompt_kernel_sk_14:
    s_bitcmp1_b32 s54, 12
    s_cbranch_scc0 L_sequential_preLN__linear_kernel_hedgehog__dense_activation_relu__prompt_kernel_sk_15
    s_add_u32 s44, s49, 44544
    buffer_load_dwordx4 v[176:179], v255, s[28:31], s44 offen sc1
L_sequential_preLN__linear_kernel_hedgehog__dense_activation_relu__prompt_kernel_sk_15:
    s_bitcmp1_b32 s54, 13
    s_cbranch_scc0 L_sequential_preLN__linear_kernel_hedgehog__dense_activation_relu__prompt_kernel_sk_16
    s_add_u32 s44, s49, 48256
    buffer_load_dwordx4 v[180:183], v255, s[28:31], s44 offen sc1
L_sequential_preLN__linear_kernel_hedgehog__dense_activation_relu__prompt_kernel_sk_16:
    s_bitcmp1_b32 s54, 14
    s_cbranch_scc0 L_sequential_preLN__linear_kernel_hedgehog__dense_activation_relu__prompt_kernel_sk_17
    s_add_u32 s44, s49, 51968
    buffer_load_dwordx4 v[184:187], v255, s[28:31], s44 offen sc1
L_sequential_preLN__linear_kernel_hedgehog__dense_activation_relu__prompt_kernel_sk_17:
    s_bitcmp1_b32 s54, 15
    s_cbranch_scc0 L_sequential_preLN__linear_kernel_hedgehog__dense_activation_relu__prompt_kernel_sk_18
    s_add_u32 s44, s49, 55680
    buffer_load_dwordx4 v[188:191], v255, s[28:31], s44 offen sc1
L_sequential_preLN__linear_kernel_hedgehog__dense_activation_relu__prompt_kernel_sk_18:
    s_waitcnt vmcnt(0)
    s_mov_b32 s54, 0
    v_cmp_ne_u32 s[62:63], v131, v196
    v_cmp_ne_u32 s[64:65], v135, v196
    v_cmp_ne_u32 s[66:67], v139, v196
    v_cmp_ne_u32 s[68:69], v143, v196
    s_and_b64 s[62:63], s[62:63], s[74:75]
    s_cselect_b32 s44, 1, 0
    s_or_b32 s54, s54, s44
    s_and_b64 s[64:65], s[64:65], s[74:75]
    s_cselect_b32 s44, 2, 0
    s_or_b32 s54, s54, s44
    s_and_b64 s[66:67], s[66:67], s[74:75]
    s_cselect_b32 s44, 4, 0
    s_or_b32 s54, s54, s44
    s_and_b64 s[68:69], s[68:69], s[74:75]
    s_cselect_b32 s44, 8, 0
    s_or_b32 s54, s54, s44
    v_cmp_ne_u32 s[62:63], v147, v196
    v_cmp_ne_u32 s[64:65], v151, v196
    v_cmp_ne_u32 s[66:67], v155, v196
    v_cmp_ne_u32 s[68:69], v159, v196
    s_and_b64 s[62:63], s[62:63], s[74:75]
    s_cselect_b32 s44, 16, 0
    s_or_b32 s54, s54, s44
    s_and_b64 s[64:65], s[64:65], s[74:75]
    s_cselect_b32 s44, 32, 0
    s_or_b32 s54, s54, s44
    s_and_b64 s[66:67], s[66:67], s[74:75]
    s_cselect_b32 s44, 64, 0
    s_or_b32 s54, s54, s44
    s_and_b64 s[68:69], s[68:69], s[74:75]
    s_cselect_b32 s44, 128, 0
    s_or_b32 s54, s54, s44
    v_cmp_ne_u32 s[62:63], v163, v196
    v_cmp_ne_u32 s[64:65], v167, v196
    v_cmp_ne_u32 s[66:67], v171, v196
    v_cmp_ne_u32 s[68:69], v175, v196
    s_and_b64 s[62:63], s[62:63], s[74:75]
    s_cselect_b32 s44, 256, 0
    s_or_b32 s54, s54, s44
    s_and_b64 s[64:65], s[64:65], s[74:75]
    s_cselect_b32 s44, 512, 0
    s_or_b32 s54, s54, s44
    s_and_b64 s[66:67], s[66:67], s[74:75]
    s_cselect_b32 s44, 1024, 0
    s_or_b32 s54, s54, s44
    s_and_b64 s[68:69], s[68:69], s[74:75]
    s_cselect_b32 s44, 2048, 0
    s_or_b32 s54, s54, s44
    v_cmp_ne_u32 s[62:63], v179, v196
    v_cmp_ne_u32 s[64:65], v183, v196
    v_cmp_ne_u32 s[66:67], v187, v196
    v_cmp_ne_u32 s[68:69], v191, v196
    s_and_b64 s[62:63], s[62:63], s[74:75]
    s_cselect_b32 s44, 4096, 0
    s_or_b32 s54, s54, s44
    s_and_b64 s[64:65], s[64:65], s[74:75]
    s_cselect_b32 s44, 8192, 0
    s_or_b32 s54, s54, s44
    s_and_b64 s[66:67], s[66:67], s[74:75]
    s_cselect_b32 s44, 16384, 0
    s_or_b32 s54, s54, s44
    s_and_b64 s[68:69], s[68:69], s[74:75]
    s_cselect_b32 s44, 32768, 0
    s_or_b32 s54, s54, s44
    s_cmp_eq_u32 s54, 0
    s_cbranch_scc1 L_sequential_preLN__linear_kernel_hedgehog__dense_activation_relu__prompt_kernel_kvok_2
    s_add_u32 s53, s53, 1
    s_cmp_lt_u32 s53, 0x20000
    s_cbranch_scc1 L_sequential_preLN__linear_kernel_hedgehog__dense_activation_relu__prompt_kernel_kvpoll_1
L_sequential_preLN__linear_kernel_hedgehog__dense_activation_relu__prompt_kernel_kvok_2:
    v_lshlrev_b32 v116, 16, v128
    v_and_b32 v117, 0xffff0000, v128
    v_lshlrev_b32 v118, 16, v129
    v_and_b32 v119, 0xffff0000, v129
    v_lshlrev_b32 v120, 16, v130
    v_and_b32 v121, 0xffff0000, v130
    v_lshlrev_b32 v124, 16, v132
    v_and_b32 v125, 0xffff0000, v132
    v_pk_add_f32 v[116:117], v[116:117], v[124:125]
    v_lshlrev_b32 v126, 16, v133
    v_and_b32 v127, 0xffff0000, v133
    v_pk_add_f32 v[118:119], v[118:119], v[126:127]
    v_lshlrev_b32 v124, 16, v134
    v_and_b32 v125, 0xffff0000, v134
    v_pk_add_f32 v[120:121], v[120:121], v[124:125]
    v_lshlrev_b32 v124, 16, v136
    v_and_b32 v125, 0xffff0000, v136
    v_pk_add_f32 v[116:117], v[116:117], v[124:125]
    v_lshlrev_b32 v126, 16, v137
    v_and_b32 v127, 0xffff0000, v137
    v_pk_add_f32 v[118:119], v[118:119], v[126:127]
    v_lshlrev_b32 v124, 16, v138
    v_and_b32 v125, 0xffff0000, v138
    v_pk_add_f32 v[120:121], v[120:121], v[124:125]
    v_lshlrev_b32 v124, 16, v140
    v_and_b32 v125, 0xffff0000, v140
    v_pk_add_f32 v[116:117], v[116:117], v[124:125]
    v_lshlrev_b32 v126, 16, v141
    v_and_b32 v127, 0xffff0000, v141
    v_pk_add_f32 v[118:119], v[118:119], v[126:127]
    v_lshlrev_b32 v124, 16, v142
    v_and_b32 v125, 0xffff0000, v142
    v_pk_add_f32 v[120:121], v[120:121], v[124:125]
    v_lshlrev_b32 v124, 16, v144
    v_and_b32 v125, 0xffff0000, v144
    v_pk_add_f32 v[116:117], v[116:117], v[124:125]
    v_lshlrev_b32 v126, 16, v145
    v_and_b32 v127, 0xffff0000, v145
    v_pk_add_f32 v[118:119], v[118:119], v[126:127]
    v_lshlrev_b32 v124, 16, v146
    v_and_b32 v125, 0xffff0000, v146
    v_pk_add_f32 v[120:121], v[120:121], v[124:125]
    v_lshlrev_b32 v124, 16, v148
    v_and_b32 v125, 0xffff0000, v148
    v_pk_add_f32 v[116:117], v[116:117], v[124:125]
    v_lshlrev_b32 v126, 16, v149
    v_and_b32 v127, 0xffff0000, v149
    v_pk_add_f32 v[118:119], v[118:119], v[126:127]
    v_lshlrev_b32 v124, 16, v150
    v_and_b32 v125, 0xffff0000, v150
    v_pk_add_f32 v[120:121], v[120:121], v[124:125]
    v_lshlrev_b32 v124, 16, v152
    v_and_b32 v125, 0xffff0000, v152
    v_pk_add_f32 v[116:117], v[116:117], v[124:125]
    v_lshlrev_b32 v126, 16, v153
    v_and_b32 v127, 0xffff0000, v153
    v_pk_add_f32 v[118:119], v[118:119], v[126:127]
    v_lshlrev_b32 v124, 16, v154
    v_and_b32 v125, 0xffff0000, v154
    v_pk_add_f32 v[120:121], v[120:121], v[124:125]
    v_lshlrev_b32 v124, 16, v156
    v_and_b32 v125, 0xffff0000, v156
    v_pk_add_f32 v[116:117], v[116:117], v[124:125]
    v_lshlrev_b32 v126, 16, v157
    v_and_b32 v127, 0xffff0000, v157
    v_pk_add_f32 v[118:119], v[118:119], v[126:127]
    v_lshlrev_b32 v124, 16, v158
    v_and_b32 v125, 0xffff0000, v158
    v_pk_add_f32 v[120:121], v[120:121], v[124:125]
    v_lshlrev_b32 v124, 16, v160
    v_and_b32 v125, 0xffff0000, v160
    v_pk_add_f32 v[116:117], v[116:117], v[124:125]
    v_lshlrev_b32 v126, 16, v161
    v_and_b32 v127, 0xffff0000, v161
    v_pk_add_f32 v[118:119], v[118:119], v[126:127]
    v_lshlrev_b32 v124, 16, v162
    v_and_b32 v125, 0xffff0000, v162
    v_pk_add_f32 v[120:121], v[120:121], v[124:125]
    v_lshlrev_b32 v124, 16, v164
    v_and_b32 v125, 0xffff0000, v164
    v_pk_add_f32 v[116:117], v[116:117], v[124:125]
    v_lshlrev_b32 v126, 16, v165
    v_and_b32 v127, 0xffff0000, v165
    v_pk_add_f32 v[118:119], v[118:119], v[126:127]
    v_lshlrev_b32 v124, 16, v166
    v_and_b32 v125, 0xffff0000, v166
    v_pk_add_f32 v[120:121], v[120:121], v[124:125]
    v_lshlrev_b32 v124, 16, v168
    v_and_b32 v125, 0xffff0000, v168
    v_pk_add_f32 v[116:117], v[116:117], v[124:125]
    v_lshlrev_b32 v126, 16, v169
    v_and_b32 v127, 0xffff0000, v169
    v_pk_add_f32 v[118:119], v[118:119], v[126:127]
    v_lshlrev_b32 v124, 16, v170
    v_and_b32 v125, 0xffff0000, v170
    v_pk_add_f32 v[120:121], v[120:121], v[124:125]
    v_lshlrev_b32 v124, 16, v172
    v_and_b32 v125, 0xffff0000, v172
    v_pk_add_f32 v[116:117], v[116:117], v[124:125]
    v_lshlrev_b32 v126, 16, v173
    v_and_b32 v127, 0xffff0000, v173
    v_pk_add_f32 v[118:119], v[118:119], v[126:127]
    v_lshlrev_b32 v124, 16, v174
    v_and_b32 v125, 0xffff0000, v174
    v_pk_add_f32 v[120:121], v[120:121], v[124:125]
    v_lshlrev_b32 v124, 16, v176
    v_and_b32 v125, 0xffff0000, v176
    v_pk_add_f32 v[116:117], v[116:117], v[124:125]
    v_lshlrev_b32 v126, 16, v177
    v_and_b32 v127, 0xffff0000, v177
    v_pk_add_f32 v[118:119], v[118:119], v[126:127]
    v_lshlrev_b32 v124, 16, v178
    v_and_b32 v125, 0xffff0000, v178
    v_pk_add_f32 v[120:121], v[120:121], v[124:125]
    v_lshlrev_b32 v124, 16, v180
    v_and_b32 v125, 0xffff0000, v180
    v_pk_add_f32 v[116:117], v[116:117], v[124:125]
    v_lshlrev_b32 v126, 16, v181
    v_and_b32 v127, 0xffff0000, v181
    v_pk_add_f32 v[118:119], v[118:119], v[126:127]
    v_lshlrev_b32 v124, 16, v182
    v_and_b32 v125, 0xffff0000, v182
    v_pk_add_f32 v[120:121], v[120:121], v[124:125]
    v_lshlrev_b32 v124, 16, v184
    v_and_b32 v125, 0xffff0000, v184
    v_pk_add_f32 v[116:117], v[116:117], v[124:125]
    v_lshlrev_b32 v126, 16, v185
    v_and_b32 v127, 0xffff0000, v185
    v_pk_add_f32 v[118:119], v[118:119], v[126:127]
    v_lshlrev_b32 v124, 16, v186
    v_and_b32 v125, 0xffff0000, v186
    v_pk_add_f32 v[120:121], v[120:121], v[124:125]
    v_lshlrev_b32 v124, 16, v188
    v_and_b32 v125, 0xffff0000, v188
    v_pk_add_f32 v[116:117], v[116:117], v[124:125]
    v_lshlrev_b32 v126, 16, v189
    v_and_b32 v127, 0xffff0000, v189
    v_pk_add_f32 v[118:119], v[118:119], v[126:127]
    v_lshlrev_b32 v124, 16, v190
    v_and_b32 v125, 0xffff0000, v190
    v_pk_add_f32 v[120:121], v[120:121], v[124:125]
    v_cvt_pk_bf16_f32 v124, v116, v117
    v_cvt_pk_bf16_f32 v125, v118, v119
    v_cvt_pk_bf16_f32 v126, v120, v121
    ds_write2_b32 v5, v124, v125 offset0:0 offset1:1
    ds_write_b32 v5, v126 offset:8
    s_waitcnt lgkmcnt(0)
    s_barrier
    ds_read_b128 v[128:131], v250 offset:0
    ds_read_b128 v[132:135], v251 offset:0
    ds_read_b128 v[136:139], v250 offset:16
    ds_read_b128 v[140:143], v251 offset:16
    ds_read_b128 v[144:147], v250 offset:32
    ds_read_b128 v[148:151], v251 offset:32
    ds_read_b128 v[152:155], v250 offset:48
    ds_read_b128 v[156:159], v251 offset:48
    ds_read_b128 v[160:163], v250 offset:64
    ds_read_b128 v[164:167], v251 offset:64
    s_waitcnt lgkmcnt(8)
    v_mfma_f32_32x32x16_bf16 v[48:63], v[132:135], v[96:99], 0
    v_mfma_f32_32x32x16_bf16 v[32:47], v[128:131], v[96:99], 0
    s_waitcnt lgkmcnt(6)
    v_mfma_f32_32x32x16_bf16 v[48:63], v[140:143], v[100:103], v[48:63]
    v_mfma_f32_32x32x16_bf16 v[32:47], v[136:139], v[100:103], v[32:47]
    s_waitcnt lgkmcnt(4)
    v_mfma_f32_32x32x16_bf16 v[48:63], v[148:151], v[104:107], v[48:63]
    v_mfma_f32_32x32x16_bf16 v[32:47], v[144:147], v[104:107], v[32:47]
    s_waitcnt lgkmcnt(2)
    v_mfma_f32_32x32x16_bf16 v[48:63], v[156:159], v[108:111], v[48:63]
    v_mfma_f32_32x32x16_bf16 v[32:47], v[152:155], v[108:111], v[32:47]
    s_waitcnt lgkmcnt(0)
    v_mfma_f32_32x32x16_bf16 v[48:63], v[164:167], v[112:115], v[48:63]
    v_mfma_f32_32x32x16_bf16 v[32:47], v[160:163], v[112:115], v[32:47]
    s_nop 10
    v_add_f32 v50, 0x358637bd, v50
    v_rcp_f32 v50, v50
    s_nop 0
    v_mov_b32 v51, v50
    v_pk_mul_f32 v[48:49], v[48:49], v[50:51]
    v_pk_mul_f32 v[32:33], v[32:33], v[50:51]
    v_pk_mul_f32 v[34:35], v[34:35], v[50:51]
    v_pk_mul_f32 v[36:37], v[36:37], v[50:51]
    v_pk_mul_f32 v[38:39], v[38:39], v[50:51]
    v_pk_mul_f32 v[40:41], v[40:41], v[50:51]
    v_pk_mul_f32 v[42:43], v[42:43], v[50:51]
    v_pk_mul_f32 v[44:45], v[44:45], v[50:51]
    v_pk_mul_f32 v[46:47], v[46:47], v[50:51]
    v_cvt_pk_bf16_f32 v64, v32, v33
    v_cvt_pk_bf16_f32 v65, v34, v35
    v_cvt_pk_bf16_f32 v66, v36, v37
    v_cvt_pk_bf16_f32 v67, v38, v39
    v_cvt_pk_bf16_f32 v68, v40, v41
    v_cvt_pk_bf16_f32 v69, v42, v43
    v_cvt_pk_bf16_f32 v70, v44, v45
    v_cvt_pk_bf16_f32 v71, v46, v47
    v_cvt_pk_bf16_f32 v72, v48, v49
    ds_write2_b32 v252, v64, v65 offset0:0 offset1:1
    ds_write2_b32 v252, v66, v67 offset0:2 offset1:3
    ds_write2_b32 v252, v68, v69 offset0:4 offset1:5
    ds_write2_b32 v252, v70, v71 offset0:6 offset1:7
    ds_write_b32 v252, v72 offset:32
    s_waitcnt lgkmcnt(0)
    ds_read_b128 v[76:79], v245 offset:0
    ds_read_b128 v[80:83], v245 offset:1024
    ds_read_b128 v[84:87], v245 offset:2048
    s_waitcnt lgkmcnt(2)
    buffer_store_dwordx4 v[76:79], v244, s[28:31], s50 offen offset:0 sc1
    s_waitcnt lgkmcnt(1)
    buffer_store_dwordx4 v[80:83], v244, s[28:31], s50 offen offset:1024 sc1
    s_waitcnt lgkmcnt(0)
    buffer_store_dwordx4 v[84:87], v9, s[28:31], s50 offen offset:2048 sc1
    s_lshl_b32 s25, s23, 2
    s_lshr_b32 s44, s24, 3
    s_add_u32 s25, s25, s44
    s_and_b32 s26, s24, 7
    s_and_b32 s27, s24, 1
    v_and_b32 v20, 15, v1
    v_lshrrev_b32 v21, 4, v1
    v_bfe_u32 v22, v1, 2, 2
    v_and_b32 v23, 3, v1
    s_lshl_b32 s46, s25, 6
    s_lshl_b32 s44, s22, 4
    s_add_u32 s46, s46, s44
    s_mul_i32 s47, s46, 1152
    s_mul_i32 s45, s26, 144
    s_add_u32 s47, s47, s45
    v_mul_u32_u24 v24, 1152, v20
    v_lshl_add_u32 v24, v21, 3, v24
    s_mov_b32 s32, s4
    s_and_b32 s33, s5, 0xffff
    s_mov_b32 s34, 2359296
    s_mov_b32 s35, 0x20000
    buffer_load_dwordx2 v[84:85], v24, s[32:35], s47 offen offset:0
    buffer_load_dwordx2 v[86:87], v24, s[32:35], s47 offen offset:32
    buffer_load_dwordx2 v[88:89], v24, s[32:35], s47 offen offset:64
    buffer_load_dwordx2 v[90:91], v24, s[32:35], s47 offen offset:96
    buffer_load_dwordx2 v[92:93], v24, s[32:35], s47 offen offset:128
    v_lshl_add_u32 v10, v21, 2, v22
    v_mul_u32_u24 v10, 160, v10
    v_lshl_add_u32 v10, v23, 3, v10
    s_mul_i32 s45, s27, 46080
    s_sub_u32 s47, 46080, s45
    v_add_u32 v11, s47, v10
    v_add_u32 v10, s45, v10
    v_add_u32 v25, s44, v20
    v_mul_u32_u24 v25, 72, v25
    v_add_u32 v25, 92160, v25
    v_add_u32 v26, 0, v21
    v_mul_u32_u24 v27, 57, v26
    v_lshrrev_b32 v27, 9, v27
    v_mul_u32_u24 v28, 9, v27
    v_sub_u32 v28, v26, v28
    v_mul_u32_u24 v27, 4608, v27
    v_lshl_add_u32 v27, v28, 3, v27
    v_add_u32 v100, v27, v25
    v_add_u32 v26, 4, v21
    v_mul_u32_u24 v27, 57, v26
    v_lshrrev_b32 v27, 9, v27
    v_mul_u32_u24 v28, 9, v27
    v_sub_u32 v28, v26, v28
    v_mul_u32_u24 v27, 4608, v27
    v_lshl_add_u32 v27, v28, 3, v27
    v_add_u32 v101, v27, v25
    v_add_u32 v26, 8, v21
    v_mul_u32_u24 v27, 57, v26
    v_lshrrev_b32 v27, 9, v27
    v_mul_u32_u24 v28, 9, v27
    v_sub_u32 v28, v26, v28
    v_mul_u32_u24 v27, 4608, v27
    v_lshl_add_u32 v27, v28, 3, v27
    v_add_u32 v102, v27, v25
    v_add_u32 v26, 12, v21
    v_mul_u32_u24 v27, 57, v26
    v_lshrrev_b32 v27, 9, v27
    v_mul_u32_u24 v28, 9, v27
    v_sub_u32 v28, v26, v28
    v_mul_u32_u24 v27, 4608, v27
    v_lshl_add_u32 v27, v28, 3, v27
    v_add_u32 v103, v27, v25
    v_add_u32 v26, 16, v21
    v_mul_u32_u24 v27, 57, v26
    v_lshrrev_b32 v27, 9, v27
    v_mul_u32_u24 v28, 9, v27
    v_sub_u32 v28, v26, v28
    v_mul_u32_u24 v27, 4608, v27
    v_lshl_add_u32 v27, v28, 3, v27
    v_add_u32 v104, v27, v25
    v_add_u32 v26, 20, v21
    v_mul_u32_u24 v27, 57, v26
    v_lshrrev_b32 v27, 9, v27
    v_mul_u32_u24 v28, 9, v27
    v_sub_u32 v28, v26, v28
    v_mul_u32_u24 v27, 4608, v27
    v_lshl_add_u32 v27, v28, 3, v27
    v_add_u32 v105, v27, v25
    v_add_u32 v26, 24, v21
    v_mul_u32_u24 v27, 57, v26
    v_lshrrev_b32 v27, 9, v27
    v_mul_u32_u24 v28, 9, v27
    v_sub_u32 v28, v26, v28
    v_mul_u32_u24 v27, 4608, v27
    v_lshl_add_u32 v27, v28, 3, v27
    v_add_u32 v106, v27, v25
    v_add_u32 v26, 28, v21
    v_mul_u32_u24 v27, 57, v26
    v_lshrrev_b32 v27, 9, v27
    v_mul_u32_u24 v28, 9, v27
    v_sub_u32 v28, v26, v28
    v_mul_u32_u24 v27, 4608, v27
    v_lshl_add_u32 v27, v28, 3, v27
    v_add_u32 v107, v27, v25
    v_add_u32 v26, 32, v21
    v_mul_u32_u24 v27, 57, v26
    v_lshrrev_b32 v27, 9, v27
    v_mul_u32_u24 v28, 9, v27
    v_sub_u32 v28, v26, v28
    v_mul_u32_u24 v27, 4608, v27
    v_lshl_add_u32 v27, v28, 3, v27
    v_add_u32 v108, v27, v25
    v_add_u32 v26, 36, v21
    v_mul_u32_u24 v27, 57, v26
    v_lshrrev_b32 v27, 9, v27
    v_mul_u32_u24 v28, 9, v27
    v_sub_u32 v28, v26, v28
    v_mul_u32_u24 v27, 4608, v27
    v_lshl_add_u32 v27, v28, 3, v27
    v_add_u32 v109, v27, v25
    v_add_u32 v26, 40, v21
    v_mul_u32_u24 v27, 57, v26
    v_lshrrev_b32 v27, 9, v27
    v_mul_u32_u24 v28, 9, v27
    v_sub_u32 v28, v26, v28
    v_mul_u32_u24 v27, 4608, v27
    v_lshl_add_u32 v27, v28, 3, v27
    v_add_u32 v110, v27, v25
    v_add_u32 v26, 44, v21
    v_mul_u32_u24 v27, 57, v26
    v_lshrrev_b32 v27, 9, v27
    v_mul_u32_u24 v28, 9, v27
    v_sub_u32 v28, v26, v28
    v_mul_u32_u24 v27, 4608, v27
    v_lshl_add_u32 v27, v28, 3, v27
    v_add_u32 v111, v27, v25
    v_add_u32 v26, 48, v21
    v_mul_u32_u24 v27, 57, v26
    v_lshrrev_b32 v27, 9, v27
    v_mul_u32_u24 v28, 9, v27
    v_sub_u32 v28, v26, v28
    v_mul_u32_u24 v27, 4608, v27
    v_lshl_add_u32 v27, v28, 3, v27
    v_add_u32 v112, v27, v25
    v_add_u32 v26, 52, v21
    v_mul_u32_u24 v27, 57, v26
    v_lshrrev_b32 v27, 9, v27
    v_mul_u32_u24 v28, 9, v27
    v_sub_u32 v28, v26, v28
    v_cmp_le_u32 vcc, 6, v27
    v_mul_u32_u24 v27, 4608, v27
    v_lshl_add_u32 v27, v28, 3, v27
    v_add_u32 v113, v27, v25
    v_add_u32 v27, -27648, v113
    v_add_u32 v28, 36864, v113
    v_cndmask_b32 v118, v28, v27, vcc
    v_add_u32 v26, 56, v21
    v_mul_u32_u24 v27, 57, v26
    v_lshrrev_b32 v27, 9, v27
    v_mul_u32_u24 v28, 9, v27
    v_sub_u32 v28, v26, v28
    v_cmp_le_u32 vcc, 6, v27
    v_mul_u32_u24 v27, 4608, v27
    v_lshl_add_u32 v27, v28, 3, v27
    v_add_u32 v114, v27, v25
    v_add_u32 v27, -27648, v114
    v_add_u32 v28, 36864, v114
    v_cndmask_b32 v119, v28, v27, vcc
    v_add_u32 v26, 60, v21
    v_mul_u32_u24 v27, 57, v26
    v_lshrrev_b32 v27, 9, v27
    v_mul_u32_u24 v28, 9, v27
    v_sub_u32 v28, v26, v28
    v_cmp_le_u32 vcc, 6, v27
    v_mul_u32_u24 v27, 4608, v27
    v_lshl_add_u32 v27, v28, 3, v27
    v_add_u32 v115, v27, v25
    v_add_u32 v27, -27648, v115
    v_add_u32 v28, 36864, v115
    v_cndmask_b32 v120, v28, v27, vcc
    v_add_u32 v26, 64, v21
    v_mul_u32_u24 v27, 57, v26
    v_lshrrev_b32 v27, 9, v27
    v_mul_u32_u24 v28, 9, v27
    v_sub_u32 v28, v26, v28
    v_cmp_le_u32 vcc, 6, v27
    v_mul_u32_u24 v27, 4608, v27
    v_lshl_add_u32 v27, v28, 3, v27
    v_add_u32 v116, v27, v25
    v_add_u32 v27, -27648, v116
    v_add_u32 v28, 36864, v116
    v_cndmask_b32 v121, v28, v27, vcc
    v_add_u32 v26, 68, v21
    v_mul_u32_u24 v27, 57, v26
    v_lshrrev_b32 v27, 9, v27
    v_mul_u32_u24 v28, 9, v27
    v_sub_u32 v28, v26, v28
    v_cmp_le_u32 vcc, 6, v27
    v_mul_u32_u24 v27, 4608, v27
    v_lshl_add_u32 v27, v28, 3, v27
    v_add_u32 v117, v27, v25
    v_add_u32 v27, -27648, v117
    v_add_u32 v28, 36864, v117
    v_cndmask_b32 v122, v28, v27, vcc
    s_mul_i32 s45, s26, 9
    v_and_b32 v26, 1, v21
    v_lshrrev_b32 v27, 1, v21
    v_lshl_add_u32 v26, v26, 1, v27
    v_add_u32 v26, s45, v26
    v_lshrrev_b32 v27, 1, v26
    v_lshlrev_b32 v16, 10, v27
    v_and_b32 v27, 1, v26
    v_lshl_add_u32 v16, v27, 9, v16
    s_and_b32 s45, s22, 1
    s_lshl_b32 s45, s45, 4
    v_add_u32 v27, s45, v20
    v_lshl_add_u32 v16, v27, 4, v16
    v_mov_b32 v27, 2146435072
    v_cmp_eq_u32 vcc, 0, v21
    s_nop 1
    v_cndmask_b32 v17, v27, v16, vcc
    v_lshlrev_b32 v18, 3, v20
    v_cndmask_b32 v18, v27, v18, vcc
    v_cmp_gt_u32 s[60:61], 2, v21
    s_lshr_b32 s48, s46, 5
    s_mul_i32 s48, s48, 36864
    s_add_u32 s48, s48, 2359296
    s_add_u32 s49, s48, 4096
    s_lshl_b32 s50, s25, 3
    s_add_u32 s50, s50, s26
    s_lshl_b32 s50, s50, 9
    s_lshl_b32 s45, s22, 7
    s_add_u32 s50, s50, s45
    s_add_u32 s50, s50, 4718592
    s_waitcnt vmcnt(5)
    s_barrier
    s_barrier
    ds_read_b64 v[76:77], v100 offset:0
    ds_read_b64 v[78:79], v101 offset:0
    ds_read_b64_tr_b16 v[48:49], v10 offset:0
    ds_read_b64_tr_b16 v[50:51], v10 offset:2560
    ds_read_b64_tr_b16 v[52:53], v10 offset:32
    ds_read_b64_tr_b16 v[54:55], v10 offset:2592
    ds_read_b64_tr_b16 v[56:57], v10 offset:64
    ds_read_b64_tr_b16 v[58:59], v10 offset:2624
    ds_read_b64_tr_b16 v[60:61], v10 offset:96
    ds_read_b64_tr_b16 v[62:63], v10 offset:2656
    ds_read_b64_tr_b16 v[64:65], v10 offset:128
    ds_read_b64_tr_b16 v[66:67], v10 offset:2688
    ds_read_b64 v[80:81], v102 offset:0
    ds_read_b64 v[82:83], v103 offset:0
    ds_read_b64_tr_b16 v[68:69], v10 offset:5120
    ds_read_b64_tr_b16 v[70:71], v10 offset:7680
    s_waitcnt lgkmcnt(10)
    v_mfma_f32_16x16x32_bf16 v[28:31], v[48:51], v[76:79], 0
    ds_read_b64_tr_b16 v[72:73], v10 offset:5152
    ds_read_b64_tr_b16 v[74:75], v10 offset:7712
    v_mfma_f32_16x16x32_bf16 v[32:35], v[52:55], v[76:79], 0
    ds_read_b64_tr_b16 v[48:49], v10 offset:5184
    ds_read_b64_tr_b16 v[50:51], v10 offset:7744
    s_waitcnt lgkmcnt(10)
    v_mfma_f32_16x16x32_bf16 v[36:39], v[56:59], v[76:79], 0
    ds_read_b64_tr_b16 v[52:53], v10 offset:5216
    ds_read_b64_tr_b16 v[54:55], v10 offset:7776
    v_mfma_f32_16x16x32_bf16 v[40:43], v[60:63], v[76:79], 0
    ds_read_b64_tr_b16 v[56:57], v10 offset:5248
    ds_read_b64_tr_b16 v[58:59], v10 offset:7808
    s_waitcnt lgkmcnt(8)
    v_mfma_f32_16x16x32_bf16 v[44:47], v[64:67], v[76:79], 0
    s_barrier
    ds_read_b64 v[76:77], v104 offset:0
    ds_read_b64 v[78:79], v105 offset:0
    ds_read_b64_tr_b16 v[60:61], v10 offset:10240
    ds_read_b64_tr_b16 v[62:63], v10 offset:12800
    v_mfma_f32_16x16x32_bf16 v[28:31], v[68:71], v[80:83], v[28:31]
    ds_read_b64_tr_b16 v[64:65], v10 offset:10272
    ds_read_b64_tr_b16 v[66:67], v10 offset:12832
    s_waitcnt lgkmcnt(10)
    v_mfma_f32_16x16x32_bf16 v[32:35], v[72:75], v[80:83], v[32:35]
    ds_read_b64_tr_b16 v[68:69], v10 offset:10304
    ds_read_b64_tr_b16 v[70:71], v10 offset:12864
    v_mfma_f32_16x16x32_bf16 v[36:39], v[48:51], v[80:83], v[36:39]
    ds_read_b64_tr_b16 v[72:73], v10 offset:10336
    ds_read_b64_tr_b16 v[74:75], v10 offset:12896
    s_waitcnt lgkmcnt(10)
    v_mfma_f32_16x16x32_bf16 v[40:43], v[52:55], v[80:83], v[40:43]
    ds_read_b64_tr_b16 v[48:49], v10 offset:10368
    ds_read_b64_tr_b16 v[50:51], v10 offset:12928
    v_mfma_f32_16x16x32_bf16 v[44:47], v[56:59], v[80:83], v[44:47]
    ds_read_b64 v[80:81], v106 offset:0
    ds_read_b64 v[82:83], v107 offset:0
    ds_read_b64_tr_b16 v[52:53], v10 offset:15360
    ds_read_b64_tr_b16 v[54:55], v10 offset:17920
    s_waitcnt lgkmcnt(10)
    v_mfma_f32_16x16x32_bf16 v[28:31], v[60:63], v[76:79], v[28:31]
    ds_read_b64_tr_b16 v[56:57], v10 offset:15392
    ds_read_b64_tr_b16 v[58:59], v10 offset:17952
    v_mfma_f32_16x16x32_bf16 v[32:35], v[64:67], v[76:79], v[32:35]
    ds_read_b64_tr_b16 v[60:61], v10 offset:15424
    ds_read_b64_tr_b16 v[62:63], v10 offset:17984
    s_waitcnt lgkmcnt(10)
    v_mfma_f32_16x16x32_bf16 v[36:39], v[68:71], v[76:79], v[36:39]
    ds_read_b64_tr_b16 v[64:65], v10 offset:15456
    ds_read_b64_tr_b16 v[66:67], v10 offset:18016
    v_mfma_f32_16x16x32_bf16 v[40:43], v[72:75], v[76:79], v[40:43]
    ds_read_b64_tr_b16 v[68:69], v10 offset:15488
    ds_read_b64_tr_b16 v[70:71], v10 offset:18048
    s_waitcnt lgkmcnt(8)
    v_mfma_f32_16x16x32_bf16 v[44:47], v[48:51], v[76:79], v[44:47]
    s_barrier
    ds_read_b64 v[76:77], v108 offset:0
    ds_read_b64 v[78:79], v109 offset:0
    ds_read_b64_tr_b16 v[72:73], v10 offset:20480
    ds_read_b64_tr_b16 v[74:75], v10 offset:23040
    v_mfma_f32_16x16x32_bf16 v[28:31], v[52:55], v[80:83], v[28:31]
    ds_read_b64_tr_b16 v[48:49], v10 offset:20512
    ds_read_b64_tr_b16 v[50:51], v10 offset:23072
    s_waitcnt lgkmcnt(10)
    v_mfma_f32_16x16x32_bf16 v[32:35], v[56:59], v[80:83], v[32:35]
    ds_read_b64_tr_b16 v[52:53], v10 offset:20544
    ds_read_b64_tr_b16 v[54:55], v10 offset:23104
    v_mfma_f32_16x16x32_bf16 v[36:39], v[60:63], v[80:83], v[36:39]
    ds_read_b64_tr_b16 v[56:57], v10 offset:20576
    ds_read_b64_tr_b16 v[58:59], v10 offset:23136
    s_waitcnt lgkmcnt(10)
    v_mfma_f32_16x16x32_bf16 v[40:43], v[64:67], v[80:83], v[40:43]
    ds_read_b64_tr_b16 v[60:61], v10 offset:20608
    ds_read_b64_tr_b16 v[62:63], v10 offset:23168
    v_mfma_f32_16x16x32_bf16 v[44:47], v[68:71], v[80:83], v[44:47]
    ds_read_b64 v[80:81], v110 offset:0
    ds_read_b64 v[82:83], v111 offset:0
    ds_read_b64_tr_b16 v[64:65], v10 offset:25600
    ds_read_b64_tr_b16 v[66:67], v10 offset:28160
    s_waitcnt lgkmcnt(10)
    v_mfma_f32_16x16x32_bf16 v[28:31], v[72:75], v[76:79], v[28:31]
    ds_read_b64_tr_b16 v[68:69], v10 offset:25632
    ds_read_b64_tr_b16 v[70:71], v10 offset:28192
    v_mfma_f32_16x16x32_bf16 v[32:35], v[48:51], v[76:79], v[32:35]
    ds_read_b64_tr_b16 v[72:73], v10 offset:25664
    ds_read_b64_tr_b16 v[74:75], v10 offset:28224
    s_waitcnt lgkmcnt(10)
    v_mfma_f32_16x16x32_bf16 v[36:39], v[52:55], v[76:79], v[36:39]
    ds_read_b64_tr_b16 v[48:49], v10 offset:25696
    ds_read_b64_tr_b16 v[50:51], v10 offset:28256
    v_mfma_f32_16x16x32_bf16 v[40:43], v[56:59], v[76:79], v[40:43]
    ds_read_b64_tr_b16 v[52:53], v10 offset:25728
    ds_read_b64_tr_b16 v[54:55], v10 offset:28288
    s_waitcnt lgkmcnt(8)
    v_mfma_f32_16x16x32_bf16 v[44:47], v[60:63], v[76:79], v[44:47]
    s_barrier
    ds_read_b64 v[76:77], v112 offset:0
    ds_read_b64 v[78:79], v113 offset:0
    ds_read_b64_tr_b16 v[56:57], v10 offset:30720
    ds_read_b64_tr_b16 v[58:59], v10 offset:33280
    v_mfma_f32_16x16x32_bf16 v[28:31], v[64:67], v[80:83], v[28:31]
    ds_read_b64_tr_b16 v[60:61], v10 offset:30752
    ds_read_b64_tr_b16 v[62:63], v10 offset:33312
    s_waitcnt lgkmcnt(10)
    v_mfma_f32_16x16x32_bf16 v[32:35], v[68:71], v[80:83], v[32:35]
    ds_read_b64_tr_b16 v[64:65], v10 offset:30784
    ds_read_b64_tr_b16 v[66:67], v10 offset:33344
    v_mfma_f32_16x16x32_bf16 v[36:39], v[72:75], v[80:83], v[36:39]
    ds_read_b64_tr_b16 v[68:69], v10 offset:30816
    ds_read_b64_tr_b16 v[70:71], v10 offset:33376
    s_waitcnt lgkmcnt(10)
    v_mfma_f32_16x16x32_bf16 v[40:43], v[48:51], v[80:83], v[40:43]
    ds_read_b64_tr_b16 v[72:73], v10 offset:30848
    ds_read_b64_tr_b16 v[74:75], v10 offset:33408
    v_mfma_f32_16x16x32_bf16 v[44:47], v[52:55], v[80:83], v[44:47]
    ds_read_b64 v[80:81], v114 offset:0
    ds_read_b64 v[82:83], v115 offset:0
    ds_read_b64_tr_b16 v[48:49], v10 offset:35840
    ds_read_b64_tr_b16 v[50:51], v10 offset:38400
    s_waitcnt lgkmcnt(10)
    v_mfma_f32_16x16x32_bf16 v[28:31], v[56:59], v[76:79], v[28:31]
    ds_read_b64_tr_b16 v[52:53], v10 offset:35872
    ds_read_b64_tr_b16 v[54:55], v10 offset:38432
    v_mfma_f32_16x16x32_bf16 v[32:35], v[60:63], v[76:79], v[32:35]
    ds_read_b64_tr_b16 v[56:57], v10 offset:35904
    ds_read_b64_tr_b16 v[58:59], v10 offset:38464
    s_waitcnt lgkmcnt(10)
    v_mfma_f32_16x16x32_bf16 v[36:39], v[64:67], v[76:79], v[36:39]
    ds_read_b64_tr_b16 v[60:61], v10 offset:35936
    ds_read_b64_tr_b16 v[62:63], v10 offset:38496
    v_mfma_f32_16x16x32_bf16 v[40:43], v[68:71], v[76:79], v[40:43]
    ds_read_b64_tr_b16 v[64:65], v10 offset:35968
    ds_read_b64_tr_b16 v[66:67], v10 offset:38528
    s_waitcnt lgkmcnt(8)
    v_mfma_f32_16x16x32_bf16 v[44:47], v[72:75], v[76:79], v[44:47]
    ds_read_b64 v[76:77], v116 offset:0
    ds_read_b64 v[78:79], v117 offset:0
    ds_read_b64_tr_b16 v[68:69], v10 offset:40960
    ds_read_b64_tr_b16 v[70:71], v10 offset:43520
    v_mfma_f32_16x16x32_bf16 v[28:31], v[48:51], v[80:83], v[28:31]
    ds_read_b64_tr_b16 v[72:73], v10 offset:40992
    ds_read_b64_tr_b16 v[74:75], v10 offset:43552
    s_waitcnt lgkmcnt(10)
    v_mfma_f32_16x16x32_bf16 v[32:35], v[52:55], v[80:83], v[32:35]
    ds_read_b64_tr_b16 v[48:49], v10 offset:41024
    ds_read_b64_tr_b16 v[50:51], v10 offset:43584
    v_mfma_f32_16x16x32_bf16 v[36:39], v[56:59], v[80:83], v[36:39]
    ds_read_b64_tr_b16 v[52:53], v10 offset:41056
    ds_read_b64_tr_b16 v[54:55], v10 offset:43616
    s_waitcnt lgkmcnt(10)
    v_mfma_f32_16x16x32_bf16 v[40:43], v[60:63], v[80:83], v[40:43]
    ds_read_b64_tr_b16 v[56:57], v10 offset:41088
    ds_read_b64_tr_b16 v[58:59], v10 offset:43648
    v_mfma_f32_16x16x32_bf16 v[44:47], v[64:67], v[80:83], v[44:47]
    s_barrier
    ds_read_b64 v[80:81], v100 offset:36864
    ds_read_b64 v[82:83], v101 offset:36864
    ds_read_b64_tr_b16 v[60:61], v11 offset:0
    ds_read_b64_tr_b16 v[62:63], v11 offset:2560
    s_waitcnt lgkmcnt(10)
    v_mfma_f32_16x16x32_bf16 v[28:31], v[68:71], v[76:79], v[28:31]
    ds_read_b64_tr_b16 v[64:65], v11 offset:32
    ds_read_b64_tr_b16 v[66:67], v11 offset:2592
    v_mfma_f32_16x16x32_bf16 v[32:35], v[72:75], v[76:79], v[32:35]
    ds_read_b64_tr_b16 v[68:69], v11 offset:64
    ds_read_b64_tr_b16 v[70:71], v11 offset:2624
    s_waitcnt lgkmcnt(10)
    v_mfma_f32_16x16x32_bf16 v[36:39], v[48:51], v[76:79], v[36:39]
    ds_read_b64_tr_b16 v[72:73], v11 offset:96
    ds_read_b64_tr_b16 v[74:75], v11 offset:2656
    v_mfma_f32_16x16x32_bf16 v[40:43], v[52:55], v[76:79], v[40:43]
    ds_read_b64_tr_b16 v[48:49], v11 offset:128
    ds_read_b64_tr_b16 v[50:51], v11 offset:2688
    s_waitcnt lgkmcnt(8)
    v_mfma_f32_16x16x32_bf16 v[44:47], v[56:59], v[76:79], v[44:47]
    ds_read_b64 v[76:77], v102 offset:36864
    ds_read_b64 v[78:79], v103 offset:36864
    ds_read_b64_tr_b16 v[52:53], v11 offset:5120
    ds_read_b64_tr_b16 v[54:55], v11 offset:7680
    v_mfma_f32_16x16x32_bf16 v[28:31], v[60:63], v[80:83], v[28:31]
    ds_read_b64_tr_b16 v[56:57], v11 offset:5152
    ds_read_b64_tr_b16 v[58:59], v11 offset:7712
    s_waitcnt lgkmcnt(10)
    v_mfma_f32_16x16x32_bf16 v[32:35], v[64:67], v[80:83], v[32:35]
    ds_read_b64_tr_b16 v[60:61], v11 offset:5184
    ds_read_b64_tr_b16 v[62:63], v11 offset:7744
    v_mfma_f32_16x16x32_bf16 v[36:39], v[68:71], v[80:83], v[36:39]
    ds_read_b64_tr_b16 v[64:65], v11 offset:5216
    ds_read_b64_tr_b16 v[66:67], v11 offset:7776
    s_waitcnt lgkmcnt(10)
    v_mfma_f32_16x16x32_bf16 v[40:43], v[72:75], v[80:83], v[40:43]
    ds_read_b64_tr_b16 v[68:69], v11 offset:5248
    ds_read_b64_tr_b16 v[70:71], v11 offset:7808
    v_mfma_f32_16x16x32_bf16 v[44:47], v[48:51], v[80:83], v[44:47]
    s_barrier
    ds_read_b64 v[80:81], v104 offset:36864
    ds_read_b64 v[82:83], v105 offset:36864
    ds_read_b64_tr_b16 v[72:73], v11 offset:10240
    ds_read_b64_tr_b16 v[74:75], v11 offset:12800
    s_waitcnt lgkmcnt(10)
    v_mfma_f32_16x16x32_bf16 v[28:31], v[52:55], v[76:79], v[28:31]
    ds_read_b64_tr_b16 v[48:49], v11 offset:10272
    ds_read_b64_tr_b16 v[50:51], v11 offset:12832
    v_mfma_f32_16x16x32_bf16 v[32:35], v[56:59], v[76:79], v[32:35]
    ds_read_b64_tr_b16 v[52:53], v11 offset:10304
    ds_read_b64_tr_b16 v[54:55], v11 offset:12864
    s_waitcnt lgkmcnt(10)
    v_mfma_f32_16x16x32_bf16 v[36:39], v[60:63], v[76:79], v[36:39]
    ds_read_b64_tr_b16 v[56:57], v11 offset:10336
    ds_read_b64_tr_b16 v[58:59], v11 offset:12896
    v_mfma_f32_16x16x32_bf16 v[40:43], v[64:67], v[76:79], v[40:43]
    ds_read_b64_tr_b16 v[60:61], v11 offset:10368
    ds_read_b64_tr_b16 v[62:63], v11 offset:12928
    s_waitcnt lgkmcnt(8)
    v_mfma_f32_16x16x32_bf16 v[44:47], v[68:71], v[76:79], v[44:47]
    ds_read_b64 v[76:77], v106 offset:36864
    ds_read_b64 v[78:79], v107 offset:36864
    ds_read_b64_tr_b16 v[64:65], v11 offset:15360
    ds_read_b64_tr_b16 v[66:67], v11 offset:17920
    v_mfma_f32_16x16x32_bf16 v[28:31], v[72:75], v[80:83], v[28:31]
    ds_read_b64_tr_b16 v[68:69], v11 offset:15392
    ds_read_b64_tr_b16 v[70:71], v11 offset:17952
    s_waitcnt lgkmcnt(10)
    v_mfma_f32_16x16x32_bf16 v[32:35], v[48:51], v[80:83], v[32:35]
    ds_read_b64_tr_b16 v[72:73], v11 offset:15424
    ds_read_b64_tr_b16 v[74:75], v11 offset:17984
    v_mfma_f32_16x16x32_bf16 v[36:39], v[52:55], v[80:83], v[36:39]
    ds_read_b64_tr_b16 v[48:49], v11 offset:15456
    ds_read_b64_tr_b16 v[50:51], v11 offset:18016
    s_waitcnt lgkmcnt(10)
    v_mfma_f32_16x16x32_bf16 v[40:43], v[56:59], v[80:83], v[40:43]
    ds_read_b64_tr_b16 v[52:53], v11 offset:15488
    ds_read_b64_tr_b16 v[54:55], v11 offset:18048
    v_mfma_f32_16x16x32_bf16 v[44:47], v[60:63], v[80:83], v[44:47]
    s_barrier
    ds_read_b64 v[80:81], v108 offset:36864
    ds_read_b64 v[82:83], v109 offset:36864
    ds_read_b64_tr_b16 v[56:57], v11 offset:20480
    ds_read_b64_tr_b16 v[58:59], v11 offset:23040
    s_waitcnt lgkmcnt(10)
    v_mfma_f32_16x16x32_bf16 v[28:31], v[64:67], v[76:79], v[28:31]
    ds_read_b64_tr_b16 v[60:61], v11 offset:20512
    ds_read_b64_tr_b16 v[62:63], v11 offset:23072
    v_mfma_f32_16x16x32_bf16 v[32:35], v[68:71], v[76:79], v[32:35]
    ds_read_b64_tr_b16 v[64:65], v11 offset:20544
    ds_read_b64_tr_b16 v[66:67], v11 offset:23104
    s_waitcnt lgkmcnt(10)
    v_mfma_f32_16x16x32_bf16 v[36:39], v[72:75], v[76:79], v[36:39]
    ds_read_b64_tr_b16 v[68:69], v11 offset:20576
    ds_read_b64_tr_b16 v[70:71], v11 offset:23136
    v_mfma_f32_16x16x32_bf16 v[40:43], v[48:51], v[76:79], v[40:43]
    ds_read_b64_tr_b16 v[72:73], v11 offset:20608
    ds_read_b64_tr_b16 v[74:75], v11 offset:23168
    s_waitcnt lgkmcnt(8)
    v_mfma_f32_16x16x32_bf16 v[44:47], v[52:55], v[76:79], v[44:47]
    ds_read_b64 v[76:77], v110 offset:36864
    ds_read_b64 v[78:79], v111 offset:36864
    ds_read_b64_tr_b16 v[48:49], v11 offset:25600
    ds_read_b64_tr_b16 v[50:51], v11 offset:28160
    v_mfma_f32_16x16x32_bf16 v[28:31], v[56:59], v[80:83], v[28:31]
    ds_read_b64_tr_b16 v[52:53], v11 offset:25632
    ds_read_b64_tr_b16 v[54:55], v11 offset:28192
    s_waitcnt lgkmcnt(10)
    v_mfma_f32_16x16x32_bf16 v[32:35], v[60:63], v[80:83], v[32:35]
    ds_read_b64_tr_b16 v[56:57], v11 offset:25664
    ds_read_b64_tr_b16 v[58:59], v11 offset:28224
    v_mfma_f32_16x16x32_bf16 v[36:39], v[64:67], v[80:83], v[36:39]
    ds_read_b64_tr_b16 v[60:61], v11 offset:25696
    ds_read_b64_tr_b16 v[62:63], v11 offset:28256
    s_waitcnt lgkmcnt(10)
    v_mfma_f32_16x16x32_bf16 v[40:43], v[68:71], v[80:83], v[40:43]
    ds_read_b64_tr_b16 v[64:65], v11 offset:25728
    ds_read_b64_tr_b16 v[66:67], v11 offset:28288
    v_mfma_f32_16x16x32_bf16 v[44:47], v[72:75], v[80:83], v[44:47]
    s_barrier
    ds_read_b64 v[80:81], v112 offset:36864
    ds_read_b64 v[82:83], v118
    ds_read_b64_tr_b16 v[68:69], v11 offset:30720
    ds_read_b64_tr_b16 v[70:71], v11 offset:33280
    s_waitcnt lgkmcnt(10)
    v_mfma_f32_16x16x32_bf16 v[28:31], v[48:51], v[76:79], v[28:31]
    ds_read_b64_tr_b16 v[72:73], v11 offset:30752
    ds_read_b64_tr_b16 v[74:75], v11 offset:33312
    v_mfma_f32_16x16x32_bf16 v[32:35], v[52:55], v[76:79], v[32:35]
    ds_read_b64_tr_b16 v[48:49], v11 offset:30784
    ds_read_b64_tr_b16 v[50:51], v11 offset:33344
    s_waitcnt lgkmcnt(10)
    v_mfma_f32_16x16x32_bf16 v[36:39], v[56:59], v[76:79], v[36:39]
    ds_read_b64_tr_b16 v[52:53], v11 offset:30816
    ds_read_b64_tr_b16 v[54:55], v11 offset:33376
    v_mfma_f32_16x16x32_bf16 v[40:43], v[60:63], v[76:79], v[40:43]
    ds_read_b64_tr_b16 v[56:57], v11 offset:30848
    ds_read_b64_tr_b16 v[58:59], v11 offset:33408
    s_waitcnt lgkmcnt(8)
    v_mfma_f32_16x16x32_bf16 v[44:47], v[64:67], v[76:79], v[44:47]
    ds_read_b64 v[76:77], v119
    ds_read_b64 v[78:79], v120
    ds_read_b64_tr_b16 v[60:61], v11 offset:35840
    ds_read_b64_tr_b16 v[62:63], v11 offset:38400
    v_mfma_f32_16x16x32_bf16 v[28:31], v[68:71], v[80:83], v[28:31]
    ds_read_b64_tr_b16 v[64:65], v11 offset:35872
    ds_read_b64_tr_b16 v[66:67], v11 offset:38432
    s_waitcnt lgkmcnt(10)
    v_mfma_f32_16x16x32_bf16 v[32:35], v[72:75], v[80:83], v[32:35]
    ds_read_b64_tr_b16 v[68:69], v11 offset:35904
    ds_read_b64_tr_b16 v[70:71], v11 offset:38464
    v_mfma_f32_16x16x32_bf16 v[36:39], v[48:51], v[80:83], v[36:39]
    ds_read_b64_tr_b16 v[72:73], v11 offset:35936
    ds_read_b64_tr_b16 v[74:75], v11 offset:38496
    s_waitcnt lgkmcnt(10)
    v_mfma_f32_16x16x32_bf16 v[40:43], v[52:55], v[80:83], v[40:43]
    ds_read_b64_tr_b16 v[48:49], v11 offset:35968
    ds_read_b64_tr_b16 v[50:51], v11 offset:38528
    v_mfma_f32_16x16x32_bf16 v[44:47], v[56:59], v[80:83], v[44:47]
    ds_read_b64 v[80:81], v121
    ds_read_b64 v[82:83], v122
    ds_read_b64_tr_b16 v[52:53], v11 offset:40960
    ds_read_b64_tr_b16 v[54:55], v11 offset:43520
    s_waitcnt lgkmcnt(10)
    v_mfma_f32_16x16x32_bf16 v[28:31], v[60:63], v[76:79], v[28:31]
    ds_read_b64_tr_b16 v[56:57], v11 offset:40992
    ds_read_b64_tr_b16 v[58:59], v11 offset:43552
    v_mfma_f32_16x16x32_bf16 v[32:35], v[64:67], v[76:79], v[32:35]
    ds_read_b64_tr_b16 v[60:61], v11 offset:41024
    ds_read_b64_tr_b16 v[62:63], v11 offset:43584
    s_waitcnt lgkmcnt(10)
    v_mfma_f32_16x16x32_bf16 v[36:39], v[68:71], v[76:79], v[36:39]
    ds_read_b64_tr_b16 v[64:65], v11 offset:41056
    ds_read_b64_tr_b16 v[66:67], v11 offset:43616
    v_mfma_f32_16x16x32_bf16 v[40:43], v[72:75], v[76:79], v[40:43]
    ds_read_b64_tr_b16 v[68:69], v11 offset:41088
    ds_read_b64_tr_b16 v[70:71], v11 offset:43648
    s_waitcnt lgkmcnt(8)
    v_mfma_f32_16x16x32_bf16 v[44:47], v[48:51], v[76:79], v[44:47]
    v_mfma_f32_16x16x32_bf16 v[28:31], v[52:55], v[80:83], v[28:31]
    s_waitcnt lgkmcnt(4)
    v_mfma_f32_16x16x32_bf16 v[32:35], v[56:59], v[80:83], v[32:35]
    v_mfma_f32_16x16x32_bf16 v[36:39], v[60:63], v[80:83], v[36:39]
    s_waitcnt lgkmcnt(0)
    v_mfma_f32_16x16x32_bf16 v[40:43], v[64:67], v[80:83], v[40:43]
    s_barrier
    v_mfma_f32_16x16x32_bf16 v[44:47], v[68:71], v[80:83], v[44:47]
    s_waitcnt vmcnt(0)
    v_mov_b32 v98, 0
    v_mov_b32 v99, 0
    v_lshlrev_b32 v48, 16, v84
    v_and_b32 v49, 0xffff0000, v84
    v_lshlrev_b32 v50, 16, v85
    v_and_b32 v51, 0xffff0000, v85
    v_pk_add_f32 v[28:29], v[28:29], v[48:49]
    v_pk_add_f32 v[30:31], v[30:31], v[50:51]
    v_cvt_pk_bf16_f32 v84, v28, v29
    v_cvt_pk_bf16_f32 v85, v30, v31
    v_dot2c_f32_bf16 v98, 0x3f803f80, v84
    v_dot2c_f32_bf16 v99, v84, v84
    v_dot2c_f32_bf16 v98, 0x3f803f80, v85
    v_dot2c_f32_bf16 v99, v85, v85
    v_lshlrev_b32 v48, 16, v86
    v_and_b32 v49, 0xffff0000, v86
    v_lshlrev_b32 v50, 16, v87
    v_and_b32 v51, 0xffff0000, v87
    v_pk_add_f32 v[32:33], v[32:33], v[48:49]
    v_pk_add_f32 v[34:35], v[34:35], v[50:51]
    v_cvt_pk_bf16_f32 v86, v32, v33
    v_cvt_pk_bf16_f32 v87, v34, v35
    v_dot2c_f32_bf16 v98, 0x3f803f80, v86
    v_dot2c_f32_bf16 v99, v86, v86
    v_dot2c_f32_bf16 v98, 0x3f803f80, v87
    v_dot2c_f32_bf16 v99, v87, v87
    v_permlane16_swap_b32 v84, v86
    v_permlane16_swap_b32 v85, v87
    buffer_store_dwordx4 v[84:87], v16, s[28:31], s48 offen offset:0 sc1
    v_lshlrev_b32 v48, 16, v88
    v_and_b32 v49, 0xffff0000, v88
    v_lshlrev_b32 v50, 16, v89
    v_and_b32 v51, 0xffff0000, v89
    v_pk_add_f32 v[36:37], v[36:37], v[48:49]
    v_pk_add_f32 v[38:39], v[38:39], v[50:51]
    v_cvt_pk_bf16_f32 v88, v36, v37
    v_cvt_pk_bf16_f32 v89, v38, v39
    v_dot2c_f32_bf16 v98, 0x3f803f80, v88
    v_dot2c_f32_bf16 v99, v88, v88
    v_dot2c_f32_bf16 v98, 0x3f803f80, v89
    v_dot2c_f32_bf16 v99, v89, v89
    v_lshlrev_b32 v48, 16, v90
    v_and_b32 v49, 0xffff0000, v90
    v_lshlrev_b32 v50, 16, v91
    v_and_b32 v51, 0xffff0000, v91
    v_pk_add_f32 v[40:41], v[40:41], v[48:49]
    v_pk_add_f32 v[42:43], v[42:43], v[50:51]
    v_cvt_pk_bf16_f32 v90, v40, v41
    v_cvt_pk_bf16_f32 v91, v42, v43
    v_dot2c_f32_bf16 v98, 0x3f803f80, v90
    v_dot2c_f32_bf16 v99, v90, v90
    v_dot2c_f32_bf16 v98, 0x3f803f80, v91
    v_dot2c_f32_bf16 v99, v91, v91
    v_permlane16_swap_b32 v88, v90
    v_permlane16_swap_b32 v89, v91
    buffer_store_dwordx4 v[88:91], v16, s[28:31], s48 offen offset:2048 sc1
    v_lshlrev_b32 v48, 16, v92
    v_and_b32 v49, 0xffff0000, v92
    v_lshlrev_b32 v50, 16, v93
    v_and_b32 v51, 0xffff0000, v93
    v_pk_add_f32 v[44:45], v[44:45], v[48:49]
    v_pk_add_f32 v[46:47], v[46:47], v[50:51]
    v_cvt_pk_bf16_f32 v92, v44, v45
    v_cvt_pk_bf16_f32 v93, v46, v47
    v_cndmask_b32 v92, 0, v92, s[60:61]
    v_cndmask_b32 v93, 0, v93, s[60:61]
    v_mov_b32 v94, v92
    v_mov_b32 v95, v93
    v_dot2c_f32_bf16 v98, 0x3f803f80, v92
    v_dot2c_f32_bf16 v99, v92, v92
    v_dot2c_f32_bf16 v98, 0x3f803f80, v93
    v_dot2c_f32_bf16 v99, v93, v93
    v_permlane16_swap_b32 v92, v94
    v_permlane16_swap_b32 v93, v95
    buffer_store_dwordx4 v[92:95], v17, s[28:31], s49 offen sc1
    v_mov_b32 v96, v98
    v_mov_b32 v97, v99
    s_nop 0
    v_permlane32_swap_b32 v98, v96
    v_permlane32_swap_b32 v99, v97
    v_add_f32 v98, v98, v96
    v_add_f32 v99, v99, v97
    v_mov_b32 v96, v98
    v_mov_b32 v97, v99
    s_nop 0
    v_permlane16_swap_b32 v98, v96
    v_permlane16_swap_b32 v99, v97
    v_add_f32 v98, v98, v96
    v_add_f32 v99, v99, v97
    buffer_store_dwordx2 v[98:99], v18, s[28:31], s50 offen sc1
    s_cmp_ge_u32 s24, 18
    s_cselect_b32 s26, 18, 0
    s_sub_u32 s26, s24, s26
    s_cmp_ge_u32 s26, 9
    s_cselect_b32 s27, 9, 0
    s_sub_u32 s27, s26, s27
    s_lshr_b32 s46, s22, 1
    s_and_b32 s47, s22, 1
    v_lshrrev_b32 v19, 5, v1
    v_bfe_u32 v20, v1, 4, 1
    v_bfe_u32 v21, v1, 2, 2
    v_and_b32 v22, 3, v1
    v_lshl_add_u32 v23, v19, 2, v21
    v_lshl_add_u32 v24, v19, 3, v21
    v_lshlrev_b32 v20, 5, v20
    v_lshl_add_u32 v20, v22, 3, v20
    v_lshrrev_b32 v21, 1, v21
    v_lshlrev_b32 v21, 6, v21
    v_mul_u32_u24 v24, 1152, v24
    v_add_u32 v24, v24, v20
    v_add_u32 v25, v24, v21
    v_sub_u32 v26, v24, v21
    s_cmp_eq_u32 s47, 1
    s_cselect_b64 s[60:61], -1, 0
    s_mul_i32 s44, s47, 576
    v_cndmask_b32 v2, v25, v26, s[60:61]
    v_cndmask_b32 v3, v26, v25, s[60:61]
    v_add_u32 v2, s44, v2
    v_add_u32 v3, s44, v3
    v_lshl_add_u32 v6, v23, 7, v20
    v_add_u32 v6, v6, v21
    s_lshl_b32 s44, s47, 6
    v_xor_b32 v6, s44, v6
    s_mul_i32 s44, s47, 18432
    s_sub_u32 s45, 18432, s44
    v_add_u32 v11, s45, v6
    v_add_u32 v6, s44, v6
    v_lshlrev_b32 v10, 4, v1
    s_lshl_b32 s44, s46, 10
    s_add_u32 s44, s44, 147456
    v_add_u32 v7, s44, v10
    s_mul_i32 s44, s22, 9216
    s_add_u32 s44, s44, 36864
    v_add_u32 v8, s44, v10
    s_xor_b32 s44, s22, 1
    s_mul_i32 s44, s44, 9216
    s_add_u32 s44, s44, 36864
    v_add_u32 v9, s44, v10
    s_lshl_b32 s44, s24, 1
    s_add_u32 s44, s44, s46
    s_lshl_b32 s48, s23, 6
    s_add_u32 s48, s48, s44
    s_mul_i32 s48, s48, 36864
    s_lshl_b32 s45, s47, 11
    s_add_u32 s48, s48, s45
    s_add_u32 s48, s48, 8388608
    s_add_u32 s49, s48, 36864
    s_lshl_b32 s45, s27, 12
    s_add_u32 s48, s48, s45
    v_and_b32 v236, 31, v1
    v_lshlrev_b32 v236, 3, v236
    s_lshl_b32 s45, s46, 8
    s_add_u32 s45, s45, 92160
    v_add_u32 v236, s45, v236
    s_waitcnt vmcnt(0)
    s_barrier
    s_barrier
    v_add_u32 v4, 0, v2
    v_add_u32 v5, 0, v3
    ds_read_b128 v[16:19], v7 offset:0
    ds_read_b64_tr_b16 v[28:29], v4 offset:0
    ds_read_b64_tr_b16 v[30:31], v4 offset:4608
    ds_read_b64_tr_b16 v[32:33], v5 offset:64
    ds_read_b64_tr_b16 v[34:35], v5 offset:4672
    ds_read_b64_tr_b16 v[36:37], v4 offset:128
    ds_read_b64_tr_b16 v[38:39], v4 offset:4736
    ds_read_b64_tr_b16 v[40:41], v5 offset:192
    ds_read_b64_tr_b16 v[42:43], v5 offset:4800
    ds_read_b64_tr_b16 v[44:45], v4 offset:256
    ds_read_b64_tr_b16 v[46:47], v4 offset:4864
    ds_read_b64_tr_b16 v[48:49], v5 offset:320
    ds_read_b64_tr_b16 v[50:51], v5 offset:4928
    ds_read_b64_tr_b16 v[52:53], v4 offset:384
    ds_read_b64_tr_b16 v[54:55], v4 offset:4992
    s_waitcnt lgkmcnt(10)
    v_mfma_f32_32x32x16_bf16 v[60:75], v[28:31], v[16:19], 0
    ds_read_b64_tr_b16 v[56:57], v5 offset:448
    ds_read_b64_tr_b16 v[58:59], v5 offset:5056
    v_mfma_f32_32x32x16_bf16 v[76:91], v[32:35], v[16:19], 0
    ds_read_b64_tr_b16 v[28:29], v4 offset:512
    ds_read_b64_tr_b16 v[30:31], v4 offset:5120
    s_waitcnt lgkmcnt(10)
    v_mfma_f32_32x32x16_bf16 v[92:107], v[36:39], v[16:19], 0
    ds_read_b128 v[20:23], v7 offset:2048
    ds_read_b64_tr_b16 v[32:33], v4 offset:18432
    ds_read_b64_tr_b16 v[34:35], v4 offset:23040
    v_mfma_f32_32x32x16_bf16 v[108:123], v[40:43], v[16:19], 0
    ds_read_b64_tr_b16 v[36:37], v5 offset:18496
    ds_read_b64_tr_b16 v[38:39], v5 offset:23104
    s_waitcnt lgkmcnt(11)
    v_mfma_f32_32x32x16_bf16 v[124:139], v[44:47], v[16:19], 0
    ds_read_b64_tr_b16 v[40:41], v4 offset:18560
    ds_read_b64_tr_b16 v[42:43], v4 offset:23168
    v_mfma_f32_32x32x16_bf16 v[140:155], v[48:51], v[16:19], 0
    ds_read_b64_tr_b16 v[44:45], v5 offset:18624
    ds_read_b64_tr_b16 v[46:47], v5 offset:23232
    s_waitcnt lgkmcnt(11)
    v_mfma_f32_32x32x16_bf16 v[156:171], v[52:55], v[16:19], 0
    ds_read_b64_tr_b16 v[48:49], v4 offset:18688
    ds_read_b64_tr_b16 v[50:51], v4 offset:23296
    v_mfma_f32_32x32x16_bf16 v[172:187], v[56:59], v[16:19], 0
    s_barrier
    ds_read_b64_tr_b16 v[52:53], v5 offset:18752
    ds_read_b64_tr_b16 v[54:55], v5 offset:23360
    s_waitcnt lgkmcnt(10)
    v_mfma_f32_32x32x16_bf16 v[188:203], v[28:31], v[16:19], 0
    ds_read_b64_tr_b16 v[56:57], v4 offset:18816
    ds_read_b64_tr_b16 v[58:59], v4 offset:23424
    v_mfma_f32_32x32x16_bf16 v[60:75], v[32:35], v[20:23], v[60:75]
    ds_read_b64_tr_b16 v[28:29], v5 offset:18880
    ds_read_b64_tr_b16 v[30:31], v5 offset:23488
    s_waitcnt lgkmcnt(10)
    v_mfma_f32_32x32x16_bf16 v[76:91], v[36:39], v[20:23], v[76:91]
    ds_read_b64_tr_b16 v[32:33], v4 offset:18944
    ds_read_b64_tr_b16 v[34:35], v4 offset:23552
    v_mfma_f32_32x32x16_bf16 v[92:107], v[40:43], v[20:23], v[92:107]
    v_add_u32 v4, 36864, v2
    v_add_u32 v5, 36864, v3
    ds_read_b128 v[24:27], v7 offset:4096
    ds_read_b64_tr_b16 v[36:37], v4 offset:0
    ds_read_b64_tr_b16 v[38:39], v4 offset:4608
    s_waitcnt lgkmcnt(11)
    v_mfma_f32_32x32x16_bf16 v[108:123], v[44:47], v[20:23], v[108:123]
    ds_read_b64_tr_b16 v[40:41], v5 offset:64
    ds_read_b64_tr_b16 v[42:43], v5 offset:4672
    v_mfma_f32_32x32x16_bf16 v[124:139], v[48:51], v[20:23], v[124:139]
    ds_read_b64_tr_b16 v[44:45], v4 offset:128
    ds_read_b64_tr_b16 v[46:47], v4 offset:4736
    s_waitcnt lgkmcnt(11)
    v_mfma_f32_32x32x16_bf16 v[140:155], v[52:55], v[20:23], v[140:155]
    ds_read_b64_tr_b16 v[48:49], v5 offset:192
    ds_read_b64_tr_b16 v[50:51], v5 offset:4800
    v_mfma_f32_32x32x16_bf16 v[156:171], v[56:59], v[20:23], v[156:171]
    ds_read_b64_tr_b16 v[52:53], v4 offset:256
    ds_read_b64_tr_b16 v[54:55], v4 offset:4864
    s_waitcnt lgkmcnt(11)
    v_mfma_f32_32x32x16_bf16 v[172:187], v[28:31], v[20:23], v[172:187]
    ds_read_b64_tr_b16 v[56:57], v5 offset:320
    ds_read_b64_tr_b16 v[58:59], v5 offset:4928
    v_mfma_f32_32x32x16_bf16 v[188:203], v[32:35], v[20:23], v[188:203]
    ds_read_b64_tr_b16 v[28:29], v4 offset:384
    ds_read_b64_tr_b16 v[30:31], v4 offset:4992
    s_waitcnt lgkmcnt(10)
    v_mfma_f32_32x32x16_bf16 v[60:75], v[36:39], v[24:27], v[60:75]
    ds_read_b64_tr_b16 v[32:33], v5 offset:448
    ds_read_b64_tr_b16 v[34:35], v5 offset:5056
    v_mfma_f32_32x32x16_bf16 v[76:91], v[40:43], v[24:27], v[76:91]
    ds_read_b64_tr_b16 v[36:37], v4 offset:512
    ds_read_b64_tr_b16 v[38:39], v4 offset:5120
    s_waitcnt lgkmcnt(10)
    v_mfma_f32_32x32x16_bf16 v[92:107], v[44:47], v[24:27], v[92:107]
    ds_read_b128 v[16:19], v7 offset:6144
    ds_read_b64_tr_b16 v[40:41], v4 offset:18432
    ds_read_b64_tr_b16 v[42:43], v4 offset:23040
    v_mfma_f32_32x32x16_bf16 v[108:123], v[48:51], v[24:27], v[108:123]
    ds_read_b64_tr_b16 v[44:45], v5 offset:18496
    ds_read_b64_tr_b16 v[46:47], v5 offset:23104
    s_waitcnt lgkmcnt(11)
    v_mfma_f32_32x32x16_bf16 v[124:139], v[52:55], v[24:27], v[124:139]
    ds_read_b64_tr_b16 v[48:49], v4 offset:18560
    ds_read_b64_tr_b16 v[50:51], v4 offset:23168
    v_mfma_f32_32x32x16_bf16 v[140:155], v[56:59], v[24:27], v[140:155]
    ds_read_b64_tr_b16 v[52:53], v5 offset:18624
    ds_read_b64_tr_b16 v[54:55], v5 offset:23232
    s_waitcnt lgkmcnt(11)
    v_mfma_f32_32x32x16_bf16 v[156:171], v[28:31], v[24:27], v[156:171]
    ds_read_b64_tr_b16 v[56:57], v4 offset:18688
    ds_read_b64_tr_b16 v[58:59], v4 offset:23296
    v_mfma_f32_32x32x16_bf16 v[172:187], v[32:35], v[24:27], v[172:187]
    s_barrier
    ds_read_b64_tr_b16 v[28:29], v5 offset:18752
    ds_read_b64_tr_b16 v[30:31], v5 offset:23360
    s_waitcnt lgkmcnt(10)
    v_mfma_f32_32x32x16_bf16 v[188:203], v[36:39], v[24:27], v[188:203]
    ds_read_b64_tr_b16 v[32:33], v4 offset:18816
    ds_read_b64_tr_b16 v[34:35], v4 offset:23424
    v_mfma_f32_32x32x16_bf16 v[60:75], v[40:43], v[16:19], v[60:75]
    ds_read_b64_tr_b16 v[36:37], v5 offset:18880
    ds_read_b64_tr_b16 v[38:39], v5 offset:23488
    s_waitcnt lgkmcnt(10)
    v_mfma_f32_32x32x16_bf16 v[76:91], v[44:47], v[16:19], v[76:91]
    ds_read_b64_tr_b16 v[40:41], v4 offset:18944
    ds_read_b64_tr_b16 v[42:43], v4 offset:23552
    v_mfma_f32_32x32x16_bf16 v[92:107], v[48:51], v[16:19], v[92:107]
    v_add_u32 v4, 73728, v2
    v_add_u32 v5, 73728, v3
    ds_read_b128 v[20:23], v7 offset:8192
    ds_read_b64_tr_b16 v[44:45], v4 offset:0
    ds_read_b64_tr_b16 v[46:47], v4 offset:4608
    s_waitcnt lgkmcnt(11)
    v_mfma_f32_32x32x16_bf16 v[108:123], v[52:55], v[16:19], v[108:123]
    ds_read_b64_tr_b16 v[48:49], v5 offset:64
    ds_read_b64_tr_b16 v[50:51], v5 offset:4672
    v_mfma_f32_32x32x16_bf16 v[124:139], v[56:59], v[16:19], v[124:139]
    ds_read_b64_tr_b16 v[52:53], v4 offset:128
    ds_read_b64_tr_b16 v[54:55], v4 offset:4736
    s_waitcnt lgkmcnt(11)
    v_mfma_f32_32x32x16_bf16 v[140:155], v[28:31], v[16:19], v[140:155]
    ds_read_b64_tr_b16 v[56:57], v5 offset:192
    ds_read_b64_tr_b16 v[58:59], v5 offset:4800
    v_mfma_f32_32x32x16_bf16 v[156:171], v[32:35], v[16:19], v[156:171]
    ds_read_b64_tr_b16 v[28:29], v4 offset:256
    ds_read_b64_tr_b16 v[30:31], v4 offset:4864
    s_waitcnt lgkmcnt(11)
    v_mfma_f32_32x32x16_bf16 v[172:187], v[36:39], v[16:19], v[172:187]
    ds_read_b64_tr_b16 v[32:33], v5 offset:320
    ds_read_b64_tr_b16 v[34:35], v5 offset:4928
    v_mfma_f32_32x32x16_bf16 v[188:203], v[40:43], v[16:19], v[188:203]
    ds_read_b64_tr_b16 v[36:37], v4 offset:384
    ds_read_b64_tr_b16 v[38:39], v4 offset:4992
    s_waitcnt lgkmcnt(10)
    v_mfma_f32_32x32x16_bf16 v[60:75], v[44:47], v[20:23], v[60:75]
    ds_read_b64_tr_b16 v[40:41], v5 offset:448
    ds_read_b64_tr_b16 v[42:43], v5 offset:5056
    v_mfma_f32_32x32x16_bf16 v[76:91], v[48:51], v[20:23], v[76:91]
    ds_read_b64_tr_b16 v[44:45], v4 offset:512
    ds_read_b64_tr_b16 v[46:47], v4 offset:5120
    s_waitcnt lgkmcnt(10)
    v_mfma_f32_32x32x16_bf16 v[92:107], v[52:55], v[20:23], v[92:107]
    ds_read_b128 v[24:27], v7 offset:10240
    ds_read_b64_tr_b16 v[48:49], v4 offset:18432
    ds_read_b64_tr_b16 v[50:51], v4 offset:23040
    v_mfma_f32_32x32x16_bf16 v[108:123], v[56:59], v[20:23], v[108:123]
    ds_read_b64_tr_b16 v[52:53], v5 offset:18496
    ds_read_b64_tr_b16 v[54:55], v5 offset:23104
    s_waitcnt lgkmcnt(11)
    v_mfma_f32_32x32x16_bf16 v[124:139], v[28:31], v[20:23], v[124:139]
    ds_read_b64_tr_b16 v[56:57], v4 offset:18560
    ds_read_b64_tr_b16 v[58:59], v4 offset:23168
    v_mfma_f32_32x32x16_bf16 v[140:155], v[32:35], v[20:23], v[140:155]
    ds_read_b64_tr_b16 v[28:29], v5 offset:18624
    ds_read_b64_tr_b16 v[30:31], v5 offset:23232
    s_waitcnt lgkmcnt(11)
    v_mfma_f32_32x32x16_bf16 v[156:171], v[36:39], v[20:23], v[156:171]
    ds_read_b64_tr_b16 v[32:33], v4 offset:18688
    ds_read_b64_tr_b16 v[34:35], v4 offset:23296
    v_mfma_f32_32x32x16_bf16 v[172:187], v[40:43], v[20:23], v[172:187]
    s_barrier
    ds_read_b64_tr_b16 v[36:37], v5 offset:18752
    ds_read_b64_tr_b16 v[38:39], v5 offset:23360
    s_waitcnt lgkmcnt(10)
    v_mfma_f32_32x32x16_bf16 v[188:203], v[44:47], v[20:23], v[188:203]
    ds_read_b64_tr_b16 v[40:41], v4 offset:18816
    ds_read_b64_tr_b16 v[42:43], v4 offset:23424
    v_mfma_f32_32x32x16_bf16 v[60:75], v[48:51], v[24:27], v[60:75]
    ds_read_b64_tr_b16 v[44:45], v5 offset:18880
    ds_read_b64_tr_b16 v[46:47], v5 offset:23488
    s_waitcnt lgkmcnt(10)
    v_mfma_f32_32x32x16_bf16 v[76:91], v[52:55], v[24:27], v[76:91]
    ds_read_b64_tr_b16 v[48:49], v4 offset:18944
    ds_read_b64_tr_b16 v[50:51], v4 offset:23552
    v_mfma_f32_32x32x16_bf16 v[92:107], v[56:59], v[24:27], v[92:107]
    v_add_u32 v4, 110592, v2
    v_add_u32 v5, 110592, v3
    ds_read_b128 v[16:19], v7 offset:12288
    ds_read_b64_tr_b16 v[52:53], v4 offset:0
    ds_read_b64_tr_b16 v[54:55], v4 offset:4608
    s_waitcnt lgkmcnt(11)
    v_mfma_f32_32x32x16_bf16 v[108:123], v[28:31], v[24:27], v[108:123]
    ds_read_b64_tr_b16 v[56:57], v5 offset:64
    ds_read_b64_tr_b16 v[58:59], v5 offset:4672
    v_mfma_f32_32x32x16_bf16 v[124:139], v[32:35], v[24:27], v[124:139]
    ds_read_b64_tr_b16 v[28:29], v4 offset:128
    ds_read_b64_tr_b16 v[30:31], v4 offset:4736
    s_waitcnt lgkmcnt(11)
    v_mfma_f32_32x32x16_bf16 v[140:155], v[36:39], v[24:27], v[140:155]
    ds_read_b64_tr_b16 v[32:33], v5 offset:192
    ds_read_b64_tr_b16 v[34:35], v5 offset:4800
    v_mfma_f32_32x32x16_bf16 v[156:171], v[40:43], v[24:27], v[156:171]
    ds_read_b64_tr_b16 v[36:37], v4 offset:256
    ds_read_b64_tr_b16 v[38:39], v4 offset:4864
    s_waitcnt lgkmcnt(11)
    v_mfma_f32_32x32x16_bf16 v[172:187], v[44:47], v[24:27], v[172:187]
    ds_read_b64_tr_b16 v[40:41], v5 offset:320
    ds_read_b64_tr_b16 v[42:43], v5 offset:4928
    v_mfma_f32_32x32x16_bf16 v[188:203], v[48:51], v[24:27], v[188:203]
    ds_read_b64_tr_b16 v[44:45], v4 offset:384
    ds_read_b64_tr_b16 v[46:47], v4 offset:4992
    s_waitcnt lgkmcnt(10)
    v_mfma_f32_32x32x16_bf16 v[60:75], v[52:55], v[16:19], v[60:75]
    ds_read_b64_tr_b16 v[48:49], v5 offset:448
    ds_read_b64_tr_b16 v[50:51], v5 offset:5056
    v_mfma_f32_32x32x16_bf16 v[76:91], v[56:59], v[16:19], v[76:91]
    ds_read_b64_tr_b16 v[52:53], v4 offset:512
    ds_read_b64_tr_b16 v[54:55], v4 offset:5120
    s_waitcnt lgkmcnt(10)
    v_mfma_f32_32x32x16_bf16 v[92:107], v[28:31], v[16:19], v[92:107]
    ds_read_b128 v[20:23], v7 offset:14336
    ds_read_b64_tr_b16 v[56:57], v4 offset:18432
    ds_read_b64_tr_b16 v[58:59], v4 offset:23040
    v_mfma_f32_32x32x16_bf16 v[108:123], v[32:35], v[16:19], v[108:123]
    ds_read_b64_tr_b16 v[28:29], v5 offset:18496
    ds_read_b64_tr_b16 v[30:31], v5 offset:23104
    s_waitcnt lgkmcnt(11)
    v_mfma_f32_32x32x16_bf16 v[124:139], v[36:39], v[16:19], v[124:139]
    ds_read_b64_tr_b16 v[32:33], v4 offset:18560
    ds_read_b64_tr_b16 v[34:35], v4 offset:23168
    v_mfma_f32_32x32x16_bf16 v[140:155], v[40:43], v[16:19], v[140:155]
    ds_read_b64_tr_b16 v[36:37], v5 offset:18624
    ds_read_b64_tr_b16 v[38:39], v5 offset:23232
    s_waitcnt lgkmcnt(11)
    v_mfma_f32_32x32x16_bf16 v[156:171], v[44:47], v[16:19], v[156:171]
    ds_read_b64_tr_b16 v[40:41], v4 offset:18688
    ds_read_b64_tr_b16 v[42:43], v4 offset:23296
    v_mfma_f32_32x32x16_bf16 v[172:187], v[48:51], v[16:19], v[172:187]
    s_barrier
    ds_read_b64_tr_b16 v[44:45], v5 offset:18752
    ds_read_b64_tr_b16 v[46:47], v5 offset:23360
    s_waitcnt lgkmcnt(10)
    v_mfma_f32_32x32x16_bf16 v[188:203], v[52:55], v[16:19], v[188:203]
    ds_read_b64_tr_b16 v[48:49], v4 offset:18816
    ds_read_b64_tr_b16 v[50:51], v4 offset:23424
    v_mfma_f32_32x32x16_bf16 v[60:75], v[56:59], v[20:23], v[60:75]
    ds_read_b64_tr_b16 v[52:53], v5 offset:18880
    ds_read_b64_tr_b16 v[54:55], v5 offset:23488
    s_waitcnt lgkmcnt(10)
    v_mfma_f32_32x32x16_bf16 v[76:91], v[28:31], v[20:23], v[76:91]
    ds_read_b64_tr_b16 v[56:57], v4 offset:18944
    ds_read_b64_tr_b16 v[58:59], v4 offset:23552
    v_mfma_f32_32x32x16_bf16 v[92:107], v[32:35], v[20:23], v[92:107]
    v_add_u32 v4, 0, v2
    v_add_u32 v5, 0, v3
    ds_read_b128 v[24:27], v7 offset:0
    ds_read_b64_tr_b16 v[28:29], v4 offset:0
    ds_read_b64_tr_b16 v[30:31], v4 offset:4608
    s_waitcnt lgkmcnt(11)
    v_mfma_f32_32x32x16_bf16 v[108:123], v[36:39], v[20:23], v[108:123]
    ds_read_b64_tr_b16 v[32:33], v5 offset:64
    ds_read_b64_tr_b16 v[34:35], v5 offset:4672
    v_mfma_f32_32x32x16_bf16 v[124:139], v[40:43], v[20:23], v[124:139]
    ds_read_b64_tr_b16 v[36:37], v4 offset:128
    ds_read_b64_tr_b16 v[38:39], v4 offset:4736
    s_waitcnt lgkmcnt(11)
    v_mfma_f32_32x32x16_bf16 v[140:155], v[44:47], v[20:23], v[140:155]
    ds_read_b64_tr_b16 v[40:41], v5 offset:192
    ds_read_b64_tr_b16 v[42:43], v5 offset:4800
    v_mfma_f32_32x32x16_bf16 v[156:171], v[48:51], v[20:23], v[156:171]
    ds_read_b64_tr_b16 v[44:45], v4 offset:256
    ds_read_b64_tr_b16 v[46:47], v4 offset:4864
    s_waitcnt lgkmcnt(11)
    v_mfma_f32_32x32x16_bf16 v[172:187], v[52:55], v[20:23], v[172:187]
    ds_read_b64_tr_b16 v[48:49], v5 offset:320
    ds_read_b64_tr_b16 v[50:51], v5 offset:4928
    v_mfma_f32_32x32x16_bf16 v[188:203], v[56:59], v[20:23], v[188:203]
    ds_read_b64_tr_b16 v[52:53], v4 offset:384
    ds_read_b64_tr_b16 v[54:55], v4 offset:4992
    s_waitcnt lgkmcnt(10)
    v_mfma_f32_32x32x16_bf16 v[60:75], v[28:31], v[24:27], v[60:75]
    ds_read_b64_tr_b16 v[56:57], v5 offset:448
    ds_read_b64_tr_b16 v[58:59], v5 offset:5056
    v_mfma_f32_32x32x16_bf16 v[76:91], v[32:35], v[24:27], v[76:91]
    ds_read_b64_tr_b16 v[28:29], v4 offset:512
    ds_read_b64_tr_b16 v[30:31], v4 offset:5120
    s_waitcnt lgkmcnt(10)
    v_mfma_f32_32x32x16_bf16 v[92:107], v[36:39], v[24:27], v[92:107]
    ds_read_b128 v[16:19], v7 offset:2048
    ds_read_b64_tr_b16 v[32:33], v4 offset:18432
    ds_read_b64_tr_b16 v[34:35], v4 offset:23040
    v_mfma_f32_32x32x16_bf16 v[108:123], v[40:43], v[24:27], v[108:123]
    ds_read_b64_tr_b16 v[36:37], v5 offset:18496
    ds_read_b64_tr_b16 v[38:39], v5 offset:23104
    s_waitcnt lgkmcnt(11)
    v_mfma_f32_32x32x16_bf16 v[124:139], v[44:47], v[24:27], v[124:139]
    ds_read_b64_tr_b16 v[40:41], v4 offset:18560
    ds_read_b64_tr_b16 v[42:43], v4 offset:23168
    v_mfma_f32_32x32x16_bf16 v[140:155], v[48:51], v[24:27], v[140:155]
    ds_read_b64_tr_b16 v[44:45], v5 offset:18624
    ds_read_b64_tr_b16 v[46:47], v5 offset:23232
    s_waitcnt lgkmcnt(11)
    v_mfma_f32_32x32x16_bf16 v[156:171], v[52:55], v[24:27], v[156:171]
    ds_read_b64_tr_b16 v[48:49], v4 offset:18688
    ds_read_b64_tr_b16 v[50:51], v4 offset:23296
    v_mfma_f32_32x32x16_bf16 v[172:187], v[56:59], v[24:27], v[172:187]
    s_barrier
    ds_read_b64_tr_b16 v[52:53], v5 offset:18752
    ds_read_b64_tr_b16 v[54:55], v5 offset:23360
    s_waitcnt lgkmcnt(10)
    v_mfma_f32_32x32x16_bf16 v[188:203], v[28:31], v[24:27], v[188:203]
    ds_read_b64_tr_b16 v[56:57], v4 offset:18816
    ds_read_b64_tr_b16 v[58:59], v4 offset:23424
    v_mfma_f32_32x32x16_bf16 v[60:75], v[32:35], v[16:19], v[60:75]
    ds_read_b64_tr_b16 v[28:29], v5 offset:18880
    ds_read_b64_tr_b16 v[30:31], v5 offset:23488
    s_waitcnt lgkmcnt(10)
    v_mfma_f32_32x32x16_bf16 v[76:91], v[36:39], v[16:19], v[76:91]
    ds_read_b64_tr_b16 v[32:33], v4 offset:18944
    ds_read_b64_tr_b16 v[34:35], v4 offset:23552
    v_mfma_f32_32x32x16_bf16 v[92:107], v[40:43], v[16:19], v[92:107]
    v_add_u32 v4, 36864, v2
    v_add_u32 v5, 36864, v3
    ds_read_b128 v[20:23], v7 offset:4096
    ds_read_b64_tr_b16 v[36:37], v4 offset:0
    ds_read_b64_tr_b16 v[38:39], v4 offset:4608
    s_waitcnt lgkmcnt(11)
    v_mfma_f32_32x32x16_bf16 v[108:123], v[44:47], v[16:19], v[108:123]
    ds_read_b64_tr_b16 v[40:41], v5 offset:64
    ds_read_b64_tr_b16 v[42:43], v5 offset:4672
    v_mfma_f32_32x32x16_bf16 v[124:139], v[48:51], v[16:19], v[124:139]
    ds_read_b64_tr_b16 v[44:45], v4 offset:128
    ds_read_b64_tr_b16 v[46:47], v4 offset:4736
    s_waitcnt lgkmcnt(11)
    v_mfma_f32_32x32x16_bf16 v[140:155], v[52:55], v[16:19], v[140:155]
    ds_read_b64_tr_b16 v[48:49], v5 offset:192
    ds_read_b64_tr_b16 v[50:51], v5 offset:4800
    v_mfma_f32_32x32x16_bf16 v[156:171], v[56:59], v[16:19], v[156:171]
    ds_read_b64_tr_b16 v[52:53], v4 offset:256
    ds_read_b64_tr_b16 v[54:55], v4 offset:4864
    s_waitcnt lgkmcnt(11)
    v_mfma_f32_32x32x16_bf16 v[172:187], v[28:31], v[16:19], v[172:187]
    ds_read_b64_tr_b16 v[56:57], v5 offset:320
    ds_read_b64_tr_b16 v[58:59], v5 offset:4928
    v_mfma_f32_32x32x16_bf16 v[188:203], v[32:35], v[16:19], v[188:203]
    ds_read_b64_tr_b16 v[28:29], v4 offset:384
    ds_read_b64_tr_b16 v[30:31], v4 offset:4992
    s_waitcnt lgkmcnt(10)
    v_mfma_f32_32x32x16_bf16 v[60:75], v[36:39], v[20:23], v[60:75]
    ds_read_b64_tr_b16 v[32:33], v5 offset:448
    ds_read_b64_tr_b16 v[34:35], v5 offset:5056
    v_mfma_f32_32x32x16_bf16 v[76:91], v[40:43], v[20:23], v[76:91]
    ds_read_b64_tr_b16 v[36:37], v4 offset:512
    ds_read_b64_tr_b16 v[38:39], v4 offset:5120
    s_waitcnt lgkmcnt(10)
    v_mfma_f32_32x32x16_bf16 v[92:107], v[44:47], v[20:23], v[92:107]
    ds_read_b128 v[24:27], v7 offset:6144
    ds_read_b64_tr_b16 v[40:41], v4 offset:18432
    ds_read_b64_tr_b16 v[42:43], v4 offset:23040
    v_mfma_f32_32x32x16_bf16 v[108:123], v[48:51], v[20:23], v[108:123]
    ds_read_b64_tr_b16 v[44:45], v5 offset:18496
    ds_read_b64_tr_b16 v[46:47], v5 offset:23104
    s_waitcnt lgkmcnt(11)
    v_mfma_f32_32x32x16_bf16 v[124:139], v[52:55], v[20:23], v[124:139]
    ds_read_b64_tr_b16 v[48:49], v4 offset:18560
    ds_read_b64_tr_b16 v[50:51], v4 offset:23168
    v_mfma_f32_32x32x16_bf16 v[140:155], v[56:59], v[20:23], v[140:155]
    ds_read_b64_tr_b16 v[52:53], v5 offset:18624
    ds_read_b64_tr_b16 v[54:55], v5 offset:23232
    s_waitcnt lgkmcnt(11)
    v_mfma_f32_32x32x16_bf16 v[156:171], v[28:31], v[20:23], v[156:171]
    ds_read_b64_tr_b16 v[56:57], v4 offset:18688
    ds_read_b64_tr_b16 v[58:59], v4 offset:23296
    v_mfma_f32_32x32x16_bf16 v[172:187], v[32:35], v[20:23], v[172:187]
    s_barrier
    ds_read_b64_tr_b16 v[28:29], v5 offset:18752
    ds_read_b64_tr_b16 v[30:31], v5 offset:23360
    s_waitcnt lgkmcnt(10)
    v_mfma_f32_32x32x16_bf16 v[188:203], v[36:39], v[20:23], v[188:203]
    ds_read_b64_tr_b16 v[32:33], v4 offset:18816
    ds_read_b64_tr_b16 v[34:35], v4 offset:23424
    v_mfma_f32_32x32x16_bf16 v[60:75], v[40:43], v[24:27], v[60:75]
    ds_read_b64_tr_b16 v[36:37], v5 offset:18880
    ds_read_b64_tr_b16 v[38:39], v5 offset:23488
    s_waitcnt lgkmcnt(10)
    v_mfma_f32_32x32x16_bf16 v[76:91], v[44:47], v[24:27], v[76:91]
    ds_read_b64_tr_b16 v[40:41], v4 offset:18944
    ds_read_b64_tr_b16 v[42:43], v4 offset:23552
    v_mfma_f32_32x32x16_bf16 v[92:107], v[48:51], v[24:27], v[92:107]
    v_add_u32 v4, 73728, v2
    v_add_u32 v5, 73728, v3
    ds_read_b128 v[16:19], v7 offset:8192
    ds_read_b64_tr_b16 v[44:45], v4 offset:0
    ds_read_b64_tr_b16 v[46:47], v4 offset:4608
    s_waitcnt lgkmcnt(11)
    v_mfma_f32_32x32x16_bf16 v[108:123], v[52:55], v[24:27], v[108:123]
    ds_read_b64_tr_b16 v[48:49], v5 offset:64
    ds_read_b64_tr_b16 v[50:51], v5 offset:4672
    v_mfma_f32_32x32x16_bf16 v[124:139], v[56:59], v[24:27], v[124:139]
    ds_read_b64_tr_b16 v[52:53], v4 offset:128
    ds_read_b64_tr_b16 v[54:55], v4 offset:4736
    s_waitcnt lgkmcnt(11)
    v_mfma_f32_32x32x16_bf16 v[140:155], v[28:31], v[24:27], v[140:155]
    ds_read_b64_tr_b16 v[56:57], v5 offset:192
    ds_read_b64_tr_b16 v[58:59], v5 offset:4800
    v_mfma_f32_32x32x16_bf16 v[156:171], v[32:35], v[24:27], v[156:171]
    ds_read_b64_tr_b16 v[28:29], v4 offset:256
    ds_read_b64_tr_b16 v[30:31], v4 offset:4864
    s_waitcnt lgkmcnt(11)
    v_mfma_f32_32x32x16_bf16 v[172:187], v[36:39], v[24:27], v[172:187]
    ds_read_b64_tr_b16 v[32:33], v5 offset:320
    ds_read_b64_tr_b16 v[34:35], v5 offset:4928
    v_mfma_f32_32x32x16_bf16 v[188:203], v[40:43], v[24:27], v[188:203]
    ds_read_b64_tr_b16 v[36:37], v4 offset:384
    ds_read_b64_tr_b16 v[38:39], v4 offset:4992
    s_waitcnt lgkmcnt(10)
    v_mfma_f32_32x32x16_bf16 v[60:75], v[44:47], v[16:19], v[60:75]
    ds_read_b64_tr_b16 v[40:41], v5 offset:448
    ds_read_b64_tr_b16 v[42:43], v5 offset:5056
    v_mfma_f32_32x32x16_bf16 v[76:91], v[48:51], v[16:19], v[76:91]
    ds_read_b64_tr_b16 v[44:45], v4 offset:512
    ds_read_b64_tr_b16 v[46:47], v4 offset:5120
    s_waitcnt lgkmcnt(10)
    v_mfma_f32_32x32x16_bf16 v[92:107], v[52:55], v[16:19], v[92:107]
    ds_read_b128 v[20:23], v7 offset:10240
    ds_read_b64_tr_b16 v[48:49], v4 offset:18432
    ds_read_b64_tr_b16 v[50:51], v4 offset:23040
    v_mfma_f32_32x32x16_bf16 v[108:123], v[56:59], v[16:19], v[108:123]
    ds_read_b64_tr_b16 v[52:53], v5 offset:18496
    ds_read_b64_tr_b16 v[54:55], v5 offset:23104
    s_waitcnt lgkmcnt(11)
    v_mfma_f32_32x32x16_bf16 v[124:139], v[28:31], v[16:19], v[124:139]
    ds_read_b64_tr_b16 v[56:57], v4 offset:18560
    ds_read_b64_tr_b16 v[58:59], v4 offset:23168
    v_mfma_f32_32x32x16_bf16 v[140:155], v[32:35], v[16:19], v[140:155]
    ds_read_b64_tr_b16 v[28:29], v5 offset:18624
    ds_read_b64_tr_b16 v[30:31], v5 offset:23232
    s_waitcnt lgkmcnt(11)
    v_mfma_f32_32x32x16_bf16 v[156:171], v[36:39], v[16:19], v[156:171]
    ds_read_b64_tr_b16 v[32:33], v4 offset:18688
    ds_read_b64_tr_b16 v[34:35], v4 offset:23296
    v_mfma_f32_32x32x16_bf16 v[172:187], v[40:43], v[16:19], v[172:187]
    s_barrier
    ds_read_b64_tr_b16 v[36:37], v5 offset:18752
    ds_read_b64_tr_b16 v[38:39], v5 offset:23360
    s_waitcnt lgkmcnt(10)
    v_mfma_f32_32x32x16_bf16 v[188:203], v[44:47], v[16:19], v[188:203]
    ds_read_b64_tr_b16 v[40:41], v4 offset:18816
    ds_read_b64_tr_b16 v[42:43], v4 offset:23424
    v_mfma_f32_32x32x16_bf16 v[60:75], v[48:51], v[20:23], v[60:75]
    ds_read_b64_tr_b16 v[44:45], v5 offset:18880
    ds_read_b64_tr_b16 v[46:47], v5 offset:23488
    s_waitcnt lgkmcnt(10)
    v_mfma_f32_32x32x16_bf16 v[76:91], v[52:55], v[20:23], v[76:91]
    ds_read_b64_tr_b16 v[48:49], v4 offset:18944
    ds_read_b64_tr_b16 v[50:51], v4 offset:23552
    v_mfma_f32_32x32x16_bf16 v[92:107], v[56:59], v[20:23], v[92:107]
    v_add_u32 v4, 110592, v2
    v_add_u32 v5, 110592, v3
    ds_read_b128 v[24:27], v7 offset:12288
    ds_read_b64_tr_b16 v[52:53], v4 offset:0
    ds_read_b64_tr_b16 v[54:55], v4 offset:4608
    s_waitcnt lgkmcnt(11)
    v_mfma_f32_32x32x16_bf16 v[108:123], v[28:31], v[20:23], v[108:123]
    ds_read_b64_tr_b16 v[56:57], v5 offset:64
    ds_read_b64_tr_b16 v[58:59], v5 offset:4672
    v_mfma_f32_32x32x16_bf16 v[124:139], v[32:35], v[20:23], v[124:139]
    ds_read_b64_tr_b16 v[28:29], v4 offset:128
    ds_read_b64_tr_b16 v[30:31], v4 offset:4736
    s_waitcnt lgkmcnt(11)
    v_mfma_f32_32x32x16_bf16 v[140:155], v[36:39], v[20:23], v[140:155]
    ds_read_b64_tr_b16 v[32:33], v5 offset:192
    ds_read_b64_tr_b16 v[34:35], v5 offset:4800
    v_mfma_f32_32x32x16_bf16 v[156:171], v[40:43], v[20:23], v[156:171]
    ds_read_b64_tr_b16 v[36:37], v4 offset:256
    ds_read_b64_tr_b16 v[38:39], v4 offset:4864
    s_waitcnt lgkmcnt(11)
    v_mfma_f32_32x32x16_bf16 v[172:187], v[44:47], v[20:23], v[172:187]
    ds_read_b64_tr_b16 v[40:41], v5 offset:320
    ds_read_b64_tr_b16 v[42:43], v5 offset:4928
    v_mfma_f32_32x32x16_bf16 v[188:203], v[48:51], v[20:23], v[188:203]
    ds_read_b64_tr_b16 v[44:45], v4 offset:384
    ds_read_b64_tr_b16 v[46:47], v4 offset:4992
    s_waitcnt lgkmcnt(10)
    v_mfma_f32_32x32x16_bf16 v[60:75], v[52:55], v[24:27], v[60:75]
    ds_read_b64_tr_b16 v[48:49], v5 offset:448
    ds_read_b64_tr_b16 v[50:51], v5 offset:5056
    v_mfma_f32_32x32x16_bf16 v[76:91], v[56:59], v[24:27], v[76:91]
    ds_read_b64_tr_b16 v[52:53], v4 offset:512
    ds_read_b64_tr_b16 v[54:55], v4 offset:5120
    s_waitcnt lgkmcnt(10)
    v_mfma_f32_32x32x16_bf16 v[92:107], v[28:31], v[24:27], v[92:107]
    ds_read_b128 v[16:19], v7 offset:14336
    ds_read_b64_tr_b16 v[56:57], v4 offset:18432
    ds_read_b64_tr_b16 v[58:59], v4 offset:23040
    v_mfma_f32_32x32x16_bf16 v[108:123], v[32:35], v[24:27], v[108:123]
    ds_read_b64_tr_b16 v[28:29], v5 offset:18496
    ds_read_b64_tr_b16 v[30:31], v5 offset:23104
    s_waitcnt lgkmcnt(11)
    v_mfma_f32_32x32x16_bf16 v[124:139], v[36:39], v[24:27], v[124:139]
    ds_read_b64_tr_b16 v[32:33], v4 offset:18560
    ds_read_b64_tr_b16 v[34:35], v4 offset:23168
    v_mfma_f32_32x32x16_bf16 v[140:155], v[40:43], v[24:27], v[140:155]
    ds_read_b64_tr_b16 v[36:37], v5 offset:18624
    ds_read_b64_tr_b16 v[38:39], v5 offset:23232
    s_waitcnt lgkmcnt(11)
    v_mfma_f32_32x32x16_bf16 v[156:171], v[44:47], v[24:27], v[156:171]
    ds_read_b64_tr_b16 v[40:41], v4 offset:18688
    ds_read_b64_tr_b16 v[42:43], v4 offset:23296
    v_mfma_f32_32x32x16_bf16 v[172:187], v[48:51], v[24:27], v[172:187]
    s_barrier
    ds_read_b64_tr_b16 v[44:45], v5 offset:18752
    ds_read_b64_tr_b16 v[46:47], v5 offset:23360
    s_waitcnt lgkmcnt(10)
    v_mfma_f32_32x32x16_bf16 v[188:203], v[52:55], v[24:27], v[188:203]
    ds_read_b64_tr_b16 v[48:49], v4 offset:18816
    ds_read_b64_tr_b16 v[50:51], v4 offset:23424
    v_mfma_f32_32x32x16_bf16 v[60:75], v[56:59], v[16:19], v[60:75]
    ds_read_b64_tr_b16 v[52:53], v5 offset:18880
    ds_read_b64_tr_b16 v[54:55], v5 offset:23488
    s_waitcnt lgkmcnt(10)
    v_mfma_f32_32x32x16_bf16 v[76:91], v[28:31], v[16:19], v[76:91]
    ds_read_b64_tr_b16 v[56:57], v4 offset:18944
    ds_read_b64_tr_b16 v[58:59], v4 offset:23552
    v_mfma_f32_32x32x16_bf16 v[92:107], v[32:35], v[16:19], v[92:107]
    v_add_u32 v4, 0, v2
    v_add_u32 v5, 0, v3
    ds_read_b128 v[20:23], v7 offset:0
    ds_read_b64_tr_b16 v[28:29], v4 offset:0
    ds_read_b64_tr_b16 v[30:31], v4 offset:4608
    s_waitcnt lgkmcnt(11)
    v_mfma_f32_32x32x16_bf16 v[108:123], v[36:39], v[16:19], v[108:123]
    ds_read_b64_tr_b16 v[32:33], v5 offset:64
    ds_read_b64_tr_b16 v[34:35], v5 offset:4672
    v_mfma_f32_32x32x16_bf16 v[124:139], v[40:43], v[16:19], v[124:139]
    ds_read_b64_tr_b16 v[36:37], v4 offset:128
    ds_read_b64_tr_b16 v[38:39], v4 offset:4736
    s_waitcnt lgkmcnt(11)
    v_mfma_f32_32x32x16_bf16 v[140:155], v[44:47], v[16:19], v[140:155]
    ds_read_b64_tr_b16 v[40:41], v5 offset:192
    ds_read_b64_tr_b16 v[42:43], v5 offset:4800
    v_mfma_f32_32x32x16_bf16 v[156:171], v[48:51], v[16:19], v[156:171]
    ds_read_b64_tr_b16 v[44:45], v4 offset:256
    ds_read_b64_tr_b16 v[46:47], v4 offset:4864
    s_waitcnt lgkmcnt(11)
    v_mfma_f32_32x32x16_bf16 v[172:187], v[52:55], v[16:19], v[172:187]
    ds_read_b64_tr_b16 v[48:49], v5 offset:320
    ds_read_b64_tr_b16 v[50:51], v5 offset:4928
    v_mfma_f32_32x32x16_bf16 v[188:203], v[56:59], v[16:19], v[188:203]
    ds_read_b64_tr_b16 v[52:53], v4 offset:384
    ds_read_b64_tr_b16 v[54:55], v4 offset:4992
    s_waitcnt lgkmcnt(10)
    v_mfma_f32_32x32x16_bf16 v[60:75], v[28:31], v[20:23], v[60:75]
    ds_read_b64_tr_b16 v[56:57], v5 offset:448
    ds_read_b64_tr_b16 v[58:59], v5 offset:5056
    v_mfma_f32_32x32x16_bf16 v[76:91], v[32:35], v[20:23], v[76:91]
    ds_read_b64_tr_b16 v[28:29], v4 offset:512
    ds_read_b64_tr_b16 v[30:31], v4 offset:5120
    s_waitcnt lgkmcnt(10)
    v_mfma_f32_32x32x16_bf16 v[92:107], v[36:39], v[20:23], v[92:107]
    ds_read_b128 v[24:27], v7 offset:2048
    ds_read_b64_tr_b16 v[32:33], v4 offset:18432
    ds_read_b64_tr_b16 v[34:35], v4 offset:23040
    v_mfma_f32_32x32x16_bf16 v[108:123], v[40:43], v[20:23], v[108:123]
    ds_read_b64_tr_b16 v[36:37], v5 offset:18496
    ds_read_b64_tr_b16 v[38:39], v5 offset:23104
    s_waitcnt lgkmcnt(11)
    v_mfma_f32_32x32x16_bf16 v[124:139], v[44:47], v[20:23], v[124:139]
    ds_read_b64_tr_b16 v[40:41], v4 offset:18560
    ds_read_b64_tr_b16 v[42:43], v4 offset:23168
    v_mfma_f32_32x32x16_bf16 v[140:155], v[48:51], v[20:23], v[140:155]
    ds_read_b64_tr_b16 v[44:45], v5 offset:18624
    ds_read_b64_tr_b16 v[46:47], v5 offset:23232
    s_waitcnt lgkmcnt(11)
    v_mfma_f32_32x32x16_bf16 v[156:171], v[52:55], v[20:23], v[156:171]
    ds_read_b64_tr_b16 v[48:49], v4 offset:18688
    ds_read_b64_tr_b16 v[50:51], v4 offset:23296
    v_mfma_f32_32x32x16_bf16 v[172:187], v[56:59], v[20:23], v[172:187]
    s_barrier
    ds_read_b64_tr_b16 v[52:53], v5 offset:18752
    ds_read_b64_tr_b16 v[54:55], v5 offset:23360
    s_waitcnt lgkmcnt(10)
    v_mfma_f32_32x32x16_bf16 v[188:203], v[28:31], v[20:23], v[188:203]
    ds_read_b64_tr_b16 v[56:57], v4 offset:18816
    ds_read_b64_tr_b16 v[58:59], v4 offset:23424
    v_mfma_f32_32x32x16_bf16 v[60:75], v[32:35], v[24:27], v[60:75]
    ds_read_b64_tr_b16 v[28:29], v5 offset:18880
    ds_read_b64_tr_b16 v[30:31], v5 offset:23488
    s_waitcnt lgkmcnt(10)
    v_mfma_f32_32x32x16_bf16 v[76:91], v[36:39], v[24:27], v[76:91]
    ds_read_b64_tr_b16 v[32:33], v4 offset:18944
    ds_read_b64_tr_b16 v[34:35], v4 offset:23552
    v_mfma_f32_32x32x16_bf16 v[92:107], v[40:43], v[24:27], v[92:107]
    v_add_u32 v4, 36864, v2
    v_add_u32 v5, 36864, v3
    ds_read_b128 v[16:19], v7 offset:4096
    ds_read_b64_tr_b16 v[36:37], v4 offset:0
    ds_read_b64_tr_b16 v[38:39], v4 offset:4608
    s_waitcnt lgkmcnt(11)
    v_mfma_f32_32x32x16_bf16 v[108:123], v[44:47], v[24:27], v[108:123]
    ds_read_b64_tr_b16 v[40:41], v5 offset:64
    ds_read_b64_tr_b16 v[42:43], v5 offset:4672
    v_mfma_f32_32x32x16_bf16 v[124:139], v[48:51], v[24:27], v[124:139]
    ds_read_b64_tr_b16 v[44:45], v4 offset:128
    ds_read_b64_tr_b16 v[46:47], v4 offset:4736
    s_waitcnt lgkmcnt(11)
    v_mfma_f32_32x32x16_bf16 v[140:155], v[52:55], v[24:27], v[140:155]
    ds_read_b64_tr_b16 v[48:49], v5 offset:192
    ds_read_b64_tr_b16 v[50:51], v5 offset:4800
    v_mfma_f32_32x32x16_bf16 v[156:171], v[56:59], v[24:27], v[156:171]
    ds_read_b64_tr_b16 v[52:53], v4 offset:256
    ds_read_b64_tr_b16 v[54:55], v4 offset:4864
    s_waitcnt lgkmcnt(11)
    v_mfma_f32_32x32x16_bf16 v[172:187], v[28:31], v[24:27], v[172:187]
    ds_read_b64_tr_b16 v[56:57], v5 offset:320
    ds_read_b64_tr_b16 v[58:59], v5 offset:4928
    v_mfma_f32_32x32x16_bf16 v[188:203], v[32:35], v[24:27], v[188:203]
    ds_read_b64_tr_b16 v[28:29], v4 offset:384
    ds_read_b64_tr_b16 v[30:31], v4 offset:4992
    s_waitcnt lgkmcnt(10)
    v_mfma_f32_32x32x16_bf16 v[60:75], v[36:39], v[16:19], v[60:75]
    ds_read_b64_tr_b16 v[32:33], v5 offset:448
    ds_read_b64_tr_b16 v[34:35], v5 offset:5056
    v_mfma_f32_32x32x16_bf16 v[76:91], v[40:43], v[16:19], v[76:91]
    ds_read_b64_tr_b16 v[36:37], v4 offset:512
    ds_read_b64_tr_b16 v[38:39], v4 offset:5120
    s_waitcnt lgkmcnt(10)
    v_mfma_f32_32x32x16_bf16 v[92:107], v[44:47], v[16:19], v[92:107]
    ds_read_b128 v[20:23], v7 offset:6144
    ds_read_b64_tr_b16 v[40:41], v4 offset:18432
    ds_read_b64_tr_b16 v[42:43], v4 offset:23040
    v_mfma_f32_32x32x16_bf16 v[108:123], v[48:51], v[16:19], v[108:123]
    ds_read_b64_tr_b16 v[44:45], v5 offset:18496
    ds_read_b64_tr_b16 v[46:47], v5 offset:23104
    s_waitcnt lgkmcnt(11)
    v_mfma_f32_32x32x16_bf16 v[124:139], v[52:55], v[16:19], v[124:139]
    ds_read_b64_tr_b16 v[48:49], v4 offset:18560
    ds_read_b64_tr_b16 v[50:51], v4 offset:23168
    v_mfma_f32_32x32x16_bf16 v[140:155], v[56:59], v[16:19], v[140:155]
    ds_read_b64_tr_b16 v[52:53], v5 offset:18624
    ds_read_b64_tr_b16 v[54:55], v5 offset:23232
    s_waitcnt lgkmcnt(11)
    v_mfma_f32_32x32x16_bf16 v[156:171], v[28:31], v[16:19], v[156:171]
    ds_read_b64_tr_b16 v[56:57], v4 offset:18688
    ds_read_b64_tr_b16 v[58:59], v4 offset:23296
    v_mfma_f32_32x32x16_bf16 v[172:187], v[32:35], v[16:19], v[172:187]
    s_barrier
    ds_read_b64_tr_b16 v[28:29], v5 offset:18752
    ds_read_b64_tr_b16 v[30:31], v5 offset:23360
    s_waitcnt lgkmcnt(10)
    v_mfma_f32_32x32x16_bf16 v[188:203], v[36:39], v[16:19], v[188:203]
    ds_read_b64_tr_b16 v[32:33], v4 offset:18816
    ds_read_b64_tr_b16 v[34:35], v4 offset:23424
    v_mfma_f32_32x32x16_bf16 v[60:75], v[40:43], v[20:23], v[60:75]
    ds_read_b64_tr_b16 v[36:37], v5 offset:18880
    ds_read_b64_tr_b16 v[38:39], v5 offset:23488
    s_waitcnt lgkmcnt(10)
    v_mfma_f32_32x32x16_bf16 v[76:91], v[44:47], v[20:23], v[76:91]
    ds_read_b64_tr_b16 v[40:41], v4 offset:18944
    ds_read_b64_tr_b16 v[42:43], v4 offset:23552
    v_mfma_f32_32x32x16_bf16 v[92:107], v[48:51], v[20:23], v[92:107]
    v_add_u32 v4, 73728, v2
    v_add_u32 v5, 73728, v3
    ds_read_b128 v[24:27], v7 offset:8192
    ds_read_b64_tr_b16 v[44:45], v4 offset:0
    ds_read_b64_tr_b16 v[46:47], v4 offset:4608
    s_waitcnt lgkmcnt(11)
    v_mfma_f32_32x32x16_bf16 v[108:123], v[52:55], v[20:23], v[108:123]
    ds_read_b64_tr_b16 v[48:49], v5 offset:64
    ds_read_b64_tr_b16 v[50:51], v5 offset:4672
    v_mfma_f32_32x32x16_bf16 v[124:139], v[56:59], v[20:23], v[124:139]
    ds_read_b64_tr_b16 v[52:53], v4 offset:128
    ds_read_b64_tr_b16 v[54:55], v4 offset:4736
    s_waitcnt lgkmcnt(11)
    v_mfma_f32_32x32x16_bf16 v[140:155], v[28:31], v[20:23], v[140:155]
    ds_read_b64_tr_b16 v[56:57], v5 offset:192
    ds_read_b64_tr_b16 v[58:59], v5 offset:4800
    v_mfma_f32_32x32x16_bf16 v[156:171], v[32:35], v[20:23], v[156:171]
    ds_read_b64_tr_b16 v[28:29], v4 offset:256
    ds_read_b64_tr_b16 v[30:31], v4 offset:4864
    s_waitcnt lgkmcnt(11)
    v_mfma_f32_32x32x16_bf16 v[172:187], v[36:39], v[20:23], v[172:187]
    ds_read_b64_tr_b16 v[32:33], v5 offset:320
    ds_read_b64_tr_b16 v[34:35], v5 offset:4928
    v_mfma_f32_32x32x16_bf16 v[188:203], v[40:43], v[20:23], v[188:203]
    ds_read_b64_tr_b16 v[36:37], v4 offset:384
    ds_read_b64_tr_b16 v[38:39], v4 offset:4992
    s_waitcnt lgkmcnt(10)
    v_mfma_f32_32x32x16_bf16 v[60:75], v[44:47], v[24:27], v[60:75]
    ds_read_b64_tr_b16 v[40:41], v5 offset:448
    ds_read_b64_tr_b16 v[42:43], v5 offset:5056
    v_mfma_f32_32x32x16_bf16 v[76:91], v[48:51], v[24:27], v[76:91]
    ds_read_b64_tr_b16 v[44:45], v4 offset:512
    ds_read_b64_tr_b16 v[46:47], v4 offset:5120
    s_waitcnt lgkmcnt(10)
    v_mfma_f32_32x32x16_bf16 v[92:107], v[52:55], v[24:27], v[92:107]
    ds_read_b128 v[16:19], v7 offset:10240
    ds_read_b64_tr_b16 v[48:49], v4 offset:18432
    ds_read_b64_tr_b16 v[50:51], v4 offset:23040
    v_mfma_f32_32x32x16_bf16 v[108:123], v[56:59], v[24:27], v[108:123]
    ds_read_b64_tr_b16 v[52:53], v5 offset:18496
    ds_read_b64_tr_b16 v[54:55], v5 offset:23104
    s_waitcnt lgkmcnt(11)
    v_mfma_f32_32x32x16_bf16 v[124:139], v[28:31], v[24:27], v[124:139]
    ds_read_b64_tr_b16 v[56:57], v4 offset:18560
    ds_read_b64_tr_b16 v[58:59], v4 offset:23168
    v_mfma_f32_32x32x16_bf16 v[140:155], v[32:35], v[24:27], v[140:155]
    ds_read_b64_tr_b16 v[28:29], v5 offset:18624
    ds_read_b64_tr_b16 v[30:31], v5 offset:23232
    s_waitcnt lgkmcnt(11)
    v_mfma_f32_32x32x16_bf16 v[156:171], v[36:39], v[24:27], v[156:171]
    ds_read_b64_tr_b16 v[32:33], v4 offset:18688
    ds_read_b64_tr_b16 v[34:35], v4 offset:23296
    v_mfma_f32_32x32x16_bf16 v[172:187], v[40:43], v[24:27], v[172:187]
    s_barrier
    ds_read_b64_tr_b16 v[36:37], v5 offset:18752
    ds_read_b64_tr_b16 v[38:39], v5 offset:23360
    s_waitcnt lgkmcnt(10)
    v_mfma_f32_32x32x16_bf16 v[188:203], v[44:47], v[24:27], v[188:203]
    ds_read_b64_tr_b16 v[40:41], v4 offset:18816
    ds_read_b64_tr_b16 v[42:43], v4 offset:23424
    v_mfma_f32_32x32x16_bf16 v[60:75], v[48:51], v[16:19], v[60:75]
    ds_read_b64_tr_b16 v[44:45], v5 offset:18880
    ds_read_b64_tr_b16 v[46:47], v5 offset:23488
    s_waitcnt lgkmcnt(10)
    v_mfma_f32_32x32x16_bf16 v[76:91], v[52:55], v[16:19], v[76:91]
    ds_read_b64_tr_b16 v[48:49], v4 offset:18944
    ds_read_b64_tr_b16 v[50:51], v4 offset:23552
    v_mfma_f32_32x32x16_bf16 v[92:107], v[56:59], v[16:19], v[92:107]
    v_add_u32 v4, 110592, v2
    v_add_u32 v5, 110592, v3
    ds_read_b128 v[20:23], v7 offset:12288
    ds_read_b64_tr_b16 v[52:53], v4 offset:0
    ds_read_b64_tr_b16 v[54:55], v4 offset:4608
    s_waitcnt lgkmcnt(11)
    v_mfma_f32_32x32x16_bf16 v[108:123], v[28:31], v[16:19], v[108:123]
    ds_read_b64_tr_b16 v[56:57], v5 offset:64
    ds_read_b64_tr_b16 v[58:59], v5 offset:4672
    v_mfma_f32_32x32x16_bf16 v[124:139], v[32:35], v[16:19], v[124:139]
    ds_read_b64_tr_b16 v[28:29], v4 offset:128
    ds_read_b64_tr_b16 v[30:31], v4 offset:4736
    s_waitcnt lgkmcnt(11)
    v_mfma_f32_32x32x16_bf16 v[140:155], v[36:39], v[16:19], v[140:155]
    ds_read_b64_tr_b16 v[32:33], v5 offset:192
    ds_read_b64_tr_b16 v[34:35], v5 offset:4800
    v_mfma_f32_32x32x16_bf16 v[156:171], v[40:43], v[16:19], v[156:171]
    ds_read_b64_tr_b16 v[36:37], v4 offset:256
    ds_read_b64_tr_b16 v[38:39], v4 offset:4864
    s_waitcnt lgkmcnt(11)
    v_mfma_f32_32x32x16_bf16 v[172:187], v[44:47], v[16:19], v[172:187]
    ds_read_b64_tr_b16 v[40:41], v5 offset:320
    ds_read_b64_tr_b16 v[42:43], v5 offset:4928
    v_mfma_f32_32x32x16_bf16 v[188:203], v[48:51], v[16:19], v[188:203]
    ds_read_b64_tr_b16 v[44:45], v4 offset:384
    ds_read_b64_tr_b16 v[46:47], v4 offset:4992
    s_waitcnt lgkmcnt(10)
    v_mfma_f32_32x32x16_bf16 v[60:75], v[52:55], v[20:23], v[60:75]
    ds_read_b64_tr_b16 v[48:49], v5 offset:448
    ds_read_b64_tr_b16 v[50:51], v5 offset:5056
    v_mfma_f32_32x32x16_bf16 v[76:91], v[56:59], v[20:23], v[76:91]
    ds_read_b64_tr_b16 v[52:53], v4 offset:512
    ds_read_b64_tr_b16 v[54:55], v4 offset:5120
    s_waitcnt lgkmcnt(10)
    v_mfma_f32_32x32x16_bf16 v[92:107], v[28:31], v[20:23], v[92:107]
    ds_read_b128 v[24:27], v7 offset:14336
    ds_read_b64_tr_b16 v[56:57], v4 offset:18432
    ds_read_b64_tr_b16 v[58:59], v4 offset:23040
    v_mfma_f32_32x32x16_bf16 v[108:123], v[32:35], v[20:23], v[108:123]
    ds_read_b64_tr_b16 v[28:29], v5 offset:18496
    ds_read_b64_tr_b16 v[30:31], v5 offset:23104
    s_waitcnt lgkmcnt(11)
    v_mfma_f32_32x32x16_bf16 v[124:139], v[36:39], v[20:23], v[124:139]
    ds_read_b64_tr_b16 v[32:33], v4 offset:18560
    ds_read_b64_tr_b16 v[34:35], v4 offset:23168
    v_mfma_f32_32x32x16_bf16 v[140:155], v[40:43], v[20:23], v[140:155]
    ds_read_b64_tr_b16 v[36:37], v5 offset:18624
    ds_read_b64_tr_b16 v[38:39], v5 offset:23232
    s_waitcnt lgkmcnt(11)
    v_mfma_f32_32x32x16_bf16 v[156:171], v[44:47], v[20:23], v[156:171]
    ds_read_b64_tr_b16 v[40:41], v4 offset:18688
    ds_read_b64_tr_b16 v[42:43], v4 offset:23296
    v_mfma_f32_32x32x16_bf16 v[172:187], v[48:51], v[20:23], v[172:187]
    s_barrier
    ds_read_b64_tr_b16 v[44:45], v5 offset:18752
    ds_read_b64_tr_b16 v[46:47], v5 offset:23360
    s_waitcnt lgkmcnt(10)
    v_mfma_f32_32x32x16_bf16 v[188:203], v[52:55], v[20:23], v[188:203]
    ds_read_b64_tr_b16 v[48:49], v4 offset:18816
    ds_read_b64_tr_b16 v[50:51], v4 offset:23424
    v_mfma_f32_32x32x16_bf16 v[60:75], v[56:59], v[24:27], v[60:75]
    ds_read_b64_tr_b16 v[52:53], v5 offset:18880
    ds_read_b64_tr_b16 v[54:55], v5 offset:23488
    s_waitcnt lgkmcnt(10)
    v_mfma_f32_32x32x16_bf16 v[76:91], v[28:31], v[24:27], v[76:91]
    ds_read_b64_tr_b16 v[56:57], v4 offset:18944
    ds_read_b64_tr_b16 v[58:59], v4 offset:23552
    v_mfma_f32_32x32x16_bf16 v[92:107], v[32:35], v[24:27], v[92:107]
    v_add_u32 v4, 0, v2
    v_add_u32 v5, 0, v3
    ds_read_b128 v[16:19], v7 offset:0
    ds_read_b64_tr_b16 v[28:29], v4 offset:0
    ds_read_b64_tr_b16 v[30:31], v4 offset:4608
    s_waitcnt lgkmcnt(11)
    v_mfma_f32_32x32x16_bf16 v[108:123], v[36:39], v[24:27], v[108:123]
    ds_read_b64_tr_b16 v[32:33], v5 offset:64
    ds_read_b64_tr_b16 v[34:35], v5 offset:4672
    v_mfma_f32_32x32x16_bf16 v[124:139], v[40:43], v[24:27], v[124:139]
    ds_read_b64_tr_b16 v[36:37], v4 offset:128
    ds_read_b64_tr_b16 v[38:39], v4 offset:4736
    s_waitcnt lgkmcnt(11)
    v_mfma_f32_32x32x16_bf16 v[140:155], v[44:47], v[24:27], v[140:155]
    ds_read_b64_tr_b16 v[40:41], v5 offset:192
    ds_read_b64_tr_b16 v[42:43], v5 offset:4800
    v_mfma_f32_32x32x16_bf16 v[156:171], v[48:51], v[24:27], v[156:171]
    ds_read_b64_tr_b16 v[44:45], v4 offset:256
    ds_read_b64_tr_b16 v[46:47], v4 offset:4864
    s_waitcnt lgkmcnt(11)
    v_mfma_f32_32x32x16_bf16 v[172:187], v[52:55], v[24:27], v[172:187]
    ds_read_b64_tr_b16 v[48:49], v5 offset:320
    ds_read_b64_tr_b16 v[50:51], v5 offset:4928
    v_mfma_f32_32x32x16_bf16 v[188:203], v[56:59], v[24:27], v[188:203]
    ds_read_b64_tr_b16 v[52:53], v4 offset:384
    ds_read_b64_tr_b16 v[54:55], v4 offset:4992
    s_waitcnt lgkmcnt(10)
    v_mfma_f32_32x32x16_bf16 v[60:75], v[28:31], v[16:19], v[60:75]
    ds_read_b64_tr_b16 v[56:57], v5 offset:448
    ds_read_b64_tr_b16 v[58:59], v5 offset:5056
    v_mfma_f32_32x32x16_bf16 v[76:91], v[32:35], v[16:19], v[76:91]
    ds_read_b64_tr_b16 v[28:29], v4 offset:512
    ds_read_b64_tr_b16 v[30:31], v4 offset:5120
    s_waitcnt lgkmcnt(10)
    v_mfma_f32_32x32x16_bf16 v[92:107], v[36:39], v[16:19], v[92:107]
    ds_read_b128 v[20:23], v7 offset:2048
    ds_read_b64_tr_b16 v[32:33], v4 offset:18432
    ds_read_b64_tr_b16 v[34:35], v4 offset:23040
    v_mfma_f32_32x32x16_bf16 v[108:123], v[40:43], v[16:19], v[108:123]
    ds_read_b64_tr_b16 v[36:37], v5 offset:18496
    ds_read_b64_tr_b16 v[38:39], v5 offset:23104
    s_waitcnt lgkmcnt(11)
    v_mfma_f32_32x32x16_bf16 v[124:139], v[44:47], v[16:19], v[124:139]
    ds_read_b64_tr_b16 v[40:41], v4 offset:18560
    ds_read_b64_tr_b16 v[42:43], v4 offset:23168
    v_mfma_f32_32x32x16_bf16 v[140:155], v[48:51], v[16:19], v[140:155]
    ds_read_b64_tr_b16 v[44:45], v5 offset:18624
    ds_read_b64_tr_b16 v[46:47], v5 offset:23232
    s_waitcnt lgkmcnt(11)
    v_mfma_f32_32x32x16_bf16 v[156:171], v[52:55], v[16:19], v[156:171]
    ds_read_b64_tr_b16 v[48:49], v4 offset:18688
    ds_read_b64_tr_b16 v[50:51], v4 offset:23296
    v_mfma_f32_32x32x16_bf16 v[172:187], v[56:59], v[16:19], v[172:187]
    s_barrier
    ds_read_b64_tr_b16 v[52:53], v5 offset:18752
    ds_read_b64_tr_b16 v[54:55], v5 offset:23360
    s_waitcnt lgkmcnt(10)
    v_mfma_f32_32x32x16_bf16 v[188:203], v[28:31], v[16:19], v[188:203]
    ds_read_b64_tr_b16 v[56:57], v4 offset:18816
    ds_read_b64_tr_b16 v[58:59], v4 offset:23424
    v_mfma_f32_32x32x16_bf16 v[60:75], v[32:35], v[20:23], v[60:75]
    ds_read_b64_tr_b16 v[28:29], v5 offset:18880
    ds_read_b64_tr_b16 v[30:31], v5 offset:23488
    s_waitcnt lgkmcnt(10)
    v_mfma_f32_32x32x16_bf16 v[76:91], v[36:39], v[20:23], v[76:91]
    ds_read_b64_tr_b16 v[32:33], v4 offset:18944
    ds_read_b64_tr_b16 v[34:35], v4 offset:23552
    v_mfma_f32_32x32x16_bf16 v[92:107], v[40:43], v[20:23], v[92:107]
    v_add_u32 v4, 36864, v2
    v_add_u32 v5, 36864, v3
    ds_read_b128 v[24:27], v7 offset:4096
    ds_read_b64_tr_b16 v[36:37], v4 offset:0
    ds_read_b64_tr_b16 v[38:39], v4 offset:4608
    s_waitcnt lgkmcnt(11)
    v_mfma_f32_32x32x16_bf16 v[108:123], v[44:47], v[20:23], v[108:123]
    ds_read_b64_tr_b16 v[40:41], v5 offset:64
    ds_read_b64_tr_b16 v[42:43], v5 offset:4672
    v_mfma_f32_32x32x16_bf16 v[124:139], v[48:51], v[20:23], v[124:139]
    ds_read_b64_tr_b16 v[44:45], v4 offset:128
    ds_read_b64_tr_b16 v[46:47], v4 offset:4736
    s_waitcnt lgkmcnt(11)
    v_mfma_f32_32x32x16_bf16 v[140:155], v[52:55], v[20:23], v[140:155]
    ds_read_b64_tr_b16 v[48:49], v5 offset:192
    ds_read_b64_tr_b16 v[50:51], v5 offset:4800
    v_mfma_f32_32x32x16_bf16 v[156:171], v[56:59], v[20:23], v[156:171]
    ds_read_b64_tr_b16 v[52:53], v4 offset:256
    ds_read_b64_tr_b16 v[54:55], v4 offset:4864
    s_waitcnt lgkmcnt(11)
    v_mfma_f32_32x32x16_bf16 v[172:187], v[28:31], v[20:23], v[172:187]
    ds_read_b64_tr_b16 v[56:57], v5 offset:320
    ds_read_b64_tr_b16 v[58:59], v5 offset:4928
    v_mfma_f32_32x32x16_bf16 v[188:203], v[32:35], v[20:23], v[188:203]
    ds_read_b64_tr_b16 v[28:29], v4 offset:384
    ds_read_b64_tr_b16 v[30:31], v4 offset:4992
    s_waitcnt lgkmcnt(10)
    v_mfma_f32_32x32x16_bf16 v[60:75], v[36:39], v[24:27], v[60:75]
    ds_read_b64_tr_b16 v[32:33], v5 offset:448
    ds_read_b64_tr_b16 v[34:35], v5 offset:5056
    v_mfma_f32_32x32x16_bf16 v[76:91], v[40:43], v[24:27], v[76:91]
    ds_read_b64_tr_b16 v[36:37], v4 offset:512
    ds_read_b64_tr_b16 v[38:39], v4 offset:5120
    s_waitcnt lgkmcnt(10)
    v_mfma_f32_32x32x16_bf16 v[92:107], v[44:47], v[24:27], v[92:107]
    ds_read_b128 v[16:19], v7 offset:6144
    ds_read_b64_tr_b16 v[40:41], v4 offset:18432
    ds_read_b64_tr_b16 v[42:43], v4 offset:23040
    v_mfma_f32_32x32x16_bf16 v[108:123], v[48:51], v[24:27], v[108:123]
    ds_read_b64_tr_b16 v[44:45], v5 offset:18496
    ds_read_b64_tr_b16 v[46:47], v5 offset:23104
    s_waitcnt lgkmcnt(11)
    v_mfma_f32_32x32x16_bf16 v[124:139], v[52:55], v[24:27], v[124:139]
    ds_read_b64_tr_b16 v[48:49], v4 offset:18560
    ds_read_b64_tr_b16 v[50:51], v4 offset:23168
    v_mfma_f32_32x32x16_bf16 v[140:155], v[56:59], v[24:27], v[140:155]
    ds_read_b64_tr_b16 v[52:53], v5 offset:18624
    ds_read_b64_tr_b16 v[54:55], v5 offset:23232
    s_waitcnt lgkmcnt(11)
    v_mfma_f32_32x32x16_bf16 v[156:171], v[28:31], v[24:27], v[156:171]
    ds_read_b64_tr_b16 v[56:57], v4 offset:18688
    ds_read_b64_tr_b16 v[58:59], v4 offset:23296
    v_mfma_f32_32x32x16_bf16 v[172:187], v[32:35], v[24:27], v[172:187]
    s_barrier
    ds_read_b64_tr_b16 v[28:29], v5 offset:18752
    ds_read_b64_tr_b16 v[30:31], v5 offset:23360
    s_waitcnt lgkmcnt(10)
    v_mfma_f32_32x32x16_bf16 v[188:203], v[36:39], v[24:27], v[188:203]
    ds_read_b64_tr_b16 v[32:33], v4 offset:18816
    ds_read_b64_tr_b16 v[34:35], v4 offset:23424
    v_mfma_f32_32x32x16_bf16 v[60:75], v[40:43], v[16:19], v[60:75]
    ds_read_b64_tr_b16 v[36:37], v5 offset:18880
    ds_read_b64_tr_b16 v[38:39], v5 offset:23488
    s_waitcnt lgkmcnt(10)
    v_mfma_f32_32x32x16_bf16 v[76:91], v[44:47], v[16:19], v[76:91]
    ds_read_b64_tr_b16 v[40:41], v4 offset:18944
    ds_read_b64_tr_b16 v[42:43], v4 offset:23552
    v_mfma_f32_32x32x16_bf16 v[92:107], v[48:51], v[16:19], v[92:107]
    v_add_u32 v4, 73728, v2
    v_add_u32 v5, 73728, v3
    ds_read_b128 v[20:23], v7 offset:8192
    ds_read_b64_tr_b16 v[44:45], v4 offset:0
    ds_read_b64_tr_b16 v[46:47], v4 offset:4608
    s_waitcnt lgkmcnt(11)
    v_mfma_f32_32x32x16_bf16 v[108:123], v[52:55], v[16:19], v[108:123]
    ds_read_b64_tr_b16 v[48:49], v5 offset:64
    ds_read_b64_tr_b16 v[50:51], v5 offset:4672
    v_mfma_f32_32x32x16_bf16 v[124:139], v[56:59], v[16:19], v[124:139]
    ds_read_b64_tr_b16 v[52:53], v4 offset:128
    ds_read_b64_tr_b16 v[54:55], v4 offset:4736
    s_waitcnt lgkmcnt(11)
    v_mfma_f32_32x32x16_bf16 v[140:155], v[28:31], v[16:19], v[140:155]
    ds_read_b64_tr_b16 v[56:57], v5 offset:192
    ds_read_b64_tr_b16 v[58:59], v5 offset:4800
    v_mfma_f32_32x32x16_bf16 v[156:171], v[32:35], v[16:19], v[156:171]
    ds_read_b64_tr_b16 v[28:29], v4 offset:256
    ds_read_b64_tr_b16 v[30:31], v4 offset:4864
    s_waitcnt lgkmcnt(11)
    v_mfma_f32_32x32x16_bf16 v[172:187], v[36:39], v[16:19], v[172:187]
    ds_read_b64_tr_b16 v[32:33], v5 offset:320
    ds_read_b64_tr_b16 v[34:35], v5 offset:4928
    v_mfma_f32_32x32x16_bf16 v[188:203], v[40:43], v[16:19], v[188:203]
    ds_read_b64_tr_b16 v[36:37], v4 offset:384
    ds_read_b64_tr_b16 v[38:39], v4 offset:4992
    s_waitcnt lgkmcnt(10)
    v_mfma_f32_32x32x16_bf16 v[60:75], v[44:47], v[20:23], v[60:75]
    ds_read_b64_tr_b16 v[40:41], v5 offset:448
    ds_read_b64_tr_b16 v[42:43], v5 offset:5056
    v_mfma_f32_32x32x16_bf16 v[76:91], v[48:51], v[20:23], v[76:91]
    ds_read_b64_tr_b16 v[44:45], v4 offset:512
    ds_read_b64_tr_b16 v[46:47], v4 offset:5120
    s_waitcnt lgkmcnt(10)
    v_mfma_f32_32x32x16_bf16 v[92:107], v[52:55], v[20:23], v[92:107]
    ds_read_b128 v[24:27], v7 offset:10240
    ds_read_b64_tr_b16 v[48:49], v4 offset:18432
    ds_read_b64_tr_b16 v[50:51], v4 offset:23040
    v_mfma_f32_32x32x16_bf16 v[108:123], v[56:59], v[20:23], v[108:123]
    ds_read_b64_tr_b16 v[52:53], v5 offset:18496
    ds_read_b64_tr_b16 v[54:55], v5 offset:23104
    s_waitcnt lgkmcnt(11)
    v_mfma_f32_32x32x16_bf16 v[124:139], v[28:31], v[20:23], v[124:139]
    ds_read_b64_tr_b16 v[56:57], v4 offset:18560
    ds_read_b64_tr_b16 v[58:59], v4 offset:23168
    v_mfma_f32_32x32x16_bf16 v[140:155], v[32:35], v[20:23], v[140:155]
    ds_read_b64_tr_b16 v[28:29], v5 offset:18624
    ds_read_b64_tr_b16 v[30:31], v5 offset:23232
    s_waitcnt lgkmcnt(11)
    v_mfma_f32_32x32x16_bf16 v[156:171], v[36:39], v[20:23], v[156:171]
    ds_read_b64_tr_b16 v[32:33], v4 offset:18688
    ds_read_b64_tr_b16 v[34:35], v4 offset:23296
    v_mfma_f32_32x32x16_bf16 v[172:187], v[40:43], v[20:23], v[172:187]
    s_barrier
    ds_read_b64_tr_b16 v[36:37], v5 offset:18752
    ds_read_b64_tr_b16 v[38:39], v5 offset:23360
    s_waitcnt lgkmcnt(10)
    v_mfma_f32_32x32x16_bf16 v[188:203], v[44:47], v[20:23], v[188:203]
    ds_read_b64_tr_b16 v[40:41], v4 offset:18816
    ds_read_b64_tr_b16 v[42:43], v4 offset:23424
    v_mfma_f32_32x32x16_bf16 v[60:75], v[48:51], v[24:27], v[60:75]
    ds_read_b64_tr_b16 v[44:45], v5 offset:18880
    ds_read_b64_tr_b16 v[46:47], v5 offset:23488
    s_waitcnt lgkmcnt(10)
    v_mfma_f32_32x32x16_bf16 v[76:91], v[52:55], v[24:27], v[76:91]
    ds_read_b64_tr_b16 v[48:49], v4 offset:18944
    ds_read_b64_tr_b16 v[50:51], v4 offset:23552
    v_mfma_f32_32x32x16_bf16 v[92:107], v[56:59], v[24:27], v[92:107]
    v_add_u32 v4, 110592, v2
    v_add_u32 v5, 110592, v3
    ds_read_b128 v[16:19], v7 offset:12288
    ds_read_b64_tr_b16 v[52:53], v4 offset:0
    ds_read_b64_tr_b16 v[54:55], v4 offset:4608
    s_waitcnt lgkmcnt(11)
    v_mfma_f32_32x32x16_bf16 v[108:123], v[28:31], v[24:27], v[108:123]
    ds_read_b64_tr_b16 v[56:57], v5 offset:64
    ds_read_b64_tr_b16 v[58:59], v5 offset:4672
    v_mfma_f32_32x32x16_bf16 v[124:139], v[32:35], v[24:27], v[124:139]
    ds_read_b64_tr_b16 v[28:29], v4 offset:128
    ds_read_b64_tr_b16 v[30:31], v4 offset:4736
    s_waitcnt lgkmcnt(11)
    v_mfma_f32_32x32x16_bf16 v[140:155], v[36:39], v[24:27], v[140:155]
    ds_read_b64_tr_b16 v[32:33], v5 offset:192
    ds_read_b64_tr_b16 v[34:35], v5 offset:4800
    v_mfma_f32_32x32x16_bf16 v[156:171], v[40:43], v[24:27], v[156:171]
    ds_read_b64_tr_b16 v[36:37], v4 offset:256
    ds_read_b64_tr_b16 v[38:39], v4 offset:4864
    s_waitcnt lgkmcnt(11)
    v_mfma_f32_32x32x16_bf16 v[172:187], v[44:47], v[24:27], v[172:187]
    ds_read_b64_tr_b16 v[40:41], v5 offset:320
    ds_read_b64_tr_b16 v[42:43], v5 offset:4928
    v_mfma_f32_32x32x16_bf16 v[188:203], v[48:51], v[24:27], v[188:203]
    ds_read_b64_tr_b16 v[44:45], v4 offset:384
    ds_read_b64_tr_b16 v[46:47], v4 offset:4992
    s_waitcnt lgkmcnt(10)
    v_mfma_f32_32x32x16_bf16 v[60:75], v[52:55], v[16:19], v[60:75]
    ds_read_b64_tr_b16 v[48:49], v5 offset:448
    ds_read_b64_tr_b16 v[50:51], v5 offset:5056
    v_mfma_f32_32x32x16_bf16 v[76:91], v[56:59], v[16:19], v[76:91]
    ds_read_b64_tr_b16 v[52:53], v4 offset:512
    ds_read_b64_tr_b16 v[54:55], v4 offset:5120
    s_waitcnt lgkmcnt(10)
    v_mfma_f32_32x32x16_bf16 v[92:107], v[28:31], v[16:19], v[92:107]
    ds_read_b128 v[20:23], v7 offset:14336
    ds_read_b64_tr_b16 v[56:57], v4 offset:18432
    ds_read_b64_tr_b16 v[58:59], v4 offset:23040
    v_mfma_f32_32x32x16_bf16 v[108:123], v[32:35], v[16:19], v[108:123]
    ds_read_b64_tr_b16 v[28:29], v5 offset:18496
    ds_read_b64_tr_b16 v[30:31], v5 offset:23104
    s_waitcnt lgkmcnt(11)
    v_mfma_f32_32x32x16_bf16 v[124:139], v[36:39], v[16:19], v[124:139]
    ds_read_b64_tr_b16 v[32:33], v4 offset:18560
    ds_read_b64_tr_b16 v[34:35], v4 offset:23168
    v_mfma_f32_32x32x16_bf16 v[140:155], v[40:43], v[16:19], v[140:155]
    ds_read_b64_tr_b16 v[36:37], v5 offset:18624
    ds_read_b64_tr_b16 v[38:39], v5 offset:23232
    s_waitcnt lgkmcnt(11)
    v_mfma_f32_32x32x16_bf16 v[156:171], v[44:47], v[16:19], v[156:171]
    ds_read_b64_tr_b16 v[40:41], v4 offset:18688
    ds_read_b64_tr_b16 v[42:43], v4 offset:23296
    v_mfma_f32_32x32x16_bf16 v[172:187], v[48:51], v[16:19], v[172:187]
    s_barrier
    ds_read_b64_tr_b16 v[44:45], v5 offset:18752
    ds_read_b64_tr_b16 v[46:47], v5 offset:23360
    s_waitcnt lgkmcnt(10)
    v_mfma_f32_32x32x16_bf16 v[188:203], v[52:55], v[16:19], v[188:203]
    ds_read_b64_tr_b16 v[48:49], v4 offset:18816
    ds_read_b64_tr_b16 v[50:51], v4 offset:23424
    v_mfma_f32_32x32x16_bf16 v[60:75], v[56:59], v[20:23], v[60:75]
    ds_read_b64_tr_b16 v[52:53], v5 offset:18880
    ds_read_b64_tr_b16 v[54:55], v5 offset:23488
    s_waitcnt lgkmcnt(10)
    v_mfma_f32_32x32x16_bf16 v[76:91], v[28:31], v[20:23], v[76:91]
    ds_read_b64_tr_b16 v[56:57], v4 offset:18944
    ds_read_b64_tr_b16 v[58:59], v4 offset:23552
    v_mfma_f32_32x32x16_bf16 v[92:107], v[32:35], v[20:23], v[92:107]
    v_add_u32 v4, 0, v2
    v_add_u32 v5, 0, v3
    ds_read_b128 v[24:27], v7 offset:0
    ds_read_b64_tr_b16 v[28:29], v4 offset:0
    ds_read_b64_tr_b16 v[30:31], v4 offset:4608
    s_waitcnt lgkmcnt(11)
    v_mfma_f32_32x32x16_bf16 v[108:123], v[36:39], v[20:23], v[108:123]
    ds_read_b64_tr_b16 v[32:33], v5 offset:64
    ds_read_b64_tr_b16 v[34:35], v5 offset:4672
    v_mfma_f32_32x32x16_bf16 v[124:139], v[40:43], v[20:23], v[124:139]
    ds_read_b64_tr_b16 v[36:37], v4 offset:128
    ds_read_b64_tr_b16 v[38:39], v4 offset:4736
    s_waitcnt lgkmcnt(11)
    v_mfma_f32_32x32x16_bf16 v[140:155], v[44:47], v[20:23], v[140:155]
    ds_read_b64_tr_b16 v[40:41], v5 offset:192
    ds_read_b64_tr_b16 v[42:43], v5 offset:4800
    v_mfma_f32_32x32x16_bf16 v[156:171], v[48:51], v[20:23], v[156:171]
    ds_read_b64_tr_b16 v[44:45], v4 offset:256
    ds_read_b64_tr_b16 v[46:47], v4 offset:4864
    s_waitcnt lgkmcnt(11)
    v_mfma_f32_32x32x16_bf16 v[172:187], v[52:55], v[20:23], v[172:187]
    ds_read_b64_tr_b16 v[48:49], v5 offset:320
    ds_read_b64_tr_b16 v[50:51], v5 offset:4928
    v_mfma_f32_32x32x16_bf16 v[188:203], v[56:59], v[20:23], v[188:203]
    ds_read_b64_tr_b16 v[52:53], v4 offset:384
    ds_read_b64_tr_b16 v[54:55], v4 offset:4992
    s_waitcnt lgkmcnt(10)
    v_mfma_f32_32x32x16_bf16 v[60:75], v[28:31], v[24:27], v[60:75]
    ds_read_b64_tr_b16 v[56:57], v5 offset:448
    ds_read_b64_tr_b16 v[58:59], v5 offset:5056
    v_mfma_f32_32x32x16_bf16 v[76:91], v[32:35], v[24:27], v[76:91]
    ds_read_b64_tr_b16 v[28:29], v4 offset:512
    ds_read_b64_tr_b16 v[30:31], v4 offset:5120
    s_waitcnt lgkmcnt(10)
    v_mfma_f32_32x32x16_bf16 v[92:107], v[36:39], v[24:27], v[92:107]
    ds_read_b128 v[16:19], v7 offset:2048
    ds_read_b64_tr_b16 v[32:33], v4 offset:18432
    ds_read_b64_tr_b16 v[34:35], v4 offset:23040
    v_mfma_f32_32x32x16_bf16 v[108:123], v[40:43], v[24:27], v[108:123]
    ds_read_b64_tr_b16 v[36:37], v5 offset:18496
    ds_read_b64_tr_b16 v[38:39], v5 offset:23104
    s_waitcnt lgkmcnt(11)
    v_mfma_f32_32x32x16_bf16 v[124:139], v[44:47], v[24:27], v[124:139]
    ds_read_b64_tr_b16 v[40:41], v4 offset:18560
    ds_read_b64_tr_b16 v[42:43], v4 offset:23168
    v_mfma_f32_32x32x16_bf16 v[140:155], v[48:51], v[24:27], v[140:155]
    ds_read_b64_tr_b16 v[44:45], v5 offset:18624
    ds_read_b64_tr_b16 v[46:47], v5 offset:23232
    s_waitcnt lgkmcnt(11)
    v_mfma_f32_32x32x16_bf16 v[156:171], v[52:55], v[24:27], v[156:171]
    ds_read_b64_tr_b16 v[48:49], v4 offset:18688
    ds_read_b64_tr_b16 v[50:51], v4 offset:23296
    v_mfma_f32_32x32x16_bf16 v[172:187], v[56:59], v[24:27], v[172:187]
    s_barrier
    ds_read_b64_tr_b16 v[52:53], v5 offset:18752
    ds_read_b64_tr_b16 v[54:55], v5 offset:23360
    s_waitcnt lgkmcnt(10)
    v_mfma_f32_32x32x16_bf16 v[188:203], v[28:31], v[24:27], v[188:203]
    ds_read_b64_tr_b16 v[56:57], v4 offset:18816
    ds_read_b64_tr_b16 v[58:59], v4 offset:23424
    v_mfma_f32_32x32x16_bf16 v[60:75], v[32:35], v[16:19], v[60:75]
    ds_read_b64_tr_b16 v[28:29], v5 offset:18880
    ds_read_b64_tr_b16 v[30:31], v5 offset:23488
    s_waitcnt lgkmcnt(10)
    v_mfma_f32_32x32x16_bf16 v[76:91], v[36:39], v[16:19], v[76:91]
    ds_read_b64_tr_b16 v[32:33], v4 offset:18944
    ds_read_b64_tr_b16 v[34:35], v4 offset:23552
    v_mfma_f32_32x32x16_bf16 v[92:107], v[40:43], v[16:19], v[92:107]
    v_add_u32 v4, 36864, v2
    v_add_u32 v5, 36864, v3
    ds_read_b128 v[20:23], v7 offset:4096
    ds_read_b64_tr_b16 v[36:37], v4 offset:0
    ds_read_b64_tr_b16 v[38:39], v4 offset:4608
    s_waitcnt lgkmcnt(11)
    v_mfma_f32_32x32x16_bf16 v[108:123], v[44:47], v[16:19], v[108:123]
    ds_read_b64_tr_b16 v[40:41], v5 offset:64
    ds_read_b64_tr_b16 v[42:43], v5 offset:4672
    v_mfma_f32_32x32x16_bf16 v[124:139], v[48:51], v[16:19], v[124:139]
    ds_read_b64_tr_b16 v[44:45], v4 offset:128
    ds_read_b64_tr_b16 v[46:47], v4 offset:4736
    s_waitcnt lgkmcnt(11)
    v_mfma_f32_32x32x16_bf16 v[140:155], v[52:55], v[16:19], v[140:155]
    ds_read_b64_tr_b16 v[48:49], v5 offset:192
    ds_read_b64_tr_b16 v[50:51], v5 offset:4800
    v_mfma_f32_32x32x16_bf16 v[156:171], v[56:59], v[16:19], v[156:171]
    ds_read_b64_tr_b16 v[52:53], v4 offset:256
    ds_read_b64_tr_b16 v[54:55], v4 offset:4864
    s_waitcnt lgkmcnt(11)
    v_mfma_f32_32x32x16_bf16 v[172:187], v[28:31], v[16:19], v[172:187]
    ds_read_b64_tr_b16 v[56:57], v5 offset:320
    ds_read_b64_tr_b16 v[58:59], v5 offset:4928
    v_mfma_f32_32x32x16_bf16 v[188:203], v[32:35], v[16:19], v[188:203]
    ds_read_b64_tr_b16 v[28:29], v4 offset:384
    ds_read_b64_tr_b16 v[30:31], v4 offset:4992
    s_waitcnt lgkmcnt(10)
    v_mfma_f32_32x32x16_bf16 v[60:75], v[36:39], v[20:23], v[60:75]
    ds_read_b64_tr_b16 v[32:33], v5 offset:448
    ds_read_b64_tr_b16 v[34:35], v5 offset:5056
    v_mfma_f32_32x32x16_bf16 v[76:91], v[40:43], v[20:23], v[76:91]
    ds_read_b64_tr_b16 v[36:37], v4 offset:512
    ds_read_b64_tr_b16 v[38:39], v4 offset:5120
    s_waitcnt lgkmcnt(10)
    v_mfma_f32_32x32x16_bf16 v[92:107], v[44:47], v[20:23], v[92:107]
    ds_read_b128 v[24:27], v7 offset:6144
    ds_read_b64_tr_b16 v[40:41], v4 offset:18432
    ds_read_b64_tr_b16 v[42:43], v4 offset:23040
    v_mfma_f32_32x32x16_bf16 v[108:123], v[48:51], v[20:23], v[108:123]
    ds_read_b64_tr_b16 v[44:45], v5 offset:18496
    ds_read_b64_tr_b16 v[46:47], v5 offset:23104
    s_waitcnt lgkmcnt(11)
    v_mfma_f32_32x32x16_bf16 v[124:139], v[52:55], v[20:23], v[124:139]
    ds_read_b64_tr_b16 v[48:49], v4 offset:18560
    ds_read_b64_tr_b16 v[50:51], v4 offset:23168
    v_mfma_f32_32x32x16_bf16 v[140:155], v[56:59], v[20:23], v[140:155]
    ds_read_b64_tr_b16 v[52:53], v5 offset:18624
    ds_read_b64_tr_b16 v[54:55], v5 offset:23232
    s_waitcnt lgkmcnt(11)
    v_mfma_f32_32x32x16_bf16 v[156:171], v[28:31], v[20:23], v[156:171]
    ds_read_b64_tr_b16 v[56:57], v4 offset:18688
    ds_read_b64_tr_b16 v[58:59], v4 offset:23296
    v_mfma_f32_32x32x16_bf16 v[172:187], v[32:35], v[20:23], v[172:187]
    s_barrier
    ds_read_b64_tr_b16 v[28:29], v5 offset:18752
    ds_read_b64_tr_b16 v[30:31], v5 offset:23360
    s_waitcnt lgkmcnt(10)
    v_mfma_f32_32x32x16_bf16 v[188:203], v[36:39], v[20:23], v[188:203]
    ds_read_b64_tr_b16 v[32:33], v4 offset:18816
    ds_read_b64_tr_b16 v[34:35], v4 offset:23424
    v_mfma_f32_32x32x16_bf16 v[60:75], v[40:43], v[24:27], v[60:75]
    ds_read_b64_tr_b16 v[36:37], v5 offset:18880
    ds_read_b64_tr_b16 v[38:39], v5 offset:23488
    s_waitcnt lgkmcnt(10)
    v_mfma_f32_32x32x16_bf16 v[76:91], v[44:47], v[24:27], v[76:91]
    ds_read_b64_tr_b16 v[40:41], v4 offset:18944
    ds_read_b64_tr_b16 v[42:43], v4 offset:23552
    v_mfma_f32_32x32x16_bf16 v[92:107], v[48:51], v[24:27], v[92:107]
    v_add_u32 v4, 73728, v2
    v_add_u32 v5, 73728, v3
    ds_read_b64 v[12:13], v236
    ds_read_b64 v[14:15], v236
    ds_read_b64_tr_b16 v[44:45], v4 offset:0
    ds_read_b64_tr_b16 v[46:47], v4 offset:4608
    s_waitcnt lgkmcnt(12)
    v_mfma_f32_32x32x16_bf16 v[108:123], v[52:55], v[24:27], v[108:123]
    ds_read_b64_tr_b16 v[48:49], v5 offset:64
    ds_read_b64_tr_b16 v[50:51], v5 offset:4672
    v_mfma_f32_32x32x16_bf16 v[124:139], v[56:59], v[24:27], v[124:139]
    ds_read_b64_tr_b16 v[52:53], v4 offset:128
    ds_read_b64_tr_b16 v[54:55], v4 offset:4736
    s_waitcnt lgkmcnt(12)
    v_mfma_f32_32x32x16_bf16 v[140:155], v[28:31], v[24:27], v[140:155]
    ds_read_b64_tr_b16 v[56:57], v5 offset:192
    ds_read_b64_tr_b16 v[58:59], v5 offset:4800
    v_mfma_f32_32x32x16_bf16 v[156:171], v[32:35], v[24:27], v[156:171]
    ds_read_b64_tr_b16 v[28:29], v4 offset:256
    ds_read_b64_tr_b16 v[30:31], v4 offset:4864
    s_waitcnt lgkmcnt(12)
    v_mfma_f32_32x32x16_bf16 v[172:187], v[36:39], v[24:27], v[172:187]
    ds_read_b64_tr_b16 v[32:33], v5 offset:320
    ds_read_b64_tr_b16 v[34:35], v5 offset:4928
    v_mfma_f32_32x32x16_bf16 v[188:203], v[40:43], v[24:27], v[188:203]
    ds_read_b64_tr_b16 v[36:37], v4 offset:384
    ds_read_b64_tr_b16 v[38:39], v4 offset:4992
    s_waitcnt lgkmcnt(10)
    v_mfma_f32_32x32x16_bf16 v[60:75], v[44:47], v[12:15], v[60:75]
    ds_read_b64_tr_b16 v[40:41], v5 offset:448
    ds_read_b64_tr_b16 v[42:43], v5 offset:5056
    v_mfma_f32_32x32x16_bf16 v[76:91], v[48:51], v[12:15], v[76:91]
    s_barrier
    ds_read_b64_tr_b16 v[44:45], v4 offset:512
    ds_read_b64_tr_b16 v[46:47], v4 offset:5120
    s_waitcnt lgkmcnt(10)
    v_mfma_f32_32x32x16_bf16 v[92:107], v[52:55], v[12:15], v[92:107]
    v_mfma_f32_32x32x16_bf16 v[108:123], v[56:59], v[12:15], v[108:123]
    s_waitcnt lgkmcnt(6)
    v_mfma_f32_32x32x16_bf16 v[124:139], v[28:31], v[12:15], v[124:139]
    v_mfma_f32_32x32x16_bf16 v[140:155], v[32:35], v[12:15], v[140:155]
    s_waitcnt lgkmcnt(2)
    v_mfma_f32_32x32x16_bf16 v[156:171], v[36:39], v[12:15], v[156:171]
    v_mfma_f32_32x32x16_bf16 v[172:187], v[40:43], v[12:15], v[172:187]
    s_waitcnt lgkmcnt(0)
    v_mfma_f32_32x32x16_bf16 v[188:203], v[44:47], v[12:15], v[188:203]
    v_cvt_pk_bf16_f32 v60, v60, v61
    v_cvt_pk_bf16_f32 v61, v62, v63
    v_cvt_pk_bf16_f32 v62, v64, v65
    v_cvt_pk_bf16_f32 v63, v66, v67
    v_pk_max_i16 v60, v60, 0
    v_pk_max_i16 v61, v61, 0
    v_pk_max_i16 v62, v62, 0
    v_pk_max_i16 v63, v63, 0
    ds_write_b128 v8, v[60:63] offset:0
    v_cvt_pk_bf16_f32 v64, v68, v69
    v_cvt_pk_bf16_f32 v65, v70, v71
    v_cvt_pk_bf16_f32 v66, v72, v73
    v_cvt_pk_bf16_f32 v67, v74, v75
    v_pk_max_i16 v64, v64, 0
    v_pk_max_i16 v65, v65, 0
    v_pk_max_i16 v66, v66, 0
    v_pk_max_i16 v67, v67, 0
    ds_write_b128 v8, v[64:67] offset:1024
    v_cvt_pk_bf16_f32 v68, v76, v77
    v_cvt_pk_bf16_f32 v69, v78, v79
    v_cvt_pk_bf16_f32 v70, v80, v81
    v_cvt_pk_bf16_f32 v71, v82, v83
    v_pk_max_i16 v68, v68, 0
    v_pk_max_i16 v69, v69, 0
    v_pk_max_i16 v70, v70, 0
    v_pk_max_i16 v71, v71, 0
    ds_write_b128 v8, v[68:71] offset:2048
    v_cvt_pk_bf16_f32 v72, v84, v85
    v_cvt_pk_bf16_f32 v73, v86, v87
    v_cvt_pk_bf16_f32 v74, v88, v89
    v_cvt_pk_bf16_f32 v75, v90, v91
    v_pk_max_i16 v72, v72, 0
    v_pk_max_i16 v73, v73, 0
    v_pk_max_i16 v74, v74, 0
    v_pk_max_i16 v75, v75, 0
    ds_write_b128 v8, v[72:75] offset:3072
    v_cvt_pk_bf16_f32 v76, v92, v93
    v_cvt_pk_bf16_f32 v77, v94, v95
    v_cvt_pk_bf16_f32 v78, v96, v97
    v_cvt_pk_bf16_f32 v79, v98, v99
    v_pk_max_i16 v76, v76, 0
    v_pk_max_i16 v77, v77, 0
    v_pk_max_i16 v78, v78, 0
    v_pk_max_i16 v79, v79, 0
    ds_write_b128 v8, v[76:79] offset:4096
    v_cvt_pk_bf16_f32 v80, v100, v101
    v_cvt_pk_bf16_f32 v81, v102, v103
    v_cvt_pk_bf16_f32 v82, v104, v105
    v_cvt_pk_bf16_f32 v83, v106, v107
    v_pk_max_i16 v80, v80, 0
    v_pk_max_i16 v81, v81, 0
    v_pk_max_i16 v82, v82, 0
    v_pk_max_i16 v83, v83, 0
    ds_write_b128 v8, v[80:83] offset:5120
    v_cvt_pk_bf16_f32 v84, v108, v109
    v_cvt_pk_bf16_f32 v85, v110, v111
    v_cvt_pk_bf16_f32 v86, v112, v113
    v_cvt_pk_bf16_f32 v87, v114, v115
    v_pk_max_i16 v84, v84, 0
    v_pk_max_i16 v85, v85, 0
    v_pk_max_i16 v86, v86, 0
    v_pk_max_i16 v87, v87, 0
    ds_write_b128 v8, v[84:87] offset:6144
    v_cvt_pk_bf16_f32 v88, v116, v117
    v_cvt_pk_bf16_f32 v89, v118, v119
    v_cvt_pk_bf16_f32 v90, v120, v121
    v_cvt_pk_bf16_f32 v91, v122, v123
    v_pk_max_i16 v88, v88, 0
    v_pk_max_i16 v89, v89, 0
    v_pk_max_i16 v90, v90, 0
    v_pk_max_i16 v91, v91, 0
    ds_write_b128 v8, v[88:91] offset:7168
    v_cvt_pk_bf16_f32 v92, v124, v125
    v_cvt_pk_bf16_f32 v93, v126, v127
    v_cvt_pk_bf16_f32 v94, v128, v129
    v_cvt_pk_bf16_f32 v95, v130, v131
    v_pk_max_i16 v92, v92, 0
    v_pk_max_i16 v93, v93, 0
    v_pk_max_i16 v94, v94, 0
    v_pk_max_i16 v95, v95, 0
    ds_write_b128 v8, v[92:95] offset:8192
    s_barrier
    v_cvt_pk_bf16_f32 v96, v132, v133
    v_cvt_pk_bf16_f32 v97, v134, v135
    v_cvt_pk_bf16_f32 v98, v136, v137
    v_cvt_pk_bf16_f32 v99, v138, v139
    v_pk_max_i16 v96, v96, 0
    v_pk_max_i16 v97, v97, 0
    v_pk_max_i16 v98, v98, 0
    v_pk_max_i16 v99, v99, 0
    ds_write_b128 v8, v[96:99] offset:36864
    v_cvt_pk_bf16_f32 v100, v140, v141
    v_cvt_pk_bf16_f32 v101, v142, v143
    v_cvt_pk_bf16_f32 v102, v144, v145
    v_cvt_pk_bf16_f32 v103, v146, v147
    v_pk_max_i16 v100, v100, 0
    v_pk_max_i16 v101, v101, 0
    v_pk_max_i16 v102, v102, 0
    v_pk_max_i16 v103, v103, 0
    ds_write_b128 v8, v[100:103] offset:37888
    v_cvt_pk_bf16_f32 v104, v148, v149
    v_cvt_pk_bf16_f32 v105, v150, v151
    v_cvt_pk_bf16_f32 v106, v152, v153
    v_cvt_pk_bf16_f32 v107, v154, v155
    v_pk_max_i16 v104, v104, 0
    v_pk_max_i16 v105, v105, 0
    v_pk_max_i16 v106, v106, 0
    v_pk_max_i16 v107, v107, 0
    ds_write_b128 v8, v[104:107] offset:38912
    v_cvt_pk_bf16_f32 v108, v156, v157
    v_cvt_pk_bf16_f32 v109, v158, v159
    v_cvt_pk_bf16_f32 v110, v160, v161
    v_cvt_pk_bf16_f32 v111, v162, v163
    v_pk_max_i16 v108, v108, 0
    v_pk_max_i16 v109, v109, 0
    v_pk_max_i16 v110, v110, 0
    v_pk_max_i16 v111, v111, 0
    ds_write_b128 v8, v[108:111] offset:39936
    v_cvt_pk_bf16_f32 v112, v164, v165
    v_cvt_pk_bf16_f32 v113, v166, v167
    v_cvt_pk_bf16_f32 v114, v168, v169
    v_cvt_pk_bf16_f32 v115, v170, v171
    v_pk_max_i16 v112, v112, 0
    v_pk_max_i16 v113, v113, 0
    v_pk_max_i16 v114, v114, 0
    v_pk_max_i16 v115, v115, 0
    ds_write_b128 v8, v[112:115] offset:40960
    v_cvt_pk_bf16_f32 v116, v172, v173
    v_cvt_pk_bf16_f32 v117, v174, v175
    v_cvt_pk_bf16_f32 v118, v176, v177
    v_cvt_pk_bf16_f32 v119, v178, v179
    v_pk_max_i16 v116, v116, 0
    v_pk_max_i16 v117, v117, 0
    v_pk_max_i16 v118, v118, 0
    v_pk_max_i16 v119, v119, 0
    ds_write_b128 v8, v[116:119] offset:41984
    v_cvt_pk_bf16_f32 v120, v180, v181
    v_cvt_pk_bf16_f32 v121, v182, v183
    v_cvt_pk_bf16_f32 v122, v184, v185
    v_cvt_pk_bf16_f32 v123, v186, v187
    v_pk_max_i16 v120, v120, 0
    v_pk_max_i16 v121, v121, 0
    v_pk_max_i16 v122, v122, 0
    v_pk_max_i16 v123, v123, 0
    ds_write_b128 v8, v[120:123] offset:43008
    v_cvt_pk_bf16_f32 v124, v188, v189
    v_cvt_pk_bf16_f32 v125, v190, v191
    v_cvt_pk_bf16_f32 v126, v192, v193
    v_cvt_pk_bf16_f32 v127, v194, v195
    v_pk_max_i16 v124, v124, 0
    v_pk_max_i16 v125, v125, 0
    v_pk_max_i16 v126, v126, 0
    v_pk_max_i16 v127, v127, 0
    ds_write_b128 v8, v[124:127] offset:44032
    v_cvt_pk_bf16_f32 v128, v196, v197
    v_cvt_pk_bf16_f32 v129, v198, v199
    v_cvt_pk_bf16_f32 v130, v200, v201
    v_cvt_pk_bf16_f32 v131, v202, v203
    v_pk_max_i16 v128, v128, 0
    v_pk_max_i16 v129, v129, 0
    v_pk_max_i16 v130, v130, 0
    v_pk_max_i16 v131, v131, 0
    ds_write_b128 v8, v[128:131] offset:45056
    s_waitcnt lgkmcnt(0)
    s_barrier
    v_add_u32 v4, 110592, v6
    v_add_u32 v5, 110592, v11
    ds_read_b64_tr_b16 v[48:49], v4 offset:0
    ds_read_b64_tr_b16 v[50:51], v4 offset:1024
    ds_read_b64_tr_b16 v[52:53], v4 offset:2048
    ds_read_b64_tr_b16 v[54:55], v4 offset:3072
    ds_read_b64_tr_b16 v[56:57], v4 offset:4096
    ds_read_b64_tr_b16 v[58:59], v4 offset:5120
    ds_read_b64_tr_b16 v[28:29], v4 offset:6144
    ds_read_b64_tr_b16 v[30:31], v4 offset:7168
    ds_read_b64_tr_b16 v[32:33], v4 offset:8192
    ds_read_b64_tr_b16 v[34:35], v4 offset:9216
    ds_read_b64_tr_b16 v[36:37], v4 offset:10240
    ds_read_b64_tr_b16 v[38:39], v4 offset:11264
    ds_read_b128 v[132:135], v9 offset:0
    ds_read_b128 v[136:139], v9 offset:1024
    ds_read_b128 v[140:143], v9 offset:2048
    ds_read_b128 v[144:147], v9 offset:3072
    ds_read_b128 v[148:151], v9 offset:4096
    ds_read_b128 v[152:155], v9 offset:5120
    ds_read_b128 v[156:159], v9 offset:6144
    ds_read_b128 v[160:163], v9 offset:7168
    ds_read_b128 v[164:167], v9 offset:8192
    ds_read_b128 v[168:171], v9 offset:36864
    ds_read_b128 v[172:175], v9 offset:37888
    ds_read_b128 v[176:179], v9 offset:38912
    ds_read_b128 v[180:183], v9 offset:39936
    ds_read_b128 v[184:187], v9 offset:40960
    ds_read_b128 v[188:191], v9 offset:41984
    ds_read_b128 v[192:195], v9 offset:43008
    ds_read_b128 v[196:199], v9 offset:44032
    ds_read_b128 v[200:203], v9 offset:45056
    ds_read_b64_tr_b16 v[40:41], v4 offset:12288
    ds_read_b64_tr_b16 v[42:43], v4 offset:13312
    s_waitcnt lgkmcnt(15)
    v_mfma_f32_32x32x16_bf16 v[204:219], v[48:51], v[60:63], 0
    ds_read_b64_tr_b16 v[44:45], v4 offset:14336
    ds_read_b64_tr_b16 v[46:47], v4 offset:15360
    v_mfma_f32_32x32x16_bf16 v[204:219], v[52:55], v[64:67], v[204:219]
    ds_read_b64_tr_b16 v[48:49], v4 offset:16384
    ds_read_b64_tr_b16 v[50:51], v4 offset:17408
    v_mfma_f32_32x32x16_bf16 v[204:219], v[56:59], v[68:71], v[204:219]
    ds_read_b64_tr_b16 v[52:53], v5 offset:0
    ds_read_b64_tr_b16 v[54:55], v5 offset:1024
    v_mfma_f32_32x32x16_bf16 v[204:219], v[28:31], v[72:75], v[204:219]
    ds_read_b64_tr_b16 v[56:57], v5 offset:2048
    ds_read_b64_tr_b16 v[58:59], v5 offset:3072
    v_mfma_f32_32x32x16_bf16 v[204:219], v[32:35], v[76:79], v[204:219]
    ds_read_b64_tr_b16 v[28:29], v5 offset:4096
    ds_read_b64_tr_b16 v[30:31], v5 offset:5120
    s_waitcnt lgkmcnt(10)
    v_mfma_f32_32x32x16_bf16 v[204:219], v[36:39], v[80:83], v[204:219]
    ds_read_b64_tr_b16 v[32:33], v5 offset:6144
    ds_read_b64_tr_b16 v[34:35], v5 offset:7168
    v_mfma_f32_32x32x16_bf16 v[204:219], v[40:43], v[84:87], v[204:219]
    ds_read_b64_tr_b16 v[36:37], v5 offset:8192
    ds_read_b64_tr_b16 v[38:39], v5 offset:9216
    s_waitcnt lgkmcnt(10)
    v_mfma_f32_32x32x16_bf16 v[204:219], v[44:47], v[88:91], v[204:219]
    s_barrier
    ds_read_b64_tr_b16 v[40:41], v5 offset:10240
    ds_read_b64_tr_b16 v[42:43], v5 offset:11264
    v_mfma_f32_32x32x16_bf16 v[204:219], v[48:51], v[92:95], v[204:219]
    ds_read_b64_tr_b16 v[44:45], v5 offset:12288
    ds_read_b64_tr_b16 v[46:47], v5 offset:13312
    s_waitcnt lgkmcnt(10)
    v_mfma_f32_32x32x16_bf16 v[204:219], v[52:55], v[132:135], v[204:219]
    ds_read_b64_tr_b16 v[48:49], v5 offset:14336
    ds_read_b64_tr_b16 v[50:51], v5 offset:15360
    v_mfma_f32_32x32x16_bf16 v[204:219], v[56:59], v[136:139], v[204:219]
    ds_read_b64_tr_b16 v[52:53], v5 offset:16384
    ds_read_b64_tr_b16 v[54:55], v5 offset:17408
    s_waitcnt lgkmcnt(10)
    v_mfma_f32_32x32x16_bf16 v[204:219], v[28:31], v[140:143], v[204:219]
    v_add_u32 v4, 0, v6
    v_add_u32 v5, 0, v11
    ds_read_b64_tr_b16 v[56:57], v4 offset:0
    ds_read_b64_tr_b16 v[58:59], v4 offset:1024
    v_mfma_f32_32x32x16_bf16 v[204:219], v[32:35], v[144:147], v[204:219]
    ds_read_b64_tr_b16 v[28:29], v4 offset:2048
    ds_read_b64_tr_b16 v[30:31], v4 offset:3072
    s_waitcnt lgkmcnt(10)
    v_mfma_f32_32x32x16_bf16 v[204:219], v[36:39], v[148:151], v[204:219]
    ds_read_b64_tr_b16 v[32:33], v4 offset:4096
    ds_read_b64_tr_b16 v[34:35], v4 offset:5120
    v_mfma_f32_32x32x16_bf16 v[204:219], v[40:43], v[152:155], v[204:219]
    ds_read_b64_tr_b16 v[36:37], v4 offset:6144
    ds_read_b64_tr_b16 v[38:39], v4 offset:7168
    s_waitcnt lgkmcnt(10)
    v_mfma_f32_32x32x16_bf16 v[204:219], v[44:47], v[156:159], v[204:219]
    ds_read_b64_tr_b16 v[40:41], v4 offset:8192
    ds_read_b64_tr_b16 v[42:43], v4 offset:9216
    v_mfma_f32_32x32x16_bf16 v[204:219], v[48:51], v[160:163], v[204:219]
    ds_read_b64_tr_b16 v[44:45], v4 offset:10240
    ds_read_b64_tr_b16 v[46:47], v4 offset:11264
    s_waitcnt lgkmcnt(10)
    v_mfma_f32_32x32x16_bf16 v[204:219], v[52:55], v[164:167], v[204:219]
    ds_read_b64_tr_b16 v[48:49], v4 offset:12288
    ds_read_b64_tr_b16 v[50:51], v4 offset:13312
    v_mfma_f32_32x32x16_bf16 v[204:219], v[56:59], v[96:99], v[204:219]
    ds_read_b64_tr_b16 v[52:53], v4 offset:14336
    ds_read_b64_tr_b16 v[54:55], v4 offset:15360
    s_waitcnt lgkmcnt(10)
    v_mfma_f32_32x32x16_bf16 v[204:219], v[28:31], v[100:103], v[204:219]
    ds_read_b64_tr_b16 v[56:57], v4 offset:16384
    ds_read_b64_tr_b16 v[58:59], v4 offset:17408
    v_mfma_f32_32x32x16_bf16 v[204:219], v[32:35], v[104:107], v[204:219]
    ds_read_b64_tr_b16 v[28:29], v5 offset:0
    ds_read_b64_tr_b16 v[30:31], v5 offset:1024
    s_waitcnt lgkmcnt(10)
    v_mfma_f32_32x32x16_bf16 v[204:219], v[36:39], v[108:111], v[204:219]
    ds_read_b64_tr_b16 v[32:33], v5 offset:2048
    ds_read_b64_tr_b16 v[34:35], v5 offset:3072
    v_mfma_f32_32x32x16_bf16 v[204:219], v[40:43], v[112:115], v[204:219]
    ds_read_b64_tr_b16 v[36:37], v5 offset:4096
    ds_read_b64_tr_b16 v[38:39], v5 offset:5120
    s_waitcnt lgkmcnt(10)
    v_mfma_f32_32x32x16_bf16 v[204:219], v[44:47], v[116:119], v[204:219]
    ds_read_b64_tr_b16 v[40:41], v5 offset:6144
    ds_read_b64_tr_b16 v[42:43], v5 offset:7168
    v_mfma_f32_32x32x16_bf16 v[204:219], v[48:51], v[120:123], v[204:219]
    ds_read_b64_tr_b16 v[44:45], v5 offset:8192
    ds_read_b64_tr_b16 v[46:47], v5 offset:9216
    s_waitcnt lgkmcnt(10)
    v_mfma_f32_32x32x16_bf16 v[204:219], v[52:55], v[124:127], v[204:219]
    s_barrier
    ds_read_b64_tr_b16 v[48:49], v5 offset:10240
    ds_read_b64_tr_b16 v[50:51], v5 offset:11264
    v_mfma_f32_32x32x16_bf16 v[204:219], v[56:59], v[128:131], v[204:219]
    ds_read_b64_tr_b16 v[52:53], v5 offset:12288
    ds_read_b64_tr_b16 v[54:55], v5 offset:13312
    s_waitcnt lgkmcnt(10)
    v_mfma_f32_32x32x16_bf16 v[204:219], v[28:31], v[168:171], v[204:219]
    ds_read_b64_tr_b16 v[56:57], v5 offset:14336
    ds_read_b64_tr_b16 v[58:59], v5 offset:15360
    v_mfma_f32_32x32x16_bf16 v[204:219], v[32:35], v[172:175], v[204:219]
    ds_read_b64_tr_b16 v[28:29], v5 offset:16384
    ds_read_b64_tr_b16 v[30:31], v5 offset:17408
    s_waitcnt lgkmcnt(10)
    v_mfma_f32_32x32x16_bf16 v[204:219], v[36:39], v[176:179], v[204:219]
    v_add_u32 v4, 36864, v6
    v_add_u32 v5, 36864, v11
    ds_read_b64_tr_b16 v[32:33], v4 offset:0
    ds_read_b64_tr_b16 v[34:35], v4 offset:1024
    v_mfma_f32_32x32x16_bf16 v[204:219], v[40:43], v[180:183], v[204:219]
    ds_read_b64_tr_b16 v[36:37], v4 offset:2048
    ds_read_b64_tr_b16 v[38:39], v4 offset:3072
    s_waitcnt lgkmcnt(10)
    v_mfma_f32_32x32x16_bf16 v[204:219], v[44:47], v[184:187], v[204:219]
    ds_read_b64_tr_b16 v[40:41], v4 offset:4096
    ds_read_b64_tr_b16 v[42:43], v4 offset:5120
    v_mfma_f32_32x32x16_bf16 v[204:219], v[48:51], v[188:191], v[204:219]
    ds_read_b64_tr_b16 v[44:45], v4 offset:6144
    ds_read_b64_tr_b16 v[46:47], v4 offset:7168
    s_waitcnt lgkmcnt(10)
    v_mfma_f32_32x32x16_bf16 v[204:219], v[52:55], v[192:195], v[204:219]
    ds_read_b64_tr_b16 v[48:49], v4 offset:8192
    ds_read_b64_tr_b16 v[50:51], v4 offset:9216
    v_mfma_f32_32x32x16_bf16 v[204:219], v[56:59], v[196:199], v[204:219]
    ds_read_b64_tr_b16 v[52:53], v4 offset:10240
    ds_read_b64_tr_b16 v[54:55], v4 offset:11264
    s_waitcnt lgkmcnt(10)
    v_mfma_f32_32x32x16_bf16 v[204:219], v[28:31], v[200:203], v[204:219]
    ds_read_b64_tr_b16 v[56:57], v4 offset:12288
    ds_read_b64_tr_b16 v[58:59], v4 offset:13312
    v_mfma_f32_32x32x16_bf16 v[220:235], v[32:35], v[60:63], 0
    ds_read_b64_tr_b16 v[28:29], v4 offset:14336
    ds_read_b64_tr_b16 v[30:31], v4 offset:15360
    s_waitcnt lgkmcnt(10)
    v_mfma_f32_32x32x16_bf16 v[220:235], v[36:39], v[64:67], v[220:235]
    ds_read_b64_tr_b16 v[32:33], v4 offset:16384
    ds_read_b64_tr_b16 v[34:35], v4 offset:17408
    v_mfma_f32_32x32x16_bf16 v[220:235], v[40:43], v[68:71], v[220:235]
    s_nop 1
    v_cvt_pk_bf16_f32 v204, v204, v205
    v_cvt_pk_bf16_f32 v205, v206, v207
    ds_read_b64_tr_b16 v[36:37], v5 offset:0
    ds_read_b64_tr_b16 v[38:39], v5 offset:1024
    s_waitcnt lgkmcnt(10)
    v_mfma_f32_32x32x16_bf16 v[220:235], v[44:47], v[72:75], v[220:235]
    v_cvt_pk_bf16_f32 v206, v208, v209
    v_cvt_pk_bf16_f32 v207, v210, v211
    ds_read_b64_tr_b16 v[40:41], v5 offset:2048
    ds_read_b64_tr_b16 v[42:43], v5 offset:3072
    v_mfma_f32_32x32x16_bf16 v[220:235], v[48:51], v[76:79], v[220:235]
    buffer_store_dwordx4 v[204:207], v10, s[28:31], s48 offen offset:0 sc1
    v_cvt_pk_bf16_f32 v212, v212, v213
    ds_read_b64_tr_b16 v[44:45], v5 offset:4096
    ds_read_b64_tr_b16 v[46:47], v5 offset:5120
    s_waitcnt lgkmcnt(10)
    v_mfma_f32_32x32x16_bf16 v[220:235], v[52:55], v[80:83], v[220:235]
    v_cvt_pk_bf16_f32 v213, v214, v215
    v_cvt_pk_bf16_f32 v214, v216, v217
    ds_read_b64_tr_b16 v[48:49], v5 offset:6144
    ds_read_b64_tr_b16 v[50:51], v5 offset:7168
    v_mfma_f32_32x32x16_bf16 v[220:235], v[56:59], v[84:87], v[220:235]
    v_cvt_pk_bf16_f32 v215, v218, v219
    buffer_store_dwordx4 v[212:215], v10, s[28:31], s48 offen offset:1024 sc1
    ds_read_b64_tr_b16 v[52:53], v5 offset:8192
    ds_read_b64_tr_b16 v[54:55], v5 offset:9216
    s_waitcnt lgkmcnt(10)
    v_mfma_f32_32x32x16_bf16 v[220:235], v[28:31], v[88:91], v[220:235]
    s_add_u32 s48, s48, 4096
    s_cmp_ge_u32 s48, s49
    s_cselect_b32 s44, 36864, 0
    s_sub_u32 s48, s48, s44
    s_barrier
    ds_read_b64_tr_b16 v[56:57], v5 offset:10240
    ds_read_b64_tr_b16 v[58:59], v5 offset:11264
    v_mfma_f32_32x32x16_bf16 v[220:235], v[32:35], v[92:95], v[220:235]
    ds_read_b64_tr_b16 v[28:29], v5 offset:12288
    ds_read_b64_tr_b16 v[30:31], v5 offset:13312
    s_waitcnt lgkmcnt(10)
    v_mfma_f32_32x32x16_bf16 v[220:235], v[36:39], v[132:135], v[220:235]
    ds_read_b64_tr_b16 v[32:33], v5 offset:14336
    ds_read_b64_tr_b16 v[34:35], v5 offset:15360
    v_mfma_f32_32x32x16_bf16 v[220:235], v[40:43], v[136:139], v[220:235]
    ds_read_b64_tr_b16 v[36:37], v5 offset:16384
    ds_read_b64_tr_b16 v[38:39], v5 offset:17408
    s_waitcnt lgkmcnt(10)
    v_mfma_f32_32x32x16_bf16 v[220:235], v[44:47], v[140:143], v[220:235]
    v_add_u32 v4, 73728, v6
    v_add_u32 v5, 73728, v11
    ds_read_b64_tr_b16 v[40:41], v4 offset:0
    ds_read_b64_tr_b16 v[42:43], v4 offset:1024
    v_mfma_f32_32x32x16_bf16 v[220:235], v[48:51], v[144:147], v[220:235]
    ds_read_b64_tr_b16 v[44:45], v4 offset:2048
    ds_read_b64_tr_b16 v[46:47], v4 offset:3072
    s_waitcnt lgkmcnt(10)
    v_mfma_f32_32x32x16_bf16 v[220:235], v[52:55], v[148:151], v[220:235]
    ds_read_b64_tr_b16 v[48:49], v4 offset:4096
    ds_read_b64_tr_b16 v[50:51], v4 offset:5120
    v_mfma_f32_32x32x16_bf16 v[220:235], v[56:59], v[152:155], v[220:235]
    ds_read_b64_tr_b16 v[52:53], v4 offset:6144
    ds_read_b64_tr_b16 v[54:55], v4 offset:7168
    s_waitcnt lgkmcnt(10)
    v_mfma_f32_32x32x16_bf16 v[220:235], v[28:31], v[156:159], v[220:235]
    ds_read_b64_tr_b16 v[56:57], v4 offset:8192
    ds_read_b64_tr_b16 v[58:59], v4 offset:9216
    v_mfma_f32_32x32x16_bf16 v[220:235], v[32:35], v[160:163], v[220:235]
    ds_read_b64_tr_b16 v[28:29], v4 offset:10240
    ds_read_b64_tr_b16 v[30:31], v4 offset:11264
    s_waitcnt lgkmcnt(10)
    v_mfma_f32_32x32x16_bf16 v[220:235], v[36:39], v[164:167], v[220:235]
    ds_read_b64_tr_b16 v[32:33], v4 offset:12288
    ds_read_b64_tr_b16 v[34:35], v4 offset:13312
    v_mfma_f32_32x32x16_bf16 v[220:235], v[40:43], v[96:99], v[220:235]
    ds_read_b64_tr_b16 v[36:37], v4 offset:14336
    ds_read_b64_tr_b16 v[38:39], v4 offset:15360
    s_waitcnt lgkmcnt(10)
    v_mfma_f32_32x32x16_bf16 v[220:235], v[44:47], v[100:103], v[220:235]
    ds_read_b64_tr_b16 v[40:41], v4 offset:16384
    ds_read_b64_tr_b16 v[42:43], v4 offset:17408
    v_mfma_f32_32x32x16_bf16 v[220:235], v[48:51], v[104:107], v[220:235]
    ds_read_b64_tr_b16 v[44:45], v5 offset:0
    ds_read_b64_tr_b16 v[46:47], v5 offset:1024
    s_waitcnt lgkmcnt(10)
    v_mfma_f32_32x32x16_bf16 v[220:235], v[52:55], v[108:111], v[220:235]
    ds_read_b64_tr_b16 v[48:49], v5 offset:2048
    ds_read_b64_tr_b16 v[50:51], v5 offset:3072
    v_mfma_f32_32x32x16_bf16 v[220:235], v[56:59], v[112:115], v[220:235]
    ds_read_b64_tr_b16 v[52:53], v5 offset:4096
    ds_read_b64_tr_b16 v[54:55], v5 offset:5120
    s_waitcnt lgkmcnt(10)
    v_mfma_f32_32x32x16_bf16 v[220:235], v[28:31], v[116:119], v[220:235]
    ds_read_b64_tr_b16 v[56:57], v5 offset:6144
    ds_read_b64_tr_b16 v[58:59], v5 offset:7168
    v_mfma_f32_32x32x16_bf16 v[220:235], v[32:35], v[120:123], v[220:235]
    ds_read_b64_tr_b16 v[28:29], v5 offset:8192
    ds_read_b64_tr_b16 v[30:31], v5 offset:9216
    s_waitcnt lgkmcnt(10)
    v_mfma_f32_32x32x16_bf16 v[220:235], v[36:39], v[124:127], v[220:235]
    s_barrier
    ds_read_b64_tr_b16 v[32:33], v5 offset:10240
    ds_read_b64_tr_b16 v[34:35], v5 offset:11264
    v_mfma_f32_32x32x16_bf16 v[220:235], v[40:43], v[128:131], v[220:235]
    ds_read_b64_tr_b16 v[36:37], v5 offset:12288
    ds_read_b64_tr_b16 v[38:39], v5 offset:13312
    s_waitcnt lgkmcnt(10)
    v_mfma_f32_32x32x16_bf16 v[220:235], v[44:47], v[168:171], v[220:235]
    ds_read_b64_tr_b16 v[40:41], v5 offset:14336
    ds_read_b64_tr_b16 v[42:43], v5 offset:15360
    v_mfma_f32_32x32x16_bf16 v[220:235], v[48:51], v[172:175], v[220:235]
    ds_read_b64_tr_b16 v[44:45], v5 offset:16384
    ds_read_b64_tr_b16 v[46:47], v5 offset:17408
    s_waitcnt lgkmcnt(10)
    v_mfma_f32_32x32x16_bf16 v[220:235], v[52:55], v[176:179], v[220:235]
    v_add_u32 v4, 110592, v6
    v_add_u32 v5, 110592, v11
    ds_read_b64_tr_b16 v[48:49], v4 offset:0
    ds_read_b64_tr_b16 v[50:51], v4 offset:1024
    v_mfma_f32_32x32x16_bf16 v[220:235], v[56:59], v[180:183], v[220:235]
    ds_read_b64_tr_b16 v[52:53], v4 offset:2048
    ds_read_b64_tr_b16 v[54:55], v4 offset:3072
    s_waitcnt lgkmcnt(10)
    v_mfma_f32_32x32x16_bf16 v[220:235], v[28:31], v[184:187], v[220:235]
    ds_read_b64_tr_b16 v[56:57], v4 offset:4096
    ds_read_b64_tr_b16 v[58:59], v4 offset:5120
    v_mfma_f32_32x32x16_bf16 v[220:235], v[32:35], v[188:191], v[220:235]
    ds_read_b64_tr_b16 v[28:29], v4 offset:6144
    ds_read_b64_tr_b16 v[30:31], v4 offset:7168
    s_waitcnt lgkmcnt(10)
    v_mfma_f32_32x32x16_bf16 v[220:235], v[36:39], v[192:195], v[220:235]
    ds_read_b64_tr_b16 v[32:33], v4 offset:8192
    ds_read_b64_tr_b16 v[34:35], v4 offset:9216
    v_mfma_f32_32x32x16_bf16 v[220:235], v[40:43], v[196:199], v[220:235]
    ds_read_b64_tr_b16 v[36:37], v4 offset:10240
    ds_read_b64_tr_b16 v[38:39], v4 offset:11264
    s_waitcnt lgkmcnt(10)
    v_mfma_f32_32x32x16_bf16 v[220:235], v[44:47], v[200:203], v[220:235]
    ds_read_b64_tr_b16 v[40:41], v4 offset:12288
    ds_read_b64_tr_b16 v[42:43], v4 offset:13312
    v_mfma_f32_32x32x16_bf16 v[204:219], v[48:51], v[60:63], 0
    ds_read_b64_tr_b16 v[44:45], v4 offset:14336
    ds_read_b64_tr_b16 v[46:47], v4 offset:15360
    s_waitcnt lgkmcnt(10)
    v_mfma_f32_32x32x16_bf16 v[204:219], v[52:55], v[64:67], v[204:219]
    ds_read_b64_tr_b16 v[48:49], v4 offset:16384
    ds_read_b64_tr_b16 v[50:51], v4 offset:17408
    v_mfma_f32_32x32x16_bf16 v[204:219], v[56:59], v[68:71], v[204:219]
    s_nop 1
    v_cvt_pk_bf16_f32 v220, v220, v221
    v_cvt_pk_bf16_f32 v221, v222, v223
    ds_read_b64_tr_b16 v[52:53], v5 offset:0
    ds_read_b64_tr_b16 v[54:55], v5 offset:1024
    s_waitcnt lgkmcnt(10)
    v_mfma_f32_32x32x16_bf16 v[204:219], v[28:31], v[72:75], v[204:219]
    v_cvt_pk_bf16_f32 v222, v224, v225
    v_cvt_pk_bf16_f32 v223, v226, v227
    ds_read_b64_tr_b16 v[56:57], v5 offset:2048
    ds_read_b64_tr_b16 v[58:59], v5 offset:3072
    v_mfma_f32_32x32x16_bf16 v[204:219], v[32:35], v[76:79], v[204:219]
    buffer_store_dwordx4 v[220:223], v10, s[28:31], s48 offen offset:0 sc1
    v_cvt_pk_bf16_f32 v228, v228, v229
    ds_read_b64_tr_b16 v[28:29], v5 offset:4096
    ds_read_b64_tr_b16 v[30:31], v5 offset:5120
    s_waitcnt lgkmcnt(10)
    v_mfma_f32_32x32x16_bf16 v[204:219], v[36:39], v[80:83], v[204:219]
    v_cvt_pk_bf16_f32 v229, v230, v231
    v_cvt_pk_bf16_f32 v230, v232, v233
    ds_read_b64_tr_b16 v[32:33], v5 offset:6144
    ds_read_b64_tr_b16 v[34:35], v5 offset:7168
    v_mfma_f32_32x32x16_bf16 v[204:219], v[40:43], v[84:87], v[204:219]
    v_cvt_pk_bf16_f32 v231, v234, v235
    buffer_store_dwordx4 v[228:231], v10, s[28:31], s48 offen offset:1024 sc1
    ds_read_b64_tr_b16 v[36:37], v5 offset:8192
    ds_read_b64_tr_b16 v[38:39], v5 offset:9216
    s_waitcnt lgkmcnt(10)
    v_mfma_f32_32x32x16_bf16 v[204:219], v[44:47], v[88:91], v[204:219]
    s_add_u32 s48, s48, 4096
    s_cmp_ge_u32 s48, s49
    s_cselect_b32 s44, 36864, 0
    s_sub_u32 s48, s48, s44
    s_waitcnt vmcnt(2)
    s_barrier
    ds_read_b64_tr_b16 v[40:41], v5 offset:10240
    ds_read_b64_tr_b16 v[42:43], v5 offset:11264
    v_mfma_f32_32x32x16_bf16 v[204:219], v[48:51], v[92:95], v[204:219]
    ds_read_b64_tr_b16 v[44:45], v5 offset:12288
    ds_read_b64_tr_b16 v[46:47], v5 offset:13312
    s_waitcnt lgkmcnt(10)
    v_mfma_f32_32x32x16_bf16 v[204:219], v[52:55], v[132:135], v[204:219]
    ds_read_b64_tr_b16 v[48:49], v5 offset:14336
    ds_read_b64_tr_b16 v[50:51], v5 offset:15360
    v_mfma_f32_32x32x16_bf16 v[204:219], v[56:59], v[136:139], v[204:219]
    ds_read_b64_tr_b16 v[52:53], v5 offset:16384
    ds_read_b64_tr_b16 v[54:55], v5 offset:17408
    s_waitcnt lgkmcnt(10)
    v_mfma_f32_32x32x16_bf16 v[204:219], v[28:31], v[140:143], v[204:219]
    v_add_u32 v4, 0, v6
    v_add_u32 v5, 0, v11
    ds_read_b64_tr_b16 v[56:57], v4 offset:0
    ds_read_b64_tr_b16 v[58:59], v4 offset:1024
    v_mfma_f32_32x32x16_bf16 v[204:219], v[32:35], v[144:147], v[204:219]
    ds_read_b64_tr_b16 v[28:29], v4 offset:2048
    ds_read_b64_tr_b16 v[30:31], v4 offset:3072
    s_waitcnt lgkmcnt(10)
    v_mfma_f32_32x32x16_bf16 v[204:219], v[36:39], v[148:151], v[204:219]
    ds_read_b64_tr_b16 v[32:33], v4 offset:4096
    ds_read_b64_tr_b16 v[34:35], v4 offset:5120
    v_mfma_f32_32x32x16_bf16 v[204:219], v[40:43], v[152:155], v[204:219]
    ds_read_b64_tr_b16 v[36:37], v4 offset:6144
    ds_read_b64_tr_b16 v[38:39], v4 offset:7168
    s_waitcnt lgkmcnt(10)
    v_mfma_f32_32x32x16_bf16 v[204:219], v[44:47], v[156:159], v[204:219]
    ds_read_b64_tr_b16 v[40:41], v4 offset:8192
    ds_read_b64_tr_b16 v[42:43], v4 offset:9216
    v_mfma_f32_32x32x16_bf16 v[204:219], v[48:51], v[160:163], v[204:219]
    ds_read_b64_tr_b16 v[44:45], v4 offset:10240
    ds_read_b64_tr_b16 v[46:47], v4 offset:11264
    s_waitcnt lgkmcnt(10)
    v_mfma_f32_32x32x16_bf16 v[204:219], v[52:55], v[164:167], v[204:219]
    ds_read_b64_tr_b16 v[48:49], v4 offset:12288
    ds_read_b64_tr_b16 v[50:51], v4 offset:13312
    v_mfma_f32_32x32x16_bf16 v[204:219], v[56:59], v[96:99], v[204:219]
    ds_read_b64_tr_b16 v[52:53], v4 offset:14336
    ds_read_b64_tr_b16 v[54:55], v4 offset:15360
    s_waitcnt lgkmcnt(10)
    v_mfma_f32_32x32x16_bf16 v[204:219], v[28:31], v[100:103], v[204:219]
    ds_read_b64_tr_b16 v[56:57], v4 offset:16384
    ds_read_b64_tr_b16 v[58:59], v4 offset:17408
    v_mfma_f32_32x32x16_bf16 v[204:219], v[32:35], v[104:107], v[204:219]
    ds_read_b64_tr_b16 v[28:29], v5 offset:0
    ds_read_b64_tr_b16 v[30:31], v5 offset:1024
    s_waitcnt lgkmcnt(10)
    v_mfma_f32_32x32x16_bf16 v[204:219], v[36:39], v[108:111], v[204:219]
    ds_read_b64_tr_b16 v[32:33], v5 offset:2048
    ds_read_b64_tr_b16 v[34:35], v5 offset:3072
    v_mfma_f32_32x32x16_bf16 v[204:219], v[40:43], v[112:115], v[204:219]
    ds_read_b64_tr_b16 v[36:37], v5 offset:4096
    ds_read_b64_tr_b16 v[38:39], v5 offset:5120
    s_waitcnt lgkmcnt(10)
    v_mfma_f32_32x32x16_bf16 v[204:219], v[44:47], v[116:119], v[204:219]
    ds_read_b64_tr_b16 v[40:41], v5 offset:6144
    ds_read_b64_tr_b16 v[42:43], v5 offset:7168
    v_mfma_f32_32x32x16_bf16 v[204:219], v[48:51], v[120:123], v[204:219]
    ds_read_b64_tr_b16 v[44:45], v5 offset:8192
    ds_read_b64_tr_b16 v[46:47], v5 offset:9216
    s_waitcnt lgkmcnt(10)
    v_mfma_f32_32x32x16_bf16 v[204:219], v[52:55], v[124:127], v[204:219]
    s_barrier
    ds_read_b64_tr_b16 v[48:49], v5 offset:10240
    ds_read_b64_tr_b16 v[50:51], v5 offset:11264
    v_mfma_f32_32x32x16_bf16 v[204:219], v[56:59], v[128:131], v[204:219]
    ds_read_b64_tr_b16 v[52:53], v5 offset:12288
    ds_read_b64_tr_b16 v[54:55], v5 offset:13312
    s_waitcnt lgkmcnt(10)
    v_mfma_f32_32x32x16_bf16 v[204:219], v[28:31], v[168:171], v[204:219]
    ds_read_b64_tr_b16 v[56:57], v5 offset:14336
    ds_read_b64_tr_b16 v[58:59], v5 offset:15360
    v_mfma_f32_32x32x16_bf16 v[204:219], v[32:35], v[172:175], v[204:219]
    ds_read_b64_tr_b16 v[28:29], v5 offset:16384
    ds_read_b64_tr_b16 v[30:31], v5 offset:17408
    s_waitcnt lgkmcnt(10)
    v_mfma_f32_32x32x16_bf16 v[204:219], v[36:39], v[176:179], v[204:219]
    v_add_u32 v4, 36864, v6
    v_add_u32 v5, 36864, v11
    ds_read_b64_tr_b16 v[32:33], v4 offset:0
    ds_read_b64_tr_b16 v[34:35], v4 offset:1024
    v_mfma_f32_32x32x16_bf16 v[204:219], v[40:43], v[180:183], v[204:219]
    ds_read_b64_tr_b16 v[36:37], v4 offset:2048
    ds_read_b64_tr_b16 v[38:39], v4 offset:3072
    s_waitcnt lgkmcnt(10)
    v_mfma_f32_32x32x16_bf16 v[204:219], v[44:47], v[184:187], v[204:219]
    ds_read_b64_tr_b16 v[40:41], v4 offset:4096
    ds_read_b64_tr_b16 v[42:43], v4 offset:5120
    v_mfma_f32_32x32x16_bf16 v[204:219], v[48:51], v[188:191], v[204:219]
    ds_read_b64_tr_b16 v[44:45], v4 offset:6144
    ds_read_b64_tr_b16 v[46:47], v4 offset:7168
    s_waitcnt lgkmcnt(10)
    v_mfma_f32_32x32x16_bf16 v[204:219], v[52:55], v[192:195], v[204:219]
    ds_read_b64_tr_b16 v[48:49], v4 offset:8192
    ds_read_b64_tr_b16 v[50:51], v4 offset:9216
    v_mfma_f32_32x32x16_bf16 v[204:219], v[56:59], v[196:199], v[204:219]
    ds_read_b64_tr_b16 v[52:53], v4 offset:10240
    ds_read_b64_tr_b16 v[54:55], v4 offset:11264
    s_waitcnt lgkmcnt(10)
    v_mfma_f32_32x32x16_bf16 v[204:219], v[28:31], v[200:203], v[204:219]
    ds_read_b64_tr_b16 v[56:57], v4 offset:12288
    ds_read_b64_tr_b16 v[58:59], v4 offset:13312
    v_mfma_f32_32x32x16_bf16 v[220:235], v[32:35], v[60:63], 0
    ds_read_b64_tr_b16 v[28:29], v4 offset:14336
    ds_read_b64_tr_b16 v[30:31], v4 offset:15360
    s_waitcnt lgkmcnt(10)
    v_mfma_f32_32x32x16_bf16 v[220:235], v[36:39], v[64:67], v[220:235]
    ds_read_b64_tr_b16 v[32:33], v4 offset:16384
    ds_read_b64_tr_b16 v[34:35], v4 offset:17408
    v_mfma_f32_32x32x16_bf16 v[220:235], v[40:43], v[68:71], v[220:235]
    s_nop 1
    v_cvt_pk_bf16_f32 v204, v204, v205
    v_cvt_pk_bf16_f32 v205, v206, v207
    ds_read_b64_tr_b16 v[36:37], v5 offset:0
    ds_read_b64_tr_b16 v[38:39], v5 offset:1024
    s_waitcnt lgkmcnt(10)
    v_mfma_f32_32x32x16_bf16 v[220:235], v[44:47], v[72:75], v[220:235]
    v_cvt_pk_bf16_f32 v206, v208, v209
    v_cvt_pk_bf16_f32 v207, v210, v211
    ds_read_b64_tr_b16 v[40:41], v5 offset:2048
    ds_read_b64_tr_b16 v[42:43], v5 offset:3072
    v_mfma_f32_32x32x16_bf16 v[220:235], v[48:51], v[76:79], v[220:235]
    buffer_store_dwordx4 v[204:207], v10, s[28:31], s48 offen offset:0 sc1
    v_cvt_pk_bf16_f32 v212, v212, v213
    ds_read_b64_tr_b16 v[44:45], v5 offset:4096
    ds_read_b64_tr_b16 v[46:47], v5 offset:5120
    s_waitcnt lgkmcnt(10)
    v_mfma_f32_32x32x16_bf16 v[220:235], v[52:55], v[80:83], v[220:235]
    v_cvt_pk_bf16_f32 v213, v214, v215
    v_cvt_pk_bf16_f32 v214, v216, v217
    ds_read_b64_tr_b16 v[48:49], v5 offset:6144
    ds_read_b64_tr_b16 v[50:51], v5 offset:7168
    v_mfma_f32_32x32x16_bf16 v[220:235], v[56:59], v[84:87], v[220:235]
    v_cvt_pk_bf16_f32 v215, v218, v219
    buffer_store_dwordx4 v[212:215], v10, s[28:31], s48 offen offset:1024 sc1
    ds_read_b64_tr_b16 v[52:53], v5 offset:8192
    ds_read_b64_tr_b16 v[54:55], v5 offset:9216
    s_waitcnt lgkmcnt(10)
    v_mfma_f32_32x32x16_bf16 v[220:235], v[28:31], v[88:91], v[220:235]
    s_add_u32 s48, s48, 4096
    s_cmp_ge_u32 s48, s49
    s_cselect_b32 s44, 36864, 0
    s_sub_u32 s48, s48, s44
    s_waitcnt vmcnt(2)
    s_barrier
    ds_read_b64_tr_b16 v[56:57], v5 offset:10240
    ds_read_b64_tr_b16 v[58:59], v5 offset:11264
    v_mfma_f32_32x32x16_bf16 v[220:235], v[32:35], v[92:95], v[220:235]
    ds_read_b64_tr_b16 v[28:29], v5 offset:12288
    ds_read_b64_tr_b16 v[30:31], v5 offset:13312
    s_waitcnt lgkmcnt(10)
    v_mfma_f32_32x32x16_bf16 v[220:235], v[36:39], v[132:135], v[220:235]
    ds_read_b64_tr_b16 v[32:33], v5 offset:14336
    ds_read_b64_tr_b16 v[34:35], v5 offset:15360
    v_mfma_f32_32x32x16_bf16 v[220:235], v[40:43], v[136:139], v[220:235]
    ds_read_b64_tr_b16 v[36:37], v5 offset:16384
    ds_read_b64_tr_b16 v[38:39], v5 offset:17408
    s_waitcnt lgkmcnt(10)
    v_mfma_f32_32x32x16_bf16 v[220:235], v[44:47], v[140:143], v[220:235]
    v_add_u32 v4, 73728, v6
    v_add_u32 v5, 73728, v11
    ds_read_b64_tr_b16 v[40:41], v4 offset:0
    ds_read_b64_tr_b16 v[42:43], v4 offset:1024
    v_mfma_f32_32x32x16_bf16 v[220:235], v[48:51], v[144:147], v[220:235]
    ds_read_b64_tr_b16 v[44:45], v4 offset:2048
    ds_read_b64_tr_b16 v[46:47], v4 offset:3072
    s_waitcnt lgkmcnt(10)
    v_mfma_f32_32x32x16_bf16 v[220:235], v[52:55], v[148:151], v[220:235]
    ds_read_b64_tr_b16 v[48:49], v4 offset:4096
    ds_read_b64_tr_b16 v[50:51], v4 offset:5120
    v_mfma_f32_32x32x16_bf16 v[220:235], v[56:59], v[152:155], v[220:235]
    ds_read_b64_tr_b16 v[52:53], v4 offset:6144
    ds_read_b64_tr_b16 v[54:55], v4 offset:7168
    s_waitcnt lgkmcnt(10)
    v_mfma_f32_32x32x16_bf16 v[220:235], v[28:31], v[156:159], v[220:235]
    ds_read_b64_tr_b16 v[56:57], v4 offset:8192
    ds_read_b64_tr_b16 v[58:59], v4 offset:9216
    v_mfma_f32_32x32x16_bf16 v[220:235], v[32:35], v[160:163], v[220:235]
    ds_read_b64_tr_b16 v[28:29], v4 offset:10240
    ds_read_b64_tr_b16 v[30:31], v4 offset:11264
    s_waitcnt lgkmcnt(10)
    v_mfma_f32_32x32x16_bf16 v[220:235], v[36:39], v[164:167], v[220:235]
    ds_read_b64_tr_b16 v[32:33], v4 offset:12288
    ds_read_b64_tr_b16 v[34:35], v4 offset:13312
    v_mfma_f32_32x32x16_bf16 v[220:235], v[40:43], v[96:99], v[220:235]
    ds_read_b64_tr_b16 v[36:37], v4 offset:14336
    ds_read_b64_tr_b16 v[38:39], v4 offset:15360
    s_waitcnt lgkmcnt(10)
    v_mfma_f32_32x32x16_bf16 v[220:235], v[44:47], v[100:103], v[220:235]
    ds_read_b64_tr_b16 v[40:41], v4 offset:16384
    ds_read_b64_tr_b16 v[42:43], v4 offset:17408
    v_mfma_f32_32x32x16_bf16 v[220:235], v[48:51], v[104:107], v[220:235]
    ds_read_b64_tr_b16 v[44:45], v5 offset:0
    ds_read_b64_tr_b16 v[46:47], v5 offset:1024
    s_waitcnt lgkmcnt(10)
    v_mfma_f32_32x32x16_bf16 v[220:235], v[52:55], v[108:111], v[220:235]
    ds_read_b64_tr_b16 v[48:49], v5 offset:2048
    ds_read_b64_tr_b16 v[50:51], v5 offset:3072
    v_mfma_f32_32x32x16_bf16 v[220:235], v[56:59], v[112:115], v[220:235]
    ds_read_b64_tr_b16 v[52:53], v5 offset:4096
    ds_read_b64_tr_b16 v[54:55], v5 offset:5120
    s_waitcnt lgkmcnt(10)
    v_mfma_f32_32x32x16_bf16 v[220:235], v[28:31], v[116:119], v[220:235]
    ds_read_b64_tr_b16 v[56:57], v5 offset:6144
    ds_read_b64_tr_b16 v[58:59], v5 offset:7168
    v_mfma_f32_32x32x16_bf16 v[220:235], v[32:35], v[120:123], v[220:235]
    ds_read_b64_tr_b16 v[28:29], v5 offset:8192
    ds_read_b64_tr_b16 v[30:31], v5 offset:9216
    s_waitcnt lgkmcnt(10)
    v_mfma_f32_32x32x16_bf16 v[220:235], v[36:39], v[124:127], v[220:235]
    s_barrier
    ds_read_b64_tr_b16 v[32:33], v5 offset:10240
    ds_read_b64_tr_b16 v[34:35], v5 offset:11264
    v_mfma_f32_32x32x16_bf16 v[220:235], v[40:43], v[128:131], v[220:235]
    ds_read_b64_tr_b16 v[36:37], v5 offset:12288
    ds_read_b64_tr_b16 v[38:39], v5 offset:13312
    s_waitcnt lgkmcnt(10)
    v_mfma_f32_32x32x16_bf16 v[220:235], v[44:47], v[168:171], v[220:235]
    ds_read_b64_tr_b16 v[40:41], v5 offset:14336
    ds_read_b64_tr_b16 v[42:43], v5 offset:15360
    v_mfma_f32_32x32x16_bf16 v[220:235], v[48:51], v[172:175], v[220:235]
    ds_read_b64_tr_b16 v[44:45], v5 offset:16384
    ds_read_b64_tr_b16 v[46:47], v5 offset:17408
    s_waitcnt lgkmcnt(10)
    v_mfma_f32_32x32x16_bf16 v[220:235], v[52:55], v[176:179], v[220:235]
    v_add_u32 v4, 110592, v6
    v_add_u32 v5, 110592, v11
    ds_read_b64_tr_b16 v[48:49], v4 offset:0
    ds_read_b64_tr_b16 v[50:51], v4 offset:1024
    v_mfma_f32_32x32x16_bf16 v[220:235], v[56:59], v[180:183], v[220:235]
    ds_read_b64_tr_b16 v[52:53], v4 offset:2048
    ds_read_b64_tr_b16 v[54:55], v4 offset:3072
    s_waitcnt lgkmcnt(10)
    v_mfma_f32_32x32x16_bf16 v[220:235], v[28:31], v[184:187], v[220:235]
    ds_read_b64_tr_b16 v[56:57], v4 offset:4096
    ds_read_b64_tr_b16 v[58:59], v4 offset:5120
    v_mfma_f32_32x32x16_bf16 v[220:235], v[32:35], v[188:191], v[220:235]
    ds_read_b64_tr_b16 v[28:29], v4 offset:6144
    ds_read_b64_tr_b16 v[30:31], v4 offset:7168
    s_waitcnt lgkmcnt(10)
    v_mfma_f32_32x32x16_bf16 v[220:235], v[36:39], v[192:195], v[220:235]
    ds_read_b64_tr_b16 v[32:33], v4 offset:8192
    ds_read_b64_tr_b16 v[34:35], v4 offset:9216
    v_mfma_f32_32x32x16_bf16 v[220:235], v[40:43], v[196:199], v[220:235]
    ds_read_b64_tr_b16 v[36:37], v4 offset:10240
    ds_read_b64_tr_b16 v[38:39], v4 offset:11264
    s_waitcnt lgkmcnt(10)
    v_mfma_f32_32x32x16_bf16 v[220:235], v[44:47], v[200:203], v[220:235]
    ds_read_b64_tr_b16 v[40:41], v4 offset:12288
    ds_read_b64_tr_b16 v[42:43], v4 offset:13312
    v_mfma_f32_32x32x16_bf16 v[204:219], v[48:51], v[60:63], 0
    ds_read_b64_tr_b16 v[44:45], v4 offset:14336
    ds_read_b64_tr_b16 v[46:47], v4 offset:15360
    s_waitcnt lgkmcnt(10)
    v_mfma_f32_32x32x16_bf16 v[204:219], v[52:55], v[64:67], v[204:219]
    ds_read_b64_tr_b16 v[48:49], v4 offset:16384
    ds_read_b64_tr_b16 v[50:51], v4 offset:17408
    v_mfma_f32_32x32x16_bf16 v[204:219], v[56:59], v[68:71], v[204:219]
    s_nop 1
    v_cvt_pk_bf16_f32 v220, v220, v221
    v_cvt_pk_bf16_f32 v221, v222, v223
    ds_read_b64_tr_b16 v[52:53], v5 offset:0
    ds_read_b64_tr_b16 v[54:55], v5 offset:1024
    s_waitcnt lgkmcnt(10)
    v_mfma_f32_32x32x16_bf16 v[204:219], v[28:31], v[72:75], v[204:219]
    v_cvt_pk_bf16_f32 v222, v224, v225
    v_cvt_pk_bf16_f32 v223, v226, v227
    ds_read_b64_tr_b16 v[56:57], v5 offset:2048
    ds_read_b64_tr_b16 v[58:59], v5 offset:3072
    v_mfma_f32_32x32x16_bf16 v[204:219], v[32:35], v[76:79], v[204:219]
    buffer_store_dwordx4 v[220:223], v10, s[28:31], s48 offen offset:0 sc1
    v_cvt_pk_bf16_f32 v228, v228, v229
    ds_read_b64_tr_b16 v[28:29], v5 offset:4096
    ds_read_b64_tr_b16 v[30:31], v5 offset:5120
    s_waitcnt lgkmcnt(10)
    v_mfma_f32_32x32x16_bf16 v[204:219], v[36:39], v[80:83], v[204:219]
    v_cvt_pk_bf16_f32 v229, v230, v231
    v_cvt_pk_bf16_f32 v230, v232, v233
    ds_read_b64_tr_b16 v[32:33], v5 offset:6144
    ds_read_b64_tr_b16 v[34:35], v5 offset:7168
    v_mfma_f32_32x32x16_bf16 v[204:219], v[40:43], v[84:87], v[204:219]
    v_cvt_pk_bf16_f32 v231, v234, v235
    buffer_store_dwordx4 v[228:231], v10, s[28:31], s48 offen offset:1024 sc1
    ds_read_b64_tr_b16 v[36:37], v5 offset:8192
    ds_read_b64_tr_b16 v[38:39], v5 offset:9216
    s_waitcnt lgkmcnt(10)
    v_mfma_f32_32x32x16_bf16 v[204:219], v[44:47], v[88:91], v[204:219]
    s_add_u32 s48, s48, 4096
    s_cmp_ge_u32 s48, s49
    s_cselect_b32 s44, 36864, 0
    s_sub_u32 s48, s48, s44
    s_waitcnt vmcnt(2)
    s_barrier
    ds_read_b64_tr_b16 v[40:41], v5 offset:10240
    ds_read_b64_tr_b16 v[42:43], v5 offset:11264
    v_mfma_f32_32x32x16_bf16 v[204:219], v[48:51], v[92:95], v[204:219]
    ds_read_b64_tr_b16 v[44:45], v5 offset:12288
    ds_read_b64_tr_b16 v[46:47], v5 offset:13312
    s_waitcnt lgkmcnt(10)
    v_mfma_f32_32x32x16_bf16 v[204:219], v[52:55], v[132:135], v[204:219]
    ds_read_b64_tr_b16 v[48:49], v5 offset:14336
    ds_read_b64_tr_b16 v[50:51], v5 offset:15360
    v_mfma_f32_32x32x16_bf16 v[204:219], v[56:59], v[136:139], v[204:219]
    ds_read_b64_tr_b16 v[52:53], v5 offset:16384
    ds_read_b64_tr_b16 v[54:55], v5 offset:17408
    s_waitcnt lgkmcnt(10)
    v_mfma_f32_32x32x16_bf16 v[204:219], v[28:31], v[140:143], v[204:219]
    v_add_u32 v4, 0, v6
    v_add_u32 v5, 0, v11
    ds_read_b64_tr_b16 v[56:57], v4 offset:0
    ds_read_b64_tr_b16 v[58:59], v4 offset:1024
    v_mfma_f32_32x32x16_bf16 v[204:219], v[32:35], v[144:147], v[204:219]
    ds_read_b64_tr_b16 v[28:29], v4 offset:2048
    ds_read_b64_tr_b16 v[30:31], v4 offset:3072
    s_waitcnt lgkmcnt(10)
    v_mfma_f32_32x32x16_bf16 v[204:219], v[36:39], v[148:151], v[204:219]
    ds_read_b64_tr_b16 v[32:33], v4 offset:4096
    ds_read_b64_tr_b16 v[34:35], v4 offset:5120
    v_mfma_f32_32x32x16_bf16 v[204:219], v[40:43], v[152:155], v[204:219]
    ds_read_b64_tr_b16 v[36:37], v4 offset:6144
    ds_read_b64_tr_b16 v[38:39], v4 offset:7168
    s_waitcnt lgkmcnt(10)
    v_mfma_f32_32x32x16_bf16 v[204:219], v[44:47], v[156:159], v[204:219]
    ds_read_b64_tr_b16 v[40:41], v4 offset:8192
    ds_read_b64_tr_b16 v[42:43], v4 offset:9216
    v_mfma_f32_32x32x16_bf16 v[204:219], v[48:51], v[160:163], v[204:219]
    ds_read_b64_tr_b16 v[44:45], v4 offset:10240
    ds_read_b64_tr_b16 v[46:47], v4 offset:11264
    s_waitcnt lgkmcnt(10)
    v_mfma_f32_32x32x16_bf16 v[204:219], v[52:55], v[164:167], v[204:219]
    ds_read_b64_tr_b16 v[48:49], v4 offset:12288
    ds_read_b64_tr_b16 v[50:51], v4 offset:13312
    v_mfma_f32_32x32x16_bf16 v[204:219], v[56:59], v[96:99], v[204:219]
    ds_read_b64_tr_b16 v[52:53], v4 offset:14336
    ds_read_b64_tr_b16 v[54:55], v4 offset:15360
    s_waitcnt lgkmcnt(10)
    v_mfma_f32_32x32x16_bf16 v[204:219], v[28:31], v[100:103], v[204:219]
    ds_read_b64_tr_b16 v[56:57], v4 offset:16384
    ds_read_b64_tr_b16 v[58:59], v4 offset:17408
    v_mfma_f32_32x32x16_bf16 v[204:219], v[32:35], v[104:107], v[204:219]
    ds_read_b64_tr_b16 v[28:29], v5 offset:0
    ds_read_b64_tr_b16 v[30:31], v5 offset:1024
    s_waitcnt lgkmcnt(10)
    v_mfma_f32_32x32x16_bf16 v[204:219], v[36:39], v[108:111], v[204:219]
    ds_read_b64_tr_b16 v[32:33], v5 offset:2048
    ds_read_b64_tr_b16 v[34:35], v5 offset:3072
    v_mfma_f32_32x32x16_bf16 v[204:219], v[40:43], v[112:115], v[204:219]
    ds_read_b64_tr_b16 v[36:37], v5 offset:4096
    ds_read_b64_tr_b16 v[38:39], v5 offset:5120
    s_waitcnt lgkmcnt(10)
    v_mfma_f32_32x32x16_bf16 v[204:219], v[44:47], v[116:119], v[204:219]
    ds_read_b64_tr_b16 v[40:41], v5 offset:6144
    ds_read_b64_tr_b16 v[42:43], v5 offset:7168
    v_mfma_f32_32x32x16_bf16 v[204:219], v[48:51], v[120:123], v[204:219]
    ds_read_b64_tr_b16 v[44:45], v5 offset:8192
    ds_read_b64_tr_b16 v[46:47], v5 offset:9216
    s_waitcnt lgkmcnt(10)
    v_mfma_f32_32x32x16_bf16 v[204:219], v[52:55], v[124:127], v[204:219]
    s_barrier
    ds_read_b64_tr_b16 v[48:49], v5 offset:10240
    ds_read_b64_tr_b16 v[50:51], v5 offset:11264
    v_mfma_f32_32x32x16_bf16 v[204:219], v[56:59], v[128:131], v[204:219]
    ds_read_b64_tr_b16 v[52:53], v5 offset:12288
    ds_read_b64_tr_b16 v[54:55], v5 offset:13312
    s_waitcnt lgkmcnt(10)
    v_mfma_f32_32x32x16_bf16 v[204:219], v[28:31], v[168:171], v[204:219]
    ds_read_b64_tr_b16 v[56:57], v5 offset:14336
    ds_read_b64_tr_b16 v[58:59], v5 offset:15360
    v_mfma_f32_32x32x16_bf16 v[204:219], v[32:35], v[172:175], v[204:219]
    ds_read_b64_tr_b16 v[28:29], v5 offset:16384
    ds_read_b64_tr_b16 v[30:31], v5 offset:17408
    s_waitcnt lgkmcnt(10)
    v_mfma_f32_32x32x16_bf16 v[204:219], v[36:39], v[176:179], v[204:219]
    v_add_u32 v4, 36864, v6
    v_add_u32 v5, 36864, v11
    ds_read_b64_tr_b16 v[32:33], v4 offset:0
    ds_read_b64_tr_b16 v[34:35], v4 offset:1024
    v_mfma_f32_32x32x16_bf16 v[204:219], v[40:43], v[180:183], v[204:219]
    ds_read_b64_tr_b16 v[36:37], v4 offset:2048
    ds_read_b64_tr_b16 v[38:39], v4 offset:3072
    s_waitcnt lgkmcnt(10)
    v_mfma_f32_32x32x16_bf16 v[204:219], v[44:47], v[184:187], v[204:219]
    ds_read_b64_tr_b16 v[40:41], v4 offset:4096
    ds_read_b64_tr_b16 v[42:43], v4 offset:5120
    v_mfma_f32_32x32x16_bf16 v[204:219], v[48:51], v[188:191], v[204:219]
    ds_read_b64_tr_b16 v[44:45], v4 offset:6144
    ds_read_b64_tr_b16 v[46:47], v4 offset:7168
    s_waitcnt lgkmcnt(10)
    v_mfma_f32_32x32x16_bf16 v[204:219], v[52:55], v[192:195], v[204:219]
    ds_read_b64_tr_b16 v[48:49], v4 offset:8192
    ds_read_b64_tr_b16 v[50:51], v4 offset:9216
    v_mfma_f32_32x32x16_bf16 v[204:219], v[56:59], v[196:199], v[204:219]
    ds_read_b64_tr_b16 v[52:53], v4 offset:10240
    ds_read_b64_tr_b16 v[54:55], v4 offset:11264
    s_waitcnt lgkmcnt(10)
    v_mfma_f32_32x32x16_bf16 v[204:219], v[28:31], v[200:203], v[204:219]
    ds_read_b64_tr_b16 v[56:57], v4 offset:12288
    ds_read_b64_tr_b16 v[58:59], v4 offset:13312
    v_mfma_f32_32x32x16_bf16 v[220:235], v[32:35], v[60:63], 0
    ds_read_b64_tr_b16 v[28:29], v4 offset:14336
    ds_read_b64_tr_b16 v[30:31], v4 offset:15360
    s_waitcnt lgkmcnt(10)
    v_mfma_f32_32x32x16_bf16 v[220:235], v[36:39], v[64:67], v[220:235]
    ds_read_b64_tr_b16 v[32:33], v4 offset:16384
    ds_read_b64_tr_b16 v[34:35], v4 offset:17408
    v_mfma_f32_32x32x16_bf16 v[220:235], v[40:43], v[68:71], v[220:235]
    s_nop 1
    v_cvt_pk_bf16_f32 v204, v204, v205
    v_cvt_pk_bf16_f32 v205, v206, v207
    ds_read_b64_tr_b16 v[36:37], v5 offset:0
    ds_read_b64_tr_b16 v[38:39], v5 offset:1024
    s_waitcnt lgkmcnt(10)
    v_mfma_f32_32x32x16_bf16 v[220:235], v[44:47], v[72:75], v[220:235]
    v_cvt_pk_bf16_f32 v206, v208, v209
    v_cvt_pk_bf16_f32 v207, v210, v211
    ds_read_b64_tr_b16 v[40:41], v5 offset:2048
    ds_read_b64_tr_b16 v[42:43], v5 offset:3072
    v_mfma_f32_32x32x16_bf16 v[220:235], v[48:51], v[76:79], v[220:235]
    buffer_store_dwordx4 v[204:207], v10, s[28:31], s48 offen offset:0 sc1
    v_cvt_pk_bf16_f32 v212, v212, v213
    ds_read_b64_tr_b16 v[44:45], v5 offset:4096
    ds_read_b64_tr_b16 v[46:47], v5 offset:5120
    s_waitcnt lgkmcnt(10)
    v_mfma_f32_32x32x16_bf16 v[220:235], v[52:55], v[80:83], v[220:235]
    v_cvt_pk_bf16_f32 v213, v214, v215
    v_cvt_pk_bf16_f32 v214, v216, v217
    ds_read_b64_tr_b16 v[48:49], v5 offset:6144
    ds_read_b64_tr_b16 v[50:51], v5 offset:7168
    v_mfma_f32_32x32x16_bf16 v[220:235], v[56:59], v[84:87], v[220:235]
    v_cvt_pk_bf16_f32 v215, v218, v219
    buffer_store_dwordx4 v[212:215], v10, s[28:31], s48 offen offset:1024 sc1
    ds_read_b64_tr_b16 v[52:53], v5 offset:8192
    ds_read_b64_tr_b16 v[54:55], v5 offset:9216
    s_waitcnt lgkmcnt(10)
    v_mfma_f32_32x32x16_bf16 v[220:235], v[28:31], v[88:91], v[220:235]
    s_add_u32 s48, s48, 4096
    s_cmp_ge_u32 s48, s49
    s_cselect_b32 s44, 36864, 0
    s_sub_u32 s48, s48, s44
    s_waitcnt vmcnt(2)
    s_barrier
    ds_read_b64_tr_b16 v[56:57], v5 offset:10240
    ds_read_b64_tr_b16 v[58:59], v5 offset:11264
    v_mfma_f32_32x32x16_bf16 v[220:235], v[32:35], v[92:95], v[220:235]
    ds_read_b64_tr_b16 v[28:29], v5 offset:12288
    ds_read_b64_tr_b16 v[30:31], v5 offset:13312
    s_waitcnt lgkmcnt(10)
    v_mfma_f32_32x32x16_bf16 v[220:235], v[36:39], v[132:135], v[220:235]
    ds_read_b64_tr_b16 v[32:33], v5 offset:14336
    ds_read_b64_tr_b16 v[34:35], v5 offset:15360
    v_mfma_f32_32x32x16_bf16 v[220:235], v[40:43], v[136:139], v[220:235]
    ds_read_b64_tr_b16 v[36:37], v5 offset:16384
    ds_read_b64_tr_b16 v[38:39], v5 offset:17408
    s_waitcnt lgkmcnt(10)
    v_mfma_f32_32x32x16_bf16 v[220:235], v[44:47], v[140:143], v[220:235]
    v_add_u32 v4, 73728, v6
    v_add_u32 v5, 73728, v11
    ds_read_b64_tr_b16 v[40:41], v4 offset:0
    ds_read_b64_tr_b16 v[42:43], v4 offset:1024
    v_mfma_f32_32x32x16_bf16 v[220:235], v[48:51], v[144:147], v[220:235]
    ds_read_b64_tr_b16 v[44:45], v4 offset:2048
    ds_read_b64_tr_b16 v[46:47], v4 offset:3072
    s_waitcnt lgkmcnt(10)
    v_mfma_f32_32x32x16_bf16 v[220:235], v[52:55], v[148:151], v[220:235]
    ds_read_b64_tr_b16 v[48:49], v4 offset:4096
    ds_read_b64_tr_b16 v[50:51], v4 offset:5120
    v_mfma_f32_32x32x16_bf16 v[220:235], v[56:59], v[152:155], v[220:235]
    ds_read_b64_tr_b16 v[52:53], v4 offset:6144
    ds_read_b64_tr_b16 v[54:55], v4 offset:7168
    s_waitcnt lgkmcnt(10)
    v_mfma_f32_32x32x16_bf16 v[220:235], v[28:31], v[156:159], v[220:235]
    ds_read_b64_tr_b16 v[56:57], v4 offset:8192
    ds_read_b64_tr_b16 v[58:59], v4 offset:9216
    v_mfma_f32_32x32x16_bf16 v[220:235], v[32:35], v[160:163], v[220:235]
    ds_read_b64_tr_b16 v[28:29], v4 offset:10240
    ds_read_b64_tr_b16 v[30:31], v4 offset:11264
    s_waitcnt lgkmcnt(10)
    v_mfma_f32_32x32x16_bf16 v[220:235], v[36:39], v[164:167], v[220:235]
    ds_read_b64_tr_b16 v[32:33], v4 offset:12288
    ds_read_b64_tr_b16 v[34:35], v4 offset:13312
    v_mfma_f32_32x32x16_bf16 v[220:235], v[40:43], v[96:99], v[220:235]
    ds_read_b64_tr_b16 v[36:37], v4 offset:14336
    ds_read_b64_tr_b16 v[38:39], v4 offset:15360
    s_waitcnt lgkmcnt(10)
    v_mfma_f32_32x32x16_bf16 v[220:235], v[44:47], v[100:103], v[220:235]
    ds_read_b64_tr_b16 v[40:41], v4 offset:16384
    ds_read_b64_tr_b16 v[42:43], v4 offset:17408
    v_mfma_f32_32x32x16_bf16 v[220:235], v[48:51], v[104:107], v[220:235]
    ds_read_b64_tr_b16 v[44:45], v5 offset:0
    ds_read_b64_tr_b16 v[46:47], v5 offset:1024
    s_waitcnt lgkmcnt(10)
    v_mfma_f32_32x32x16_bf16 v[220:235], v[52:55], v[108:111], v[220:235]
    ds_read_b64_tr_b16 v[48:49], v5 offset:2048
    ds_read_b64_tr_b16 v[50:51], v5 offset:3072
    v_mfma_f32_32x32x16_bf16 v[220:235], v[56:59], v[112:115], v[220:235]
    ds_read_b64_tr_b16 v[52:53], v5 offset:4096
    ds_read_b64_tr_b16 v[54:55], v5 offset:5120
    s_waitcnt lgkmcnt(10)
    v_mfma_f32_32x32x16_bf16 v[220:235], v[28:31], v[116:119], v[220:235]
    ds_read_b64_tr_b16 v[56:57], v5 offset:6144
    ds_read_b64_tr_b16 v[58:59], v5 offset:7168
    v_mfma_f32_32x32x16_bf16 v[220:235], v[32:35], v[120:123], v[220:235]
    ds_read_b64_tr_b16 v[28:29], v5 offset:8192
    ds_read_b64_tr_b16 v[30:31], v5 offset:9216
    s_waitcnt lgkmcnt(10)
    v_mfma_f32_32x32x16_bf16 v[220:235], v[36:39], v[124:127], v[220:235]
    s_barrier
    ds_read_b64_tr_b16 v[32:33], v5 offset:10240
    ds_read_b64_tr_b16 v[34:35], v5 offset:11264
    v_mfma_f32_32x32x16_bf16 v[220:235], v[40:43], v[128:131], v[220:235]
    ds_read_b64_tr_b16 v[36:37], v5 offset:12288
    ds_read_b64_tr_b16 v[38:39], v5 offset:13312
    s_waitcnt lgkmcnt(10)
    v_mfma_f32_32x32x16_bf16 v[220:235], v[44:47], v[168:171], v[220:235]
    ds_read_b64_tr_b16 v[40:41], v5 offset:14336
    ds_read_b64_tr_b16 v[42:43], v5 offset:15360
    v_mfma_f32_32x32x16_bf16 v[220:235], v[48:51], v[172:175], v[220:235]
    ds_read_b64_tr_b16 v[44:45], v5 offset:16384
    ds_read_b64_tr_b16 v[46:47], v5 offset:17408
    s_waitcnt lgkmcnt(10)
    v_mfma_f32_32x32x16_bf16 v[220:235], v[52:55], v[176:179], v[220:235]
    v_add_u32 v4, 110592, v6
    v_add_u32 v5, 110592, v11
    ds_read_b64_tr_b16 v[48:49], v4 offset:0
    ds_read_b64_tr_b16 v[50:51], v4 offset:1024
    v_mfma_f32_32x32x16_bf16 v[220:235], v[56:59], v[180:183], v[220:235]
    ds_read_b64_tr_b16 v[52:53], v4 offset:2048
    ds_read_b64_tr_b16 v[54:55], v4 offset:3072
    s_waitcnt lgkmcnt(10)
    v_mfma_f32_32x32x16_bf16 v[220:235], v[28:31], v[184:187], v[220:235]
    ds_read_b64_tr_b16 v[56:57], v4 offset:4096
    ds_read_b64_tr_b16 v[58:59], v4 offset:5120
    v_mfma_f32_32x32x16_bf16 v[220:235], v[32:35], v[188:191], v[220:235]
    ds_read_b64_tr_b16 v[28:29], v4 offset:6144
    ds_read_b64_tr_b16 v[30:31], v4 offset:7168
    s_waitcnt lgkmcnt(10)
    v_mfma_f32_32x32x16_bf16 v[220:235], v[36:39], v[192:195], v[220:235]
    ds_read_b64_tr_b16 v[32:33], v4 offset:8192
    ds_read_b64_tr_b16 v[34:35], v4 offset:9216
    v_mfma_f32_32x32x16_bf16 v[220:235], v[40:43], v[196:199], v[220:235]
    ds_read_b64_tr_b16 v[36:37], v4 offset:10240
    ds_read_b64_tr_b16 v[38:39], v4 offset:11264
    s_waitcnt lgkmcnt(10)
    v_mfma_f32_32x32x16_bf16 v[220:235], v[44:47], v[200:203], v[220:235]
    ds_read_b64_tr_b16 v[40:41], v4 offset:12288
    ds_read_b64_tr_b16 v[42:43], v4 offset:13312
    v_mfma_f32_32x32x16_bf16 v[204:219], v[48:51], v[60:63], 0
    ds_read_b64_tr_b16 v[44:45], v4 offset:14336
    ds_read_b64_tr_b16 v[46:47], v4 offset:15360
    s_waitcnt lgkmcnt(10)
    v_mfma_f32_32x32x16_bf16 v[204:219], v[52:55], v[64:67], v[204:219]
    ds_read_b64_tr_b16 v[48:49], v4 offset:16384
    ds_read_b64_tr_b16 v[50:51], v4 offset:17408
    v_mfma_f32_32x32x16_bf16 v[204:219], v[56:59], v[68:71], v[204:219]
    s_nop 1
    v_cvt_pk_bf16_f32 v220, v220, v221
    v_cvt_pk_bf16_f32 v221, v222, v223
    ds_read_b64_tr_b16 v[52:53], v5 offset:0
    ds_read_b64_tr_b16 v[54:55], v5 offset:1024
    s_waitcnt lgkmcnt(10)
    v_mfma_f32_32x32x16_bf16 v[204:219], v[28:31], v[72:75], v[204:219]
    v_cvt_pk_bf16_f32 v222, v224, v225
    v_cvt_pk_bf16_f32 v223, v226, v227
    ds_read_b64_tr_b16 v[56:57], v5 offset:2048
    ds_read_b64_tr_b16 v[58:59], v5 offset:3072
    v_mfma_f32_32x32x16_bf16 v[204:219], v[32:35], v[76:79], v[204:219]
    buffer_store_dwordx4 v[220:223], v10, s[28:31], s48 offen offset:0 sc1
    v_cvt_pk_bf16_f32 v228, v228, v229
    ds_read_b64_tr_b16 v[28:29], v5 offset:4096
    ds_read_b64_tr_b16 v[30:31], v5 offset:5120
    s_waitcnt lgkmcnt(10)
    v_mfma_f32_32x32x16_bf16 v[204:219], v[36:39], v[80:83], v[204:219]
    v_cvt_pk_bf16_f32 v229, v230, v231
    v_cvt_pk_bf16_f32 v230, v232, v233
    ds_read_b64_tr_b16 v[32:33], v5 offset:6144
    ds_read_b64_tr_b16 v[34:35], v5 offset:7168
    v_mfma_f32_32x32x16_bf16 v[204:219], v[40:43], v[84:87], v[204:219]
    v_cvt_pk_bf16_f32 v231, v234, v235
    buffer_store_dwordx4 v[228:231], v10, s[28:31], s48 offen offset:1024 sc1
    ds_read_b64_tr_b16 v[36:37], v5 offset:8192
    ds_read_b64_tr_b16 v[38:39], v5 offset:9216
    s_waitcnt lgkmcnt(10)
    v_mfma_f32_32x32x16_bf16 v[204:219], v[44:47], v[88:91], v[204:219]
    s_add_u32 s48, s48, 4096
    s_cmp_ge_u32 s48, s49
    s_cselect_b32 s44, 36864, 0
    s_sub_u32 s48, s48, s44
    s_waitcnt vmcnt(2)
    s_barrier
    ds_read_b64_tr_b16 v[40:41], v5 offset:10240
    ds_read_b64_tr_b16 v[42:43], v5 offset:11264
    v_mfma_f32_32x32x16_bf16 v[204:219], v[48:51], v[92:95], v[204:219]
    ds_read_b64_tr_b16 v[44:45], v5 offset:12288
    ds_read_b64_tr_b16 v[46:47], v5 offset:13312
    s_waitcnt lgkmcnt(10)
    v_mfma_f32_32x32x16_bf16 v[204:219], v[52:55], v[132:135], v[204:219]
    ds_read_b64_tr_b16 v[48:49], v5 offset:14336
    ds_read_b64_tr_b16 v[50:51], v5 offset:15360
    v_mfma_f32_32x32x16_bf16 v[204:219], v[56:59], v[136:139], v[204:219]
    ds_read_b64_tr_b16 v[52:53], v5 offset:16384
    ds_read_b64_tr_b16 v[54:55], v5 offset:17408
    s_waitcnt lgkmcnt(10)
    v_mfma_f32_32x32x16_bf16 v[204:219], v[28:31], v[140:143], v[204:219]
    v_add_u32 v4, 0, v6
    v_add_u32 v5, 0, v11
    ds_read_b64_tr_b16 v[56:57], v4 offset:0
    ds_read_b64_tr_b16 v[58:59], v4 offset:1024
    v_mfma_f32_32x32x16_bf16 v[204:219], v[32:35], v[144:147], v[204:219]
    ds_read_b64_tr_b16 v[28:29], v4 offset:2048
    ds_read_b64_tr_b16 v[30:31], v4 offset:3072
    s_waitcnt lgkmcnt(10)
    v_mfma_f32_32x32x16_bf16 v[204:219], v[36:39], v[148:151], v[204:219]
    ds_read_b64_tr_b16 v[32:33], v4 offset:4096
    ds_read_b64_tr_b16 v[34:35], v4 offset:5120
    v_mfma_f32_32x32x16_bf16 v[204:219], v[40:43], v[152:155], v[204:219]
    ds_read_b64_tr_b16 v[36:37], v4 offset:6144
    ds_read_b64_tr_b16 v[38:39], v4 offset:7168
    s_waitcnt lgkmcnt(10)
    v_mfma_f32_32x32x16_bf16 v[204:219], v[44:47], v[156:159], v[204:219]
    ds_read_b64_tr_b16 v[40:41], v4 offset:8192
    ds_read_b64_tr_b16 v[42:43], v4 offset:9216
    v_mfma_f32_32x32x16_bf16 v[204:219], v[48:51], v[160:163], v[204:219]
    ds_read_b64_tr_b16 v[44:45], v4 offset:10240
    ds_read_b64_tr_b16 v[46:47], v4 offset:11264
    s_waitcnt lgkmcnt(10)
    v_mfma_f32_32x32x16_bf16 v[204:219], v[52:55], v[164:167], v[204:219]
    ds_read_b64_tr_b16 v[48:49], v4 offset:12288
    ds_read_b64_tr_b16 v[50:51], v4 offset:13312
    v_mfma_f32_32x32x16_bf16 v[204:219], v[56:59], v[96:99], v[204:219]
    ds_read_b64_tr_b16 v[52:53], v4 offset:14336
    ds_read_b64_tr_b16 v[54:55], v4 offset:15360
    s_waitcnt lgkmcnt(10)
    v_mfma_f32_32x32x16_bf16 v[204:219], v[28:31], v[100:103], v[204:219]
    ds_read_b64_tr_b16 v[56:57], v4 offset:16384
    ds_read_b64_tr_b16 v[58:59], v4 offset:17408
    v_mfma_f32_32x32x16_bf16 v[204:219], v[32:35], v[104:107], v[204:219]
    ds_read_b64_tr_b16 v[28:29], v5 offset:0
    ds_read_b64_tr_b16 v[30:31], v5 offset:1024
    s_waitcnt lgkmcnt(10)
    v_mfma_f32_32x32x16_bf16 v[204:219], v[36:39], v[108:111], v[204:219]
    ds_read_b64_tr_b16 v[32:33], v5 offset:2048
    ds_read_b64_tr_b16 v[34:35], v5 offset:3072
    v_mfma_f32_32x32x16_bf16 v[204:219], v[40:43], v[112:115], v[204:219]
    ds_read_b64_tr_b16 v[36:37], v5 offset:4096
    ds_read_b64_tr_b16 v[38:39], v5 offset:5120
    s_waitcnt lgkmcnt(10)
    v_mfma_f32_32x32x16_bf16 v[204:219], v[44:47], v[116:119], v[204:219]
    ds_read_b64_tr_b16 v[40:41], v5 offset:6144
    ds_read_b64_tr_b16 v[42:43], v5 offset:7168
    v_mfma_f32_32x32x16_bf16 v[204:219], v[48:51], v[120:123], v[204:219]
    ds_read_b64_tr_b16 v[44:45], v5 offset:8192
    ds_read_b64_tr_b16 v[46:47], v5 offset:9216
    s_waitcnt lgkmcnt(10)
    v_mfma_f32_32x32x16_bf16 v[204:219], v[52:55], v[124:127], v[204:219]
    s_barrier
    ds_read_b64_tr_b16 v[48:49], v5 offset:10240
    ds_read_b64_tr_b16 v[50:51], v5 offset:11264
    v_mfma_f32_32x32x16_bf16 v[204:219], v[56:59], v[128:131], v[204:219]
    ds_read_b64_tr_b16 v[52:53], v5 offset:12288
    ds_read_b64_tr_b16 v[54:55], v5 offset:13312
    s_waitcnt lgkmcnt(10)
    v_mfma_f32_32x32x16_bf16 v[204:219], v[28:31], v[168:171], v[204:219]
    ds_read_b64_tr_b16 v[56:57], v5 offset:14336
    ds_read_b64_tr_b16 v[58:59], v5 offset:15360
    v_mfma_f32_32x32x16_bf16 v[204:219], v[32:35], v[172:175], v[204:219]
    ds_read_b64_tr_b16 v[28:29], v5 offset:16384
    ds_read_b64_tr_b16 v[30:31], v5 offset:17408
    s_waitcnt lgkmcnt(10)
    v_mfma_f32_32x32x16_bf16 v[204:219], v[36:39], v[176:179], v[204:219]
    v_add_u32 v4, 36864, v6
    v_add_u32 v5, 36864, v11
    ds_read_b64_tr_b16 v[32:33], v4 offset:0
    ds_read_b64_tr_b16 v[34:35], v4 offset:1024
    v_mfma_f32_32x32x16_bf16 v[204:219], v[40:43], v[180:183], v[204:219]
    ds_read_b64_tr_b16 v[36:37], v4 offset:2048
    ds_read_b64_tr_b16 v[38:39], v4 offset:3072
    s_waitcnt lgkmcnt(10)
    v_mfma_f32_32x32x16_bf16 v[204:219], v[44:47], v[184:187], v[204:219]
    ds_read_b64_tr_b16 v[40:41], v4 offset:4096
    ds_read_b64_tr_b16 v[42:43], v4 offset:5120
    v_mfma_f32_32x32x16_bf16 v[204:219], v[48:51], v[188:191], v[204:219]
    ds_read_b64_tr_b16 v[44:45], v4 offset:6144
    ds_read_b64_tr_b16 v[46:47], v4 offset:7168
    s_waitcnt lgkmcnt(10)
    v_mfma_f32_32x32x16_bf16 v[204:219], v[52:55], v[192:195], v[204:219]
    ds_read_b64_tr_b16 v[48:49], v4 offset:8192
    ds_read_b64_tr_b16 v[50:51], v4 offset:9216
    v_mfma_f32_32x32x16_bf16 v[204:219], v[56:59], v[196:199], v[204:219]
    ds_read_b64_tr_b16 v[52:53], v4 offset:10240
    ds_read_b64_tr_b16 v[54:55], v4 offset:11264
    s_waitcnt lgkmcnt(10)
    v_mfma_f32_32x32x16_bf16 v[204:219], v[28:31], v[200:203], v[204:219]
    ds_read_b64_tr_b16 v[56:57], v4 offset:12288
    ds_read_b64_tr_b16 v[58:59], v4 offset:13312
    v_mfma_f32_32x32x16_bf16 v[220:235], v[32:35], v[60:63], 0
    ds_read_b64_tr_b16 v[28:29], v4 offset:14336
    ds_read_b64_tr_b16 v[30:31], v4 offset:15360
    s_waitcnt lgkmcnt(10)
    v_mfma_f32_32x32x16_bf16 v[220:235], v[36:39], v[64:67], v[220:235]
    ds_read_b64_tr_b16 v[32:33], v4 offset:16384
    ds_read_b64_tr_b16 v[34:35], v4 offset:17408
    v_mfma_f32_32x32x16_bf16 v[220:235], v[40:43], v[68:71], v[220:235]
    s_nop 1
    v_cvt_pk_bf16_f32 v204, v204, v205
    v_cvt_pk_bf16_f32 v205, v206, v207
    ds_read_b64_tr_b16 v[36:37], v5 offset:0
    ds_read_b64_tr_b16 v[38:39], v5 offset:1024
    s_waitcnt lgkmcnt(10)
    v_mfma_f32_32x32x16_bf16 v[220:235], v[44:47], v[72:75], v[220:235]
    v_cvt_pk_bf16_f32 v206, v208, v209
    v_cvt_pk_bf16_f32 v207, v210, v211
    ds_read_b64_tr_b16 v[40:41], v5 offset:2048
    ds_read_b64_tr_b16 v[42:43], v5 offset:3072
    v_mfma_f32_32x32x16_bf16 v[220:235], v[48:51], v[76:79], v[220:235]
    buffer_store_dwordx4 v[204:207], v10, s[28:31], s48 offen offset:0 sc1
    v_cvt_pk_bf16_f32 v212, v212, v213
    ds_read_b64_tr_b16 v[44:45], v5 offset:4096
    ds_read_b64_tr_b16 v[46:47], v5 offset:5120
    s_waitcnt lgkmcnt(10)
    v_mfma_f32_32x32x16_bf16 v[220:235], v[52:55], v[80:83], v[220:235]
    v_cvt_pk_bf16_f32 v213, v214, v215
    v_cvt_pk_bf16_f32 v214, v216, v217
    ds_read_b64_tr_b16 v[48:49], v5 offset:6144
    ds_read_b64_tr_b16 v[50:51], v5 offset:7168
    v_mfma_f32_32x32x16_bf16 v[220:235], v[56:59], v[84:87], v[220:235]
    v_cvt_pk_bf16_f32 v215, v218, v219
    buffer_store_dwordx4 v[212:215], v10, s[28:31], s48 offen offset:1024 sc1
    ds_read_b64_tr_b16 v[52:53], v5 offset:8192
    ds_read_b64_tr_b16 v[54:55], v5 offset:9216
    s_waitcnt lgkmcnt(10)
    v_mfma_f32_32x32x16_bf16 v[220:235], v[28:31], v[88:91], v[220:235]
    s_add_u32 s48, s48, 4096
    s_cmp_ge_u32 s48, s49
    s_cselect_b32 s44, 36864, 0
    s_sub_u32 s48, s48, s44
    s_waitcnt vmcnt(2)
    s_barrier
    ds_read_b64_tr_b16 v[56:57], v5 offset:10240
    ds_read_b64_tr_b16 v[58:59], v5 offset:11264
    v_mfma_f32_32x32x16_bf16 v[220:235], v[32:35], v[92:95], v[220:235]
    ds_read_b64_tr_b16 v[28:29], v5 offset:12288
    ds_read_b64_tr_b16 v[30:31], v5 offset:13312
    s_waitcnt lgkmcnt(10)
    v_mfma_f32_32x32x16_bf16 v[220:235], v[36:39], v[132:135], v[220:235]
    ds_read_b64_tr_b16 v[32:33], v5 offset:14336
    ds_read_b64_tr_b16 v[34:35], v5 offset:15360
    v_mfma_f32_32x32x16_bf16 v[220:235], v[40:43], v[136:139], v[220:235]
    ds_read_b64_tr_b16 v[36:37], v5 offset:16384
    ds_read_b64_tr_b16 v[38:39], v5 offset:17408
    s_waitcnt lgkmcnt(10)
    v_mfma_f32_32x32x16_bf16 v[220:235], v[44:47], v[140:143], v[220:235]
    v_add_u32 v4, 73728, v6
    v_add_u32 v5, 73728, v11
    ds_read_b64_tr_b16 v[40:41], v4 offset:0
    ds_read_b64_tr_b16 v[42:43], v4 offset:1024
    v_mfma_f32_32x32x16_bf16 v[220:235], v[48:51], v[144:147], v[220:235]
    ds_read_b64_tr_b16 v[44:45], v4 offset:2048
    ds_read_b64_tr_b16 v[46:47], v4 offset:3072
    s_waitcnt lgkmcnt(10)
    v_mfma_f32_32x32x16_bf16 v[220:235], v[52:55], v[148:151], v[220:235]
    ds_read_b64_tr_b16 v[48:49], v4 offset:4096
    ds_read_b64_tr_b16 v[50:51], v4 offset:5120
    v_mfma_f32_32x32x16_bf16 v[220:235], v[56:59], v[152:155], v[220:235]
    ds_read_b64_tr_b16 v[52:53], v4 offset:6144
    ds_read_b64_tr_b16 v[54:55], v4 offset:7168
    s_waitcnt lgkmcnt(10)
    v_mfma_f32_32x32x16_bf16 v[220:235], v[28:31], v[156:159], v[220:235]
    ds_read_b64_tr_b16 v[56:57], v4 offset:8192
    ds_read_b64_tr_b16 v[58:59], v4 offset:9216
    v_mfma_f32_32x32x16_bf16 v[220:235], v[32:35], v[160:163], v[220:235]
    ds_read_b64_tr_b16 v[28:29], v4 offset:10240
    ds_read_b64_tr_b16 v[30:31], v4 offset:11264
    s_waitcnt lgkmcnt(10)
    v_mfma_f32_32x32x16_bf16 v[220:235], v[36:39], v[164:167], v[220:235]
    ds_read_b64_tr_b16 v[32:33], v4 offset:12288
    ds_read_b64_tr_b16 v[34:35], v4 offset:13312
    v_mfma_f32_32x32x16_bf16 v[220:235], v[40:43], v[96:99], v[220:235]
    ds_read_b64_tr_b16 v[36:37], v4 offset:14336
    ds_read_b64_tr_b16 v[38:39], v4 offset:15360
    s_waitcnt lgkmcnt(10)
    v_mfma_f32_32x32x16_bf16 v[220:235], v[44:47], v[100:103], v[220:235]
    ds_read_b64_tr_b16 v[40:41], v4 offset:16384
    ds_read_b64_tr_b16 v[42:43], v4 offset:17408
    v_mfma_f32_32x32x16_bf16 v[220:235], v[48:51], v[104:107], v[220:235]
    ds_read_b64_tr_b16 v[44:45], v5 offset:0
    ds_read_b64_tr_b16 v[46:47], v5 offset:1024
    s_waitcnt lgkmcnt(10)
    v_mfma_f32_32x32x16_bf16 v[220:235], v[52:55], v[108:111], v[220:235]
    ds_read_b64_tr_b16 v[48:49], v5 offset:2048
    ds_read_b64_tr_b16 v[50:51], v5 offset:3072
    v_mfma_f32_32x32x16_bf16 v[220:235], v[56:59], v[112:115], v[220:235]
    ds_read_b64_tr_b16 v[52:53], v5 offset:4096
    ds_read_b64_tr_b16 v[54:55], v5 offset:5120
    s_waitcnt lgkmcnt(10)
    v_mfma_f32_32x32x16_bf16 v[220:235], v[28:31], v[116:119], v[220:235]
    ds_read_b64_tr_b16 v[56:57], v5 offset:6144
    ds_read_b64_tr_b16 v[58:59], v5 offset:7168
    v_mfma_f32_32x32x16_bf16 v[220:235], v[32:35], v[120:123], v[220:235]
    ds_read_b64_tr_b16 v[28:29], v5 offset:8192
    ds_read_b64_tr_b16 v[30:31], v5 offset:9216
    s_waitcnt lgkmcnt(10)
    v_mfma_f32_32x32x16_bf16 v[220:235], v[36:39], v[124:127], v[220:235]
    s_barrier
    ds_read_b64_tr_b16 v[32:33], v5 offset:10240
    ds_read_b64_tr_b16 v[34:35], v5 offset:11264
    v_mfma_f32_32x32x16_bf16 v[220:235], v[40:43], v[128:131], v[220:235]
    ds_read_b64_tr_b16 v[36:37], v5 offset:12288
    ds_read_b64_tr_b16 v[38:39], v5 offset:13312
    s_waitcnt lgkmcnt(10)
    v_mfma_f32_32x32x16_bf16 v[220:235], v[44:47], v[168:171], v[220:235]
    ds_read_b64_tr_b16 v[40:41], v5 offset:14336
    ds_read_b64_tr_b16 v[42:43], v5 offset:15360
    v_mfma_f32_32x32x16_bf16 v[220:235], v[48:51], v[172:175], v[220:235]
    ds_read_b64_tr_b16 v[44:45], v5 offset:16384
    ds_read_b64_tr_b16 v[46:47], v5 offset:17408
    s_waitcnt lgkmcnt(10)
    v_mfma_f32_32x32x16_bf16 v[220:235], v[52:55], v[176:179], v[220:235]
    v_add_u32 v4, 110592, v6
    v_add_u32 v5, 110592, v11
    ds_read_b64_tr_b16 v[48:49], v4 offset:0
    ds_read_b64_tr_b16 v[50:51], v4 offset:1024
    v_mfma_f32_32x32x16_bf16 v[220:235], v[56:59], v[180:183], v[220:235]
    ds_read_b64_tr_b16 v[52:53], v4 offset:2048
    ds_read_b64_tr_b16 v[54:55], v4 offset:3072
    s_waitcnt lgkmcnt(10)
    v_mfma_f32_32x32x16_bf16 v[220:235], v[28:31], v[184:187], v[220:235]
    ds_read_b64_tr_b16 v[56:57], v4 offset:4096
    ds_read_b64_tr_b16 v[58:59], v4 offset:5120
    v_mfma_f32_32x32x16_bf16 v[220:235], v[32:35], v[188:191], v[220:235]
    ds_read_b64_tr_b16 v[28:29], v4 offset:6144
    ds_read_b64_tr_b16 v[30:31], v4 offset:7168
    s_waitcnt lgkmcnt(10)
    v_mfma_f32_32x32x16_bf16 v[220:235], v[36:39], v[192:195], v[220:235]
    ds_read_b64_tr_b16 v[32:33], v4 offset:8192
    ds_read_b64_tr_b16 v[34:35], v4 offset:9216
    v_mfma_f32_32x32x16_bf16 v[220:235], v[40:43], v[196:199], v[220:235]
    ds_read_b64_tr_b16 v[36:37], v4 offset:10240
    ds_read_b64_tr_b16 v[38:39], v4 offset:11264
    s_waitcnt lgkmcnt(10)
    v_mfma_f32_32x32x16_bf16 v[220:235], v[44:47], v[200:203], v[220:235]
    ds_read_b64_tr_b16 v[40:41], v4 offset:12288
    ds_read_b64_tr_b16 v[42:43], v4 offset:13312
    v_mfma_f32_32x32x16_bf16 v[204:219], v[48:51], v[60:63], 0
    ds_read_b64_tr_b16 v[44:45], v4 offset:14336
    ds_read_b64_tr_b16 v[46:47], v4 offset:15360
    s_waitcnt lgkmcnt(10)
    v_mfma_f32_32x32x16_bf16 v[204:219], v[52:55], v[64:67], v[204:219]
    ds_read_b64_tr_b16 v[48:49], v4 offset:16384
    ds_read_b64_tr_b16 v[50:51], v4 offset:17408
    v_mfma_f32_32x32x16_bf16 v[204:219], v[56:59], v[68:71], v[204:219]
    s_nop 1
    v_cvt_pk_bf16_f32 v220, v220, v221
    v_cvt_pk_bf16_f32 v221, v222, v223
    ds_read_b64_tr_b16 v[52:53], v5 offset:0
    ds_read_b64_tr_b16 v[54:55], v5 offset:1024
    s_waitcnt lgkmcnt(10)
    v_mfma_f32_32x32x16_bf16 v[204:219], v[28:31], v[72:75], v[204:219]
    v_cvt_pk_bf16_f32 v222, v224, v225
    v_cvt_pk_bf16_f32 v223, v226, v227
    ds_read_b64_tr_b16 v[56:57], v5 offset:2048
    ds_read_b64_tr_b16 v[58:59], v5 offset:3072
    v_mfma_f32_32x32x16_bf16 v[204:219], v[32:35], v[76:79], v[204:219]
    buffer_store_dwordx4 v[220:223], v10, s[28:31], s48 offen offset:0 sc1
    v_cvt_pk_bf16_f32 v228, v228, v229
    ds_read_b64_tr_b16 v[28:29], v5 offset:4096
    ds_read_b64_tr_b16 v[30:31], v5 offset:5120
    s_waitcnt lgkmcnt(10)
    v_mfma_f32_32x32x16_bf16 v[204:219], v[36:39], v[80:83], v[204:219]
    v_cvt_pk_bf16_f32 v229, v230, v231
    v_cvt_pk_bf16_f32 v230, v232, v233
    ds_read_b64_tr_b16 v[32:33], v5 offset:6144
    ds_read_b64_tr_b16 v[34:35], v5 offset:7168
    v_mfma_f32_32x32x16_bf16 v[204:219], v[40:43], v[84:87], v[204:219]
    v_cvt_pk_bf16_f32 v231, v234, v235
    buffer_store_dwordx4 v[228:231], v10, s[28:31], s48 offen offset:1024 sc1
    ds_read_b64_tr_b16 v[36:37], v5 offset:8192
    ds_read_b64_tr_b16 v[38:39], v5 offset:9216
    s_waitcnt lgkmcnt(10)
    v_mfma_f32_32x32x16_bf16 v[204:219], v[44:47], v[88:91], v[204:219]
    s_add_u32 s48, s48, 4096
    s_cmp_ge_u32 s48, s49
    s_cselect_b32 s44, 36864, 0
    s_sub_u32 s48, s48, s44
    s_waitcnt vmcnt(2)
    s_barrier
    ds_read_b64_tr_b16 v[40:41], v5 offset:10240
    ds_read_b64_tr_b16 v[42:43], v5 offset:11264
    v_mfma_f32_32x32x16_bf16 v[204:219], v[48:51], v[92:95], v[204:219]
    ds_read_b64_tr_b16 v[44:45], v5 offset:12288
    ds_read_b64_tr_b16 v[46:47], v5 offset:13312
    s_waitcnt lgkmcnt(10)
    v_mfma_f32_32x32x16_bf16 v[204:219], v[52:55], v[132:135], v[204:219]
    ds_read_b64_tr_b16 v[48:49], v5 offset:14336
    ds_read_b64_tr_b16 v[50:51], v5 offset:15360
    v_mfma_f32_32x32x16_bf16 v[204:219], v[56:59], v[136:139], v[204:219]
    ds_read_b64_tr_b16 v[52:53], v5 offset:16384
    ds_read_b64_tr_b16 v[54:55], v5 offset:17408
    s_waitcnt lgkmcnt(10)
    v_mfma_f32_32x32x16_bf16 v[204:219], v[28:31], v[140:143], v[204:219]
    v_add_u32 v4, 0, v6
    v_add_u32 v5, 0, v11
    ds_read_b64_tr_b16 v[56:57], v4 offset:0
    ds_read_b64_tr_b16 v[58:59], v4 offset:1024
    v_mfma_f32_32x32x16_bf16 v[204:219], v[32:35], v[144:147], v[204:219]
    ds_read_b64_tr_b16 v[28:29], v4 offset:2048
    ds_read_b64_tr_b16 v[30:31], v4 offset:3072
    s_waitcnt lgkmcnt(10)
    v_mfma_f32_32x32x16_bf16 v[204:219], v[36:39], v[148:151], v[204:219]
    ds_read_b64_tr_b16 v[32:33], v4 offset:4096
    ds_read_b64_tr_b16 v[34:35], v4 offset:5120
    v_mfma_f32_32x32x16_bf16 v[204:219], v[40:43], v[152:155], v[204:219]
    ds_read_b64_tr_b16 v[36:37], v4 offset:6144
    ds_read_b64_tr_b16 v[38:39], v4 offset:7168
    s_waitcnt lgkmcnt(10)
    v_mfma_f32_32x32x16_bf16 v[204:219], v[44:47], v[156:159], v[204:219]
    ds_read_b64_tr_b16 v[40:41], v4 offset:8192
    ds_read_b64_tr_b16 v[42:43], v4 offset:9216
    v_mfma_f32_32x32x16_bf16 v[204:219], v[48:51], v[160:163], v[204:219]
    ds_read_b64_tr_b16 v[44:45], v4 offset:10240
    ds_read_b64_tr_b16 v[46:47], v4 offset:11264
    s_waitcnt lgkmcnt(10)
    v_mfma_f32_32x32x16_bf16 v[204:219], v[52:55], v[164:167], v[204:219]
    ds_read_b64_tr_b16 v[48:49], v4 offset:12288
    ds_read_b64_tr_b16 v[50:51], v4 offset:13312
    v_mfma_f32_32x32x16_bf16 v[204:219], v[56:59], v[96:99], v[204:219]
    ds_read_b64_tr_b16 v[52:53], v4 offset:14336
    ds_read_b64_tr_b16 v[54:55], v4 offset:15360
    s_waitcnt lgkmcnt(10)
    v_mfma_f32_32x32x16_bf16 v[204:219], v[28:31], v[100:103], v[204:219]
    ds_read_b64_tr_b16 v[56:57], v4 offset:16384
    ds_read_b64_tr_b16 v[58:59], v4 offset:17408
    v_mfma_f32_32x32x16_bf16 v[204:219], v[32:35], v[104:107], v[204:219]
    ds_read_b64_tr_b16 v[28:29], v5 offset:0
    ds_read_b64_tr_b16 v[30:31], v5 offset:1024
    s_waitcnt lgkmcnt(10)
    v_mfma_f32_32x32x16_bf16 v[204:219], v[36:39], v[108:111], v[204:219]
    ds_read_b64_tr_b16 v[32:33], v5 offset:2048
    ds_read_b64_tr_b16 v[34:35], v5 offset:3072
    v_mfma_f32_32x32x16_bf16 v[204:219], v[40:43], v[112:115], v[204:219]
    ds_read_b64_tr_b16 v[36:37], v5 offset:4096
    ds_read_b64_tr_b16 v[38:39], v5 offset:5120
    s_waitcnt lgkmcnt(10)
    v_mfma_f32_32x32x16_bf16 v[204:219], v[44:47], v[116:119], v[204:219]
    ds_read_b64_tr_b16 v[40:41], v5 offset:6144
    ds_read_b64_tr_b16 v[42:43], v5 offset:7168
    v_mfma_f32_32x32x16_bf16 v[204:219], v[48:51], v[120:123], v[204:219]
    ds_read_b64_tr_b16 v[44:45], v5 offset:8192
    ds_read_b64_tr_b16 v[46:47], v5 offset:9216
    s_waitcnt lgkmcnt(10)
    v_mfma_f32_32x32x16_bf16 v[204:219], v[52:55], v[124:127], v[204:219]
    s_barrier
    ds_read_b64_tr_b16 v[48:49], v5 offset:10240
    ds_read_b64_tr_b16 v[50:51], v5 offset:11264
    v_mfma_f32_32x32x16_bf16 v[204:219], v[56:59], v[128:131], v[204:219]
    ds_read_b64_tr_b16 v[52:53], v5 offset:12288
    ds_read_b64_tr_b16 v[54:55], v5 offset:13312
    s_waitcnt lgkmcnt(10)
    v_mfma_f32_32x32x16_bf16 v[204:219], v[28:31], v[168:171], v[204:219]
    ds_read_b64_tr_b16 v[56:57], v5 offset:14336
    ds_read_b64_tr_b16 v[58:59], v5 offset:15360
    v_mfma_f32_32x32x16_bf16 v[204:219], v[32:35], v[172:175], v[204:219]
    ds_read_b64_tr_b16 v[28:29], v5 offset:16384
    ds_read_b64_tr_b16 v[30:31], v5 offset:17408
    s_waitcnt lgkmcnt(10)
    v_mfma_f32_32x32x16_bf16 v[204:219], v[36:39], v[176:179], v[204:219]
    v_mfma_f32_32x32x16_bf16 v[204:219], v[40:43], v[180:183], v[204:219]
    s_waitcnt lgkmcnt(6)
    v_mfma_f32_32x32x16_bf16 v[204:219], v[44:47], v[184:187], v[204:219]
    v_mfma_f32_32x32x16_bf16 v[204:219], v[48:51], v[188:191], v[204:219]
    s_waitcnt lgkmcnt(2)
    v_mfma_f32_32x32x16_bf16 v[204:219], v[52:55], v[192:195], v[204:219]
    v_mfma_f32_32x32x16_bf16 v[204:219], v[56:59], v[196:199], v[204:219]
    s_waitcnt lgkmcnt(0)
    v_mfma_f32_32x32x16_bf16 v[204:219], v[28:31], v[200:203], v[204:219]
    s_nop 11
    v_cvt_pk_bf16_f32 v204, v204, v205
    v_cvt_pk_bf16_f32 v205, v206, v207
    v_cvt_pk_bf16_f32 v206, v208, v209
    v_cvt_pk_bf16_f32 v207, v210, v211
    buffer_store_dwordx4 v[204:207], v10, s[28:31], s48 offen offset:0 sc1
    v_cvt_pk_bf16_f32 v212, v212, v213
    v_cvt_pk_bf16_f32 v213, v214, v215
    v_cvt_pk_bf16_f32 v214, v216, v217
    v_cvt_pk_bf16_f32 v215, v218, v219
    buffer_store_dwordx4 v[212:215], v10, s[28:31], s48 offen offset:1024 sc1
    s_add_u32 s48, s48, 4096
    s_cmp_ge_u32 s48, s49
    s_cselect_b32 s44, 36864, 0
    s_sub_u32 s48, s48, s44
    v_and_b32 v2, 7, v1
    v_bfe_u32 v3, v1, 3, 2
    v_lshrrev_b32 v4, 5, v1
    s_and_b32 s44, s23, 3
    s_lshl_b32 s44, s44, 3
    v_add_u32 v5, s44, v2
    v_lshlrev_b32 v6, 10, v3
    v_lshl_add_u32 v6, v4, 9, v6
    v_lshl_add_u32 v6, v5, 4, v6
    v_mul_u32_u24 v7, 1152, v2
    v_lshl_add_u32 v7, v3, 5, v7
    v_lshl_add_u32 v7, v4, 4, v7
    s_mov_b32 s32, s16
    s_and_b32 s33, s17, 0xffff
    s_mov_b32 s34, 2359296
    s_mov_b32 s35, 0x20000
    s_lshr_b32 s44, s23, 2
    s_lshl_b32 s45, s24, 1
    s_add_u32 s44, s44, s45
    s_mul_i32 s46, s44, 36864
    s_add_u32 s47, s46, 2359296
    s_add_u32 s46, s46, 8388608
    s_lshl_b32 s44, s24, 6
    s_lshl_b32 s45, s23, 3
    s_add_u32 s44, s44, s45
    s_mul_i32 s48, s44, 1152
    v_lshlrev_b32 v10, 2, v2
    s_lshl_b32 s44, s23, 5
    s_add_u32 s44, s44, 147456
    v_add_u32 v10, s44, v10
    ds_read_b32 v14, v10
    s_add_u32 s55, s22, 2
    s_waitcnt vmcnt(2)
    s_barrier
    s_add_u32 s52, s27, s55
    s_cmp_ge_u32 s52, 9
    s_cselect_b32 s44, 9, 0
    s_sub_u32 s52, s52, s44
    s_lshl_b32 s44, s52, 12
    s_add_u32 s54, s46, s44
    s_add_u32 s44, s47, s44
    buffer_load_dwordx4 v[32:35], v6, s[28:31], s54 offen sc1
    s_add_u32 s54, s54, 2359296
    buffer_load_dwordx4 v[36:39], v6, s[28:31], s54 offen sc1
    s_add_u32 s54, s54, 2359296
    buffer_load_dwordx4 v[40:43], v6, s[28:31], s54 offen sc1
    s_add_u32 s54, s54, 2359296
    buffer_load_dwordx4 v[44:47], v6, s[28:31], s54 offen sc1
    s_add_u32 s54, s54, 2359296
    buffer_load_dwordx4 v[64:67], v6, s[28:31], s44 offen sc1
    buffer_load_dwordx4 v[48:51], v6, s[28:31], s54 offen sc1
    s_add_u32 s54, s54, 2359296
    buffer_load_dwordx4 v[52:55], v6, s[28:31], s54 offen sc1
    s_add_u32 s54, s54, 2359296
    buffer_load_dwordx4 v[56:59], v6, s[28:31], s54 offen sc1
    s_add_u32 s54, s54, 2359296
    buffer_load_dwordx4 v[60:63], v6, s[28:31], s54 offen sc1
    s_waitcnt vmcnt(9)
    s_barrier
    s_waitcnt lgkmcnt(0)
    s_waitcnt vmcnt(8)
    v_lshlrev_b32 v68, 16, v32
    v_and_b32 v69, 0xffff0000, v32
    v_lshlrev_b32 v70, 16, v33
    v_and_b32 v71, 0xffff0000, v33
    v_lshlrev_b32 v72, 16, v34
    v_and_b32 v73, 0xffff0000, v34
    v_lshlrev_b32 v74, 16, v35
    v_and_b32 v75, 0xffff0000, v35
    s_waitcnt vmcnt(7)
    v_lshlrev_b32 v24, 16, v36
    v_and_b32 v25, 0xffff0000, v36
    v_pk_add_f32 v[68:69], v[68:69], v[24:25]
    v_lshlrev_b32 v26, 16, v37
    v_and_b32 v27, 0xffff0000, v37
    v_pk_add_f32 v[70:71], v[70:71], v[26:27]
    v_lshlrev_b32 v24, 16, v38
    v_and_b32 v25, 0xffff0000, v38
    v_pk_add_f32 v[72:73], v[72:73], v[24:25]
    v_lshlrev_b32 v26, 16, v39
    v_and_b32 v27, 0xffff0000, v39
    v_pk_add_f32 v[74:75], v[74:75], v[26:27]
    s_waitcnt vmcnt(6)
    v_lshlrev_b32 v24, 16, v40
    v_and_b32 v25, 0xffff0000, v40
    v_pk_add_f32 v[68:69], v[68:69], v[24:25]
    v_lshlrev_b32 v26, 16, v41
    v_and_b32 v27, 0xffff0000, v41
    v_pk_add_f32 v[70:71], v[70:71], v[26:27]
    v_lshlrev_b32 v24, 16, v42
    v_and_b32 v25, 0xffff0000, v42
    v_pk_add_f32 v[72:73], v[72:73], v[24:25]
    v_lshlrev_b32 v26, 16, v43
    v_and_b32 v27, 0xffff0000, v43
    v_pk_add_f32 v[74:75], v[74:75], v[26:27]
    s_waitcnt vmcnt(5)
    v_lshlrev_b32 v24, 16, v44
    v_and_b32 v25, 0xffff0000, v44
    v_pk_add_f32 v[68:69], v[68:69], v[24:25]
    v_lshlrev_b32 v26, 16, v45
    v_and_b32 v27, 0xffff0000, v45
    v_pk_add_f32 v[70:71], v[70:71], v[26:27]
    v_lshlrev_b32 v24, 16, v46
    v_and_b32 v25, 0xffff0000, v46
    v_pk_add_f32 v[72:73], v[72:73], v[24:25]
    v_lshlrev_b32 v26, 16, v47
    v_and_b32 v27, 0xffff0000, v47
    v_pk_add_f32 v[74:75], v[74:75], v[26:27]
    s_waitcnt vmcnt(3)
    v_lshlrev_b32 v24, 16, v48
    v_and_b32 v25, 0xffff0000, v48
    v_pk_add_f32 v[68:69], v[68:69], v[24:25]
    v_lshlrev_b32 v26, 16, v49
    v_and_b32 v27, 0xffff0000, v49
    v_pk_add_f32 v[70:71], v[70:71], v[26:27]
    v_lshlrev_b32 v24, 16, v50
    v_and_b32 v25, 0xffff0000, v50
    v_pk_add_f32 v[72:73], v[72:73], v[24:25]
    v_lshlrev_b32 v26, 16, v51
    v_and_b32 v27, 0xffff0000, v51
    v_pk_add_f32 v[74:75], v[74:75], v[26:27]
    s_waitcnt vmcnt(2)
    v_lshlrev_b32 v24, 16, v52
    v_and_b32 v25, 0xffff0000, v52
    v_pk_add_f32 v[68:69], v[68:69], v[24:25]
    v_lshlrev_b32 v26, 16, v53
    v_and_b32 v27, 0xffff0000, v53
    v_pk_add_f32 v[70:71], v[70:71], v[26:27]
    v_lshlrev_b32 v24, 16, v54
    v_and_b32 v25, 0xffff0000, v54
    v_pk_add_f32 v[72:73], v[72:73], v[24:25]
    v_lshlrev_b32 v26, 16, v55
    v_and_b32 v27, 0xffff0000, v55
    v_pk_add_f32 v[74:75], v[74:75], v[26:27]
    s_waitcnt vmcnt(1)
    v_lshlrev_b32 v24, 16, v56
    v_and_b32 v25, 0xffff0000, v56
    v_pk_add_f32 v[68:69], v[68:69], v[24:25]
    v_lshlrev_b32 v26, 16, v57
    v_and_b32 v27, 0xffff0000, v57
    v_pk_add_f32 v[70:71], v[70:71], v[26:27]
    v_lshlrev_b32 v24, 16, v58
    v_and_b32 v25, 0xffff0000, v58
    v_pk_add_f32 v[72:73], v[72:73], v[24:25]
    v_lshlrev_b32 v26, 16, v59
    v_and_b32 v27, 0xffff0000, v59
    v_pk_add_f32 v[74:75], v[74:75], v[26:27]
    s_waitcnt vmcnt(0)
    v_lshlrev_b32 v24, 16, v60
    v_and_b32 v25, 0xffff0000, v60
    v_pk_add_f32 v[68:69], v[68:69], v[24:25]
    v_lshlrev_b32 v26, 16, v61
    v_and_b32 v27, 0xffff0000, v61
    v_pk_add_f32 v[70:71], v[70:71], v[26:27]
    v_lshlrev_b32 v24, 16, v62
    v_and_b32 v25, 0xffff0000, v62
    v_pk_add_f32 v[72:73], v[72:73], v[24:25]
    v_lshlrev_b32 v26, 16, v63
    v_and_b32 v27, 0xffff0000, v63
    v_pk_add_f32 v[74:75], v[74:75], v[26:27]
    v_permlane32_swap_b32 v68, v72
    v_permlane32_swap_b32 v69, v73
    v_permlane32_swap_b32 v70, v74
    v_permlane32_swap_b32 v71, v75
    v_lshlrev_b32 v24, 16, v64
    v_and_b32 v25, 0xffff0000, v64
    v_fma_f32 v68, v68, v14, v24
    v_fma_f32 v69, v69, v14, v25
    v_lshlrev_b32 v24, 16, v65
    v_and_b32 v25, 0xffff0000, v65
    v_fma_f32 v70, v70, v14, v24
    v_fma_f32 v71, v71, v14, v25
    v_lshlrev_b32 v24, 16, v66
    v_and_b32 v25, 0xffff0000, v66
    v_fma_f32 v72, v72, v14, v24
    v_fma_f32 v73, v73, v14, v25
    v_lshlrev_b32 v24, 16, v67
    v_and_b32 v25, 0xffff0000, v67
    v_fma_f32 v74, v74, v14, v24
    v_fma_f32 v75, v75, v14, v25
    v_cvt_pk_bf16_f32 v28, v68, v69
    v_cvt_pk_bf16_f32 v29, v70, v71
    v_cvt_pk_bf16_f32 v30, v72, v73
    v_cvt_pk_bf16_f32 v31, v74, v75
    s_lshl_b32 s44, s52, 7
    s_add_u32 s44, s44, s48
    buffer_store_dwordx4 v[28:31], v7, s[32:35], s44 offen
    s_endpgm
L_r4:
    s_lshr_b32 s25, s23, 2
    s_lshl_b32 s25, s25, 3
    s_lshr_b32 s44, s24, 2
    s_add_u32 s25, s25, s44
    s_and_b32 s26, s23, 3
    s_lshl_b32 s26, s26, 2
    s_and_b32 s45, s24, 3
    s_add_u32 s26, s26, s45
    s_lshl_b32 s45, s45, 1
    s_add_u32 s27, s44, s45
    s_cmp_ge_u32 s27, 9
    s_cselect_b32 s44, 9, 0
    s_sub_u32 s27, s27, s44
    v_lshrrev_b32 v20, 3, v1
    v_and_b32 v21, 7, v1
    v_lshrrev_b32 v22, 1, v20
    v_xor_b32 v21, v21, v22
    v_mul_u32_u24 v20, 1152, v20
    v_lshl_add_u32 v2, v21, 4, v20
    v_xor_b32 v21, 4, v21
    v_lshl_add_u32 v3, v21, 4, v20
    v_add_u32 v3, 8192, v3
    v_add_u32 v4, 16384, v2
    v_add_u32 v5, 16384, v3
    s_mul_i32 s46, s25, 147456
    s_add_u32 s47, s46, 1152
    s_lshl_b32 s44, s27, 7
    s_add_u32 s46, s46, s44
    s_waitcnt lgkmcnt(0)
    s_mov_b32 s32, s4
    s_and_b32 s33, s5, 0xffff
    s_mov_b32 s34, 2359296
    s_mov_b32 s35, 0x20000
    s_mov_b32 s28, s20
    s_and_b32 s29, s21, 0xffff
    s_mov_b32 s30, 27262976
    s_mov_b32 s31, 0x20000
    s_mov_b32 s36, s18
    s_and_b32 s37, s19, 0xffff
    s_mov_b32 s38, 256
    s_mov_b32 s39, 0x20000
    s_mov_b32 m0, 0
    s_nop 0
    buffer_load_dwordx4 v2, s[32:35], s46 offen offset:0 lds
    buffer_load_dwordx4 v3, s[32:35], s46 offen offset:1024 lds
    buffer_load_dwordx4 v4, s[32:35], s46 offen offset:2048 lds
    buffer_load_dwordx4 v5, s[32:35], s46 offen offset:3072 lds
    s_mov_b32 m0, 4096
    s_add_u32 s45, s46, 36864
    buffer_load_dwordx4 v2, s[32:35], s45 offen offset:0 lds
    buffer_load_dwordx4 v3, s[32:35], s45 offen offset:1024 lds
    buffer_load_dwordx4 v4, s[32:35], s45 offen offset:2048 lds
    buffer_load_dwordx4 v5, s[32:35], s45 offen offset:3072 lds
    s_mov_b32 m0, 8192
    s_add_u32 s45, s46, 73728
    buffer_load_dwordx4 v2, s[32:35], s45 offen offset:0 lds
    buffer_load_dwordx4 v3, s[32:35], s45 offen offset:1024 lds
    buffer_load_dwordx4 v4, s[32:35], s45 offen offset:2048 lds
    buffer_load_dwordx4 v5, s[32:35], s45 offen offset:3072 lds
    s_mov_b32 m0, 12288
    s_add_u32 s45, s46, 110592
    buffer_load_dwordx4 v2, s[32:35], s45 offen offset:0 lds
    buffer_load_dwordx4 v3, s[32:35], s45 offen offset:1024 lds
    buffer_load_dwordx4 v4, s[32:35], s45 offen offset:2048 lds
    buffer_load_dwordx4 v5, s[32:35], s45 offen offset:3072 lds
    s_add_u32 s46, s46, 128
    s_cmp_ge_u32 s46, s47
    s_cselect_b32 s44, 1152, 0
    s_sub_u32 s46, s46, s44
    s_mov_b32 m0, 32768
    s_nop 0
    buffer_load_dwordx4 v2, s[32:35], s46 offen offset:0 lds
    buffer_load_dwordx4 v3, s[32:35], s46 offen offset:1024 lds
    buffer_load_dwordx4 v4, s[32:35], s46 offen offset:2048 lds
    buffer_load_dwordx4 v5, s[32:35], s46 offen offset:3072 lds
    s_mov_b32 m0, 36864
    s_add_u32 s45, s46, 36864
    buffer_load_dwordx4 v2, s[32:35], s45 offen offset:0 lds
    buffer_load_dwordx4 v3, s[32:35], s45 offen offset:1024 lds
    buffer_load_dwordx4 v4, s[32:35], s45 offen offset:2048 lds
    buffer_load_dwordx4 v5, s[32:35], s45 offen offset:3072 lds
    s_mov_b32 m0, 40960
    s_add_u32 s45, s46, 73728
    buffer_load_dwordx4 v2, s[32:35], s45 offen offset:0 lds
    buffer_load_dwordx4 v3, s[32:35], s45 offen offset:1024 lds
    buffer_load_dwordx4 v4, s[32:35], s45 offen offset:2048 lds
    buffer_load_dwordx4 v5, s[32:35], s45 offen offset:3072 lds
    s_mov_b32 m0, 45056
    s_add_u32 s45, s46, 110592
    buffer_load_dwordx4 v2, s[32:35], s45 offen offset:0 lds
    buffer_load_dwordx4 v3, s[32:35], s45 offen offset:1024 lds
    buffer_load_dwordx4 v4, s[32:35], s45 offen offset:2048 lds
    buffer_load_dwordx4 v5, s[32:35], s45 offen offset:3072 lds
    s_add_u32 s46, s46, 128
    s_cmp_ge_u32 s46, s47
    s_cselect_b32 s44, 1152, 0
    s_sub_u32 s46, s46, s44
    s_waitcnt vmcnt(16)
    s_barrier
    s_mov_b32 m0, 65536
    s_nop 0
    buffer_load_dwordx4 v2, s[32:35], s46 offen offset:0 lds
    buffer_load_dwordx4 v3, s[32:35], s46 offen offset:1024 lds
    buffer_load_dwordx4 v4, s[32:35], s46 offen offset:2048 lds
    buffer_load_dwordx4 v5, s[32:35], s46 offen offset:3072 lds
    s_mov_b32 m0, 69632
    s_add_u32 s45, s46, 36864
    buffer_load_dwordx4 v2, s[32:35], s45 offen offset:0 lds
    buffer_load_dwordx4 v3, s[32:35], s45 offen offset:1024 lds
    buffer_load_dwordx4 v4, s[32:35], s45 offen offset:2048 lds
    buffer_load_dwordx4 v5, s[32:35], s45 offen offset:3072 lds
    s_mov_b32 m0, 73728
    s_add_u32 s45, s46, 73728
    buffer_load_dwordx4 v2, s[32:35], s45 offen offset:0 lds
    buffer_load_dwordx4 v3, s[32:35], s45 offen offset:1024 lds
    buffer_load_dwordx4 v4, s[32:35], s45 offen offset:2048 lds
    buffer_load_dwordx4 v5, s[32:35], s45 offen offset:3072 lds
    s_mov_b32 m0, 77824
    s_add_u32 s45, s46, 110592
    buffer_load_dwordx4 v2, s[32:35], s45 offen offset:0 lds
    buffer_load_dwordx4 v3, s[32:35], s45 offen offset:1024 lds
    buffer_load_dwordx4 v4, s[32:35], s45 offen offset:2048 lds
    buffer_load_dwordx4 v5, s[32:35], s45 offen offset:3072 lds
    s_add_u32 s46, s46, 128
    s_cmp_ge_u32 s46, s47
    s_cselect_b32 s44, 1152, 0
    s_sub_u32 s46, s46, s44
    s_waitcnt vmcnt(16)
    s_barrier
    s_mov_b32 m0, 98304
    s_nop 0
    buffer_load_dwordx4 v2, s[32:35], s46 offen offset:0 lds
    buffer_load_dwordx4 v3, s[32:35], s46 offen offset:1024 lds
    buffer_load_dwordx4 v4, s[32:35], s46 offen offset:2048 lds
    buffer_load_dwordx4 v5, s[32:35], s46 offen offset:3072 lds
    s_mov_b32 m0, 102400
    s_add_u32 s45, s46, 36864
    buffer_load_dwordx4 v2, s[32:35], s45 offen offset:0 lds
    buffer_load_dwordx4 v3, s[32:35], s45 offen offset:1024 lds
    buffer_load_dwordx4 v4, s[32:35], s45 offen offset:2048 lds
    buffer_load_dwordx4 v5, s[32:35], s45 offen offset:3072 lds
    s_mov_b32 m0, 106496
    s_add_u32 s45, s46, 73728
    buffer_load_dwordx4 v2, s[32:35], s45 offen offset:0 lds
    buffer_load_dwordx4 v3, s[32:35], s45 offen offset:1024 lds
    buffer_load_dwordx4 v4, s[32:35], s45 offen offset:2048 lds
    buffer_load_dwordx4 v5, s[32:35], s45 offen offset:3072 lds
    s_mov_b32 m0, 110592
    s_add_u32 s45, s46, 110592
    buffer_load_dwordx4 v2, s[32:35], s45 offen offset:0 lds
    buffer_load_dwordx4 v3, s[32:35], s45 offen offset:1024 lds
    buffer_load_dwordx4 v4, s[32:35], s45 offen offset:2048 lds
    buffer_load_dwordx4 v5, s[32:35], s45 offen offset:3072 lds
    s_add_u32 s46, s46, 128
    s_cmp_ge_u32 s46, s47
    s_cselect_b32 s44, 1152, 0
    s_sub_u32 s46, s46, s44
    s_waitcnt vmcnt(16)
    s_barrier
    s_mov_b32 m0, 0
    s_nop 0
    buffer_load_dwordx4 v2, s[32:35], s46 offen offset:0 lds
    buffer_load_dwordx4 v3, s[32:35], s46 offen offset:1024 lds
    buffer_load_dwordx4 v4, s[32:35], s46 offen offset:2048 lds
    buffer_load_dwordx4 v5, s[32:35], s46 offen offset:3072 lds
    s_mov_b32 m0, 4096
    s_add_u32 s45, s46, 36864
    buffer_load_dwordx4 v2, s[32:35], s45 offen offset:0 lds
    buffer_load_dwordx4 v3, s[32:35], s45 offen offset:1024 lds
    buffer_load_dwordx4 v4, s[32:35], s45 offen offset:2048 lds
    buffer_load_dwordx4 v5, s[32:35], s45 offen offset:3072 lds
    s_mov_b32 m0, 8192
    s_add_u32 s45, s46, 73728
    buffer_load_dwordx4 v2, s[32:35], s45 offen offset:0 lds
    buffer_load_dwordx4 v3, s[32:35], s45 offen offset:1024 lds
    buffer_load_dwordx4 v4, s[32:35], s45 offen offset:2048 lds
    buffer_load_dwordx4 v5, s[32:35], s45 offen offset:3072 lds
    s_mov_b32 m0, 12288
    s_add_u32 s45, s46, 110592
    buffer_load_dwordx4 v2, s[32:35], s45 offen offset:0 lds
    buffer_load_dwordx4 v3, s[32:35], s45 offen offset:1024 lds
    buffer_load_dwordx4 v4, s[32:35], s45 offen offset:2048 lds
    buffer_load_dwordx4 v5, s[32:35], s45 offen offset:3072 lds
    s_add_u32 s46, s46, 128
    s_cmp_ge_u32 s46, s47
    s_cselect_b32 s44, 1152, 0
    s_sub_u32 s46, s46, s44
    s_waitcnt vmcnt(16)
    s_barrier
    s_mov_b32 m0, 32768
    s_nop 0
    buffer_load_dwordx4 v2, s[32:35], s46 offen offset:0 lds
    buffer_load_dwordx4 v3, s[32:35], s46 offen offset:1024 lds
    buffer_load_dwordx4 v4, s[32:35], s46 offen offset:2048 lds
    buffer_load_dwordx4 v5, s[32:35], s46 offen offset:3072 lds
    s_mov_b32 m0, 36864
    s_add_u32 s45, s46, 36864
    buffer_load_dwordx4 v2, s[32:35], s45 offen offset:0 lds
    buffer_load_dwordx4 v3, s[32:35], s45 offen offset:1024 lds
    buffer_load_dwordx4 v4, s[32:35], s45 offen offset:2048 lds
    buffer_load_dwordx4 v5, s[32:35], s45 offen offset:3072 lds
    s_mov_b32 m0, 40960
    s_add_u32 s45, s46, 73728
    buffer_load_dwordx4 v2, s[32:35], s45 offen offset:0 lds
    buffer_load_dwordx4 v3, s[32:35], s45 offen offset:1024 lds
    buffer_load_dwordx4 v4, s[32:35], s45 offen offset:2048 lds
    buffer_load_dwordx4 v5, s[32:35], s45 offen offset:3072 lds
    s_mov_b32 m0, 45056
    s_add_u32 s45, s46, 110592
    buffer_load_dwordx4 v2, s[32:35], s45 offen offset:0 lds
    buffer_load_dwordx4 v3, s[32:35], s45 offen offset:1024 lds
    buffer_load_dwordx4 v4, s[32:35], s45 offen offset:2048 lds
    buffer_load_dwordx4 v5, s[32:35], s45 offen offset:3072 lds
    s_add_u32 s46, s46, 128
    s_cmp_ge_u32 s46, s47
    s_cselect_b32 s44, 1152, 0
    s_sub_u32 s46, s46, s44
    s_waitcnt vmcnt(16)
    s_barrier
    s_mov_b32 m0, 65536
    s_nop 0
    buffer_load_dwordx4 v2, s[32:35], s46 offen offset:0 lds
    buffer_load_dwordx4 v3, s[32:35], s46 offen offset:1024 lds
    buffer_load_dwordx4 v4, s[32:35], s46 offen offset:2048 lds
    buffer_load_dwordx4 v5, s[32:35], s46 offen offset:3072 lds
    s_mov_b32 m0, 69632
    s_add_u32 s45, s46, 36864
    buffer_load_dwordx4 v2, s[32:35], s45 offen offset:0 lds
    buffer_load_dwordx4 v3, s[32:35], s45 offen offset:1024 lds
    buffer_load_dwordx4 v4, s[32:35], s45 offen offset:2048 lds
    buffer_load_dwordx4 v5, s[32:35], s45 offen offset:3072 lds
    s_mov_b32 m0, 73728
    s_add_u32 s45, s46, 73728
    buffer_load_dwordx4 v2, s[32:35], s45 offen offset:0 lds
    buffer_load_dwordx4 v3, s[32:35], s45 offen offset:1024 lds
    buffer_load_dwordx4 v4, s[32:35], s45 offen offset:2048 lds
    buffer_load_dwordx4 v5, s[32:35], s45 offen offset:3072 lds
    s_mov_b32 m0, 77824
    s_add_u32 s45, s46, 110592
    buffer_load_dwordx4 v2, s[32:35], s45 offen offset:0 lds
    buffer_load_dwordx4 v3, s[32:35], s45 offen offset:1024 lds
    buffer_load_dwordx4 v4, s[32:35], s45 offen offset:2048 lds
    buffer_load_dwordx4 v5, s[32:35], s45 offen offset:3072 lds
    s_add_u32 s46, s46, 128
    s_cmp_ge_u32 s46, s47
    s_cselect_b32 s44, 1152, 0
    s_sub_u32 s46, s46, s44
    s_waitcnt vmcnt(16)
    s_barrier
    s_mov_b32 m0, 98304
    s_nop 0
    buffer_load_dwordx4 v2, s[32:35], s46 offen offset:0 lds
    buffer_load_dwordx4 v3, s[32:35], s46 offen offset:1024 lds
    buffer_load_dwordx4 v4, s[32:35], s46 offen offset:2048 lds
    buffer_load_dwordx4 v5, s[32:35], s46 offen offset:3072 lds
    s_mov_b32 m0, 102400
    s_add_u32 s45, s46, 36864
    buffer_load_dwordx4 v2, s[32:35], s45 offen offset:0 lds
    buffer_load_dwordx4 v3, s[32:35], s45 offen offset:1024 lds
    buffer_load_dwordx4 v4, s[32:35], s45 offen offset:2048 lds
    buffer_load_dwordx4 v5, s[32:35], s45 offen offset:3072 lds
    s_mov_b32 m0, 106496
    s_add_u32 s45, s46, 73728
    buffer_load_dwordx4 v2, s[32:35], s45 offen offset:0 lds
    buffer_load_dwordx4 v3, s[32:35], s45 offen offset:1024 lds
    buffer_load_dwordx4 v4, s[32:35], s45 offen offset:2048 lds
    buffer_load_dwordx4 v5, s[32:35], s45 offen offset:3072 lds
    s_mov_b32 m0, 110592
    s_add_u32 s45, s46, 110592
    buffer_load_dwordx4 v2, s[32:35], s45 offen offset:0 lds
    buffer_load_dwordx4 v3, s[32:35], s45 offen offset:1024 lds
    buffer_load_dwordx4 v4, s[32:35], s45 offen offset:2048 lds
    buffer_load_dwordx4 v5, s[32:35], s45 offen offset:3072 lds
    s_add_u32 s46, s46, 128
    s_cmp_ge_u32 s46, s47
    s_cselect_b32 s44, 1152, 0
    s_sub_u32 s46, s46, s44
    s_waitcnt vmcnt(16)
    s_barrier
    s_mov_b32 m0, 0
    s_nop 0
    buffer_load_dwordx4 v2, s[32:35], s46 offen offset:0 lds
    buffer_load_dwordx4 v3, s[32:35], s46 offen offset:1024 lds
    buffer_load_dwordx4 v4, s[32:35], s46 offen offset:2048 lds
    buffer_load_dwordx4 v5, s[32:35], s46 offen offset:3072 lds
    s_mov_b32 m0, 4096
    s_add_u32 s45, s46, 36864
    buffer_load_dwordx4 v2, s[32:35], s45 offen offset:0 lds
    buffer_load_dwordx4 v3, s[32:35], s45 offen offset:1024 lds
    buffer_load_dwordx4 v4, s[32:35], s45 offen offset:2048 lds
    buffer_load_dwordx4 v5, s[32:35], s45 offen offset:3072 lds
    s_mov_b32 m0, 8192
    s_add_u32 s45, s46, 73728
    buffer_load_dwordx4 v2, s[32:35], s45 offen offset:0 lds
    buffer_load_dwordx4 v3, s[32:35], s45 offen offset:1024 lds
    buffer_load_dwordx4 v4, s[32:35], s45 offen offset:2048 lds
    buffer_load_dwordx4 v5, s[32:35], s45 offen offset:3072 lds
    s_mov_b32 m0, 12288
    s_add_u32 s45, s46, 110592
    buffer_load_dwordx4 v2, s[32:35], s45 offen offset:0 lds
    buffer_load_dwordx4 v3, s[32:35], s45 offen offset:1024 lds
    buffer_load_dwordx4 v4, s[32:35], s45 offen offset:2048 lds
    buffer_load_dwordx4 v5, s[32:35], s45 offen offset:3072 lds
    s_add_u32 s46, s46, 128
    s_cmp_ge_u32 s46, s47
    s_cselect_b32 s44, 1152, 0
    s_sub_u32 s46, s46, s44
    s_waitcnt vmcnt(16)
    s_barrier
    s_waitcnt vmcnt(0)
    s_barrier
    v_mov_b32 v35, 0
    s_mov_b32 s56, 0
L_sequential_preLN__linear_kernel_hedgehog__dense_activation_relu__prompt_kernel_renonce_19:
    buffer_load_dword v37, v35, s[36:39], 0 offen sc1
    s_waitcnt vmcnt(0)
    v_readfirstlane_b32 s57, v37
    s_nop 0
    s_cmp_lg_u32 s57, 0
    s_cbranch_scc1 L_sequential_preLN__linear_kernel_hedgehog__dense_activation_relu__prompt_kernel_gotnonce_20
    s_add_u32 s56, s56, 1
    s_cmp_lt_u32 s56, 0x40000
    s_cbranch_scc1 L_sequential_preLN__linear_kernel_hedgehog__dense_activation_relu__prompt_kernel_renonce_19
L_sequential_preLN__linear_kernel_hedgehog__dense_activation_relu__prompt_kernel_gotnonce_20:
    s_lshl_b32 s50, s25, 7
    s_add_u32 s50, s50, 6490112
    s_lshl_b32 s44, s26, 2
    v_mov_b32 v34, s44
    s_lshl_b32 s25, s23, 2
    s_lshr_b32 s44, s24, 3
    s_add_u32 s25, s25, s44
    s_and_b32 s26, s24, 7
    s_and_b32 s27, s24, 1
    s_mov_b32 s44, 14913081
    v_add_u32 v40, 0, v1
    v_mul_hi_u32 v41, v40, s44
    v_mul_u32_u24 v42, 288, v41
    v_sub_u32 v42, v40, v42
    v_mul_u32_u24 v41, 9216, v41
    v_lshl_add_u32 v2, v42, 4, v41
    v_add_u32 v40, 64, v1
    v_mul_hi_u32 v41, v40, s44
    v_mul_u32_u24 v42, 288, v41
    v_sub_u32 v42, v40, v42
    v_mul_u32_u24 v41, 9216, v41
    v_lshl_add_u32 v3, v42, 4, v41
    v_subrev_u32 v3, 1024, v3
    v_add_u32 v40, 128, v1
    v_mul_hi_u32 v41, v40, s44
    v_mul_u32_u24 v42, 288, v41
    v_sub_u32 v42, v40, v42
    v_mul_u32_u24 v41, 9216, v41
    v_lshl_add_u32 v4, v42, 4, v41
    v_subrev_u32 v4, 2048, v4
    v_add_u32 v40, 192, v1
    v_mul_hi_u32 v41, v40, s44
    v_mul_u32_u24 v42, 288, v41
    v_sub_u32 v42, v40, v42
    v_mul_u32_u24 v41, 9216, v41
    v_lshl_add_u32 v5, v42, 4, v41
    v_subrev_u32 v5, 3072, v5
    v_add_u32 v40, 256, v1
    v_mul_hi_u32 v41, v40, s44
    v_mul_u32_u24 v42, 288, v41
    v_sub_u32 v42, v40, v42
    v_mul_u32_u24 v41, 9216, v41
    v_lshl_add_u32 v6, v42, 4, v41
    v_add_u32 v40, 320, v1
    v_mul_hi_u32 v41, v40, s44
    v_mul_u32_u24 v42, 288, v41
    v_sub_u32 v42, v40, v42
    v_mul_u32_u24 v41, 9216, v41
    v_lshl_add_u32 v7, v42, 4, v41
    v_subrev_u32 v7, 1024, v7
    v_add_u32 v40, 384, v1
    v_mul_hi_u32 v41, v40, s44
    v_mul_u32_u24 v42, 288, v41
    v_sub_u32 v42, v40, v42
    v_mul_u32_u24 v41, 9216, v41
    v_lshl_add_u32 v8, v42, 4, v41
    v_subrev_u32 v8, 2048, v8
    v_add_u32 v40, 448, v1
    v_mul_hi_u32 v41, v40, s44
    v_mul_u32_u24 v42, 288, v41
    v_sub_u32 v42, v40, v42
    v_mul_u32_u24 v41, 9216, v41
    v_lshl_add_u32 v9, v42, 4, v41
    v_subrev_u32 v9, 3072, v9
    v_add_u32 v40, 512, v1
    v_mul_hi_u32 v41, v40, s44
    v_mul_u32_u24 v42, 288, v41
    v_sub_u32 v42, v40, v42
    v_mul_u32_u24 v41, 9216, v41
    v_lshl_add_u32 v10, v42, 4, v41
    s_lshr_b32 s44, s25, 1
    s_lshl_b32 s51, s44, 7
    s_add_u32 s51, s51, 6490112
    s_mul_i32 s46, s44, 147456
    s_and_b32 s44, s25, 1
    s_mul_i32 s44, s44, 4608
    s_add_u32 s46, s46, s44
    s_add_u32 s46, s46, 0
    s_add_u32 s47, s46, 147456
    s_mul_i32 s44, s27, 73728
    s_add_u32 s46, s46, s44
    v_and_b32 v36, 15, v1
    v_lshlrev_b32 v36, 2, v36
    s_barrier
    s_barrier
    s_barrier
    s_barrier
    s_barrier
    s_mov_b64 exec, 1
    buffer_store_dword v37, v34, s[28:31], s50 offen sc1
    s_mov_b64 exec, -1
    s_mov_b32 s56, 0
L_sequential_preLN__linear_kernel_hedgehog__dense_activation_relu__prompt_kernel_poll_21:
    buffer_load_dword v39, v36, s[28:31], s51 offen sc1
    s_waitcnt vmcnt(0)
    v_cmp_ne_u32 vcc, v39, v37
    s_nop 0
    s_cmp_eq_u64 vcc, 0
    s_cbranch_scc1 L_sequential_preLN__linear_kernel_hedgehog__dense_activation_relu__prompt_kernel_polled_22
    s_sleep 1
    s_add_u32 s56, s56, 1
    s_cmp_lt_u32 s56, 0x20000
    s_cbranch_scc1 L_sequential_preLN__linear_kernel_hedgehog__dense_activation_relu__prompt_kernel_poll_21
L_sequential_preLN__linear_kernel_hedgehog__dense_activation_relu__prompt_kernel_polled_22:
    s_mov_b32 m0, 92160
    s_nop 0
    buffer_load_dwordx4 v2, s[28:31], s46 offen offset:0 sc1 lds
    buffer_load_dwordx4 v3, s[28:31], s46 offen offset:1024 sc1 lds
    buffer_load_dwordx4 v4, s[28:31], s46 offen offset:2048 sc1 lds
    buffer_load_dwordx4 v5, s[28:31], s46 offen offset:3072 sc1 lds
    s_mov_b32 m0, 96256
    s_nop 0
    buffer_load_dwordx4 v6, s[28:31], s46 offen offset:0 sc1 lds
    buffer_load_dwordx4 v7, s[28:31], s46 offen offset:1024 sc1 lds
    buffer_load_dwordx4 v8, s[28:31], s46 offen offset:2048 sc1 lds
    buffer_load_dwordx4 v9, s[28:31], s46 offen offset:3072 sc1 lds
    s_mov_b32 m0, 100352
    s_nop 0
    buffer_load_dwordx4 v10, s[28:31], s46 offen offset:0 sc1 lds
    s_add_u32 s46, s46, 18432
    s_cmp_ge_u32 s46, s47
    s_cselect_b32 s44, 147456, 0
    s_sub_u32 s46, s46, s44
    s_mov_b32 m0, 101376
    s_nop 0
    buffer_load_dwordx4 v2, s[28:31], s46 offen offset:0 sc1 lds
    buffer_load_dwordx4 v3, s[28:31], s46 offen offset:1024 sc1 lds
    buffer_load_dwordx4 v4, s[28:31], s46 offen offset:2048 sc1 lds
    buffer_load_dwordx4 v5, s[28:31], s46 offen offset:3072 sc1 lds
    s_mov_b32 m0, 105472
    s_nop 0
    buffer_load_dwordx4 v6, s[28:31], s46 offen offset:0 sc1 lds
    buffer_load_dwordx4 v7, s[28:31], s46 offen offset:1024 sc1 lds
    buffer_load_dwordx4 v8, s[28:31], s46 offen offset:2048 sc1 lds
    buffer_load_dwordx4 v9, s[28:31], s46 offen offset:3072 sc1 lds
    s_mov_b32 m0, 109568
    s_nop 0
    buffer_load_dwordx4 v10, s[28:31], s46 offen offset:0 sc1 lds
    s_add_u32 s46, s46, 18432
    s_cmp_ge_u32 s46, s47
    s_cselect_b32 s44, 147456, 0
    s_sub_u32 s46, s46, s44
    s_mov_b32 m0, 110592
    s_nop 0
    buffer_load_dwordx4 v2, s[28:31], s46 offen offset:0 sc1 lds
    buffer_load_dwordx4 v3, s[28:31], s46 offen offset:1024 sc1 lds
    buffer_load_dwordx4 v4, s[28:31], s46 offen offset:2048 sc1 lds
    buffer_load_dwordx4 v5, s[28:31], s46 offen offset:3072 sc1 lds
    s_mov_b32 m0, 114688
    s_nop 0
    buffer_load_dwordx4 v6, s[28:31], s46 offen offset:0 sc1 lds
    buffer_load_dwordx4 v7, s[28:31], s46 offen offset:1024 sc1 lds
    buffer_load_dwordx4 v8, s[28:31], s46 offen offset:2048 sc1 lds
    buffer_load_dwordx4 v9, s[28:31], s46 offen offset:3072 sc1 lds
    s_mov_b32 m0, 118784
    s_nop 0
    buffer_load_dwordx4 v10, s[28:31], s46 offen offset:0 sc1 lds
    s_add_u32 s46, s46, 18432
    s_cmp_ge_u32 s46, s47
    s_cselect_b32 s44, 147456, 0
    s_sub_u32 s46, s46, s44
    s_mov_b32 m0, 119808
    s_nop 0
    buffer_load_dwordx4 v2, s[28:31], s46 offen offset:0 sc1 lds
    buffer_load_dwordx4 v3, s[28:31], s46 offen offset:1024 sc1 lds
    buffer_load_dwordx4 v4, s[28:31], s46 offen offset:2048 sc1 lds
    buffer_load_dwordx4 v5, s[28:31], s46 offen offset:3072 sc1 lds
    s_mov_b32 m0, 123904
    s_nop 0
    buffer_load_dwordx4 v6, s[28:31], s46 offen offset:0 sc1 lds
    buffer_load_dwordx4 v7, s[28:31], s46 offen offset:1024 sc1 lds
    buffer_load_dwordx4 v8, s[28:31], s46 offen offset:2048 sc1 lds
    buffer_load_dwordx4 v9, s[28:31], s46 offen offset:3072 sc1 lds
    s_mov_b32 m0, 128000
    s_nop 0
    buffer_load_dwordx4 v10, s[28:31], s46 offen offset:0 sc1 lds
    s_add_u32 s46, s46, 18432
    s_cmp_ge_u32 s46, s47
    s_cselect_b32 s44, 147456, 0
    s_sub_u32 s46, s46, s44
    s_waitcnt vmcnt(27)
    s_barrier
    s_mov_b32 m0, 129024
    s_nop 0
    buffer_load_dwordx4 v2, s[28:31], s46 offen offset:0 sc1 lds
    buffer_load_dwordx4 v3, s[28:31], s46 offen offset:1024 sc1 lds
    buffer_load_dwordx4 v4, s[28:31], s46 offen offset:2048 sc1 lds
    buffer_load_dwordx4 v5, s[28:31], s46 offen offset:3072 sc1 lds
    s_mov_b32 m0, 133120
    s_nop 0
    buffer_load_dwordx4 v6, s[28:31], s46 offen offset:0 sc1 lds
    buffer_load_dwordx4 v7, s[28:31], s46 offen offset:1024 sc1 lds
    buffer_load_dwordx4 v8, s[28:31], s46 offen offset:2048 sc1 lds
    buffer_load_dwordx4 v9, s[28:31], s46 offen offset:3072 sc1 lds
    s_mov_b32 m0, 137216
    s_nop 0
    buffer_load_dwordx4 v10, s[28:31], s46 offen offset:0 sc1 lds
    s_add_u32 s46, s46, 18432
    s_cmp_ge_u32 s46, s47
    s_cselect_b32 s44, 147456, 0
    s_sub_u32 s46, s46, s44
    s_waitcnt vmcnt(27)
    s_barrier
    s_mov_b32 m0, 138240
    s_nop 0
    buffer_load_dwordx4 v2, s[28:31], s46 offen offset:0 sc1 lds
    buffer_load_dwordx4 v3, s[28:31], s46 offen offset:1024 sc1 lds
    buffer_load_dwordx4 v4, s[28:31], s46 offen offset:2048 sc1 lds
    buffer_load_dwordx4 v5, s[28:31], s46 offen offset:3072 sc1 lds
    s_mov_b32 m0, 142336
    s_nop 0
    buffer_load_dwordx4 v6, s[28:31], s46 offen offset:0 sc1 lds
    buffer_load_dwordx4 v7, s[28:31], s46 offen offset:1024 sc1 lds
    buffer_load_dwordx4 v8, s[28:31], s46 offen offset:2048 sc1 lds
    buffer_load_dwordx4 v9, s[28:31], s46 offen offset:3072 sc1 lds
    s_mov_b32 m0, 146432
    s_nop 0
    buffer_load_dwordx4 v10, s[28:31], s46 offen offset:0 sc1 lds
    s_add_u32 s46, s46, 18432
    s_cmp_ge_u32 s46, s47
    s_cselect_b32 s44, 147456, 0
    s_sub_u32 s46, s46, s44
    s_waitcnt vmcnt(27)
    s_barrier
    s_mov_b32 m0, 147456
    s_nop 0
    buffer_load_dwordx4 v2, s[28:31], s46 offen offset:0 sc1 lds
    buffer_load_dwordx4 v3, s[28:31], s46 offen offset:1024 sc1 lds
    buffer_load_dwordx4 v4, s[28:31], s46 offen offset:2048 sc1 lds
    buffer_load_dwordx4 v5, s[28:31], s46 offen offset:3072 sc1 lds
    s_mov_b32 m0, 151552
    s_nop 0
    buffer_load_dwordx4 v6, s[28:31], s46 offen offset:0 sc1 lds
    buffer_load_dwordx4 v7, s[28:31], s46 offen offset:1024 sc1 lds
    buffer_load_dwordx4 v8, s[28:31], s46 offen offset:2048 sc1 lds
    buffer_load_dwordx4 v9, s[28:31], s46 offen offset:3072 sc1 lds
    s_mov_b32 m0, 155648
    s_nop 0
    buffer_load_dwordx4 v10, s[28:31], s46 offen offset:0 sc1 lds
    s_add_u32 s46, s46, 18432
    s_cmp_ge_u32 s46, s47
    s_cselect_b32 s44, 147456, 0
    s_sub_u32 s46, s46, s44
    s_waitcnt vmcnt(27)
    s_barrier
    s_mov_b32 m0, 92160
    s_nop 0
    buffer_load_dwordx4 v2, s[28:31], s46 offen offset:0 sc1 lds
    buffer_load_dwordx4 v3, s[28:31], s46 offen offset:1024 sc1 lds
    buffer_load_dwordx4 v4, s[28:31], s46 offen offset:2048 sc1 lds
    buffer_load_dwordx4 v5, s[28:31], s46 offen offset:3072 sc1 lds
    s_mov_b32 m0, 96256
    s_nop 0
    buffer_load_dwordx4 v6, s[28:31], s46 offen offset:0 sc1 lds
    buffer_load_dwordx4 v7, s[28:31], s46 offen offset:1024 sc1 lds
    buffer_load_dwordx4 v8, s[28:31], s46 offen offset:2048 sc1 lds
    buffer_load_dwordx4 v9, s[28:31], s46 offen offset:3072 sc1 lds
    s_mov_b32 m0, 100352
    s_nop 0
    buffer_load_dwordx4 v10, s[28:31], s46 offen offset:0 sc1 lds
    s_add_u32 s46, s46, 18432
    s_cmp_ge_u32 s46, s47
    s_cselect_b32 s44, 147456, 0
    s_sub_u32 s46, s46, s44
    s_waitcnt vmcnt(27)
    s_barrier
    s_waitcnt vmcnt(18)
    s_barrier
    s_waitcnt vmcnt(9)
    s_barrier
    s_waitcnt vmcnt(0)
    s_barrier
    s_cmp_ge_u32 s24, 18
    s_cselect_b32 s26, 18, 0
    s_sub_u32 s26, s24, s26
    s_cmp_ge_u32 s26, 9
    s_cselect_b32 s27, 9, 0
    s_sub_u32 s27, s26, s27
    s_mov_b32 s44, 59652324
    v_add_u32 v40, 0, v1
    v_mul_hi_u32 v41, v40, s44
    v_mul_u32_u24 v42, 72, v41
    v_sub_u32 v42, v40, v42
    v_bfe_u32 v43, v41, 1, 1
    v_lshlrev_b32 v43, 2, v43
    v_xor_b32 v42, v42, v43
    v_mul_u32_u24 v41, 9216, v41
    v_lshl_add_u32 v2, v42, 4, v41
    v_add_u32 v40, 64, v1
    v_mul_hi_u32 v41, v40, s44
    v_mul_u32_u24 v42, 72, v41
    v_sub_u32 v42, v40, v42
    v_bfe_u32 v43, v41, 1, 1
    v_lshlrev_b32 v43, 2, v43
    v_xor_b32 v42, v42, v43
    v_mul_u32_u24 v41, 9216, v41
    v_lshl_add_u32 v3, v42, 4, v41
    v_subrev_u32 v3, 1024, v3
    v_add_u32 v40, 128, v1
    v_mul_hi_u32 v41, v40, s44
    v_mul_u32_u24 v42, 72, v41
    v_sub_u32 v42, v40, v42
    v_bfe_u32 v43, v41, 1, 1
    v_lshlrev_b32 v43, 2, v43
    v_xor_b32 v42, v42, v43
    v_mul_u32_u24 v41, 9216, v41
    v_lshl_add_u32 v4, v42, 4, v41
    v_subrev_u32 v4, 2048, v4
    v_add_u32 v40, 192, v1
    v_mul_hi_u32 v41, v40, s44
    v_mul_u32_u24 v42, 72, v41
    v_sub_u32 v42, v40, v42
    v_bfe_u32 v43, v41, 1, 1
    v_lshlrev_b32 v43, 2, v43
    v_xor_b32 v42, v42, v43
    v_mul_u32_u24 v41, 9216, v41
    v_lshl_add_u32 v5, v42, 4, v41
    v_subrev_u32 v5, 3072, v5
    v_add_u32 v40, 256, v1
    v_mul_hi_u32 v41, v40, s44
    v_mul_u32_u24 v42, 72, v41
    v_sub_u32 v42, v40, v42
    v_bfe_u32 v43, v41, 1, 1
    v_lshlrev_b32 v43, 2, v43
    v_xor_b32 v42, v42, v43
    v_mul_u32_u24 v41, 9216, v41
    v_lshl_add_u32 v6, v42, 4, v41
    v_add_u32 v40, 320, v1
    v_mul_hi_u32 v41, v40, s44
    v_mul_u32_u24 v42, 72, v41
    v_sub_u32 v42, v40, v42
    v_bfe_u32 v43, v41, 1, 1
    v_lshlrev_b32 v43, 2, v43
    v_xor_b32 v42, v42, v43
    v_mul_u32_u24 v41, 9216, v41
    v_lshl_add_u32 v7, v42, 4, v41
    v_subrev_u32 v7, 1024, v7
    v_add_u32 v40, 384, v1
    v_mul_hi_u32 v41, v40, s44
    v_mul_u32_u24 v42, 72, v41
    v_sub_u32 v42, v40, v42
    v_bfe_u32 v43, v41, 1, 1
    v_lshlrev_b32 v43, 2, v43
    v_xor_b32 v42, v42, v43
    v_mul_u32_u24 v41, 9216, v41
    v_lshl_add_u32 v8, v42, 4, v41
    v_subrev_u32 v8, 2048, v8
    v_add_u32 v40, 448, v1
    v_mul_hi_u32 v41, v40, s44
    v_mul_u32_u24 v42, 72, v41
    v_sub_u32 v42, v40, v42
    v_bfe_u32 v43, v41, 1, 1
    v_lshlrev_b32 v43, 2, v43
    v_xor_b32 v42, v42, v43
    v_mul_u32_u24 v41, 9216, v41
    v_lshl_add_u32 v9, v42, 4, v41
    v_subrev_u32 v9, 3072, v9
    v_add_u32 v40, 512, v1
    v_mul_hi_u32 v41, v40, s44
    v_mul_u32_u24 v42, 72, v41
    v_sub_u32 v42, v40, v42
    v_bfe_u32 v43, v41, 1, 1
    v_lshlrev_b32 v43, 2, v43
    v_xor_b32 v42, v42, v43
    v_mul_u32_u24 v41, 9216, v41
    v_lshl_add_u32 v10, v42, 4, v41
    v_add_u32 v40, 576, v1
    v_mul_hi_u32 v41, v40, s44
    v_mul_u32_u24 v42, 72, v41
    v_sub_u32 v42, v40, v42
    v_bfe_u32 v43, v41, 1, 1
    v_lshlrev_b32 v43, 2, v43
    v_xor_b32 v42, v42, v43
    v_mul_u32_u24 v41, 9216, v41
    v_lshl_add_u32 v11, v42, 4, v41
    v_subrev_u32 v11, 1024, v11
    v_add_u32 v40, 640, v1
    v_mul_hi_u32 v41, v40, s44
    v_mul_u32_u24 v42, 72, v41
    v_sub_u32 v42, v40, v42
    v_bfe_u32 v43, v41, 1, 1
    v_lshlrev_b32 v43, 2, v43
    v_xor_b32 v42, v42, v43
    v_mul_u32_u24 v41, 9216, v41
    v_lshl_add_u32 v12, v42, 4, v41
    v_subrev_u32 v12, 2048, v12
    v_add_u32 v40, 704, v1
    v_mul_hi_u32 v41, v40, s44
    v_mul_u32_u24 v42, 72, v41
    v_sub_u32 v42, v40, v42
    v_bfe_u32 v43, v41, 1, 1
    v_lshlrev_b32 v43, 2, v43
    v_xor_b32 v42, v42, v43
    v_mul_u32_u24 v41, 9216, v41
    v_lshl_add_u32 v13, v42, 4, v41
    v_subrev_u32 v13, 3072, v13
    v_add_u32 v40, 768, v1
    v_mul_hi_u32 v41, v40, s44
    v_mul_u32_u24 v42, 72, v41
    v_sub_u32 v42, v40, v42
    v_bfe_u32 v43, v41, 1, 1
    v_lshlrev_b32 v43, 2, v43
    v_xor_b32 v42, v42, v43
    v_mul_u32_u24 v41, 9216, v41
    v_lshl_add_u32 v14, v42, 4, v41
    v_add_u32 v40, 832, v1
    v_mul_hi_u32 v41, v40, s44
    v_mul_u32_u24 v42, 72, v41
    v_sub_u32 v42, v40, v42
    v_bfe_u32 v43, v41, 1, 1
    v_lshlrev_b32 v43, 2, v43
    v_xor_b32 v42, v42, v43
    v_mul_u32_u24 v41, 9216, v41
    v_lshl_add_u32 v15, v42, 4, v41
    v_subrev_u32 v15, 1024, v15
    v_add_u32 v40, 896, v1
    v_mul_hi_u32 v41, v40, s44
    v_mul_u32_u24 v42, 72, v41
    v_sub_u32 v42, v40, v42
    v_bfe_u32 v43, v41, 1, 1
    v_lshlrev_b32 v43, 2, v43
    v_xor_b32 v42, v42, v43
    v_mul_u32_u24 v41, 9216, v41
    v_lshl_add_u32 v16, v42, 4, v41
    v_subrev_u32 v16, 2048, v16
    v_add_u32 v40, 960, v1
    v_mul_hi_u32 v41, v40, s44
    v_mul_u32_u24 v42, 72, v41
    v_sub_u32 v42, v40, v42
    v_bfe_u32 v43, v41, 1, 1
    v_lshlrev_b32 v43, 2, v43
    v_xor_b32 v42, v42, v43
    v_mul_u32_u24 v41, 9216, v41
    v_lshl_add_u32 v17, v42, 4, v41
    v_subrev_u32 v17, 3072, v17
    v_add_u32 v40, 1024, v1
    v_mul_hi_u32 v41, v40, s44
    v_mul_u32_u24 v42, 72, v41
    v_sub_u32 v42, v40, v42
    v_bfe_u32 v43, v41, 1, 1
    v_lshlrev_b32 v43, 2, v43
    v_xor_b32 v42, v42, v43
    v_mul_u32_u24 v41, 9216, v41
    v_lshl_add_u32 v18, v42, 4, v41
    v_add_u32 v40, 1088, v1
    v_mul_hi_u32 v41, v40, s44
    v_mul_u32_u24 v42, 72, v41
    v_sub_u32 v42, v40, v42
    v_bfe_u32 v43, v41, 1, 1
    v_lshlrev_b32 v43, 2, v43
    v_xor_b32 v42, v42, v43
    v_mul_u32_u24 v41, 9216, v41
    v_lshl_add_u32 v19, v42, 4, v41
    v_subrev_u32 v19, 1024, v19
    v_lshlrev_b32 v38, 4, v1
    v_and_b32 v36, 7, v1
    v_lshlrev_b32 v36, 2, v36
    s_mov_b32 s32, s12
    s_and_b32 s33, s13, 0xffff
    s_mov_b32 s34, 5308416
    s_mov_b32 s35, 0x20000
    s_mov_b32 s36, s14
    s_and_b32 s37, s15, 0xffff
    s_mov_b32 s38, 5308416
    s_mov_b32 s39, 0x20000
    s_mul_i32 s46, s23, 1152
    s_add_u32 s53, s46, 6553600
    s_add_u32 s46, s46, 0
    s_add_u32 s47, s46, 5308416
    s_mul_i32 s44, s26, 294912
    s_add_u32 s46, s46, s44
    s_lshl_b32 s48, s24, 1
    s_add_u32 s48, s48, 0
    s_mul_i32 s48, s48, 36864
    s_add_u32 s48, s48, 2359296
    s_add_u32 s49, s48, 36864
    s_lshl_b32 s44, s26, 11
    s_add_u32 s48, s48, s44
    s_mul_i32 s50, s23, 663552
    s_add_u32 s50, s50, 0
    s_add_u32 s51, s50, 1152
    s_lshl_b32 s44, s27, 7
    s_add_u32 s50, s50, s44
    s_lshl_b32 s54, s24, 7
    s_add_u32 s54, s54, 6492160
    s_barrier
    s_barrier
    s_mov_b32 m0, 0
    s_nop 0
    buffer_load_dwordx4 v2, s[32:35], s46 offen offset:0  lds
    buffer_load_dwordx4 v3, s[32:35], s46 offen offset:1024  lds
    buffer_load_dwordx4 v4, s[32:35], s46 offen offset:2048  lds
    buffer_load_dwordx4 v5, s[32:35], s46 offen offset:3072  lds
    s_mov_b32 m0, 4096
    s_nop 0
    buffer_load_dwordx4 v6, s[32:35], s46 offen offset:0  lds
    buffer_load_dwordx4 v7, s[32:35], s46 offen offset:1024  lds
    buffer_load_dwordx4 v8, s[32:35], s46 offen offset:2048  lds
    buffer_load_dwordx4 v9, s[32:35], s46 offen offset:3072  lds
    s_mov_b32 m0, 8192
    s_nop 0
    buffer_load_dwordx4 v10, s[32:35], s46 offen offset:0  lds
    buffer_load_dwordx4 v11, s[32:35], s46 offen offset:1024  lds
    buffer_load_dwordx4 v12, s[32:35], s46 offen offset:2048  lds
    buffer_load_dwordx4 v13, s[32:35], s46 offen offset:3072  lds
    s_mov_b32 m0, 12288
    s_nop 0
    buffer_load_dwordx4 v14, s[32:35], s46 offen offset:0  lds
    buffer_load_dwordx4 v15, s[32:35], s46 offen offset:1024  lds
    buffer_load_dwordx4 v16, s[32:35], s46 offen offset:2048  lds
    buffer_load_dwordx4 v17, s[32:35], s46 offen offset:3072  lds
    s_mov_b32 m0, 16384
    s_nop 0
    buffer_load_dwordx4 v18, s[32:35], s46 offen offset:0  lds
    buffer_load_dwordx4 v19, s[32:35], s46 offen offset:1024  lds
    s_add_u32 s46, s46, 294912
    s_cmp_ge_u32 s46, s47
    s_cselect_b32 s44, 5308416, 0
    s_sub_u32 s46, s46, s44
    s_mov_b32 m0, 36864
    s_nop 0
    buffer_load_dwordx4 v2, s[32:35], s46 offen offset:0  lds
    buffer_load_dwordx4 v3, s[32:35], s46 offen offset:1024  lds
    buffer_load_dwordx4 v4, s[32:35], s46 offen offset:2048  lds
    buffer_load_dwordx4 v5, s[32:35], s46 offen offset:3072  lds
    s_mov_b32 m0, 40960
    s_nop 0
    buffer_load_dwordx4 v6, s[32:35], s46 offen offset:0  lds
    buffer_load_dwordx4 v7, s[32:35], s46 offen offset:1024  lds
    buffer_load_dwordx4 v8, s[32:35], s46 offen offset:2048  lds
    buffer_load_dwordx4 v9, s[32:35], s46 offen offset:3072  lds
    s_mov_b32 m0, 45056
    s_nop 0
    buffer_load_dwordx4 v10, s[32:35], s46 offen offset:0  lds
    buffer_load_dwordx4 v11, s[32:35], s46 offen offset:1024  lds
    buffer_load_dwordx4 v12, s[32:35], s46 offen offset:2048  lds
    buffer_load_dwordx4 v13, s[32:35], s46 offen offset:3072  lds
    s_mov_b32 m0, 49152
    s_nop 0
    buffer_load_dwordx4 v14, s[32:35], s46 offen offset:0  lds
    buffer_load_dwordx4 v15, s[32:35], s46 offen offset:1024  lds
    buffer_load_dwordx4 v16, s[32:35], s46 offen offset:2048  lds
    buffer_load_dwordx4 v17, s[32:35], s46 offen offset:3072  lds
    s_mov_b32 m0, 53248
    s_nop 0
    buffer_load_dwordx4 v18, s[32:35], s46 offen offset:0  lds
    buffer_load_dwordx4 v19, s[32:35], s46 offen offset:1024  lds
    s_add_u32 s46, s46, 294912
    s_cmp_ge_u32 s46, s47
    s_cselect_b32 s44, 5308416, 0
    s_sub_u32 s46, s46, s44
    s_add_u32 s48, s48, 2048
    s_cmp_ge_u32 s48, s49
    s_cselect_b32 s44, 36864, 0
    s_sub_u32 s48, s48, s44
    s_add_u32 s48, s48, 2048
    s_cmp_ge_u32 s48, s49
    s_cselect_b32 s44, 36864, 0
    s_sub_u32 s48, s48, s44
    s_add_u32 s48, s48, 2048
    s_cmp_ge_u32 s48, s49
    s_cselect_b32 s44, 36864, 0
    s_sub_u32 s48, s48, s44
    s_waitcnt vmcnt(18)
    s_barrier
    s_mov_b32 m0, 73728
    s_nop 0
    buffer_load_dwordx4 v2, s[32:35], s46 offen offset:0  lds
    buffer_load_dwordx4 v3, s[32:35], s46 offen offset:1024  lds
    buffer_load_dwordx4 v4, s[32:35], s46 offen offset:2048  lds
    buffer_load_dwordx4 v5, s[32:35], s46 offen offset:3072  lds
    s_mov_b32 m0, 77824
    s_nop 0
    buffer_load_dwordx4 v6, s[32:35], s46 offen offset:0  lds
    buffer_load_dwordx4 v7, s[32:35], s46 offen offset:1024  lds
    buffer_load_dwordx4 v8, s[32:35], s46 offen offset:2048  lds
    buffer_load_dwordx4 v9, s[32:35], s46 offen offset:3072  lds
    s_mov_b32 m0, 81920
    s_nop 0
    buffer_load_dwordx4 v10, s[32:35], s46 offen offset:0  lds
    buffer_load_dwordx4 v11, s[32:35], s46 offen offset:1024  lds
    buffer_load_dwordx4 v12, s[32:35], s46 offen offset:2048  lds
    buffer_load_dwordx4 v13, s[32:35], s46 offen offset:3072  lds
    s_mov_b32 m0, 86016
    s_nop 0
    buffer_load_dwordx4 v14, s[32:35], s46 offen offset:0  lds
    buffer_load_dwordx4 v15, s[32:35], s46 offen offset:1024  lds
    buffer_load_dwordx4 v16, s[32:35], s46 offen offset:2048  lds
    buffer_load_dwordx4 v17, s[32:35], s46 offen offset:3072  lds
    s_mov_b32 m0, 90112
    s_nop 0
    buffer_load_dwordx4 v18, s[32:35], s46 offen offset:0  lds
    buffer_load_dwordx4 v19, s[32:35], s46 offen offset:1024  lds
    s_add_u32 s46, s46, 294912
    s_cmp_ge_u32 s46, s47
    s_cselect_b32 s44, 5308416, 0
    s_sub_u32 s46, s46, s44
    s_waitcnt vmcnt(18)
    s_barrier
    s_mov_b32 m0, 159744
    s_nop 0
    buffer_load_dwordx4 v38, s[28:31], s48 offen sc1 lds
    s_mov_b32 m0, 160768
    s_nop 0
    buffer_load_dwordx4 v38, s[28:31], s48 offen offset:1024 sc1 lds
    s_add_u32 s48, s48, 2048
    s_cmp_ge_u32 s48, s49
    s_cselect_b32 s44, 36864, 0
    s_sub_u32 s48, s48, s44
    s_mov_b32 m0, 110592
    s_nop 0
    buffer_load_dwordx4 v2, s[32:35], s46 offen offset:0  lds
    buffer_load_dwordx4 v3, s[32:35], s46 offen offset:1024  lds
    buffer_load_dwordx4 v4, s[32:35], s46 offen offset:2048  lds
    buffer_load_dwordx4 v5, s[32:35], s46 offen offset:3072  lds
    s_mov_b32 m0, 114688
    s_nop 0
    buffer_load_dwordx4 v6, s[32:35], s46 offen offset:0  lds
    buffer_load_dwordx4 v7, s[32:35], s46 offen offset:1024  lds
    buffer_load_dwordx4 v8, s[32:35], s46 offen offset:2048  lds
    buffer_load_dwordx4 v9, s[32:35], s46 offen offset:3072  lds
    s_mov_b32 m0, 118784
    s_nop 0
    buffer_load_dwordx4 v10, s[32:35], s46 offen offset:0  lds
    buffer_load_dwordx4 v11, s[32:35], s46 offen offset:1024  lds
    buffer_load_dwordx4 v12, s[32:35], s46 offen offset:2048  lds
    buffer_load_dwordx4 v13, s[32:35], s46 offen offset:3072  lds
    s_mov_b32 m0, 122880
    s_nop 0
    buffer_load_dwordx4 v14, s[32:35], s46 offen offset:0  lds
    buffer_load_dwordx4 v15, s[32:35], s46 offen offset:1024  lds
    buffer_load_dwordx4 v16, s[32:35], s46 offen offset:2048  lds
    buffer_load_dwordx4 v17, s[32:35], s46 offen offset:3072  lds
    s_mov_b32 m0, 126976
    s_nop 0
    buffer_load_dwordx4 v18, s[32:35], s46 offen offset:0  lds
    buffer_load_dwordx4 v19, s[32:35], s46 offen offset:1024  lds
    s_add_u32 s46, s46, 294912
    s_cmp_ge_u32 s46, s47
    s_cselect_b32 s44, 5308416, 0
    s_sub_u32 s46, s46, s44
    s_waitcnt vmcnt(20)
    s_barrier
    s_mov_b32 m0, 147456
    s_nop 0
    buffer_load_dwordx4 v38, s[28:31], s48 offen sc1 lds
    s_mov_b32 m0, 148480
    s_nop 0
    buffer_load_dwordx4 v38, s[28:31], s48 offen offset:1024 sc1 lds
    s_add_u32 s48, s48, 2048
    s_cmp_ge_u32 s48, s49
    s_cselect_b32 s44, 36864, 0
    s_sub_u32 s48, s48, s44
    s_mov_b32 m0, 0
    s_nop 0
    buffer_load_dwordx4 v2, s[32:35], s46 offen offset:0  lds
    buffer_load_dwordx4 v3, s[32:35], s46 offen offset:1024  lds
    buffer_load_dwordx4 v4, s[32:35], s46 offen offset:2048  lds
    buffer_load_dwordx4 v5, s[32:35], s46 offen offset:3072  lds
    s_mov_b32 m0, 4096
    s_nop 0
    buffer_load_dwordx4 v6, s[32:35], s46 offen offset:0  lds
    buffer_load_dwordx4 v7, s[32:35], s46 offen offset:1024  lds
    buffer_load_dwordx4 v8, s[32:35], s46 offen offset:2048  lds
    buffer_load_dwordx4 v9, s[32:35], s46 offen offset:3072  lds
    s_mov_b32 m0, 8192
    s_nop 0
    buffer_load_dwordx4 v10, s[32:35], s46 offen offset:0  lds
    buffer_load_dwordx4 v11, s[32:35], s46 offen offset:1024  lds
    buffer_load_dwordx4 v12, s[32:35], s46 offen offset:2048  lds
    buffer_load_dwordx4 v13, s[32:35], s46 offen offset:3072  lds
    s_mov_b32 m0, 12288
    s_nop 0
    buffer_load_dwordx4 v14, s[32:35], s46 offen offset:0  lds
    buffer_load_dwordx4 v15, s[32:35], s46 offen offset:1024  lds
    buffer_load_dwordx4 v16, s[32:35], s46 offen offset:2048  lds
    buffer_load_dwordx4 v17, s[32:35], s46 offen offset:3072  lds
    s_mov_b32 m0, 16384
    s_nop 0
    buffer_load_dwordx4 v18, s[32:35], s46 offen offset:0  lds
    buffer_load_dwordx4 v19, s[32:35], s46 offen offset:1024  lds
    s_add_u32 s46, s46, 294912
    s_cmp_ge_u32 s46, s47
    s_cselect_b32 s44, 5308416, 0
    s_sub_u32 s46, s46, s44
    s_waitcnt vmcnt(20)
    s_barrier
    s_mov_b32 m0, 151552
    s_nop 0
    buffer_load_dwordx4 v38, s[28:31], s48 offen sc1 lds
    s_mov_b32 m0, 152576
    s_nop 0
    buffer_load_dwordx4 v38, s[28:31], s48 offen offset:1024 sc1 lds
    s_add_u32 s48, s48, 2048
    s_cmp_ge_u32 s48, s49
    s_cselect_b32 s44, 36864, 0
    s_sub_u32 s48, s48, s44
    s_mov_b32 m0, 36864
    s_nop 0
    buffer_load_dwordx4 v2, s[32:35], s46 offen offset:0  lds
    buffer_load_dwordx4 v3, s[32:35], s46 offen offset:1024  lds
    buffer_load_dwordx4 v4, s[32:35], s46 offen offset:2048  lds
    buffer_load_dwordx4 v5, s[32:35], s46 offen offset:3072  lds
    s_mov_b32 m0, 40960
    s_nop 0
    buffer_load_dwordx4 v6, s[32:35], s46 offen offset:0  lds
    buffer_load_dwordx4 v7, s[32:35], s46 offen offset:1024  lds
    buffer_load_dwordx4 v8, s[32:35], s46 offen offset:2048  lds
    buffer_load_dwordx4 v9, s[32:35], s46 offen offset:3072  lds
    s_mov_b32 m0, 45056
    s_nop 0
    buffer_load_dwordx4 v10, s[32:35], s46 offen offset:0  lds
    buffer_load_dwordx4 v11, s[32:35], s46 offen offset:1024  lds
    buffer_load_dwordx4 v12, s[32:35], s46 offen offset:2048  lds
    buffer_load_dwordx4 v13, s[32:35], s46 offen offset:3072  lds
    s_mov_b32 m0, 49152
    s_nop 0
    buffer_load_dwordx4 v14, s[32:35], s46 offen offset:0  lds
    buffer_load_dwordx4 v15, s[32:35], s46 offen offset:1024  lds
    buffer_load_dwordx4 v16, s[32:35], s46 offen offset:2048  lds
    buffer_load_dwordx4 v17, s[32:35], s46 offen offset:3072  lds
    s_mov_b32 m0, 53248
    s_nop 0
    buffer_load_dwordx4 v18, s[32:35], s46 offen offset:0  lds
    buffer_load_dwordx4 v19, s[32:35], s46 offen offset:1024  lds
    s_add_u32 s46, s46, 294912
    s_cmp_ge_u32 s46, s47
    s_cselect_b32 s44, 5308416, 0
    s_sub_u32 s46, s46, s44
    s_waitcnt vmcnt(20)
    s_barrier
    s_mov_b32 m0, 155648
    s_nop 0
    buffer_load_dwordx4 v38, s[28:31], s48 offen sc1 lds
    s_mov_b32 m0, 156672
    s_nop 0
    buffer_load_dwordx4 v38, s[28:31], s48 offen offset:1024 sc1 lds
    s_add_u32 s48, s48, 2048
    s_cmp_ge_u32 s48, s49
    s_cselect_b32 s44, 36864, 0
    s_sub_u32 s48, s48, s44
    s_mov_b32 m0, 73728
    s_nop 0
    buffer_load_dwordx4 v2, s[32:35], s46 offen offset:0  lds
    buffer_load_dwordx4 v3, s[32:35], s46 offen offset:1024  lds
    buffer_load_dwordx4 v4, s[32:35], s46 offen offset:2048  lds
    buffer_load_dwordx4 v5, s[32:35], s46 offen offset:3072  lds
    s_mov_b32 m0, 77824
    s_nop 0
    buffer_load_dwordx4 v6, s[32:35], s46 offen offset:0  lds
    buffer_load_dwordx4 v7, s[32:35], s46 offen offset:1024  lds
    buffer_load_dwordx4 v8, s[32:35], s46 offen offset:2048  lds
    buffer_load_dwordx4 v9, s[32:35], s46 offen offset:3072  lds
    s_mov_b32 m0, 81920
    s_nop 0
    buffer_load_dwordx4 v10, s[32:35], s46 offen offset:0  lds
    buffer_load_dwordx4 v11, s[32:35], s46 offen offset:1024  lds
    buffer_load_dwordx4 v12, s[32:35], s46 offen offset:2048  lds
    buffer_load_dwordx4 v13, s[32:35], s46 offen offset:3072  lds
    s_mov_b32 m0, 86016
    s_nop 0
    buffer_load_dwordx4 v14, s[32:35], s46 offen offset:0  lds
    buffer_load_dwordx4 v15, s[32:35], s46 offen offset:1024  lds
    buffer_load_dwordx4 v16, s[32:35], s46 offen offset:2048  lds
    buffer_load_dwordx4 v17, s[32:35], s46 offen offset:3072  lds
    s_mov_b32 m0, 90112
    s_nop 0
    buffer_load_dwordx4 v18, s[32:35], s46 offen offset:0  lds
    buffer_load_dwordx4 v19, s[32:35], s46 offen offset:1024  lds
    s_add_u32 s46, s46, 294912
    s_cmp_ge_u32 s46, s47
    s_cselect_b32 s44, 5308416, 0
    s_sub_u32 s46, s46, s44
    s_waitcnt vmcnt(20)
    s_barrier
    s_mov_b32 m0, 159744
    s_nop 0
    buffer_load_dwordx4 v38, s[28:31], s48 offen sc1 lds
    s_mov_b32 m0, 160768
    s_nop 0
    buffer_load_dwordx4 v38, s[28:31], s48 offen offset:1024 sc1 lds
    s_add_u32 s48, s48, 2048
    s_cmp_ge_u32 s48, s49
    s_cselect_b32 s44, 36864, 0
    s_sub_u32 s48, s48, s44
    s_mov_b32 m0, 110592
    s_nop 0
    buffer_load_dwordx4 v2, s[32:35], s46 offen offset:0  lds
    buffer_load_dwordx4 v3, s[32:35], s46 offen offset:1024  lds
    buffer_load_dwordx4 v4, s[32:35], s46 offen offset:2048  lds
    buffer_load_dwordx4 v5, s[32:35], s46 offen offset:3072  lds
    s_mov_b32 m0, 114688
    s_nop 0
    buffer_load_dwordx4 v6, s[32:35], s46 offen offset:0  lds
    buffer_load_dwordx4 v7, s[32:35], s46 offen offset:1024  lds
    buffer_load_dwordx4 v8, s[32:35], s46 offen offset:2048  lds
    buffer_load_dwordx4 v9, s[32:35], s46 offen offset:3072  lds
    s_mov_b32 m0, 118784
    s_nop 0
    buffer_load_dwordx4 v10, s[32:35], s46 offen offset:0  lds
    buffer_load_dwordx4 v11, s[32:35], s46 offen offset:1024  lds
    buffer_load_dwordx4 v12, s[32:35], s46 offen offset:2048  lds
    buffer_load_dwordx4 v13, s[32:35], s46 offen offset:3072  lds
    s_mov_b32 m0, 122880
    s_nop 0
    buffer_load_dwordx4 v14, s[32:35], s46 offen offset:0  lds
    buffer_load_dwordx4 v15, s[32:35], s46 offen offset:1024  lds
    buffer_load_dwordx4 v16, s[32:35], s46 offen offset:2048  lds
    buffer_load_dwordx4 v17, s[32:35], s46 offen offset:3072  lds
    s_mov_b32 m0, 126976
    s_nop 0
    buffer_load_dwordx4 v18, s[32:35], s46 offen offset:0  lds
    buffer_load_dwordx4 v19, s[32:35], s46 offen offset:1024  lds
    s_add_u32 s46, s46, 294912
    s_cmp_ge_u32 s46, s47
    s_cselect_b32 s44, 5308416, 0
    s_sub_u32 s46, s46, s44
    s_waitcnt vmcnt(20)
    s_barrier
    s_mov_b32 m0, 147456
    s_nop 0
    buffer_load_dwordx4 v38, s[28:31], s48 offen sc1 lds
    s_mov_b32 m0, 148480
    s_nop 0
    buffer_load_dwordx4 v38, s[28:31], s48 offen offset:1024 sc1 lds
    s_add_u32 s48, s48, 2048
    s_cmp_ge_u32 s48, s49
    s_cselect_b32 s44, 36864, 0
    s_sub_u32 s48, s48, s44
    s_mov_b32 m0, 0
    s_nop 0
    buffer_load_dwordx4 v2, s[32:35], s46 offen offset:0  lds
    buffer_load_dwordx4 v3, s[32:35], s46 offen offset:1024  lds
    buffer_load_dwordx4 v4, s[32:35], s46 offen offset:2048  lds
    buffer_load_dwordx4 v5, s[32:35], s46 offen offset:3072  lds
    s_mov_b32 m0, 4096
    s_nop 0
    buffer_load_dwordx4 v6, s[32:35], s46 offen offset:0  lds
    buffer_load_dwordx4 v7, s[32:35], s46 offen offset:1024  lds
    buffer_load_dwordx4 v8, s[32:35], s46 offen offset:2048  lds
    buffer_load_dwordx4 v9, s[32:35], s46 offen offset:3072  lds
    s_mov_b32 m0, 8192
    s_nop 0
    buffer_load_dwordx4 v10, s[32:35], s46 offen offset:0  lds
    buffer_load_dwordx4 v11, s[32:35], s46 offen offset:1024  lds
    buffer_load_dwordx4 v12, s[32:35], s46 offen offset:2048  lds
    buffer_load_dwordx4 v13, s[32:35], s46 offen offset:3072  lds
    s_mov_b32 m0, 12288
    s_nop 0
    buffer_load_dwordx4 v14, s[32:35], s46 offen offset:0  lds
    buffer_load_dwordx4 v15, s[32:35], s46 offen offset:1024  lds
    buffer_load_dwordx4 v16, s[32:35], s46 offen offset:2048  lds
    buffer_load_dwordx4 v17, s[32:35], s46 offen offset:3072  lds
    s_mov_b32 m0, 16384
    s_nop 0
    buffer_load_dwordx4 v18, s[32:35], s46 offen offset:0  lds
    buffer_load_dwordx4 v19, s[32:35], s46 offen offset:1024  lds
    s_add_u32 s46, s46, 294912
    s_cmp_ge_u32 s46, s47
    s_cselect_b32 s44, 5308416, 0
    s_sub_u32 s46, s46, s44
    s_waitcnt vmcnt(20)
    s_barrier
    s_mov_b32 m0, 151552
    s_nop 0
    buffer_load_dwordx4 v38, s[28:31], s48 offen sc1 lds
    s_mov_b32 m0, 152576
    s_nop 0
    buffer_load_dwordx4 v38, s[28:31], s48 offen offset:1024 sc1 lds
    s_add_u32 s48, s48, 2048
    s_cmp_ge_u32 s48, s49
    s_cselect_b32 s44, 36864, 0
    s_sub_u32 s48, s48, s44
    s_mov_b32 m0, 36864
    s_nop 0
    buffer_load_dwordx4 v2, s[32:35], s46 offen offset:0  lds
    buffer_load_dwordx4 v3, s[32:35], s46 offen offset:1024  lds
    buffer_load_dwordx4 v4, s[32:35], s46 offen offset:2048  lds
    buffer_load_dwordx4 v5, s[32:35], s46 offen offset:3072  lds
    s_mov_b32 m0, 40960
    s_nop 0
    buffer_load_dwordx4 v6, s[32:35], s46 offen offset:0  lds
    buffer_load_dwordx4 v7, s[32:35], s46 offen offset:1024  lds
    buffer_load_dwordx4 v8, s[32:35], s46 offen offset:2048  lds
    buffer_load_dwordx4 v9, s[32:35], s46 offen offset:3072  lds
    s_mov_b32 m0, 45056
    s_nop 0
    buffer_load_dwordx4 v10, s[32:35], s46 offen offset:0  lds
    buffer_load_dwordx4 v11, s[32:35], s46 offen offset:1024  lds
    buffer_load_dwordx4 v12, s[32:35], s46 offen offset:2048  lds
    buffer_load_dwordx4 v13, s[32:35], s46 offen offset:3072  lds
    s_mov_b32 m0, 49152
    s_nop 0
    buffer_load_dwordx4 v14, s[32:35], s46 offen offset:0  lds
    buffer_load_dwordx4 v15, s[32:35], s46 offen offset:1024  lds
    buffer_load_dwordx4 v16, s[32:35], s46 offen offset:2048  lds
    buffer_load_dwordx4 v17, s[32:35], s46 offen offset:3072  lds
    s_mov_b32 m0, 53248
    s_nop 0
    buffer_load_dwordx4 v18, s[32:35], s46 offen offset:0  lds
    buffer_load_dwordx4 v19, s[32:35], s46 offen offset:1024  lds
    s_add_u32 s46, s46, 294912
    s_cmp_ge_u32 s46, s47
    s_cselect_b32 s44, 5308416, 0
    s_sub_u32 s46, s46, s44
    s_waitcnt vmcnt(20)
    s_barrier
    s_mov_b32 m0, 155648
    s_nop 0
    buffer_load_dwordx4 v38, s[28:31], s48 offen sc1 lds
    s_mov_b32 m0, 156672
    s_nop 0
    buffer_load_dwordx4 v38, s[28:31], s48 offen offset:1024 sc1 lds
    s_add_u32 s48, s48, 2048
    s_cmp_ge_u32 s48, s49
    s_cselect_b32 s44, 36864, 0
    s_sub_u32 s48, s48, s44
    s_mov_b32 m0, 73728
    s_nop 0
    buffer_load_dwordx4 v2, s[32:35], s46 offen offset:0  lds
    buffer_load_dwordx4 v3, s[32:35], s46 offen offset:1024  lds
    buffer_load_dwordx4 v4, s[32:35], s46 offen offset:2048  lds
    buffer_load_dwordx4 v5, s[32:35], s46 offen offset:3072  lds
    s_mov_b32 m0, 77824
    s_nop 0
    buffer_load_dwordx4 v6, s[32:35], s46 offen offset:0  lds
    buffer_load_dwordx4 v7, s[32:35], s46 offen offset:1024  lds
    buffer_load_dwordx4 v8, s[32:35], s46 offen offset:2048  lds
    buffer_load_dwordx4 v9, s[32:35], s46 offen offset:3072  lds
    s_mov_b32 m0, 81920
    s_nop 0
    buffer_load_dwordx4 v10, s[32:35], s46 offen offset:0  lds
    buffer_load_dwordx4 v11, s[32:35], s46 offen offset:1024  lds
    buffer_load_dwordx4 v12, s[32:35], s46 offen offset:2048  lds
    buffer_load_dwordx4 v13, s[32:35], s46 offen offset:3072  lds
    s_mov_b32 m0, 86016
    s_nop 0
    buffer_load_dwordx4 v14, s[32:35], s46 offen offset:0  lds
    buffer_load_dwordx4 v15, s[32:35], s46 offen offset:1024  lds
    buffer_load_dwordx4 v16, s[32:35], s46 offen offset:2048  lds
    buffer_load_dwordx4 v17, s[32:35], s46 offen offset:3072  lds
    s_mov_b32 m0, 90112
    s_nop 0
    buffer_load_dwordx4 v18, s[32:35], s46 offen offset:0  lds
    buffer_load_dwordx4 v19, s[32:35], s46 offen offset:1024  lds
    s_add_u32 s46, s46, 294912
    s_cmp_ge_u32 s46, s47
    s_cselect_b32 s44, 5308416, 0
    s_sub_u32 s46, s46, s44
    s_waitcnt vmcnt(20)
    s_barrier
    s_mov_b32 m0, 159744
    s_nop 0
    buffer_load_dwordx4 v38, s[28:31], s48 offen sc1 lds
    s_mov_b32 m0, 160768
    s_nop 0
    buffer_load_dwordx4 v38, s[28:31], s48 offen offset:1024 sc1 lds
    s_add_u32 s48, s48, 2048
    s_cmp_ge_u32 s48, s49
    s_cselect_b32 s44, 36864, 0
    s_sub_u32 s48, s48, s44
    s_mov_b32 m0, 110592
    s_nop 0
    buffer_load_dwordx4 v2, s[32:35], s46 offen offset:0  lds
    buffer_load_dwordx4 v3, s[32:35], s46 offen offset:1024  lds
    buffer_load_dwordx4 v4, s[32:35], s46 offen offset:2048  lds
    buffer_load_dwordx4 v5, s[32:35], s46 offen offset:3072  lds
    s_mov_b32 m0, 114688
    s_nop 0
    buffer_load_dwordx4 v6, s[32:35], s46 offen offset:0  lds
    buffer_load_dwordx4 v7, s[32:35], s46 offen offset:1024  lds
    buffer_load_dwordx4 v8, s[32:35], s46 offen offset:2048  lds
    buffer_load_dwordx4 v9, s[32:35], s46 offen offset:3072  lds
    s_mov_b32 m0, 118784
    s_nop 0
    buffer_load_dwordx4 v10, s[32:35], s46 offen offset:0  lds
    buffer_load_dwordx4 v11, s[32:35], s46 offen offset:1024  lds
    buffer_load_dwordx4 v12, s[32:35], s46 offen offset:2048  lds
    buffer_load_dwordx4 v13, s[32:35], s46 offen offset:3072  lds
    s_mov_b32 m0, 122880
    s_nop 0
    buffer_load_dwordx4 v14, s[32:35], s46 offen offset:0  lds
    buffer_load_dwordx4 v15, s[32:35], s46 offen offset:1024  lds
    buffer_load_dwordx4 v16, s[32:35], s46 offen offset:2048  lds
    buffer_load_dwordx4 v17, s[32:35], s46 offen offset:3072  lds
    s_mov_b32 m0, 126976
    s_nop 0
    buffer_load_dwordx4 v18, s[32:35], s46 offen offset:0  lds
    buffer_load_dwordx4 v19, s[32:35], s46 offen offset:1024  lds
    s_add_u32 s46, s46, 294912
    s_cmp_ge_u32 s46, s47
    s_cselect_b32 s44, 5308416, 0
    s_sub_u32 s46, s46, s44
    s_waitcnt vmcnt(20)
    s_barrier
    s_mov_b32 m0, 147456
    s_nop 0
    buffer_load_dwordx4 v38, s[28:31], s48 offen sc1 lds
    s_mov_b32 m0, 148480
    s_nop 0
    buffer_load_dwordx4 v38, s[28:31], s48 offen offset:1024 sc1 lds
    s_add_u32 s48, s48, 2048
    s_cmp_ge_u32 s48, s49
    s_cselect_b32 s44, 36864, 0
    s_sub_u32 s48, s48, s44
    s_mov_b32 m0, 0
    s_nop 0
    buffer_load_dwordx4 v2, s[32:35], s46 offen offset:0  lds
    buffer_load_dwordx4 v3, s[32:35], s46 offen offset:1024  lds
    buffer_load_dwordx4 v4, s[32:35], s46 offen offset:2048  lds
    buffer_load_dwordx4 v5, s[32:35], s46 offen offset:3072  lds
    s_mov_b32 m0, 4096
    s_nop 0
    buffer_load_dwordx4 v6, s[32:35], s46 offen offset:0  lds
    buffer_load_dwordx4 v7, s[32:35], s46 offen offset:1024  lds
    buffer_load_dwordx4 v8, s[32:35], s46 offen offset:2048  lds
    buffer_load_dwordx4 v9, s[32:35], s46 offen offset:3072  lds
    s_mov_b32 m0, 8192
    s_nop 0
    buffer_load_dwordx4 v10, s[32:35], s46 offen offset:0  lds
    buffer_load_dwordx4 v11, s[32:35], s46 offen offset:1024  lds
    buffer_load_dwordx4 v12, s[32:35], s46 offen offset:2048  lds
    buffer_load_dwordx4 v13, s[32:35], s46 offen offset:3072  lds
    s_mov_b32 m0, 12288
    s_nop 0
    buffer_load_dwordx4 v14, s[32:35], s46 offen offset:0  lds
    buffer_load_dwordx4 v15, s[32:35], s46 offen offset:1024  lds
    buffer_load_dwordx4 v16, s[32:35], s46 offen offset:2048  lds
    buffer_load_dwordx4 v17, s[32:35], s46 offen offset:3072  lds
    s_mov_b32 m0, 16384
    s_nop 0
    buffer_load_dwordx4 v18, s[32:35], s46 offen offset:0  lds
    buffer_load_dwordx4 v19, s[32:35], s46 offen offset:1024  lds
    s_add_u32 s46, s46, 294912
    s_cmp_ge_u32 s46, s47
    s_cselect_b32 s44, 5308416, 0
    s_sub_u32 s46, s46, s44
    s_waitcnt vmcnt(20)
    s_barrier
    s_mov_b32 m0, 151552
    s_nop 0
    buffer_load_dwordx4 v38, s[28:31], s48 offen sc1 lds
    s_mov_b32 m0, 152576
    s_nop 0
    buffer_load_dwordx4 v38, s[28:31], s48 offen offset:1024 sc1 lds
    s_add_u32 s48, s48, 2048
    s_cmp_ge_u32 s48, s49
    s_cselect_b32 s44, 36864, 0
    s_sub_u32 s48, s48, s44
    s_mov_b32 m0, 36864
    s_nop 0
    buffer_load_dwordx4 v2, s[32:35], s46 offen offset:0  lds
    buffer_load_dwordx4 v3, s[32:35], s46 offen offset:1024  lds
    buffer_load_dwordx4 v4, s[32:35], s46 offen offset:2048  lds
    buffer_load_dwordx4 v5, s[32:35], s46 offen offset:3072  lds
    s_mov_b32 m0, 40960
    s_nop 0
    buffer_load_dwordx4 v6, s[32:35], s46 offen offset:0  lds
    buffer_load_dwordx4 v7, s[32:35], s46 offen offset:1024  lds
    buffer_load_dwordx4 v8, s[32:35], s46 offen offset:2048  lds
    buffer_load_dwordx4 v9, s[32:35], s46 offen offset:3072  lds
    s_mov_b32 m0, 45056
    s_nop 0
    buffer_load_dwordx4 v10, s[32:35], s46 offen offset:0  lds
    buffer_load_dwordx4 v11, s[32:35], s46 offen offset:1024  lds
    buffer_load_dwordx4 v12, s[32:35], s46 offen offset:2048  lds
    buffer_load_dwordx4 v13, s[32:35], s46 offen offset:3072  lds
    s_mov_b32 m0, 49152
    s_nop 0
    buffer_load_dwordx4 v14, s[32:35], s46 offen offset:0  lds
    buffer_load_dwordx4 v15, s[32:35], s46 offen offset:1024  lds
    buffer_load_dwordx4 v16, s[32:35], s46 offen offset:2048  lds
    buffer_load_dwordx4 v17, s[32:35], s46 offen offset:3072  lds
    s_mov_b32 m0, 53248
    s_nop 0
    buffer_load_dwordx4 v18, s[32:35], s46 offen offset:0  lds
    buffer_load_dwordx4 v19, s[32:35], s46 offen offset:1024  lds
    s_add_u32 s46, s46, 294912
    s_cmp_ge_u32 s46, s47
    s_cselect_b32 s44, 5308416, 0
    s_sub_u32 s46, s46, s44
    s_waitcnt vmcnt(20)
    s_barrier
    s_mov_b32 m0, 155648
    s_nop 0
    buffer_load_dwordx4 v38, s[28:31], s48 offen sc1 lds
    s_mov_b32 m0, 156672
    s_nop 0
    buffer_load_dwordx4 v38, s[28:31], s48 offen offset:1024 sc1 lds
    s_add_u32 s48, s48, 2048
    s_cmp_ge_u32 s48, s49
    s_cselect_b32 s44, 36864, 0
    s_sub_u32 s48, s48, s44
    s_mov_b32 m0, 73728
    s_nop 0
    buffer_load_dwordx4 v2, s[32:35], s46 offen offset:0  lds
    buffer_load_dwordx4 v3, s[32:35], s46 offen offset:1024  lds
    buffer_load_dwordx4 v4, s[32:35], s46 offen offset:2048  lds
    buffer_load_dwordx4 v5, s[32:35], s46 offen offset:3072  lds
    s_mov_b32 m0, 77824
    s_nop 0
    buffer_load_dwordx4 v6, s[32:35], s46 offen offset:0  lds
    buffer_load_dwordx4 v7, s[32:35], s46 offen offset:1024  lds
    buffer_load_dwordx4 v8, s[32:35], s46 offen offset:2048  lds
    buffer_load_dwordx4 v9, s[32:35], s46 offen offset:3072  lds
    s_mov_b32 m0, 81920
    s_nop 0
    buffer_load_dwordx4 v10, s[32:35], s46 offen offset:0  lds
    buffer_load_dwordx4 v11, s[32:35], s46 offen offset:1024  lds
    buffer_load_dwordx4 v12, s[32:35], s46 offen offset:2048  lds
    buffer_load_dwordx4 v13, s[32:35], s46 offen offset:3072  lds
    s_mov_b32 m0, 86016
    s_nop 0
    buffer_load_dwordx4 v14, s[32:35], s46 offen offset:0  lds
    buffer_load_dwordx4 v15, s[32:35], s46 offen offset:1024  lds
    buffer_load_dwordx4 v16, s[32:35], s46 offen offset:2048  lds
    buffer_load_dwordx4 v17, s[32:35], s46 offen offset:3072  lds
    s_mov_b32 m0, 90112
    s_nop 0
    buffer_load_dwordx4 v18, s[32:35], s46 offen offset:0  lds
    buffer_load_dwordx4 v19, s[32:35], s46 offen offset:1024  lds
    s_add_u32 s46, s46, 294912
    s_cmp_ge_u32 s46, s47
    s_cselect_b32 s44, 5308416, 0
    s_sub_u32 s46, s46, s44
    s_waitcnt vmcnt(20)
    s_barrier
    s_mov_b32 m0, 159744
    s_nop 0
    buffer_load_dwordx4 v38, s[28:31], s48 offen sc1 lds
    s_mov_b32 m0, 160768
    s_nop 0
    buffer_load_dwordx4 v38, s[28:31], s48 offen offset:1024 sc1 lds
    s_add_u32 s48, s48, 2048
    s_cmp_ge_u32 s48, s49
    s_cselect_b32 s44, 36864, 0
    s_sub_u32 s48, s48, s44
    s_mov_b32 m0, 110592
    s_nop 0
    buffer_load_dwordx4 v2, s[32:35], s46 offen offset:0  lds
    buffer_load_dwordx4 v3, s[32:35], s46 offen offset:1024  lds
    buffer_load_dwordx4 v4, s[32:35], s46 offen offset:2048  lds
    buffer_load_dwordx4 v5, s[32:35], s46 offen offset:3072  lds
    s_mov_b32 m0, 114688
    s_nop 0
    buffer_load_dwordx4 v6, s[32:35], s46 offen offset:0  lds
    buffer_load_dwordx4 v7, s[32:35], s46 offen offset:1024  lds
    buffer_load_dwordx4 v8, s[32:35], s46 offen offset:2048  lds
    buffer_load_dwordx4 v9, s[32:35], s46 offen offset:3072  lds
    s_mov_b32 m0, 118784
    s_nop 0
    buffer_load_dwordx4 v10, s[32:35], s46 offen offset:0  lds
    buffer_load_dwordx4 v11, s[32:35], s46 offen offset:1024  lds
    buffer_load_dwordx4 v12, s[32:35], s46 offen offset:2048  lds
    buffer_load_dwordx4 v13, s[32:35], s46 offen offset:3072  lds
    s_mov_b32 m0, 122880
    s_nop 0
    buffer_load_dwordx4 v14, s[32:35], s46 offen offset:0  lds
    buffer_load_dwordx4 v15, s[32:35], s46 offen offset:1024  lds
    buffer_load_dwordx4 v16, s[32:35], s46 offen offset:2048  lds
    buffer_load_dwordx4 v17, s[32:35], s46 offen offset:3072  lds
    s_mov_b32 m0, 126976
    s_nop 0
    buffer_load_dwordx4 v18, s[32:35], s46 offen offset:0  lds
    buffer_load_dwordx4 v19, s[32:35], s46 offen offset:1024  lds
    s_add_u32 s46, s46, 294912
    s_cmp_ge_u32 s46, s47
    s_cselect_b32 s44, 5308416, 0
    s_sub_u32 s46, s46, s44
    s_waitcnt vmcnt(20)
    s_barrier
    s_mov_b32 m0, 147456
    s_nop 0
    buffer_load_dwordx4 v38, s[28:31], s48 offen sc1 lds
    s_mov_b32 m0, 148480
    s_nop 0
    buffer_load_dwordx4 v38, s[28:31], s48 offen offset:1024 sc1 lds
    s_add_u32 s48, s48, 2048
    s_cmp_ge_u32 s48, s49
    s_cselect_b32 s44, 36864, 0
    s_sub_u32 s48, s48, s44
    s_mov_b32 m0, 0
    s_nop 0
    buffer_load_dwordx4 v2, s[32:35], s46 offen offset:0  lds
    buffer_load_dwordx4 v3, s[32:35], s46 offen offset:1024  lds
    buffer_load_dwordx4 v4, s[32:35], s46 offen offset:2048  lds
    buffer_load_dwordx4 v5, s[32:35], s46 offen offset:3072  lds
    s_mov_b32 m0, 4096
    s_nop 0
    buffer_load_dwordx4 v6, s[32:35], s46 offen offset:0  lds
    buffer_load_dwordx4 v7, s[32:35], s46 offen offset:1024  lds
    buffer_load_dwordx4 v8, s[32:35], s46 offen offset:2048  lds
    buffer_load_dwordx4 v9, s[32:35], s46 offen offset:3072  lds
    s_mov_b32 m0, 8192
    s_nop 0
    buffer_load_dwordx4 v10, s[32:35], s46 offen offset:0  lds
    buffer_load_dwordx4 v11, s[32:35], s46 offen offset:1024  lds
    buffer_load_dwordx4 v12, s[32:35], s46 offen offset:2048  lds
    buffer_load_dwordx4 v13, s[32:35], s46 offen offset:3072  lds
    s_mov_b32 m0, 12288
    s_nop 0
    buffer_load_dwordx4 v14, s[32:35], s46 offen offset:0  lds
    buffer_load_dwordx4 v15, s[32:35], s46 offen offset:1024  lds
    buffer_load_dwordx4 v16, s[32:35], s46 offen offset:2048  lds
    buffer_load_dwordx4 v17, s[32:35], s46 offen offset:3072  lds
    s_mov_b32 m0, 16384
    s_nop 0
    buffer_load_dwordx4 v18, s[32:35], s46 offen offset:0  lds
    buffer_load_dwordx4 v19, s[32:35], s46 offen offset:1024  lds
    s_add_u32 s46, s46, 294912
    s_cmp_ge_u32 s46, s47
    s_cselect_b32 s44, 5308416, 0
    s_sub_u32 s46, s46, s44
    s_waitcnt vmcnt(20)
    s_barrier
    s_mov_b32 m0, 151552
    s_nop 0
    buffer_load_dwordx4 v38, s[28:31], s48 offen sc1 lds
    s_mov_b32 m0, 152576
    s_nop 0
    buffer_load_dwordx4 v38, s[28:31], s48 offen offset:1024 sc1 lds
    s_add_u32 s48, s48, 2048
    s_cmp_ge_u32 s48, s49
    s_cselect_b32 s44, 36864, 0
    s_sub_u32 s48, s48, s44
    s_mov_b32 m0, 36864
    s_nop 0
    buffer_load_dwordx4 v2, s[32:35], s46 offen offset:0  lds
    buffer_load_dwordx4 v3, s[32:35], s46 offen offset:1024  lds
    buffer_load_dwordx4 v4, s[32:35], s46 offen offset:2048  lds
    buffer_load_dwordx4 v5, s[32:35], s46 offen offset:3072  lds
    s_mov_b32 m0, 40960
    s_nop 0
    buffer_load_dwordx4 v6, s[32:35], s46 offen offset:0  lds
    buffer_load_dwordx4 v7, s[32:35], s46 offen offset:1024  lds
    buffer_load_dwordx4 v8, s[32:35], s46 offen offset:2048  lds
    buffer_load_dwordx4 v9, s[32:35], s46 offen offset:3072  lds
    s_mov_b32 m0, 45056
    s_nop 0
    buffer_load_dwordx4 v10, s[32:35], s46 offen offset:0  lds
    buffer_load_dwordx4 v11, s[32:35], s46 offen offset:1024  lds
    buffer_load_dwordx4 v12, s[32:35], s46 offen offset:2048  lds
    buffer_load_dwordx4 v13, s[32:35], s46 offen offset:3072  lds
    s_mov_b32 m0, 49152
    s_nop 0
    buffer_load_dwordx4 v14, s[32:35], s46 offen offset:0  lds
    buffer_load_dwordx4 v15, s[32:35], s46 offen offset:1024  lds
    buffer_load_dwordx4 v16, s[32:35], s46 offen offset:2048  lds
    buffer_load_dwordx4 v17, s[32:35], s46 offen offset:3072  lds
    s_mov_b32 m0, 53248
    s_nop 0
    buffer_load_dwordx4 v18, s[32:35], s46 offen offset:0  lds
    buffer_load_dwordx4 v19, s[32:35], s46 offen offset:1024  lds
    s_add_u32 s46, s46, 294912
    s_cmp_ge_u32 s46, s47
    s_cselect_b32 s44, 5308416, 0
    s_sub_u32 s46, s46, s44
    s_waitcnt vmcnt(20)
    s_barrier
    s_mov_b32 m0, 73728
    s_nop 0
    buffer_load_dwordx4 v2, s[28:31], s53 offen offset:0 sc1 lds
    buffer_load_dwordx4 v3, s[28:31], s53 offen offset:1024 sc1 lds
    buffer_load_dwordx4 v4, s[28:31], s53 offen offset:2048 sc1 lds
    buffer_load_dwordx4 v5, s[28:31], s53 offen offset:3072 sc1 lds
    s_mov_b32 m0, 77824
    s_nop 0
    buffer_load_dwordx4 v6, s[28:31], s53 offen offset:0 sc1 lds
    buffer_load_dwordx4 v7, s[28:31], s53 offen offset:1024 sc1 lds
    buffer_load_dwordx4 v8, s[28:31], s53 offen offset:2048 sc1 lds
    buffer_load_dwordx4 v9, s[28:31], s53 offen offset:3072 sc1 lds
    s_mov_b32 m0, 81920
    s_nop 0
    buffer_load_dwordx4 v10, s[28:31], s53 offen offset:0 sc1 lds
    buffer_load_dwordx4 v11, s[28:31], s53 offen offset:1024 sc1 lds
    buffer_load_dwordx4 v12, s[28:31], s53 offen offset:2048 sc1 lds
    buffer_load_dwordx4 v13, s[28:31], s53 offen offset:3072 sc1 lds
    s_mov_b32 m0, 86016
    s_nop 0
    buffer_load_dwordx4 v14, s[28:31], s53 offen offset:0 sc1 lds
    buffer_load_dwordx4 v15, s[28:31], s53 offen offset:1024 sc1 lds
    buffer_load_dwordx4 v16, s[28:31], s53 offen offset:2048 sc1 lds
    buffer_load_dwordx4 v17, s[28:31], s53 offen offset:3072 sc1 lds
    s_mov_b32 m0, 90112
    s_nop 0
    buffer_load_dwordx4 v18, s[28:31], s53 offen offset:0 sc1 lds
    buffer_load_dwordx4 v19, s[28:31], s53 offen offset:1024 sc1 lds
    s_waitcnt vmcnt(18)
    s_barrier
    v_lshrrev_b32 v40, 3, v1
    v_bfe_u32 v41, v1, 4, 1
    v_lshlrev_b32 v41, 2, v41
    v_and_b32 v42, 7, v1
    v_xor_b32 v42, v42, v41
    v_mul_u32_u24 v40, 1152, v40
    v_lshl_add_u32 v2, v42, 4, v40
    v_add_u32 v3, 8192, v2
    v_add_u32 v4, 16384, v2
    v_add_u32 v5, 24576, v2
    v_add_u32 v6, 36864, v2
    v_add_u32 v7, 45056, v2
    v_add_u32 v8, 53248, v2
    v_add_u32 v9, 61440, v2
    v_add_u32 v10, 73728, v2
    v_add_u32 v11, 81920, v2
    v_add_u32 v12, 90112, v2
    v_add_u32 v13, 98304, v2
    v_add_u32 v14, 110592, v2
    v_add_u32 v15, 118784, v2
    v_add_u32 v16, 126976, v2
    v_add_u32 v17, 135168, v2
    v_add_u32 v18, 147456, v2
    v_add_u32 v19, 155648, v2
    s_mov_b32 m0, 110592
    s_nop 0
    buffer_load_dwordx4 v2, s[36:39], s50 offen offset:0  lds
    buffer_load_dwordx4 v3, s[36:39], s50 offen offset:1024  lds
    buffer_load_dwordx4 v4, s[36:39], s50 offen offset:2048  lds
    buffer_load_dwordx4 v5, s[36:39], s50 offen offset:3072  lds
    s_mov_b32 m0, 114688
    s_nop 0
    buffer_load_dwordx4 v6, s[36:39], s50 offen offset:0  lds
    buffer_load_dwordx4 v7, s[36:39], s50 offen offset:1024  lds
    buffer_load_dwordx4 v8, s[36:39], s50 offen offset:2048  lds
    buffer_load_dwordx4 v9, s[36:39], s50 offen offset:3072  lds
    s_mov_b32 m0, 118784
    s_nop 0
    buffer_load_dwordx4 v10, s[36:39], s50 offen offset:0  lds
    buffer_load_dwordx4 v11, s[36:39], s50 offen offset:1024  lds
    buffer_load_dwordx4 v12, s[36:39], s50 offen offset:2048  lds
    buffer_load_dwordx4 v13, s[36:39], s50 offen offset:3072  lds
    s_mov_b32 m0, 122880
    s_nop 0
    buffer_load_dwordx4 v14, s[36:39], s50 offen offset:0  lds
    buffer_load_dwordx4 v15, s[36:39], s50 offen offset:1024  lds
    buffer_load_dwordx4 v16, s[36:39], s50 offen offset:2048  lds
    buffer_load_dwordx4 v17, s[36:39], s50 offen offset:3072  lds
    s_mov_b32 m0, 126976
    s_nop 0
    buffer_load_dwordx4 v18, s[36:39], s50 offen offset:0  lds
    buffer_load_dwordx4 v19, s[36:39], s50 offen offset:1024  lds
    s_waitcnt vmcnt(18)
    s_barrier
    s_add_u32 s52, s50, 165888
    s_mov_b32 m0, 0
    s_nop 0
    buffer_load_dwordx4 v2, s[36:39], s52 offen offset:0  lds
    buffer_load_dwordx4 v3, s[36:39], s52 offen offset:1024  lds
    buffer_load_dwordx4 v4, s[36:39], s52 offen offset:2048  lds
    buffer_load_dwordx4 v5, s[36:39], s52 offen offset:3072  lds
    s_mov_b32 m0, 4096
    s_nop 0
    buffer_load_dwordx4 v6, s[36:39], s52 offen offset:0  lds
    buffer_load_dwordx4 v7, s[36:39], s52 offen offset:1024  lds
    buffer_load_dwordx4 v8, s[36:39], s52 offen offset:2048  lds
    buffer_load_dwordx4 v9, s[36:39], s52 offen offset:3072  lds
    s_mov_b32 m0, 8192
    s_nop 0
    buffer_load_dwordx4 v10, s[36:39], s52 offen offset:0  lds
    buffer_load_dwordx4 v11, s[36:39], s52 offen offset:1024  lds
    buffer_load_dwordx4 v12, s[36:39], s52 offen offset:2048  lds
    buffer_load_dwordx4 v13, s[36:39], s52 offen offset:3072  lds
    s_mov_b32 m0, 12288
    s_nop 0
    buffer_load_dwordx4 v14, s[36:39], s52 offen offset:0  lds
    buffer_load_dwordx4 v15, s[36:39], s52 offen offset:1024  lds
    buffer_load_dwordx4 v16, s[36:39], s52 offen offset:2048  lds
    buffer_load_dwordx4 v17, s[36:39], s52 offen offset:3072  lds
    s_mov_b32 m0, 16384
    s_nop 0
    buffer_load_dwordx4 v18, s[36:39], s52 offen offset:0  lds
    buffer_load_dwordx4 v19, s[36:39], s52 offen offset:1024  lds
    s_add_u32 s50, s50, 128
    s_cmp_ge_u32 s50, s51
    s_cselect_b32 s44, 1152, 0
    s_sub_u32 s50, s50, s44
    s_barrier
    s_barrier
    s_waitcnt vmcnt(18)
    s_barrier
    s_waitcnt vmcnt(0)
    s_barrier
    s_mov_b32 m0, 36864
    s_nop 0
    buffer_load_dwordx4 v2, s[36:39], s50 offen offset:0  lds
    buffer_load_dwordx4 v3, s[36:39], s50 offen offset:1024  lds
    buffer_load_dwordx4 v4, s[36:39], s50 offen offset:2048  lds
    buffer_load_dwordx4 v5, s[36:39], s50 offen offset:3072  lds
    s_mov_b32 m0, 40960
    s_nop 0
    buffer_load_dwordx4 v6, s[36:39], s50 offen offset:0  lds
    buffer_load_dwordx4 v7, s[36:39], s50 offen offset:1024  lds
    buffer_load_dwordx4 v8, s[36:39], s50 offen offset:2048  lds
    buffer_load_dwordx4 v9, s[36:39], s50 offen offset:3072  lds
    s_mov_b32 m0, 45056
    s_nop 0
    buffer_load_dwordx4 v10, s[36:39], s50 offen offset:0  lds
    buffer_load_dwordx4 v11, s[36:39], s50 offen offset:1024  lds
    buffer_load_dwordx4 v12, s[36:39], s50 offen offset:2048  lds
    buffer_load_dwordx4 v13, s[36:39], s50 offen offset:3072  lds
    s_mov_b32 m0, 49152
    s_nop 0
    buffer_load_dwordx4 v14, s[36:39], s50 offen offset:0  lds
    buffer_load_dwordx4 v15, s[36:39], s50 offen offset:1024  lds
    buffer_load_dwordx4 v16, s[36:39], s50 offen offset:2048  lds
    buffer_load_dwordx4 v17, s[36:39], s50 offen offset:3072  lds
    s_mov_b32 m0, 53248
    s_nop 0
    buffer_load_dwordx4 v18, s[36:39], s50 offen offset:0  lds
    buffer_load_dwordx4 v19, s[36:39], s50 offen offset:1024  lds
    s_add_u32 s52, s50, 165888
    s_mov_b32 m0, 73728
    s_nop 0
    buffer_load_dwordx4 v2, s[36:39], s52 offen offset:0  lds
    buffer_load_dwordx4 v3, s[36:39], s52 offen offset:1024  lds
    buffer_load_dwordx4 v4, s[36:39], s52 offen offset:2048  lds
    buffer_load_dwordx4 v5, s[36:39], s52 offen offset:3072  lds
    s_mov_b32 m0, 77824
    s_nop 0
    buffer_load_dwordx4 v6, s[36:39], s52 offen offset:0  lds
    buffer_load_dwordx4 v7, s[36:39], s52 offen offset:1024  lds
    buffer_load_dwordx4 v8, s[36:39], s52 offen offset:2048  lds
    buffer_load_dwordx4 v9, s[36:39], s52 offen offset:3072  lds
    s_mov_b32 m0, 81920
    s_nop 0
    buffer_load_dwordx4 v10, s[36:39], s52 offen offset:0  lds
    buffer_load_dwordx4 v11, s[36:39], s52 offen offset:1024  lds
    buffer_load_dwordx4 v12, s[36:39], s52 offen offset:2048  lds
    buffer_load_dwordx4 v13, s[36:39], s52 offen offset:3072  lds
    s_mov_b32 m0, 86016
    s_nop 0
    buffer_load_dwordx4 v14, s[36:39], s52 offen offset:0  lds
    buffer_load_dwordx4 v15, s[36:39], s52 offen offset:1024  lds
    buffer_load_dwordx4 v16, s[36:39], s52 offen offset:2048  lds
    buffer_load_dwordx4 v17, s[36:39], s52 offen offset:3072  lds
    s_mov_b32 m0, 90112
    s_nop 0
    buffer_load_dwordx4 v18, s[36:39], s52 offen offset:0  lds
    buffer_load_dwordx4 v19, s[36:39], s52 offen offset:1024  lds
    s_add_u32 s50, s50, 128
    s_cmp_ge_u32 s50, s51
    s_cselect_b32 s44, 1152, 0
    s_sub_u32 s50, s50, s44
    s_waitcnt vmcnt(18)
    s_barrier
    s_mov_b32 m0, 110592
    s_nop 0
    buffer_load_dwordx4 v2, s[36:39], s50 offen offset:0  lds
    buffer_load_dwordx4 v3, s[36:39], s50 offen offset:1024  lds
    buffer_load_dwordx4 v4, s[36:39], s50 offen offset:2048  lds
    buffer_load_dwordx4 v5, s[36:39], s50 offen offset:3072  lds
    s_mov_b32 m0, 114688
    s_nop 0
    buffer_load_dwordx4 v6, s[36:39], s50 offen offset:0  lds
    buffer_load_dwordx4 v7, s[36:39], s50 offen offset:1024  lds
    buffer_load_dwordx4 v8, s[36:39], s50 offen offset:2048  lds
    buffer_load_dwordx4 v9, s[36:39], s50 offen offset:3072  lds
    s_mov_b32 m0, 118784
    s_nop 0
    buffer_load_dwordx4 v10, s[36:39], s50 offen offset:0  lds
    buffer_load_dwordx4 v11, s[36:39], s50 offen offset:1024  lds
    buffer_load_dwordx4 v12, s[36:39], s50 offen offset:2048  lds
    buffer_load_dwordx4 v13, s[36:39], s50 offen offset:3072  lds
    s_mov_b32 m0, 122880
    s_nop 0
    buffer_load_dwordx4 v14, s[36:39], s50 offen offset:0  lds
    buffer_load_dwordx4 v15, s[36:39], s50 offen offset:1024  lds
    buffer_load_dwordx4 v16, s[36:39], s50 offen offset:2048  lds
    buffer_load_dwordx4 v17, s[36:39], s50 offen offset:3072  lds
    s_mov_b32 m0, 126976
    s_nop 0
    buffer_load_dwordx4 v18, s[36:39], s50 offen offset:0  lds
    buffer_load_dwordx4 v19, s[36:39], s50 offen offset:1024  lds
    s_waitcnt vmcnt(18)
    s_barrier
    s_add_u32 s52, s50, 165888
    s_mov_b32 m0, 0
    s_nop 0
    buffer_load_dwordx4 v2, s[36:39], s52 offen offset:0  lds
    buffer_load_dwordx4 v3, s[36:39], s52 offen offset:1024  lds
    buffer_load_dwordx4 v4, s[36:39], s52 offen offset:2048  lds
    buffer_load_dwordx4 v5, s[36:39], s52 offen offset:3072  lds
    s_mov_b32 m0, 4096
    s_nop 0
    buffer_load_dwordx4 v6, s[36:39], s52 offen offset:0  lds
    buffer_load_dwordx4 v7, s[36:39], s52 offen offset:1024  lds
    buffer_load_dwordx4 v8, s[36:39], s52 offen offset:2048  lds
    buffer_load_dwordx4 v9, s[36:39], s52 offen offset:3072  lds
    s_mov_b32 m0, 8192
    s_nop 0
    buffer_load_dwordx4 v10, s[36:39], s52 offen offset:0  lds
    buffer_load_dwordx4 v11, s[36:39], s52 offen offset:1024  lds
    buffer_load_dwordx4 v12, s[36:39], s52 offen offset:2048  lds
    buffer_load_dwordx4 v13, s[36:39], s52 offen offset:3072  lds
    s_mov_b32 m0, 12288
    s_nop 0
    buffer_load_dwordx4 v14, s[36:39], s52 offen offset:0  lds
    buffer_load_dwordx4 v15, s[36:39], s52 offen offset:1024  lds
    buffer_load_dwordx4 v16, s[36:39], s52 offen offset:2048  lds
    buffer_load_dwordx4 v17, s[36:39], s52 offen offset:3072  lds
    s_mov_b32 m0, 16384
    s_nop 0
    buffer_load_dwordx4 v18, s[36:39], s52 offen offset:0  lds
    buffer_load_dwordx4 v19, s[36:39], s52 offen offset:1024  lds
    s_add_u32 s50, s50, 128
    s_cmp_ge_u32 s50, s51
    s_cselect_b32 s44, 1152, 0
    s_sub_u32 s50, s50, s44
    s_waitcnt vmcnt(18)
    s_barrier
    s_mov_b32 m0, 36864
    s_nop 0
    buffer_load_dwordx4 v2, s[36:39], s50 offen offset:0  lds
    buffer_load_dwordx4 v3, s[36:39], s50 offen offset:1024  lds
    buffer_load_dwordx4 v4, s[36:39], s50 offen offset:2048  lds
    buffer_load_dwordx4 v5, s[36:39], s50 offen offset:3072  lds
    s_mov_b32 m0, 40960
    s_nop 0
    buffer_load_dwordx4 v6, s[36:39], s50 offen offset:0  lds
    buffer_load_dwordx4 v7, s[36:39], s50 offen offset:1024  lds
    buffer_load_dwordx4 v8, s[36:39], s50 offen offset:2048  lds
    buffer_load_dwordx4 v9, s[36:39], s50 offen offset:3072  lds
    s_mov_b32 m0, 45056
    s_nop 0
    buffer_load_dwordx4 v10, s[36:39], s50 offen offset:0  lds
    buffer_load_dwordx4 v11, s[36:39], s50 offen offset:1024  lds
    buffer_load_dwordx4 v12, s[36:39], s50 offen offset:2048  lds
    buffer_load_dwordx4 v13, s[36:39], s50 offen offset:3072  lds
    s_mov_b32 m0, 49152
    s_nop 0
    buffer_load_dwordx4 v14, s[36:39], s50 offen offset:0  lds
    buffer_load_dwordx4 v15, s[36:39], s50 offen offset:1024  lds
    buffer_load_dwordx4 v16, s[36:39], s50 offen offset:2048  lds
    buffer_load_dwordx4 v17, s[36:39], s50 offen offset:3072  lds
    s_mov_b32 m0, 53248
    s_nop 0
    buffer_load_dwordx4 v18, s[36:39], s50 offen offset:0  lds
    buffer_load_dwordx4 v19, s[36:39], s50 offen offset:1024  lds
    s_waitcnt vmcnt(18)
    s_barrier
    s_add_u32 s52, s50, 165888
    s_mov_b32 m0, 73728
    s_nop 0
    buffer_load_dwordx4 v2, s[36:39], s52 offen offset:0  lds
    buffer_load_dwordx4 v3, s[36:39], s52 offen offset:1024  lds
    buffer_load_dwordx4 v4, s[36:39], s52 offen offset:2048  lds
    buffer_load_dwordx4 v5, s[36:39], s52 offen offset:3072  lds
    s_mov_b32 m0, 77824
    s_nop 0
    buffer_load_dwordx4 v6, s[36:39], s52 offen offset:0  lds
    buffer_load_dwordx4 v7, s[36:39], s52 offen offset:1024  lds
    buffer_load_dwordx4 v8, s[36:39], s52 offen offset:2048  lds
    buffer_load_dwordx4 v9, s[36:39], s52 offen offset:3072  lds
    s_mov_b32 m0, 81920
    s_nop 0
    buffer_load_dwordx4 v10, s[36:39], s52 offen offset:0  lds
    buffer_load_dwordx4 v11, s[36:39], s52 offen offset:1024  lds
    buffer_load_dwordx4 v12, s[36:39], s52 offen offset:2048  lds
    buffer_load_dwordx4 v13, s[36:39], s52 offen offset:3072  lds
    s_mov_b32 m0, 86016
    s_nop 0
    buffer_load_dwordx4 v14, s[36:39], s52 offen offset:0  lds
    buffer_load_dwordx4 v15, s[36:39], s52 offen offset:1024  lds
    buffer_load_dwordx4 v16, s[36:39], s52 offen offset:2048  lds
    buffer_load_dwordx4 v17, s[36:39], s52 offen offset:3072  lds
    s_mov_b32 m0, 90112
    s_nop 0
    buffer_load_dwordx4 v18, s[36:39], s52 offen offset:0  lds
    buffer_load_dwordx4 v19, s[36:39], s52 offen offset:1024  lds
    s_add_u32 s50, s50, 128
    s_cmp_ge_u32 s50, s51
    s_cselect_b32 s44, 1152, 0
    s_sub_u32 s50, s50, s44
    s_waitcnt vmcnt(18)
    s_barrier
    s_mov_b32 m0, 110592
    s_nop 0
    buffer_load_dwordx4 v2, s[36:39], s50 offen offset:0  lds
    buffer_load_dwordx4 v3, s[36:39], s50 offen offset:1024  lds
    buffer_load_dwordx4 v4, s[36:39], s50 offen offset:2048  lds
    buffer_load_dwordx4 v5, s[36:39], s50 offen offset:3072  lds
    s_mov_b32 m0, 114688
    s_nop 0
    buffer_load_dwordx4 v6, s[36:39], s50 offen offset:0  lds
    buffer_load_dwordx4 v7, s[36:39], s50 offen offset:1024  lds
    buffer_load_dwordx4 v8, s[36:39], s50 offen offset:2048  lds
    buffer_load_dwordx4 v9, s[36:39], s50 offen offset:3072  lds
    s_mov_b32 m0, 118784
    s_nop 0
    buffer_load_dwordx4 v10, s[36:39], s50 offen offset:0  lds
    buffer_load_dwordx4 v11, s[36:39], s50 offen offset:1024  lds
    buffer_load_dwordx4 v12, s[36:39], s50 offen offset:2048  lds
    buffer_load_dwordx4 v13, s[36:39], s50 offen offset:3072  lds
    s_mov_b32 m0, 122880
    s_nop 0
    buffer_load_dwordx4 v14, s[36:39], s50 offen offset:0  lds
    buffer_load_dwordx4 v15, s[36:39], s50 offen offset:1024  lds
    buffer_load_dwordx4 v16, s[36:39], s50 offen offset:2048  lds
    buffer_load_dwordx4 v17, s[36:39], s50 offen offset:3072  lds
    s_mov_b32 m0, 126976
    s_nop 0
    buffer_load_dwordx4 v18, s[36:39], s50 offen offset:0  lds
    buffer_load_dwordx4 v19, s[36:39], s50 offen offset:1024  lds
    s_waitcnt vmcnt(18)
    s_barrier
    s_add_u32 s52, s50, 165888
    s_mov_b32 m0, 0
    s_nop 0
    buffer_load_dwordx4 v2, s[36:39], s52 offen offset:0  lds
    buffer_load_dwordx4 v3, s[36:39], s52 offen offset:1024  lds
    buffer_load_dwordx4 v4, s[36:39], s52 offen offset:2048  lds
    buffer_load_dwordx4 v5, s[36:39], s52 offen offset:3072  lds
    s_mov_b32 m0, 4096
    s_nop 0
    buffer_load_dwordx4 v6, s[36:39], s52 offen offset:0  lds
    buffer_load_dwordx4 v7, s[36:39], s52 offen offset:1024  lds
    buffer_load_dwordx4 v8, s[36:39], s52 offen offset:2048  lds
    buffer_load_dwordx4 v9, s[36:39], s52 offen offset:3072  lds
    s_mov_b32 m0, 8192
    s_nop 0
    buffer_load_dwordx4 v10, s[36:39], s52 offen offset:0  lds
    buffer_load_dwordx4 v11, s[36:39], s52 offen offset:1024  lds
    buffer_load_dwordx4 v12, s[36:39], s52 offen offset:2048  lds
    buffer_load_dwordx4 v13, s[36:39], s52 offen offset:3072  lds
    s_mov_b32 m0, 12288
    s_nop 0
    buffer_load_dwordx4 v14, s[36:39], s52 offen offset:0  lds
    buffer_load_dwordx4 v15, s[36:39], s52 offen offset:1024  lds
    buffer_load_dwordx4 v16, s[36:39], s52 offen offset:2048  lds
    buffer_load_dwordx4 v17, s[36:39], s52 offen offset:3072  lds
    s_mov_b32 m0, 16384
    s_nop 0
    buffer_load_dwordx4 v18, s[36:39], s52 offen offset:0  lds
    buffer_load_dwordx4 v19, s[36:39], s52 offen offset:1024  lds
    s_add_u32 s50, s50, 128
    s_cmp_ge_u32 s50, s51
    s_cselect_b32 s44, 1152, 0
    s_sub_u32 s50, s50, s44
    s_waitcnt vmcnt(18)
    s_barrier
    s_mov_b32 m0, 36864
    s_nop 0
    buffer_load_dwordx4 v2, s[36:39], s50 offen offset:0  lds
    buffer_load_dwordx4 v3, s[36:39], s50 offen offset:1024  lds
    buffer_load_dwordx4 v4, s[36:39], s50 offen offset:2048  lds
    buffer_load_dwordx4 v5, s[36:39], s50 offen offset:3072  lds
    s_mov_b32 m0, 40960
    s_nop 0
    buffer_load_dwordx4 v6, s[36:39], s50 offen offset:0  lds
    buffer_load_dwordx4 v7, s[36:39], s50 offen offset:1024  lds
    buffer_load_dwordx4 v8, s[36:39], s50 offen offset:2048  lds
    buffer_load_dwordx4 v9, s[36:39], s50 offen offset:3072  lds
    s_mov_b32 m0, 45056
    s_nop 0
    buffer_load_dwordx4 v10, s[36:39], s50 offen offset:0  lds
    buffer_load_dwordx4 v11, s[36:39], s50 offen offset:1024  lds
    buffer_load_dwordx4 v12, s[36:39], s50 offen offset:2048  lds
    buffer_load_dwordx4 v13, s[36:39], s50 offen offset:3072  lds
    s_mov_b32 m0, 49152
    s_nop 0
    buffer_load_dwordx4 v14, s[36:39], s50 offen offset:0  lds
    buffer_load_dwordx4 v15, s[36:39], s50 offen offset:1024  lds
    buffer_load_dwordx4 v16, s[36:39], s50 offen offset:2048  lds
    buffer_load_dwordx4 v17, s[36:39], s50 offen offset:3072  lds
    s_mov_b32 m0, 53248
    s_nop 0
    buffer_load_dwordx4 v18, s[36:39], s50 offen offset:0  lds
    buffer_load_dwordx4 v19, s[36:39], s50 offen offset:1024  lds
    s_waitcnt vmcnt(18)
    s_barrier
    s_add_u32 s52, s50, 165888
    s_mov_b32 m0, 73728
    s_nop 0
    buffer_load_dwordx4 v2, s[36:39], s52 offen offset:0  lds
    buffer_load_dwordx4 v3, s[36:39], s52 offen offset:1024  lds
    buffer_load_dwordx4 v4, s[36:39], s52 offen offset:2048  lds
    buffer_load_dwordx4 v5, s[36:39], s52 offen offset:3072  lds
    s_mov_b32 m0, 77824
    s_nop 0
    buffer_load_dwordx4 v6, s[36:39], s52 offen offset:0  lds
    buffer_load_dwordx4 v7, s[36:39], s52 offen offset:1024  lds
    buffer_load_dwordx4 v8, s[36:39], s52 offen offset:2048  lds
    buffer_load_dwordx4 v9, s[36:39], s52 offen offset:3072  lds
    s_mov_b32 m0, 81920
    s_nop 0
    buffer_load_dwordx4 v10, s[36:39], s52 offen offset:0  lds
    buffer_load_dwordx4 v11, s[36:39], s52 offen offset:1024  lds
    buffer_load_dwordx4 v12, s[36:39], s52 offen offset:2048  lds
    buffer_load_dwordx4 v13, s[36:39], s52 offen offset:3072  lds
    s_mov_b32 m0, 86016
    s_nop 0
    buffer_load_dwordx4 v14, s[36:39], s52 offen offset:0  lds
    buffer_load_dwordx4 v15, s[36:39], s52 offen offset:1024  lds
    buffer_load_dwordx4 v16, s[36:39], s52 offen offset:2048  lds
    buffer_load_dwordx4 v17, s[36:39], s52 offen offset:3072  lds
    s_mov_b32 m0, 90112
    s_nop 0
    buffer_load_dwordx4 v18, s[36:39], s52 offen offset:0  lds
    buffer_load_dwordx4 v19, s[36:39], s52 offen offset:1024  lds
    s_add_u32 s50, s50, 128
    s_cmp_ge_u32 s50, s51
    s_cselect_b32 s44, 1152, 0
    s_sub_u32 s50, s50, s44
    s_waitcnt vmcnt(18)
    s_barrier
    s_mov_b32 m0, 110592
    s_nop 0
    buffer_load_dwordx4 v2, s[36:39], s50 offen offset:0  lds
    buffer_load_dwordx4 v3, s[36:39], s50 offen offset:1024  lds
    buffer_load_dwordx4 v4, s[36:39], s50 offen offset:2048  lds
    buffer_load_dwordx4 v5, s[36:39], s50 offen offset:3072  lds
    s_mov_b32 m0, 114688
    s_nop 0
    buffer_load_dwordx4 v6, s[36:39], s50 offen offset:0  lds
    buffer_load_dwordx4 v7, s[36:39], s50 offen offset:1024  lds
    buffer_load_dwordx4 v8, s[36:39], s50 offen offset:2048  lds
    buffer_load_dwordx4 v9, s[36:39], s50 offen offset:3072  lds
    s_mov_b32 m0, 118784
    s_nop 0
    buffer_load_dwordx4 v10, s[36:39], s50 offen offset:0  lds
    buffer_load_dwordx4 v11, s[36:39], s50 offen offset:1024  lds
    buffer_load_dwordx4 v12, s[36:39], s50 offen offset:2048  lds
    buffer_load_dwordx4 v13, s[36:39], s50 offen offset:3072  lds
    s_mov_b32 m0, 122880
    s_nop 0
    buffer_load_dwordx4 v14, s[36:39], s50 offen offset:0  lds
    buffer_load_dwordx4 v15, s[36:39], s50 offen offset:1024  lds
    buffer_load_dwordx4 v16, s[36:39], s50 offen offset:2048  lds
    buffer_load_dwordx4 v17, s[36:39], s50 offen offset:3072  lds
    s_mov_b32 m0, 126976
    s_nop 0
    buffer_load_dwordx4 v18, s[36:39], s50 offen offset:0  lds
    buffer_load_dwordx4 v19, s[36:39], s50 offen offset:1024  lds
    s_waitcnt vmcnt(18)
    s_barrier
    s_add_u32 s52, s50, 165888
    s_mov_b32 m0, 0
    s_nop 0
    buffer_load_dwordx4 v2, s[36:39], s52 offen offset:0  lds
    buffer_load_dwordx4 v3, s[36:39], s52 offen offset:1024  lds
    buffer_load_dwordx4 v4, s[36:39], s52 offen offset:2048  lds
    buffer_load_dwordx4 v5, s[36:39], s52 offen offset:3072  lds
    s_mov_b32 m0, 4096
    s_nop 0
    buffer_load_dwordx4 v6, s[36:39], s52 offen offset:0  lds
    buffer_load_dwordx4 v7, s[36:39], s52 offen offset:1024  lds
    buffer_load_dwordx4 v8, s[36:39], s52 offen offset:2048  lds
    buffer_load_dwordx4 v9, s[36:39], s52 offen offset:3072  lds
    s_mov_b32 m0, 8192
    s_nop 0
    buffer_load_dwordx4 v10, s[36:39], s52 offen offset:0  lds
    buffer_load_dwordx4 v11, s[36:39], s52 offen offset:1024  lds
    buffer_load_dwordx4 v12, s[36:39], s52 offen offset:2048  lds
    buffer_load_dwordx4 v13, s[36:39], s52 offen offset:3072  lds
    s_mov_b32 m0, 12288
    s_nop 0
    buffer_load_dwordx4 v14, s[36:39], s52 offen offset:0  lds
    buffer_load_dwordx4 v15, s[36:39], s52 offen offset:1024  lds
    buffer_load_dwordx4 v16, s[36:39], s52 offen offset:2048  lds
    buffer_load_dwordx4 v17, s[36:39], s52 offen offset:3072  lds
    s_mov_b32 m0, 16384
    s_nop 0
    buffer_load_dwordx4 v18, s[36:39], s52 offen offset:0  lds
    buffer_load_dwordx4 v19, s[36:39], s52 offen offset:1024  lds
    s_add_u32 s50, s50, 128
    s_cmp_ge_u32 s50, s51
    s_cselect_b32 s44, 1152, 0
    s_sub_u32 s50, s50, s44
    s_waitcnt vmcnt(18)
    s_barrier
    s_mov_b32 m0, 36864
    s_nop 0
    buffer_load_dwordx4 v2, s[36:39], s50 offen offset:0  lds
    buffer_load_dwordx4 v3, s[36:39], s50 offen offset:1024  lds
    buffer_load_dwordx4 v4, s[36:39], s50 offen offset:2048  lds
    buffer_load_dwordx4 v5, s[36:39], s50 offen offset:3072  lds
    s_mov_b32 m0, 40960
    s_nop 0
    buffer_load_dwordx4 v6, s[36:39], s50 offen offset:0  lds
    buffer_load_dwordx4 v7, s[36:39], s50 offen offset:1024  lds
    buffer_load_dwordx4 v8, s[36:39], s50 offen offset:2048  lds
    buffer_load_dwordx4 v9, s[36:39], s50 offen offset:3072  lds
    s_mov_b32 m0, 45056
    s_nop 0
    buffer_load_dwordx4 v10, s[36:39], s50 offen offset:0  lds
    buffer_load_dwordx4 v11, s[36:39], s50 offen offset:1024  lds
    buffer_load_dwordx4 v12, s[36:39], s50 offen offset:2048  lds
    buffer_load_dwordx4 v13, s[36:39], s50 offen offset:3072  lds
    s_mov_b32 m0, 49152
    s_nop 0
    buffer_load_dwordx4 v14, s[36:39], s50 offen offset:0  lds
    buffer_load_dwordx4 v15, s[36:39], s50 offen offset:1024  lds
    buffer_load_dwordx4 v16, s[36:39], s50 offen offset:2048  lds
    buffer_load_dwordx4 v17, s[36:39], s50 offen offset:3072  lds
    s_mov_b32 m0, 53248
    s_nop 0
    buffer_load_dwordx4 v18, s[36:39], s50 offen offset:0  lds
    buffer_load_dwordx4 v19, s[36:39], s50 offen offset:1024  lds
    s_waitcnt vmcnt(18)
    s_barrier
    s_add_u32 s52, s50, 165888
    s_mov_b32 m0, 73728
    s_nop 0
    buffer_load_dwordx4 v2, s[36:39], s52 offen offset:0  lds
    buffer_load_dwordx4 v3, s[36:39], s52 offen offset:1024  lds
    buffer_load_dwordx4 v4, s[36:39], s52 offen offset:2048  lds
    buffer_load_dwordx4 v5, s[36:39], s52 offen offset:3072  lds
    s_mov_b32 m0, 77824
    s_nop 0
    buffer_load_dwordx4 v6, s[36:39], s52 offen offset:0  lds
    buffer_load_dwordx4 v7, s[36:39], s52 offen offset:1024  lds
    buffer_load_dwordx4 v8, s[36:39], s52 offen offset:2048  lds
    buffer_load_dwordx4 v9, s[36:39], s52 offen offset:3072  lds
    s_mov_b32 m0, 81920
    s_nop 0
    buffer_load_dwordx4 v10, s[36:39], s52 offen offset:0  lds
    buffer_load_dwordx4 v11, s[36:39], s52 offen offset:1024  lds
    buffer_load_dwordx4 v12, s[36:39], s52 offen offset:2048  lds
    buffer_load_dwordx4 v13, s[36:39], s52 offen offset:3072  lds
    s_mov_b32 m0, 86016
    s_nop 0
    buffer_load_dwordx4 v14, s[36:39], s52 offen offset:0  lds
    buffer_load_dwordx4 v15, s[36:39], s52 offen offset:1024  lds
    buffer_load_dwordx4 v16, s[36:39], s52 offen offset:2048  lds
    buffer_load_dwordx4 v17, s[36:39], s52 offen offset:3072  lds
    s_mov_b32 m0, 90112
    s_nop 0
    buffer_load_dwordx4 v18, s[36:39], s52 offen offset:0  lds
    buffer_load_dwordx4 v19, s[36:39], s52 offen offset:1024  lds
    s_add_u32 s50, s50, 128
    s_cmp_ge_u32 s50, s51
    s_cselect_b32 s44, 1152, 0
    s_sub_u32 s50, s50, s44
    s_waitcnt vmcnt(18)
    s_barrier
    s_mov_b32 m0, 110592
    s_nop 0
    buffer_load_dwordx4 v2, s[36:39], s50 offen offset:0  lds
    buffer_load_dwordx4 v3, s[36:39], s50 offen offset:1024  lds
    buffer_load_dwordx4 v4, s[36:39], s50 offen offset:2048  lds
    buffer_load_dwordx4 v5, s[36:39], s50 offen offset:3072  lds
    s_mov_b32 m0, 114688
    s_nop 0
    buffer_load_dwordx4 v6, s[36:39], s50 offen offset:0  lds
    buffer_load_dwordx4 v7, s[36:39], s50 offen offset:1024  lds
    buffer_load_dwordx4 v8, s[36:39], s50 offen offset:2048  lds
    buffer_load_dwordx4 v9, s[36:39], s50 offen offset:3072  lds
    s_mov_b32 m0, 118784
    s_nop 0
    buffer_load_dwordx4 v10, s[36:39], s50 offen offset:0  lds
    buffer_load_dwordx4 v11, s[36:39], s50 offen offset:1024  lds
    buffer_load_dwordx4 v12, s[36:39], s50 offen offset:2048  lds
    buffer_load_dwordx4 v13, s[36:39], s50 offen offset:3072  lds
    s_mov_b32 m0, 122880
    s_nop 0
    buffer_load_dwordx4 v14, s[36:39], s50 offen offset:0  lds
    buffer_load_dwordx4 v15, s[36:39], s50 offen offset:1024  lds
    buffer_load_dwordx4 v16, s[36:39], s50 offen offset:2048  lds
    buffer_load_dwordx4 v17, s[36:39], s50 offen offset:3072  lds
    s_mov_b32 m0, 126976
    s_nop 0
    buffer_load_dwordx4 v18, s[36:39], s50 offen offset:0  lds
    buffer_load_dwordx4 v19, s[36:39], s50 offen offset:1024  lds
    s_waitcnt vmcnt(18)
    s_barrier
    s_add_u32 s52, s50, 165888
    s_mov_b32 m0, 0
    s_nop 0
    buffer_load_dwordx4 v2, s[36:39], s52 offen offset:0  lds
    buffer_load_dwordx4 v3, s[36:39], s52 offen offset:1024  lds
    buffer_load_dwordx4 v4, s[36:39], s52 offen offset:2048  lds
    buffer_load_dwordx4 v5, s[36:39], s52 offen offset:3072  lds
    s_mov_b32 m0, 4096
    s_nop 0
    buffer_load_dwordx4 v6, s[36:39], s52 offen offset:0  lds
    buffer_load_dwordx4 v7, s[36:39], s52 offen offset:1024  lds
    buffer_load_dwordx4 v8, s[36:39], s52 offen offset:2048  lds
    buffer_load_dwordx4 v9, s[36:39], s52 offen offset:3072  lds
    s_mov_b32 m0, 8192
    s_nop 0
    buffer_load_dwordx4 v10, s[36:39], s52 offen offset:0  lds
    buffer_load_dwordx4 v11, s[36:39], s52 offen offset:1024  lds
    buffer_load_dwordx4 v12, s[36:39], s52 offen offset:2048  lds
    buffer_load_dwordx4 v13, s[36:39], s52 offen offset:3072  lds
    s_mov_b32 m0, 12288
    s_nop 0
    buffer_load_dwordx4 v14, s[36:39], s52 offen offset:0  lds
    buffer_load_dwordx4 v15, s[36:39], s52 offen offset:1024  lds
    buffer_load_dwordx4 v16, s[36:39], s52 offen offset:2048  lds
    buffer_load_dwordx4 v17, s[36:39], s52 offen offset:3072  lds
    s_mov_b32 m0, 16384
    s_nop 0
    buffer_load_dwordx4 v18, s[36:39], s52 offen offset:0  lds
    buffer_load_dwordx4 v19, s[36:39], s52 offen offset:1024  lds
    s_add_u32 s50, s50, 128
    s_cmp_ge_u32 s50, s51
    s_cselect_b32 s44, 1152, 0
    s_sub_u32 s50, s50, s44
    s_waitcnt vmcnt(18)
    s_barrier
    s_waitcnt vmcnt(0)
    s_barrier
    s_endpgm
L_r5:
    s_lshr_b32 s25, s23, 2
    s_lshl_b32 s25, s25, 3
    s_lshr_b32 s44, s24, 2
    s_add_u32 s25, s25, s44
    s_and_b32 s26, s23, 3
    s_lshl_b32 s26, s26, 2
    s_and_b32 s45, s24, 3
    s_add_u32 s26, s26, s45
    s_lshl_b32 s45, s45, 1
    s_add_u32 s27, s44, s45
    s_cmp_ge_u32 s27, 9
    s_cselect_b32 s44, 9, 0
    s_sub_u32 s27, s27, s44
    v_lshrrev_b32 v20, 4, v1
    v_lshlrev_b32 v21, 2, v20
    v_sub_u32 v21, v1, v21
    v_and_b32 v21, 15, v21
    v_mul_u32_u24 v22, 52, v21
    v_lshrrev_b32 v22, 8, v22
    v_mul_u32_u24 v23, 5, v22
    v_sub_u32 v23, v21, v23
    v_mul_u32_u24 v20, 3456, v20
    v_mul_u32_u24 v22, 1152, v22
    v_add_u32 v20, v20, v22
    v_lshl_add_u32 v6, v23, 4, v20
    v_lshrrev_b32 v23, 2, v23
    v_lshlrev_b32 v23, 3, v23
    v_sub_u32 v6, v6, v23
    v_add_u32 v7, 12800, v6
    v_add_u32 v8, 25600, v6
    v_add_u32 v9, 38400, v6
    s_mov_b32 s60, 0xfff77fff
    s_mov_b32 s61, 0xf7ffff7f
    s_mul_i32 s46, s26, 72
    s_add_u32 s47, s46, 1990656
    s_mul_i32 s44, s27, 221184
    s_add_u32 s46, s46, s44
    s_waitcnt lgkmcnt(0)
    s_mov_b32 s32, s6
    s_and_b32 s33, s7, 0xffff
    s_mov_b32 s34, 1990656
    s_mov_b32 s35, 0x20000
    s_mov_b32 s28, s20
    s_and_b32 s29, s21, 0xffff
    s_mov_b32 s30, 27262976
    s_mov_b32 s31, 0x20000
    s_mov_b32 s36, s18
    s_and_b32 s37, s19, 0xffff
    s_mov_b32 s38, 256
    s_mov_b32 s39, 0x20000
    s_mov_b32 s40, s10
    s_and_b32 s41, s11, 0xffff
    s_mov_b32 s42, 663552
    s_mov_b32 s43, 0x20000
    s_mov_b64 exec, s[60:61]
    s_mov_b32 m0, 16384
    s_nop 0
    buffer_load_dwordx4 v6, s[32:35], s46 offen offset:0 lds
    buffer_load_dwordx4 v7, s[32:35], s46 offen offset:1024 lds
    buffer_load_dwordx4 v8, s[32:35], s46 offen offset:2048 lds
    buffer_load_dwordx4 v9, s[32:35], s46 offen offset:3072 lds
    s_mov_b32 m0, 20480
    s_add_u32 s45, s46, 55296
    buffer_load_dwordx4 v6, s[32:35], s45 offen offset:0 lds
    buffer_load_dwordx4 v7, s[32:35], s45 offen offset:1024 lds
    buffer_load_dwordx4 v8, s[32:35], s45 offen offset:2048 lds
    buffer_load_dwordx4 v9, s[32:35], s45 offen offset:3072 lds
    s_mov_b32 m0, 24576
    s_add_u32 s45, s46, 110592
    buffer_load_dwordx4 v6, s[32:35], s45 offen offset:0 lds
    buffer_load_dwordx4 v7, s[32:35], s45 offen offset:1024 lds
    buffer_load_dwordx4 v8, s[32:35], s45 offen offset:2048 lds
    buffer_load_dwordx4 v9, s[32:35], s45 offen offset:3072 lds
    s_mov_b32 m0, 28672
    s_add_u32 s45, s46, 165888
    buffer_load_dwordx4 v6, s[32:35], s45 offen offset:0 lds
    buffer_load_dwordx4 v7, s[32:35], s45 offen offset:1024 lds
    buffer_load_dwordx4 v8, s[32:35], s45 offen offset:2048 lds
    buffer_load_dwordx4 v9, s[32:35], s45 offen offset:3072 lds
    s_mov_b64 exec, -1
    s_add_u32 s46, s46, 221184
    s_cmp_ge_u32 s46, s47
    s_cselect_b32 s44, 1990656, 0
    s_sub_u32 s46, s46, s44
    s_mov_b64 exec, s[60:61]
    s_mov_b32 m0, 49152
    s_nop 0
    buffer_load_dwordx4 v6, s[32:35], s46 offen offset:0 lds
    buffer_load_dwordx4 v7, s[32:35], s46 offen offset:1024 lds
    buffer_load_dwordx4 v8, s[32:35], s46 offen offset:2048 lds
    buffer_load_dwordx4 v9, s[32:35], s46 offen offset:3072 lds
    s_mov_b32 m0, 53248
    s_add_u32 s45, s46, 55296
    buffer_load_dwordx4 v6, s[32:35], s45 offen offset:0 lds
    buffer_load_dwordx4 v7, s[32:35], s45 offen offset:1024 lds
    buffer_load_dwordx4 v8, s[32:35], s45 offen offset:2048 lds
    buffer_load_dwordx4 v9, s[32:35], s45 offen offset:3072 lds
    s_mov_b32 m0, 57344
    s_add_u32 s45, s46, 110592
    buffer_load_dwordx4 v6, s[32:35], s45 offen offset:0 lds
    buffer_load_dwordx4 v7, s[32:35], s45 offen offset:1024 lds
    buffer_load_dwordx4 v8, s[32:35], s45 offen offset:2048 lds
    buffer_load_dwordx4 v9, s[32:35], s45 offen offset:3072 lds
    s_mov_b32 m0, 61440
    s_add_u32 s45, s46, 165888
    buffer_load_dwordx4 v6, s[32:35], s45 offen offset:0 lds
    buffer_load_dwordx4 v7, s[32:35], s45 offen offset:1024 lds
    buffer_load_dwordx4 v8, s[32:35], s45 offen offset:2048 lds
    buffer_load_dwordx4 v9, s[32:35], s45 offen offset:3072 lds
    s_mov_b64 exec, -1
    s_add_u32 s46, s46, 221184
    s_cmp_ge_u32 s46, s47
    s_cselect_b32 s44, 1990656, 0
    s_sub_u32 s46, s46, s44
    s_waitcnt vmcnt(16)
    s_barrier
    s_mov_b64 exec, s[60:61]
    s_mov_b32 m0, 81920
    s_nop 0
    buffer_load_dwordx4 v6, s[32:35], s46 offen offset:0 lds
    buffer_load_dwordx4 v7, s[32:35], s46 offen offset:1024 lds
    buffer_load_dwordx4 v8, s[32:35], s46 offen offset:2048 lds
    buffer_load_dwordx4 v9, s[32:35], s46 offen offset:3072 lds
    s_mov_b32 m0, 86016
    s_add_u32 s45, s46, 55296
    buffer_load_dwordx4 v6, s[32:35], s45 offen offset:0 lds
    buffer_load_dwordx4 v7, s[32:35], s45 offen offset:1024 lds
    buffer_load_dwordx4 v8, s[32:35], s45 offen offset:2048 lds
    buffer_load_dwordx4 v9, s[32:35], s45 offen offset:3072 lds
    s_mov_b32 m0, 90112
    s_add_u32 s45, s46, 110592
    buffer_load_dwordx4 v6, s[32:35], s45 offen offset:0 lds
    buffer_load_dwordx4 v7, s[32:35], s45 offen offset:1024 lds
    buffer_load_dwordx4 v8, s[32:35], s45 offen offset:2048 lds
    buffer_load_dwordx4 v9, s[32:35], s45 offen offset:3072 lds
    s_mov_b32 m0, 94208
    s_add_u32 s45, s46, 165888
    buffer_load_dwordx4 v6, s[32:35], s45 offen offset:0 lds
    buffer_load_dwordx4 v7, s[32:35], s45 offen offset:1024 lds
    buffer_load_dwordx4 v8, s[32:35], s45 offen offset:2048 lds
    buffer_load_dwordx4 v9, s[32:35], s45 offen offset:3072 lds
    s_mov_b64 exec, -1
    s_add_u32 s46, s46, 221184
    s_cmp_ge_u32 s46, s47
    s_cselect_b32 s44, 1990656, 0
    s_sub_u32 s46, s46, s44
    s_waitcnt vmcnt(16)
    s_barrier
    s_mov_b64 exec, s[60:61]
    s_mov_b32 m0, 114688
    s_nop 0
    buffer_load_dwordx4 v6, s[32:35], s46 offen offset:0 lds
    buffer_load_dwordx4 v7, s[32:35], s46 offen offset:1024 lds
    buffer_load_dwordx4 v8, s[32:35], s46 offen offset:2048 lds
    buffer_load_dwordx4 v9, s[32:35], s46 offen offset:3072 lds
    s_mov_b32 m0, 118784
    s_add_u32 s45, s46, 55296
    buffer_load_dwordx4 v6, s[32:35], s45 offen offset:0 lds
    buffer_load_dwordx4 v7, s[32:35], s45 offen offset:1024 lds
    buffer_load_dwordx4 v8, s[32:35], s45 offen offset:2048 lds
    buffer_load_dwordx4 v9, s[32:35], s45 offen offset:3072 lds
    s_mov_b32 m0, 122880
    s_add_u32 s45, s46, 110592
    buffer_load_dwordx4 v6, s[32:35], s45 offen offset:0 lds
    buffer_load_dwordx4 v7, s[32:35], s45 offen offset:1024 lds
    buffer_load_dwordx4 v8, s[32:35], s45 offen offset:2048 lds
    buffer_load_dwordx4 v9, s[32:35], s45 offen offset:3072 lds
    s_mov_b32 m0, 126976
    s_add_u32 s45, s46, 165888
    buffer_load_dwordx4 v6, s[32:35], s45 offen offset:0 lds
    buffer_load_dwordx4 v7, s[32:35], s45 offen offset:1024 lds
    buffer_load_dwordx4 v8, s[32:35], s45 offen offset:2048 lds
    buffer_load_dwordx4 v9, s[32:35], s45 offen offset:3072 lds
    s_mov_b64 exec, -1
    s_add_u32 s46, s46, 221184
    s_cmp_ge_u32 s46, s47
    s_cselect_b32 s44, 1990656, 0
    s_sub_u32 s46, s46, s44
    s_waitcnt vmcnt(16)
    s_barrier
    s_mov_b64 exec, s[60:61]
    s_mov_b32 m0, 16384
    s_nop 0
    buffer_load_dwordx4 v6, s[32:35], s46 offen offset:0 lds
    buffer_load_dwordx4 v7, s[32:35], s46 offen offset:1024 lds
    buffer_load_dwordx4 v8, s[32:35], s46 offen offset:2048 lds
    buffer_load_dwordx4 v9, s[32:35], s46 offen offset:3072 lds
    s_mov_b32 m0, 20480
    s_add_u32 s45, s46, 55296
    buffer_load_dwordx4 v6, s[32:35], s45 offen offset:0 lds
    buffer_load_dwordx4 v7, s[32:35], s45 offen offset:1024 lds
    buffer_load_dwordx4 v8, s[32:35], s45 offen offset:2048 lds
    buffer_load_dwordx4 v9, s[32:35], s45 offen offset:3072 lds
    s_mov_b32 m0, 24576
    s_add_u32 s45, s46, 110592
    buffer_load_dwordx4 v6, s[32:35], s45 offen offset:0 lds
    buffer_load_dwordx4 v7, s[32:35], s45 offen offset:1024 lds
    buffer_load_dwordx4 v8, s[32:35], s45 offen offset:2048 lds
    buffer_load_dwordx4 v9, s[32:35], s45 offen offset:3072 lds
    s_mov_b32 m0, 28672
    s_add_u32 s45, s46, 165888
    buffer_load_dwordx4 v6, s[32:35], s45 offen offset:0 lds
    buffer_load_dwordx4 v7, s[32:35], s45 offen offset:1024 lds
    buffer_load_dwordx4 v8, s[32:35], s45 offen offset:2048 lds
    buffer_load_dwordx4 v9, s[32:35], s45 offen offset:3072 lds
    s_mov_b64 exec, -1
    s_add_u32 s46, s46, 221184
    s_cmp_ge_u32 s46, s47
    s_cselect_b32 s44, 1990656, 0
    s_sub_u32 s46, s46, s44
    s_waitcnt vmcnt(16)
    s_barrier
    s_mov_b64 exec, s[60:61]
    s_mov_b32 m0, 49152
    s_nop 0
    buffer_load_dwordx4 v6, s[32:35], s46 offen offset:0 lds
    buffer_load_dwordx4 v7, s[32:35], s46 offen offset:1024 lds
    buffer_load_dwordx4 v8, s[32:35], s46 offen offset:2048 lds
    buffer_load_dwordx4 v9, s[32:35], s46 offen offset:3072 lds
    s_mov_b32 m0, 53248
    s_add_u32 s45, s46, 55296
    buffer_load_dwordx4 v6, s[32:35], s45 offen offset:0 lds
    buffer_load_dwordx4 v7, s[32:35], s45 offen offset:1024 lds
    buffer_load_dwordx4 v8, s[32:35], s45 offen offset:2048 lds
    buffer_load_dwordx4 v9, s[32:35], s45 offen offset:3072 lds
    s_mov_b32 m0, 57344
    s_add_u32 s45, s46, 110592
    buffer_load_dwordx4 v6, s[32:35], s45 offen offset:0 lds
    buffer_load_dwordx4 v7, s[32:35], s45 offen offset:1024 lds
    buffer_load_dwordx4 v8, s[32:35], s45 offen offset:2048 lds
    buffer_load_dwordx4 v9, s[32:35], s45 offen offset:3072 lds
    s_mov_b32 m0, 61440
    s_add_u32 s45, s46, 165888
    buffer_load_dwordx4 v6, s[32:35], s45 offen offset:0 lds
    buffer_load_dwordx4 v7, s[32:35], s45 offen offset:1024 lds
    buffer_load_dwordx4 v8, s[32:35], s45 offen offset:2048 lds
    buffer_load_dwordx4 v9, s[32:35], s45 offen offset:3072 lds
    s_mov_b64 exec, -1
    s_add_u32 s46, s46, 221184
    s_cmp_ge_u32 s46, s47
    s_cselect_b32 s44, 1990656, 0
    s_sub_u32 s46, s46, s44
    s_waitcnt vmcnt(16)
    s_barrier
    s_mov_b64 exec, s[60:61]
    s_mov_b32 m0, 81920
    s_nop 0
    buffer_load_dwordx4 v6, s[32:35], s46 offen offset:0 lds
    buffer_load_dwordx4 v7, s[32:35], s46 offen offset:1024 lds
    buffer_load_dwordx4 v8, s[32:35], s46 offen offset:2048 lds
    buffer_load_dwordx4 v9, s[32:35], s46 offen offset:3072 lds
    s_mov_b32 m0, 86016
    s_add_u32 s45, s46, 55296
    buffer_load_dwordx4 v6, s[32:35], s45 offen offset:0 lds
    buffer_load_dwordx4 v7, s[32:35], s45 offen offset:1024 lds
    buffer_load_dwordx4 v8, s[32:35], s45 offen offset:2048 lds
    buffer_load_dwordx4 v9, s[32:35], s45 offen offset:3072 lds
    s_mov_b32 m0, 90112
    s_add_u32 s45, s46, 110592
    buffer_load_dwordx4 v6, s[32:35], s45 offen offset:0 lds
    buffer_load_dwordx4 v7, s[32:35], s45 offen offset:1024 lds
    buffer_load_dwordx4 v8, s[32:35], s45 offen offset:2048 lds
    buffer_load_dwordx4 v9, s[32:35], s45 offen offset:3072 lds
    s_mov_b32 m0, 94208
    s_add_u32 s45, s46, 165888
    buffer_load_dwordx4 v6, s[32:35], s45 offen offset:0 lds
    buffer_load_dwordx4 v7, s[32:35], s45 offen offset:1024 lds
    buffer_load_dwordx4 v8, s[32:35], s45 offen offset:2048 lds
    buffer_load_dwordx4 v9, s[32:35], s45 offen offset:3072 lds
    s_mov_b64 exec, -1
    s_add_u32 s46, s46, 221184
    s_cmp_ge_u32 s46, s47
    s_cselect_b32 s44, 1990656, 0
    s_sub_u32 s46, s46, s44
    s_waitcnt vmcnt(16)
    s_barrier
    s_mov_b64 exec, s[60:61]
    s_mov_b32 m0, 114688
    s_nop 0
    buffer_load_dwordx4 v6, s[32:35], s46 offen offset:0 lds
    buffer_load_dwordx4 v7, s[32:35], s46 offen offset:1024 lds
    buffer_load_dwordx4 v8, s[32:35], s46 offen offset:2048 lds
    buffer_load_dwordx4 v9, s[32:35], s46 offen offset:3072 lds
    s_mov_b32 m0, 118784
    s_add_u32 s45, s46, 55296
    buffer_load_dwordx4 v6, s[32:35], s45 offen offset:0 lds
    buffer_load_dwordx4 v7, s[32:35], s45 offen offset:1024 lds
    buffer_load_dwordx4 v8, s[32:35], s45 offen offset:2048 lds
    buffer_load_dwordx4 v9, s[32:35], s45 offen offset:3072 lds
    s_mov_b32 m0, 122880
    s_add_u32 s45, s46, 110592
    buffer_load_dwordx4 v6, s[32:35], s45 offen offset:0 lds
    buffer_load_dwordx4 v7, s[32:35], s45 offen offset:1024 lds
    buffer_load_dwordx4 v8, s[32:35], s45 offen offset:2048 lds
    buffer_load_dwordx4 v9, s[32:35], s45 offen offset:3072 lds
    s_mov_b32 m0, 126976
    s_add_u32 s45, s46, 165888
    buffer_load_dwordx4 v6, s[32:35], s45 offen offset:0 lds
    buffer_load_dwordx4 v7, s[32:35], s45 offen offset:1024 lds
    buffer_load_dwordx4 v8, s[32:35], s45 offen offset:2048 lds
    buffer_load_dwordx4 v9, s[32:35], s45 offen offset:3072 lds
    s_mov_b64 exec, -1
    s_add_u32 s46, s46, 221184
    s_cmp_ge_u32 s46, s47
    s_cselect_b32 s44, 1990656, 0
    s_sub_u32 s46, s46, s44
    s_waitcnt vmcnt(16)
    s_barrier
    s_mov_b64 exec, s[60:61]
    s_mov_b32 m0, 16384
    s_nop 0
    buffer_load_dwordx4 v6, s[32:35], s46 offen offset:0 lds
    buffer_load_dwordx4 v7, s[32:35], s46 offen offset:1024 lds
    buffer_load_dwordx4 v8, s[32:35], s46 offen offset:2048 lds
    buffer_load_dwordx4 v9, s[32:35], s46 offen offset:3072 lds
    s_mov_b32 m0, 20480
    s_add_u32 s45, s46, 55296
    buffer_load_dwordx4 v6, s[32:35], s45 offen offset:0 lds
    buffer_load_dwordx4 v7, s[32:35], s45 offen offset:1024 lds
    buffer_load_dwordx4 v8, s[32:35], s45 offen offset:2048 lds
    buffer_load_dwordx4 v9, s[32:35], s45 offen offset:3072 lds
    s_mov_b32 m0, 24576
    s_add_u32 s45, s46, 110592
    buffer_load_dwordx4 v6, s[32:35], s45 offen offset:0 lds
    buffer_load_dwordx4 v7, s[32:35], s45 offen offset:1024 lds
    buffer_load_dwordx4 v8, s[32:35], s45 offen offset:2048 lds
    buffer_load_dwordx4 v9, s[32:35], s45 offen offset:3072 lds
    s_mov_b32 m0, 28672
    s_add_u32 s45, s46, 165888
    buffer_load_dwordx4 v6, s[32:35], s45 offen offset:0 lds
    buffer_load_dwordx4 v7, s[32:35], s45 offen offset:1024 lds
    buffer_load_dwordx4 v8, s[32:35], s45 offen offset:2048 lds
    buffer_load_dwordx4 v9, s[32:35], s45 offen offset:3072 lds
    s_mov_b64 exec, -1
    s_add_u32 s46, s46, 221184
    s_cmp_ge_u32 s46, s47
    s_cselect_b32 s44, 1990656, 0
    s_sub_u32 s46, s46, s44
    s_waitcnt vmcnt(16)
    s_barrier
    s_waitcnt vmcnt(0)
    s_barrier
    v_mov_b32 v35, 0
    s_mov_b32 s56, 0
L_sequential_preLN__linear_kernel_hedgehog__dense_activation_relu__prompt_kernel_renonce_23:
    buffer_load_dword v37, v35, s[36:39], 0 offen sc1
    s_waitcnt vmcnt(0)
    v_readfirstlane_b32 s57, v37
    s_nop 0
    s_cmp_lg_u32 s57, 0
    s_cbranch_scc1 L_sequential_preLN__linear_kernel_hedgehog__dense_activation_relu__prompt_kernel_gotnonce_24
    s_add_u32 s56, s56, 1
    s_cmp_lt_u32 s56, 0x40000
    s_cbranch_scc1 L_sequential_preLN__linear_kernel_hedgehog__dense_activation_relu__prompt_kernel_renonce_23
L_sequential_preLN__linear_kernel_hedgehog__dense_activation_relu__prompt_kernel_gotnonce_24:
    s_mov_b32 s56, 429496730
    v_add_u32 v20, 0, v1
    v_mul_hi_u32 v21, v20, s56
    v_mul_u32_u24 v22, 10, v21
    v_sub_u32 v22, v20, v22
    v_mul_u32_u24 v21, 1152, v21
    v_lshl_add_u32 v2, v22, 4, v21
    v_add_u32 v20, 64, v1
    v_mul_hi_u32 v21, v20, s56
    v_mul_u32_u24 v22, 10, v21
    v_sub_u32 v22, v20, v22
    v_mul_u32_u24 v21, 1152, v21
    v_lshl_add_u32 v3, v22, 4, v21
    v_subrev_u32 v3, 1024, v3
    v_add_u32 v20, 128, v1
    v_mul_hi_u32 v21, v20, s56
    v_mul_u32_u24 v22, 10, v21
    v_sub_u32 v22, v20, v22
    v_mul_u32_u24 v21, 1152, v21
    v_lshl_add_u32 v4, v22, 4, v21
    v_subrev_u32 v4, 2048, v4
    v_add_u32 v20, 192, v1
    v_mul_hi_u32 v21, v20, s56
    v_mul_u32_u24 v22, 10, v21
    v_sub_u32 v22, v20, v22
    v_mul_u32_u24 v21, 1152, v21
    v_lshl_add_u32 v5, v22, 4, v21
    v_subrev_u32 v5, 3072, v5
    v_add_u32 v20, 256, v1
    v_mul_hi_u32 v21, v20, s56
    v_mul_u32_u24 v22, 10, v21
    v_sub_u32 v22, v20, v22
    v_mul_u32_u24 v21, 1152, v21
    v_lshl_add_u32 v6, v22, 4, v21
    s_and_b32 s57, s24, 7
    s_mul_i32 s57, s57, 144
    s_barrier
    s_and_b32 s57, s24, 7
    s_mul_i32 s57, s57, 144
    s_barrier
    s_and_b32 s57, s24, 7
    s_mul_i32 s57, s57, 144
    s_barrier
    s_and_b32 s57, s24, 7
    s_mul_i32 s57, s57, 144
    s_add_u32 s56, s57, 0
    s_mov_b32 m0, 0
    s_nop 0
    buffer_load_dwordx4 v2, s[40:43], s56 offen offset:0 lds
    buffer_load_dwordx4 v3, s[40:43], s56 offen offset:1024 lds
    buffer_load_dwordx4 v4, s[40:43], s56 offen offset:2048 lds
    buffer_load_dwordx4 v5, s[40:43], s56 offen offset:3072 lds
    s_mov_b32 m0, 4096
    s_nop 0
    buffer_load_dwordx4 v6, s[40:43], s56 offen offset:0 lds
    s_add_u32 s56, s57, 36864
    s_mov_b32 m0, 5120
    s_nop 0
    buffer_load_dwordx4 v2, s[40:43], s56 offen offset:0 lds
    buffer_load_dwordx4 v3, s[40:43], s56 offen offset:1024 lds
    buffer_load_dwordx4 v4, s[40:43], s56 offen offset:2048 lds
    buffer_load_dwordx4 v5, s[40:43], s56 offen offset:3072 lds
    s_mov_b32 m0, 9216
    s_nop 0
    buffer_load_dwordx4 v6, s[40:43], s56 offen offset:0 lds
    s_add_u32 s56, s57, 73728
    s_mov_b32 m0, 10240
    s_nop 0
    buffer_load_dwordx4 v2, s[40:43], s56 offen offset:0 lds
    buffer_load_dwordx4 v3, s[40:43], s56 offen offset:1024 lds
    buffer_load_dwordx4 v4, s[40:43], s56 offen offset:2048 lds
    buffer_load_dwordx4 v5, s[40:43], s56 offen offset:3072 lds
    s_mov_b32 m0, 14336
    s_nop 0
    buffer_load_dwordx4 v6, s[40:43], s56 offen offset:0 lds
    s_add_u32 s56, s57, 110592
    s_mov_b32 m0, 15360
    s_nop 0
    buffer_load_dwordx4 v2, s[40:43], s56 offen offset:0 lds
    buffer_load_dwordx4 v3, s[40:43], s56 offen offset:1024 lds
    buffer_load_dwordx4 v4, s[40:43], s56 offen offset:2048 lds
    buffer_load_dwordx4 v5, s[40:43], s56 offen offset:3072 lds
    s_mov_b32 m0, 19456
    s_nop 0
    buffer_load_dwordx4 v6, s[40:43], s56 offen offset:0 lds
    s_add_u32 s56, s57, 147456
    s_mov_b32 m0, 20480
    s_nop 0
    buffer_load_dwordx4 v2, s[40:43], s56 offen offset:0 lds
    buffer_load_dwordx4 v3, s[40:43], s56 offen offset:1024 lds
    buffer_load_dwordx4 v4, s[40:43], s56 offen offset:2048 lds
    buffer_load_dwordx4 v5, s[40:43], s56 offen offset:3072 lds
    s_mov_b32 m0, 24576
    s_nop 0
    buffer_load_dwordx4 v6, s[40:43], s56 offen offset:0 lds
    s_add_u32 s56, s57, 184320
    s_mov_b32 m0, 25600
    s_nop 0
    buffer_load_dwordx4 v2, s[40:43], s56 offen offset:0 lds
    buffer_load_dwordx4 v3, s[40:43], s56 offen offset:1024 lds
    buffer_load_dwordx4 v4, s[40:43], s56 offen offset:2048 lds
    buffer_load_dwordx4 v5, s[40:43], s56 offen offset:3072 lds
    s_mov_b32 m0, 29696
    s_nop 0
    buffer_load_dwordx4 v6, s[40:43], s56 offen offset:0 lds
    s_add_u32 s56, s57, 221184
    s_mov_b32 m0, 30720
    s_nop 0
    buffer_load_dwordx4 v2, s[40:43], s56 offen offset:0 lds
    buffer_load_dwordx4 v3, s[40:43], s56 offen offset:1024 lds
    buffer_load_dwordx4 v4, s[40:43], s56 offen offset:2048 lds
    buffer_load_dwordx4 v5, s[40:43], s56 offen offset:3072 lds
    s_mov_b32 m0, 34816
    s_nop 0
    buffer_load_dwordx4 v6, s[40:43], s56 offen offset:0 lds
    s_add_u32 s56, s57, 258048
    s_mov_b32 m0, 35840
    s_nop 0
    buffer_load_dwordx4 v2, s[40:43], s56 offen offset:0 lds
    buffer_load_dwordx4 v3, s[40:43], s56 offen offset:1024 lds
    buffer_load_dwordx4 v4, s[40:43], s56 offen offset:2048 lds
    buffer_load_dwordx4 v5, s[40:43], s56 offen offset:3072 lds
    s_mov_b32 m0, 39936
    s_nop 0
    buffer_load_dwordx4 v6, s[40:43], s56 offen offset:0 lds
    s_add_u32 s56, s57, 294912
    s_mov_b32 m0, 40960
    s_nop 0
    buffer_load_dwordx4 v2, s[40:43], s56 offen offset:0 lds
    buffer_load_dwordx4 v3, s[40:43], s56 offen offset:1024 lds
    buffer_load_dwordx4 v4, s[40:43], s56 offen offset:2048 lds
    buffer_load_dwordx4 v5, s[40:43], s56 offen offset:3072 lds
    s_mov_b32 m0, 45056
    s_nop 0
    buffer_load_dwordx4 v6, s[40:43], s56 offen offset:0 lds
    s_barrier
    s_and_b32 s57, s24, 7
    s_mul_i32 s57, s57, 144
    s_barrier
    s_and_b32 s57, s24, 7
    s_mul_i32 s57, s57, 144
    s_add_u32 s56, s57, 331776
    s_mov_b32 m0, 46080
    s_nop 0
    buffer_load_dwordx4 v2, s[40:43], s56 offen offset:0 lds
    buffer_load_dwordx4 v3, s[40:43], s56 offen offset:1024 lds
    buffer_load_dwordx4 v4, s[40:43], s56 offen offset:2048 lds
    buffer_load_dwordx4 v5, s[40:43], s56 offen offset:3072 lds
    s_mov_b32 m0, 50176
    s_nop 0
    buffer_load_dwordx4 v6, s[40:43], s56 offen offset:0 lds
    s_add_u32 s56, s57, 368640
    s_mov_b32 m0, 51200
    s_nop 0
    buffer_load_dwordx4 v2, s[40:43], s56 offen offset:0 lds
    buffer_load_dwordx4 v3, s[40:43], s56 offen offset:1024 lds
    buffer_load_dwordx4 v4, s[40:43], s56 offen offset:2048 lds
    buffer_load_dwordx4 v5, s[40:43], s56 offen offset:3072 lds
    s_mov_b32 m0, 55296
    s_nop 0
    buffer_load_dwordx4 v6, s[40:43], s56 offen offset:0 lds
    s_add_u32 s56, s57, 405504
    s_mov_b32 m0, 56320
    s_nop 0
    buffer_load_dwordx4 v2, s[40:43], s56 offen offset:0 lds
    buffer_load_dwordx4 v3, s[40:43], s56 offen offset:1024 lds
    buffer_load_dwordx4 v4, s[40:43], s56 offen offset:2048 lds
    buffer_load_dwordx4 v5, s[40:43], s56 offen offset:3072 lds
    s_mov_b32 m0, 60416
    s_nop 0
    buffer_load_dwordx4 v6, s[40:43], s56 offen offset:0 lds
    s_add_u32 s56, s57, 442368
    s_mov_b32 m0, 61440
    s_nop 0
    buffer_load_dwordx4 v2, s[40:43], s56 offen offset:0 lds
    buffer_load_dwordx4 v3, s[40:43], s56 offen offset:1024 lds
    buffer_load_dwordx4 v4, s[40:43], s56 offen offset:2048 lds
    buffer_load_dwordx4 v5, s[40:43], s56 offen offset:3072 lds
    s_mov_b32 m0, 65536
    s_nop 0
    buffer_load_dwordx4 v6, s[40:43], s56 offen offset:0 lds
    s_add_u32 s56, s57, 479232
    s_mov_b32 m0, 66560
    s_nop 0
    buffer_load_dwordx4 v2, s[40:43], s56 offen offset:0 lds
    buffer_load_dwordx4 v3, s[40:43], s56 offen offset:1024 lds
    buffer_load_dwordx4 v4, s[40:43], s56 offen offset:2048 lds
    buffer_load_dwordx4 v5, s[40:43], s56 offen offset:3072 lds
    s_mov_b32 m0, 70656
    s_nop 0
    buffer_load_dwordx4 v6, s[40:43], s56 offen offset:0 lds
    s_add_u32 s56, s57, 516096
    s_mov_b32 m0, 71680
    s_nop 0
    buffer_load_dwordx4 v2, s[40:43], s56 offen offset:0 lds
    buffer_load_dwordx4 v3, s[40:43], s56 offen offset:1024 lds
    buffer_load_dwordx4 v4, s[40:43], s56 offen offset:2048 lds
    buffer_load_dwordx4 v5, s[40:43], s56 offen offset:3072 lds
    s_mov_b32 m0, 75776
    s_nop 0
    buffer_load_dwordx4 v6, s[40:43], s56 offen offset:0 lds
    s_add_u32 s56, s57, 552960
    s_mov_b32 m0, 76800
    s_nop 0
    buffer_load_dwordx4 v2, s[40:43], s56 offen offset:0 lds
    buffer_load_dwordx4 v3, s[40:43], s56 offen offset:1024 lds
    buffer_load_dwordx4 v4, s[40:43], s56 offen offset:2048 lds
    buffer_load_dwordx4 v5, s[40:43], s56 offen offset:3072 lds
    s_mov_b32 m0, 80896
    s_nop 0
    buffer_load_dwordx4 v6, s[40:43], s56 offen offset:0 lds
    s_add_u32 s56, s57, 589824
    s_mov_b32 m0, 81920
    s_nop 0
    buffer_load_dwordx4 v2, s[40:43], s56 offen offset:0 lds
    buffer_load_dwordx4 v3, s[40:43], s56 offen offset:1024 lds
    buffer_load_dwordx4 v4, s[40:43], s56 offen offset:2048 lds
    buffer_load_dwordx4 v5, s[40:43], s56 offen offset:3072 lds
    s_mov_b32 m0, 86016
    s_nop 0
    buffer_load_dwordx4 v6, s[40:43], s56 offen offset:0 lds
    s_add_u32 s56, s57, 626688
    s_mov_b32 m0, 87040
    s_nop 0
    buffer_load_dwordx4 v2, s[40:43], s56 offen offset:0 lds
    buffer_load_dwordx4 v3, s[40:43], s56 offen offset:1024 lds
    buffer_load_dwordx4 v4, s[40:43], s56 offen offset:2048 lds
    buffer_load_dwordx4 v5, s[40:43], s56 offen offset:3072 lds
    s_mov_b32 m0, 91136
    s_nop 0
    buffer_load_dwordx4 v6, s[40:43], s56 offen offset:0 lds
    s_waitcnt vmcnt(0)
    s_barrier
    s_barrier
    s_barrier
    s_barrier
    s_barrier
    s_barrier
    s_barrier
    s_barrier
    s_cmp_ge_u32 s24, 18
    s_cselect_b32 s26, 18, 0
    s_sub_u32 s26, s24, s26
    s_cmp_ge_u32 s26, 9
    s_cselect_b32 s27, 9, 0
    s_sub_u32 s27, s26, s27
    s_mov_b32 s44, 59652324
    v_add_u32 v40, 0, v1
    v_mul_hi_u32 v41, v40, s44
    v_mul_u32_u24 v42, 72, v41
    v_sub_u32 v42, v40, v42
    v_bfe_u32 v43, v41, 1, 1
    v_lshlrev_b32 v43, 2, v43
    v_xor_b32 v42, v42, v43
    v_mul_u32_u24 v41, 9216, v41
    v_lshl_add_u32 v2, v42, 4, v41
    v_add_u32 v40, 64, v1
    v_mul_hi_u32 v41, v40, s44
    v_mul_u32_u24 v42, 72, v41
    v_sub_u32 v42, v40, v42
    v_bfe_u32 v43, v41, 1, 1
    v_lshlrev_b32 v43, 2, v43
    v_xor_b32 v42, v42, v43
    v_mul_u32_u24 v41, 9216, v41
    v_lshl_add_u32 v3, v42, 4, v41
    v_subrev_u32 v3, 1024, v3
    v_add_u32 v40, 128, v1
    v_mul_hi_u32 v41, v40, s44
    v_mul_u32_u24 v42, 72, v41
    v_sub_u32 v42, v40, v42
    v_bfe_u32 v43, v41, 1, 1
    v_lshlrev_b32 v43, 2, v43
    v_xor_b32 v42, v42, v43
    v_mul_u32_u24 v41, 9216, v41
    v_lshl_add_u32 v4, v42, 4, v41
    v_subrev_u32 v4, 2048, v4
    v_add_u32 v40, 192, v1
    v_mul_hi_u32 v41, v40, s44
    v_mul_u32_u24 v42, 72, v41
    v_sub_u32 v42, v40, v42
    v_bfe_u32 v43, v41, 1, 1
    v_lshlrev_b32 v43, 2, v43
    v_xor_b32 v42, v42, v43
    v_mul_u32_u24 v41, 9216, v41
    v_lshl_add_u32 v5, v42, 4, v41
    v_subrev_u32 v5, 3072, v5
    v_add_u32 v40, 256, v1
    v_mul_hi_u32 v41, v40, s44
    v_mul_u32_u24 v42, 72, v41
    v_sub_u32 v42, v40, v42
    v_bfe_u32 v43, v41, 1, 1
    v_lshlrev_b32 v43, 2, v43
    v_xor_b32 v42, v42, v43
    v_mul_u32_u24 v41, 9216, v41
    v_lshl_add_u32 v6, v42, 4, v41
    v_add_u32 v40, 320, v1
    v_mul_hi_u32 v41, v40, s44
    v_mul_u32_u24 v42, 72, v41
    v_sub_u32 v42, v40, v42
    v_bfe_u32 v43, v41, 1, 1
    v_lshlrev_b32 v43, 2, v43
    v_xor_b32 v42, v42, v43
    v_mul_u32_u24 v41, 9216, v41
    v_lshl_add_u32 v7, v42, 4, v41
    v_subrev_u32 v7, 1024, v7
    v_add_u32 v40, 384, v1
    v_mul_hi_u32 v41, v40, s44
    v_mul_u32_u24 v42, 72, v41
    v_sub_u32 v42, v40, v42
    v_bfe_u32 v43, v41, 1, 1
    v_lshlrev_b32 v43, 2, v43
    v_xor_b32 v42, v42, v43
    v_mul_u32_u24 v41, 9216, v41
    v_lshl_add_u32 v8, v42, 4, v41
    v_subrev_u32 v8, 2048, v8
    v_add_u32 v40, 448, v1
    v_mul_hi_u32 v41, v40, s44
    v_mul_u32_u24 v42, 72, v41
    v_sub_u32 v42, v40, v42
    v_bfe_u32 v43, v41, 1, 1
    v_lshlrev_b32 v43, 2, v43
    v_xor_b32 v42, v42, v43
    v_mul_u32_u24 v41, 9216, v41
    v_lshl_add_u32 v9, v42, 4, v41
    v_subrev_u32 v9, 3072, v9
    v_add_u32 v40, 512, v1
    v_mul_hi_u32 v41, v40, s44
    v_mul_u32_u24 v42, 72, v41
    v_sub_u32 v42, v40, v42
    v_bfe_u32 v43, v41, 1, 1
    v_lshlrev_b32 v43, 2, v43
    v_xor_b32 v42, v42, v43
    v_mul_u32_u24 v41, 9216, v41
    v_lshl_add_u32 v10, v42, 4, v41
    v_add_u32 v40, 576, v1
    v_mul_hi_u32 v41, v40, s44
    v_mul_u32_u24 v42, 72, v41
    v_sub_u32 v42, v40, v42
    v_bfe_u32 v43, v41, 1, 1
    v_lshlrev_b32 v43, 2, v43
    v_xor_b32 v42, v42, v43
    v_mul_u32_u24 v41, 9216, v41
    v_lshl_add_u32 v11, v42, 4, v41
    v_subrev_u32 v11, 1024, v11
    v_add_u32 v40, 640, v1
    v_mul_hi_u32 v41, v40, s44
    v_mul_u32_u24 v42, 72, v41
    v_sub_u32 v42, v40, v42
    v_bfe_u32 v43, v41, 1, 1
    v_lshlrev_b32 v43, 2, v43
    v_xor_b32 v42, v42, v43
    v_mul_u32_u24 v41, 9216, v41
    v_lshl_add_u32 v12, v42, 4, v41
    v_subrev_u32 v12, 2048, v12
    v_add_u32 v40, 704, v1
    v_mul_hi_u32 v41, v40, s44
    v_mul_u32_u24 v42, 72, v41
    v_sub_u32 v42, v40, v42
    v_bfe_u32 v43, v41, 1, 1
    v_lshlrev_b32 v43, 2, v43
    v_xor_b32 v42, v42, v43
    v_mul_u32_u24 v41, 9216, v41
    v_lshl_add_u32 v13, v42, 4, v41
    v_subrev_u32 v13, 3072, v13
    v_add_u32 v40, 768, v1
    v_mul_hi_u32 v41, v40, s44
    v_mul_u32_u24 v42, 72, v41
    v_sub_u32 v42, v40, v42
    v_bfe_u32 v43, v41, 1, 1
    v_lshlrev_b32 v43, 2, v43
    v_xor_b32 v42, v42, v43
    v_mul_u32_u24 v41, 9216, v41
    v_lshl_add_u32 v14, v42, 4, v41
    v_add_u32 v40, 832, v1
    v_mul_hi_u32 v41, v40, s44
    v_mul_u32_u24 v42, 72, v41
    v_sub_u32 v42, v40, v42
    v_bfe_u32 v43, v41, 1, 1
    v_lshlrev_b32 v43, 2, v43
    v_xor_b32 v42, v42, v43
    v_mul_u32_u24 v41, 9216, v41
    v_lshl_add_u32 v15, v42, 4, v41
    v_subrev_u32 v15, 1024, v15
    v_add_u32 v40, 896, v1
    v_mul_hi_u32 v41, v40, s44
    v_mul_u32_u24 v42, 72, v41
    v_sub_u32 v42, v40, v42
    v_bfe_u32 v43, v41, 1, 1
    v_lshlrev_b32 v43, 2, v43
    v_xor_b32 v42, v42, v43
    v_mul_u32_u24 v41, 9216, v41
    v_lshl_add_u32 v16, v42, 4, v41
    v_subrev_u32 v16, 2048, v16
    v_add_u32 v40, 960, v1
    v_mul_hi_u32 v41, v40, s44
    v_mul_u32_u24 v42, 72, v41
    v_sub_u32 v42, v40, v42
    v_bfe_u32 v43, v41, 1, 1
    v_lshlrev_b32 v43, 2, v43
    v_xor_b32 v42, v42, v43
    v_mul_u32_u24 v41, 9216, v41
    v_lshl_add_u32 v17, v42, 4, v41
    v_subrev_u32 v17, 3072, v17
    v_add_u32 v40, 1024, v1
    v_mul_hi_u32 v41, v40, s44
    v_mul_u32_u24 v42, 72, v41
    v_sub_u32 v42, v40, v42
    v_bfe_u32 v43, v41, 1, 1
    v_lshlrev_b32 v43, 2, v43
    v_xor_b32 v42, v42, v43
    v_mul_u32_u24 v41, 9216, v41
    v_lshl_add_u32 v18, v42, 4, v41
    v_add_u32 v40, 1088, v1
    v_mul_hi_u32 v41, v40, s44
    v_mul_u32_u24 v42, 72, v41
    v_sub_u32 v42, v40, v42
    v_bfe_u32 v43, v41, 1, 1
    v_lshlrev_b32 v43, 2, v43
    v_xor_b32 v42, v42, v43
    v_mul_u32_u24 v41, 9216, v41
    v_lshl_add_u32 v19, v42, 4, v41
    v_subrev_u32 v19, 1024, v19
    v_lshlrev_b32 v38, 4, v1
    v_and_b32 v36, 7, v1
    v_lshlrev_b32 v36, 2, v36
    s_mov_b32 s32, s12
    s_and_b32 s33, s13, 0xffff
    s_mov_b32 s34, 5308416
    s_mov_b32 s35, 0x20000
    s_mov_b32 s36, s14
    s_and_b32 s37, s15, 0xffff
    s_mov_b32 s38, 5308416
    s_mov_b32 s39, 0x20000
    s_mul_i32 s46, s23, 1152
    s_add_u32 s53, s46, 6553600
    s_add_u32 s46, s46, 147456
    s_add_u32 s47, s46, 5308416
    s_mul_i32 s44, s26, 294912
    s_add_u32 s46, s46, s44
    s_lshl_b32 s48, s24, 1
    s_add_u32 s48, s48, 1
    s_mul_i32 s48, s48, 36864
    s_add_u32 s48, s48, 2359296
    s_add_u32 s49, s48, 36864
    s_lshl_b32 s44, s26, 11
    s_add_u32 s48, s48, s44
    s_mul_i32 s50, s23, 663552
    s_add_u32 s50, s50, 331776
    s_add_u32 s51, s50, 1152
    s_lshl_b32 s44, s27, 7
    s_add_u32 s50, s50, s44
    s_lshl_b32 s54, s24, 7
    s_add_u32 s54, s54, 6492160
    s_barrier
    s_barrier
    s_mov_b32 m0, 18432
    s_nop 0
    buffer_load_dwordx4 v2, s[32:35], s46 offen offset:0  lds
    buffer_load_dwordx4 v3, s[32:35], s46 offen offset:1024  lds
    buffer_load_dwordx4 v4, s[32:35], s46 offen offset:2048  lds
    buffer_load_dwordx4 v5, s[32:35], s46 offen offset:3072  lds
    s_mov_b32 m0, 22528
    s_nop 0
    buffer_load_dwordx4 v6, s[32:35], s46 offen offset:0  lds
    buffer_load_dwordx4 v7, s[32:35], s46 offen offset:1024  lds
    buffer_load_dwordx4 v8, s[32:35], s46 offen offset:2048  lds
    buffer_load_dwordx4 v9, s[32:35], s46 offen offset:3072  lds
    s_mov_b32 m0, 26624
    s_nop 0
    buffer_load_dwordx4 v10, s[32:35], s46 offen offset:0  lds
    buffer_load_dwordx4 v11, s[32:35], s46 offen offset:1024  lds
    buffer_load_dwordx4 v12, s[32:35], s46 offen offset:2048  lds
    buffer_load_dwordx4 v13, s[32:35], s46 offen offset:3072  lds
    s_mov_b32 m0, 30720
    s_nop 0
    buffer_load_dwordx4 v14, s[32:35], s46 offen offset:0  lds
    buffer_load_dwordx4 v15, s[32:35], s46 offen offset:1024  lds
    buffer_load_dwordx4 v16, s[32:35], s46 offen offset:2048  lds
    buffer_load_dwordx4 v17, s[32:35], s46 offen offset:3072  lds
    s_mov_b32 m0, 34816
    s_nop 0
    buffer_load_dwordx4 v18, s[32:35], s46 offen offset:0  lds
    buffer_load_dwordx4 v19, s[32:35], s46 offen offset:1024  lds
    s_add_u32 s46, s46, 294912
    s_cmp_ge_u32 s46, s47
    s_cselect_b32 s44, 5308416, 0
    s_sub_u32 s46, s46, s44
    s_mov_b32 m0, 55296
    s_nop 0
    buffer_load_dwordx4 v2, s[32:35], s46 offen offset:0  lds
    buffer_load_dwordx4 v3, s[32:35], s46 offen offset:1024  lds
    buffer_load_dwordx4 v4, s[32:35], s46 offen offset:2048  lds
    buffer_load_dwordx4 v5, s[32:35], s46 offen offset:3072  lds
    s_mov_b32 m0, 59392
    s_nop 0
    buffer_load_dwordx4 v6, s[32:35], s46 offen offset:0  lds
    buffer_load_dwordx4 v7, s[32:35], s46 offen offset:1024  lds
    buffer_load_dwordx4 v8, s[32:35], s46 offen offset:2048  lds
    buffer_load_dwordx4 v9, s[32:35], s46 offen offset:3072  lds
    s_mov_b32 m0, 63488
    s_nop 0
    buffer_load_dwordx4 v10, s[32:35], s46 offen offset:0  lds
    buffer_load_dwordx4 v11, s[32:35], s46 offen offset:1024  lds
    buffer_load_dwordx4 v12, s[32:35], s46 offen offset:2048  lds
    buffer_load_dwordx4 v13, s[32:35], s46 offen offset:3072  lds
    s_mov_b32 m0, 67584
    s_nop 0
    buffer_load_dwordx4 v14, s[32:35], s46 offen offset:0  lds
    buffer_load_dwordx4 v15, s[32:35], s46 offen offset:1024  lds
    buffer_load_dwordx4 v16, s[32:35], s46 offen offset:2048  lds
    buffer_load_dwordx4 v17, s[32:35], s46 offen offset:3072  lds
    s_mov_b32 m0, 71680
    s_nop 0
    buffer_load_dwordx4 v18, s[32:35], s46 offen offset:0  lds
    buffer_load_dwordx4 v19, s[32:35], s46 offen offset:1024  lds
    s_add_u32 s46, s46, 294912
    s_cmp_ge_u32 s46, s47
    s_cselect_b32 s44, 5308416, 0
    s_sub_u32 s46, s46, s44
    s_add_u32 s48, s48, 2048
    s_cmp_ge_u32 s48, s49
    s_cselect_b32 s44, 36864, 0
    s_sub_u32 s48, s48, s44
    s_add_u32 s48, s48, 2048
    s_cmp_ge_u32 s48, s49
    s_cselect_b32 s44, 36864, 0
    s_sub_u32 s48, s48, s44
    s_add_u32 s48, s48, 2048
    s_cmp_ge_u32 s48, s49
    s_cselect_b32 s44, 36864, 0
    s_sub_u32 s48, s48, s44
    s_waitcnt vmcnt(18)
    s_barrier
    s_mov_b32 m0, 92160
    s_nop 0
    buffer_load_dwordx4 v2, s[32:35], s46 offen offset:0  lds
    buffer_load_dwordx4 v3, s[32:35], s46 offen offset:1024  lds
    buffer_load_dwordx4 v4, s[32:35], s46 offen offset:2048  lds
    buffer_load_dwordx4 v5, s[32:35], s46 offen offset:3072  lds
    s_mov_b32 m0, 96256
    s_nop 0
    buffer_load_dwordx4 v6, s[32:35], s46 offen offset:0  lds
    buffer_load_dwordx4 v7, s[32:35], s46 offen offset:1024  lds
    buffer_load_dwordx4 v8, s[32:35], s46 offen offset:2048  lds
    buffer_load_dwordx4 v9, s[32:35], s46 offen offset:3072  lds
    s_mov_b32 m0, 100352
    s_nop 0
    buffer_load_dwordx4 v10, s[32:35], s46 offen offset:0  lds
    buffer_load_dwordx4 v11, s[32:35], s46 offen offset:1024  lds
    buffer_load_dwordx4 v12, s[32:35], s46 offen offset:2048  lds
    buffer_load_dwordx4 v13, s[32:35], s46 offen offset:3072  lds
    s_mov_b32 m0, 104448
    s_nop 0
    buffer_load_dwordx4 v14, s[32:35], s46 offen offset:0  lds
    buffer_load_dwordx4 v15, s[32:35], s46 offen offset:1024  lds
    buffer_load_dwordx4 v16, s[32:35], s46 offen offset:2048  lds
    buffer_load_dwordx4 v17, s[32:35], s46 offen offset:3072  lds
    s_mov_b32 m0, 108544
    s_nop 0
    buffer_load_dwordx4 v18, s[32:35], s46 offen offset:0  lds
    buffer_load_dwordx4 v19, s[32:35], s46 offen offset:1024  lds
    s_add_u32 s46, s46, 294912
    s_cmp_ge_u32 s46, s47
    s_cselect_b32 s44, 5308416, 0
    s_sub_u32 s46, s46, s44
    s_waitcnt vmcnt(18)
    s_barrier
    s_mov_b32 m0, 160768
    s_nop 0
    buffer_load_dwordx4 v38, s[28:31], s48 offen sc1 lds
    s_mov_b32 m0, 161792
    s_nop 0
    buffer_load_dwordx4 v38, s[28:31], s48 offen offset:1024 sc1 lds
    s_add_u32 s48, s48, 2048
    s_cmp_ge_u32 s48, s49
    s_cselect_b32 s44, 36864, 0
    s_sub_u32 s48, s48, s44
    s_mov_b32 m0, 129024
    s_nop 0
    buffer_load_dwordx4 v2, s[32:35], s46 offen offset:0  lds
    buffer_load_dwordx4 v3, s[32:35], s46 offen offset:1024  lds
    buffer_load_dwordx4 v4, s[32:35], s46 offen offset:2048  lds
    buffer_load_dwordx4 v5, s[32:35], s46 offen offset:3072  lds
    s_mov_b32 m0, 133120
    s_nop 0
    buffer_load_dwordx4 v6, s[32:35], s46 offen offset:0  lds
    buffer_load_dwordx4 v7, s[32:35], s46 offen offset:1024  lds
    buffer_load_dwordx4 v8, s[32:35], s46 offen offset:2048  lds
    buffer_load_dwordx4 v9, s[32:35], s46 offen offset:3072  lds
    s_mov_b32 m0, 137216
    s_nop 0
    buffer_load_dwordx4 v10, s[32:35], s46 offen offset:0  lds
    buffer_load_dwordx4 v11, s[32:35], s46 offen offset:1024  lds
    buffer_load_dwordx4 v12, s[32:35], s46 offen offset:2048  lds
    buffer_load_dwordx4 v13, s[32:35], s46 offen offset:3072  lds
    s_mov_b32 m0, 141312
    s_nop 0
    buffer_load_dwordx4 v14, s[32:35], s46 offen offset:0  lds
    buffer_load_dwordx4 v15, s[32:35], s46 offen offset:1024  lds
    buffer_load_dwordx4 v16, s[32:35], s46 offen offset:2048  lds
    buffer_load_dwordx4 v17, s[32:35], s46 offen offset:3072  lds
    s_mov_b32 m0, 145408
    s_nop 0
    buffer_load_dwordx4 v18, s[32:35], s46 offen offset:0  lds
    buffer_load_dwordx4 v19, s[32:35], s46 offen offset:1024  lds
    s_add_u32 s46, s46, 294912
    s_cmp_ge_u32 s46, s47
    s_cselect_b32 s44, 5308416, 0
    s_sub_u32 s46, s46, s44
    s_waitcnt vmcnt(20)
    s_barrier
    s_mov_b32 m0, 148480
    s_nop 0
    buffer_load_dwordx4 v38, s[28:31], s48 offen sc1 lds
    s_mov_b32 m0, 149504
    s_nop 0
    buffer_load_dwordx4 v38, s[28:31], s48 offen offset:1024 sc1 lds
    s_add_u32 s48, s48, 2048
    s_cmp_ge_u32 s48, s49
    s_cselect_b32 s44, 36864, 0
    s_sub_u32 s48, s48, s44
    s_mov_b32 m0, 18432
    s_nop 0
    buffer_load_dwordx4 v2, s[32:35], s46 offen offset:0  lds
    buffer_load_dwordx4 v3, s[32:35], s46 offen offset:1024  lds
    buffer_load_dwordx4 v4, s[32:35], s46 offen offset:2048  lds
    buffer_load_dwordx4 v5, s[32:35], s46 offen offset:3072  lds
    s_mov_b32 m0, 22528
    s_nop 0
    buffer_load_dwordx4 v6, s[32:35], s46 offen offset:0  lds
    buffer_load_dwordx4 v7, s[32:35], s46 offen offset:1024  lds
    buffer_load_dwordx4 v8, s[32:35], s46 offen offset:2048  lds
    buffer_load_dwordx4 v9, s[32:35], s46 offen offset:3072  lds
    s_mov_b32 m0, 26624
    s_nop 0
    buffer_load_dwordx4 v10, s[32:35], s46 offen offset:0  lds
    buffer_load_dwordx4 v11, s[32:35], s46 offen offset:1024  lds
    buffer_load_dwordx4 v12, s[32:35], s46 offen offset:2048  lds
    buffer_load_dwordx4 v13, s[32:35], s46 offen offset:3072  lds
    s_mov_b32 m0, 30720
    s_nop 0
    buffer_load_dwordx4 v14, s[32:35], s46 offen offset:0  lds
    buffer_load_dwordx4 v15, s[32:35], s46 offen offset:1024  lds
    buffer_load_dwordx4 v16, s[32:35], s46 offen offset:2048  lds
    buffer_load_dwordx4 v17, s[32:35], s46 offen offset:3072  lds
    s_mov_b32 m0, 34816
    s_nop 0
    buffer_load_dwordx4 v18, s[32:35], s46 offen offset:0  lds
    buffer_load_dwordx4 v19, s[32:35], s46 offen offset:1024  lds
    s_add_u32 s46, s46, 294912
    s_cmp_ge_u32 s46, s47
    s_cselect_b32 s44, 5308416, 0
    s_sub_u32 s46, s46, s44
    s_waitcnt vmcnt(20)
    s_barrier
    s_mov_b32 m0, 152576
    s_nop 0
    buffer_load_dwordx4 v38, s[28:31], s48 offen sc1 lds
    s_mov_b32 m0, 153600
    s_nop 0
    buffer_load_dwordx4 v38, s[28:31], s48 offen offset:1024 sc1 lds
    s_add_u32 s48, s48, 2048
    s_cmp_ge_u32 s48, s49
    s_cselect_b32 s44, 36864, 0
    s_sub_u32 s48, s48, s44
    s_mov_b32 m0, 55296
    s_nop 0
    buffer_load_dwordx4 v2, s[32:35], s46 offen offset:0  lds
    buffer_load_dwordx4 v3, s[32:35], s46 offen offset:1024  lds
    buffer_load_dwordx4 v4, s[32:35], s46 offen offset:2048  lds
    buffer_load_dwordx4 v5, s[32:35], s46 offen offset:3072  lds
    s_mov_b32 m0, 59392
    s_nop 0
    buffer_load_dwordx4 v6, s[32:35], s46 offen offset:0  lds
    buffer_load_dwordx4 v7, s[32:35], s46 offen offset:1024  lds
    buffer_load_dwordx4 v8, s[32:35], s46 offen offset:2048  lds
    buffer_load_dwordx4 v9, s[32:35], s46 offen offset:3072  lds
    s_mov_b32 m0, 63488
    s_nop 0
    buffer_load_dwordx4 v10, s[32:35], s46 offen offset:0  lds
    buffer_load_dwordx4 v11, s[32:35], s46 offen offset:1024  lds
    buffer_load_dwordx4 v12, s[32:35], s46 offen offset:2048  lds
    buffer_load_dwordx4 v13, s[32:35], s46 offen offset:3072  lds
    s_mov_b32 m0, 67584
    s_nop 0
    buffer_load_dwordx4 v14, s[32:35], s46 offen offset:0  lds
    buffer_load_dwordx4 v15, s[32:35], s46 offen offset:1024  lds
    buffer_load_dwordx4 v16, s[32:35], s46 offen offset:2048  lds
    buffer_load_dwordx4 v17, s[32:35], s46 offen offset:3072  lds
    s_mov_b32 m0, 71680
    s_nop 0
    buffer_load_dwordx4 v18, s[32:35], s46 offen offset:0  lds
    buffer_load_dwordx4 v19, s[32:35], s46 offen offset:1024  lds
    s_add_u32 s46, s46, 294912
    s_cmp_ge_u32 s46, s47
    s_cselect_b32 s44, 5308416, 0
    s_sub_u32 s46, s46, s44
    s_waitcnt vmcnt(20)
    s_barrier
    s_mov_b32 m0, 156672
    s_nop 0
    buffer_load_dwordx4 v38, s[28:31], s48 offen sc1 lds
    s_mov_b32 m0, 157696
    s_nop 0
    buffer_load_dwordx4 v38, s[28:31], s48 offen offset:1024 sc1 lds
    s_add_u32 s48, s48, 2048
    s_cmp_ge_u32 s48, s49
    s_cselect_b32 s44, 36864, 0
    s_sub_u32 s48, s48, s44
    s_mov_b32 m0, 92160
    s_nop 0
    buffer_load_dwordx4 v2, s[32:35], s46 offen offset:0  lds
    buffer_load_dwordx4 v3, s[32:35], s46 offen offset:1024  lds
    buffer_load_dwordx4 v4, s[32:35], s46 offen offset:2048  lds
    buffer_load_dwordx4 v5, s[32:35], s46 offen offset:3072  lds
    s_mov_b32 m0, 96256
    s_nop 0
    buffer_load_dwordx4 v6, s[32:35], s46 offen offset:0  lds
    buffer_load_dwordx4 v7, s[32:35], s46 offen offset:1024  lds
    buffer_load_dwordx4 v8, s[32:35], s46 offen offset:2048  lds
    buffer_load_dwordx4 v9, s[32:35], s46 offen offset:3072  lds
    s_mov_b32 m0, 100352
    s_nop 0
    buffer_load_dwordx4 v10, s[32:35], s46 offen offset:0  lds
    buffer_load_dwordx4 v11, s[32:35], s46 offen offset:1024  lds
    buffer_load_dwordx4 v12, s[32:35], s46 offen offset:2048  lds
    buffer_load_dwordx4 v13, s[32:35], s46 offen offset:3072  lds
    s_mov_b32 m0, 104448
    s_nop 0
    buffer_load_dwordx4 v14, s[32:35], s46 offen offset:0  lds
    buffer_load_dwordx4 v15, s[32:35], s46 offen offset:1024  lds
    buffer_load_dwordx4 v16, s[32:35], s46 offen offset:2048  lds
    buffer_load_dwordx4 v17, s[32:35], s46 offen offset:3072  lds
    s_mov_b32 m0, 108544
    s_nop 0
    buffer_load_dwordx4 v18, s[32:35], s46 offen offset:0  lds
    buffer_load_dwordx4 v19, s[32:35], s46 offen offset:1024  lds
    s_add_u32 s46, s46, 294912
    s_cmp_ge_u32 s46, s47
    s_cselect_b32 s44, 5308416, 0
    s_sub_u32 s46, s46, s44
    s_waitcnt vmcnt(20)
    s_barrier
    s_mov_b32 m0, 160768
    s_nop 0
    buffer_load_dwordx4 v38, s[28:31], s48 offen sc1 lds
    s_mov_b32 m0, 161792
    s_nop 0
    buffer_load_dwordx4 v38, s[28:31], s48 offen offset:1024 sc1 lds
    s_add_u32 s48, s48, 2048
    s_cmp_ge_u32 s48, s49
    s_cselect_b32 s44, 36864, 0
    s_sub_u32 s48, s48, s44
    s_mov_b32 m0, 129024
    s_nop 0
    buffer_load_dwordx4 v2, s[32:35], s46 offen offset:0  lds
    buffer_load_dwordx4 v3, s[32:35], s46 offen offset:1024  lds
    buffer_load_dwordx4 v4, s[32:35], s46 offen offset:2048  lds
    buffer_load_dwordx4 v5, s[32:35], s46 offen offset:3072  lds
    s_mov_b32 m0, 133120
    s_nop 0
    buffer_load_dwordx4 v6, s[32:35], s46 offen offset:0  lds
    buffer_load_dwordx4 v7, s[32:35], s46 offen offset:1024  lds
    buffer_load_dwordx4 v8, s[32:35], s46 offen offset:2048  lds
    buffer_load_dwordx4 v9, s[32:35], s46 offen offset:3072  lds
    s_mov_b32 m0, 137216
    s_nop 0
    buffer_load_dwordx4 v10, s[32:35], s46 offen offset:0  lds
    buffer_load_dwordx4 v11, s[32:35], s46 offen offset:1024  lds
    buffer_load_dwordx4 v12, s[32:35], s46 offen offset:2048  lds
    buffer_load_dwordx4 v13, s[32:35], s46 offen offset:3072  lds
    s_mov_b32 m0, 141312
    s_nop 0
    buffer_load_dwordx4 v14, s[32:35], s46 offen offset:0  lds
    buffer_load_dwordx4 v15, s[32:35], s46 offen offset:1024  lds
    buffer_load_dwordx4 v16, s[32:35], s46 offen offset:2048  lds
    buffer_load_dwordx4 v17, s[32:35], s46 offen offset:3072  lds
    s_mov_b32 m0, 145408
    s_nop 0
    buffer_load_dwordx4 v18, s[32:35], s46 offen offset:0  lds
    buffer_load_dwordx4 v19, s[32:35], s46 offen offset:1024  lds
    s_add_u32 s46, s46, 294912
    s_cmp_ge_u32 s46, s47
    s_cselect_b32 s44, 5308416, 0
    s_sub_u32 s46, s46, s44
    s_waitcnt vmcnt(20)
    s_barrier
    s_mov_b32 m0, 148480
    s_nop 0
    buffer_load_dwordx4 v38, s[28:31], s48 offen sc1 lds
    s_mov_b32 m0, 149504
    s_nop 0
    buffer_load_dwordx4 v38, s[28:31], s48 offen offset:1024 sc1 lds
    s_add_u32 s48, s48, 2048
    s_cmp_ge_u32 s48, s49
    s_cselect_b32 s44, 36864, 0
    s_sub_u32 s48, s48, s44
    s_mov_b32 m0, 18432
    s_nop 0
    buffer_load_dwordx4 v2, s[32:35], s46 offen offset:0  lds
    buffer_load_dwordx4 v3, s[32:35], s46 offen offset:1024  lds
    buffer_load_dwordx4 v4, s[32:35], s46 offen offset:2048  lds
    buffer_load_dwordx4 v5, s[32:35], s46 offen offset:3072  lds
    s_mov_b32 m0, 22528
    s_nop 0
    buffer_load_dwordx4 v6, s[32:35], s46 offen offset:0  lds
    buffer_load_dwordx4 v7, s[32:35], s46 offen offset:1024  lds
    buffer_load_dwordx4 v8, s[32:35], s46 offen offset:2048  lds
    buffer_load_dwordx4 v9, s[32:35], s46 offen offset:3072  lds
    s_mov_b32 m0, 26624
    s_nop 0
    buffer_load_dwordx4 v10, s[32:35], s46 offen offset:0  lds
    buffer_load_dwordx4 v11, s[32:35], s46 offen offset:1024  lds
    buffer_load_dwordx4 v12, s[32:35], s46 offen offset:2048  lds
    buffer_load_dwordx4 v13, s[32:35], s46 offen offset:3072  lds
    s_mov_b32 m0, 30720
    s_nop 0
    buffer_load_dwordx4 v14, s[32:35], s46 offen offset:0  lds
    buffer_load_dwordx4 v15, s[32:35], s46 offen offset:1024  lds
    buffer_load_dwordx4 v16, s[32:35], s46 offen offset:2048  lds
    buffer_load_dwordx4 v17, s[32:35], s46 offen offset:3072  lds
    s_mov_b32 m0, 34816
    s_nop 0
    buffer_load_dwordx4 v18, s[32:35], s46 offen offset:0  lds
    buffer_load_dwordx4 v19, s[32:35], s46 offen offset:1024  lds
    s_add_u32 s46, s46, 294912
    s_cmp_ge_u32 s46, s47
    s_cselect_b32 s44, 5308416, 0
    s_sub_u32 s46, s46, s44
    s_waitcnt vmcnt(20)
    s_barrier
    s_mov_b32 m0, 152576
    s_nop 0
    buffer_load_dwordx4 v38, s[28:31], s48 offen sc1 lds
    s_mov_b32 m0, 153600
    s_nop 0
    buffer_load_dwordx4 v38, s[28:31], s48 offen offset:1024 sc1 lds
    s_add_u32 s48, s48, 2048
    s_cmp_ge_u32 s48, s49
    s_cselect_b32 s44, 36864, 0
    s_sub_u32 s48, s48, s44
    s_mov_b32 m0, 55296
    s_nop 0
    buffer_load_dwordx4 v2, s[32:35], s46 offen offset:0  lds
    buffer_load_dwordx4 v3, s[32:35], s46 offen offset:1024  lds
    buffer_load_dwordx4 v4, s[32:35], s46 offen offset:2048  lds
    buffer_load_dwordx4 v5, s[32:35], s46 offen offset:3072  lds
    s_mov_b32 m0, 59392
    s_nop 0
    buffer_load_dwordx4 v6, s[32:35], s46 offen offset:0  lds
    buffer_load_dwordx4 v7, s[32:35], s46 offen offset:1024  lds
    buffer_load_dwordx4 v8, s[32:35], s46 offen offset:2048  lds
    buffer_load_dwordx4 v9, s[32:35], s46 offen offset:3072  lds
    s_mov_b32 m0, 63488
    s_nop 0
    buffer_load_dwordx4 v10, s[32:35], s46 offen offset:0  lds
    buffer_load_dwordx4 v11, s[32:35], s46 offen offset:1024  lds
    buffer_load_dwordx4 v12, s[32:35], s46 offen offset:2048  lds
    buffer_load_dwordx4 v13, s[32:35], s46 offen offset:3072  lds
    s_mov_b32 m0, 67584
    s_nop 0
    buffer_load_dwordx4 v14, s[32:35], s46 offen offset:0  lds
    buffer_load_dwordx4 v15, s[32:35], s46 offen offset:1024  lds
    buffer_load_dwordx4 v16, s[32:35], s46 offen offset:2048  lds
    buffer_load_dwordx4 v17, s[32:35], s46 offen offset:3072  lds
    s_mov_b32 m0, 71680
    s_nop 0
    buffer_load_dwordx4 v18, s[32:35], s46 offen offset:0  lds
    buffer_load_dwordx4 v19, s[32:35], s46 offen offset:1024  lds
    s_add_u32 s46, s46, 294912
    s_cmp_ge_u32 s46, s47
    s_cselect_b32 s44, 5308416, 0
    s_sub_u32 s46, s46, s44
    s_waitcnt vmcnt(20)
    s_barrier
    s_mov_b32 m0, 156672
    s_nop 0
    buffer_load_dwordx4 v38, s[28:31], s48 offen sc1 lds
    s_mov_b32 m0, 157696
    s_nop 0
    buffer_load_dwordx4 v38, s[28:31], s48 offen offset:1024 sc1 lds
    s_add_u32 s48, s48, 2048
    s_cmp_ge_u32 s48, s49
    s_cselect_b32 s44, 36864, 0
    s_sub_u32 s48, s48, s44
    s_mov_b32 m0, 92160
    s_nop 0
    buffer_load_dwordx4 v2, s[32:35], s46 offen offset:0  lds
    buffer_load_dwordx4 v3, s[32:35], s46 offen offset:1024  lds
    buffer_load_dwordx4 v4, s[32:35], s46 offen offset:2048  lds
    buffer_load_dwordx4 v5, s[32:35], s46 offen offset:3072  lds
    s_mov_b32 m0, 96256
    s_nop 0
    buffer_load_dwordx4 v6, s[32:35], s46 offen offset:0  lds
    buffer_load_dwordx4 v7, s[32:35], s46 offen offset:1024  lds
    buffer_load_dwordx4 v8, s[32:35], s46 offen offset:2048  lds
    buffer_load_dwordx4 v9, s[32:35], s46 offen offset:3072  lds
    s_mov_b32 m0, 100352
    s_nop 0
    buffer_load_dwordx4 v10, s[32:35], s46 offen offset:0  lds
    buffer_load_dwordx4 v11, s[32:35], s46 offen offset:1024  lds
    buffer_load_dwordx4 v12, s[32:35], s46 offen offset:2048  lds
    buffer_load_dwordx4 v13, s[32:35], s46 offen offset:3072  lds
    s_mov_b32 m0, 104448
    s_nop 0
    buffer_load_dwordx4 v14, s[32:35], s46 offen offset:0  lds
    buffer_load_dwordx4 v15, s[32:35], s46 offen offset:1024  lds
    buffer_load_dwordx4 v16, s[32:35], s46 offen offset:2048  lds
    buffer_load_dwordx4 v17, s[32:35], s46 offen offset:3072  lds
    s_mov_b32 m0, 108544
    s_nop 0
    buffer_load_dwordx4 v18, s[32:35], s46 offen offset:0  lds
    buffer_load_dwordx4 v19, s[32:35], s46 offen offset:1024  lds
    s_add_u32 s46, s46, 294912
    s_cmp_ge_u32 s46, s47
    s_cselect_b32 s44, 5308416, 0
    s_sub_u32 s46, s46, s44
    s_waitcnt vmcnt(20)
    s_barrier
    s_mov_b32 m0, 160768
    s_nop 0
    buffer_load_dwordx4 v38, s[28:31], s48 offen sc1 lds
    s_mov_b32 m0, 161792
    s_nop 0
    buffer_load_dwordx4 v38, s[28:31], s48 offen offset:1024 sc1 lds
    s_add_u32 s48, s48, 2048
    s_cmp_ge_u32 s48, s49
    s_cselect_b32 s44, 36864, 0
    s_sub_u32 s48, s48, s44
    s_mov_b32 m0, 129024
    s_nop 0
    buffer_load_dwordx4 v2, s[32:35], s46 offen offset:0  lds
    buffer_load_dwordx4 v3, s[32:35], s46 offen offset:1024  lds
    buffer_load_dwordx4 v4, s[32:35], s46 offen offset:2048  lds
    buffer_load_dwordx4 v5, s[32:35], s46 offen offset:3072  lds
    s_mov_b32 m0, 133120
    s_nop 0
    buffer_load_dwordx4 v6, s[32:35], s46 offen offset:0  lds
    buffer_load_dwordx4 v7, s[32:35], s46 offen offset:1024  lds
    buffer_load_dwordx4 v8, s[32:35], s46 offen offset:2048  lds
    buffer_load_dwordx4 v9, s[32:35], s46 offen offset:3072  lds
    s_mov_b32 m0, 137216
    s_nop 0
    buffer_load_dwordx4 v10, s[32:35], s46 offen offset:0  lds
    buffer_load_dwordx4 v11, s[32:35], s46 offen offset:1024  lds
    buffer_load_dwordx4 v12, s[32:35], s46 offen offset:2048  lds
    buffer_load_dwordx4 v13, s[32:35], s46 offen offset:3072  lds
    s_mov_b32 m0, 141312
    s_nop 0
    buffer_load_dwordx4 v14, s[32:35], s46 offen offset:0  lds
    buffer_load_dwordx4 v15, s[32:35], s46 offen offset:1024  lds
    buffer_load_dwordx4 v16, s[32:35], s46 offen offset:2048  lds
    buffer_load_dwordx4 v17, s[32:35], s46 offen offset:3072  lds
    s_mov_b32 m0, 145408
    s_nop 0
    buffer_load_dwordx4 v18, s[32:35], s46 offen offset:0  lds
    buffer_load_dwordx4 v19, s[32:35], s46 offen offset:1024  lds
    s_add_u32 s46, s46, 294912
    s_cmp_ge_u32 s46, s47
    s_cselect_b32 s44, 5308416, 0
    s_sub_u32 s46, s46, s44
    s_waitcnt vmcnt(20)
    s_barrier
    s_mov_b32 m0, 148480
    s_nop 0
    buffer_load_dwordx4 v38, s[28:31], s48 offen sc1 lds
    s_mov_b32 m0, 149504
    s_nop 0
    buffer_load_dwordx4 v38, s[28:31], s48 offen offset:1024 sc1 lds
    s_add_u32 s48, s48, 2048
    s_cmp_ge_u32 s48, s49
    s_cselect_b32 s44, 36864, 0
    s_sub_u32 s48, s48, s44
    s_mov_b32 m0, 18432
    s_nop 0
    buffer_load_dwordx4 v2, s[32:35], s46 offen offset:0  lds
    buffer_load_dwordx4 v3, s[32:35], s46 offen offset:1024  lds
    buffer_load_dwordx4 v4, s[32:35], s46 offen offset:2048  lds
    buffer_load_dwordx4 v5, s[32:35], s46 offen offset:3072  lds
    s_mov_b32 m0, 22528
    s_nop 0
    buffer_load_dwordx4 v6, s[32:35], s46 offen offset:0  lds
    buffer_load_dwordx4 v7, s[32:35], s46 offen offset:1024  lds
    buffer_load_dwordx4 v8, s[32:35], s46 offen offset:2048  lds
    buffer_load_dwordx4 v9, s[32:35], s46 offen offset:3072  lds
    s_mov_b32 m0, 26624
    s_nop 0
    buffer_load_dwordx4 v10, s[32:35], s46 offen offset:0  lds
    buffer_load_dwordx4 v11, s[32:35], s46 offen offset:1024  lds
    buffer_load_dwordx4 v12, s[32:35], s46 offen offset:2048  lds
    buffer_load_dwordx4 v13, s[32:35], s46 offen offset:3072  lds
    s_mov_b32 m0, 30720
    s_nop 0
    buffer_load_dwordx4 v14, s[32:35], s46 offen offset:0  lds
    buffer_load_dwordx4 v15, s[32:35], s46 offen offset:1024  lds
    buffer_load_dwordx4 v16, s[32:35], s46 offen offset:2048  lds
    buffer_load_dwordx4 v17, s[32:35], s46 offen offset:3072  lds
    s_mov_b32 m0, 34816
    s_nop 0
    buffer_load_dwordx4 v18, s[32:35], s46 offen offset:0  lds
    buffer_load_dwordx4 v19, s[32:35], s46 offen offset:1024  lds
    s_add_u32 s46, s46, 294912
    s_cmp_ge_u32 s46, s47
    s_cselect_b32 s44, 5308416, 0
    s_sub_u32 s46, s46, s44
    s_waitcnt vmcnt(20)
    s_barrier
    s_mov_b32 m0, 152576
    s_nop 0
    buffer_load_dwordx4 v38, s[28:31], s48 offen sc1 lds
    s_mov_b32 m0, 153600
    s_nop 0
    buffer_load_dwordx4 v38, s[28:31], s48 offen offset:1024 sc1 lds
    s_add_u32 s48, s48, 2048
    s_cmp_ge_u32 s48, s49
    s_cselect_b32 s44, 36864, 0
    s_sub_u32 s48, s48, s44
    s_mov_b32 m0, 55296
    s_nop 0
    buffer_load_dwordx4 v2, s[32:35], s46 offen offset:0  lds
    buffer_load_dwordx4 v3, s[32:35], s46 offen offset:1024  lds
    buffer_load_dwordx4 v4, s[32:35], s46 offen offset:2048  lds
    buffer_load_dwordx4 v5, s[32:35], s46 offen offset:3072  lds
    s_mov_b32 m0, 59392
    s_nop 0
    buffer_load_dwordx4 v6, s[32:35], s46 offen offset:0  lds
    buffer_load_dwordx4 v7, s[32:35], s46 offen offset:1024  lds
    buffer_load_dwordx4 v8, s[32:35], s46 offen offset:2048  lds
    buffer_load_dwordx4 v9, s[32:35], s46 offen offset:3072  lds
    s_mov_b32 m0, 63488
    s_nop 0
    buffer_load_dwordx4 v10, s[32:35], s46 offen offset:0  lds
    buffer_load_dwordx4 v11, s[32:35], s46 offen offset:1024  lds
    buffer_load_dwordx4 v12, s[32:35], s46 offen offset:2048  lds
    buffer_load_dwordx4 v13, s[32:35], s46 offen offset:3072  lds
    s_mov_b32 m0, 67584
    s_nop 0
    buffer_load_dwordx4 v14, s[32:35], s46 offen offset:0  lds
    buffer_load_dwordx4 v15, s[32:35], s46 offen offset:1024  lds
    buffer_load_dwordx4 v16, s[32:35], s46 offen offset:2048  lds
    buffer_load_dwordx4 v17, s[32:35], s46 offen offset:3072  lds
    s_mov_b32 m0, 71680
    s_nop 0
    buffer_load_dwordx4 v18, s[32:35], s46 offen offset:0  lds
    buffer_load_dwordx4 v19, s[32:35], s46 offen offset:1024  lds
    s_add_u32 s46, s46, 294912
    s_cmp_ge_u32 s46, s47
    s_cselect_b32 s44, 5308416, 0
    s_sub_u32 s46, s46, s44
    s_waitcnt vmcnt(20)
    s_barrier
    s_mov_b32 m0, 156672
    s_nop 0
    buffer_load_dwordx4 v38, s[28:31], s48 offen sc1 lds
    s_mov_b32 m0, 157696
    s_nop 0
    buffer_load_dwordx4 v38, s[28:31], s48 offen offset:1024 sc1 lds
    s_add_u32 s48, s48, 2048
    s_cmp_ge_u32 s48, s49
    s_cselect_b32 s44, 36864, 0
    s_sub_u32 s48, s48, s44
    s_mov_b32 m0, 92160
    s_nop 0
    buffer_load_dwordx4 v2, s[32:35], s46 offen offset:0  lds
    buffer_load_dwordx4 v3, s[32:35], s46 offen offset:1024  lds
    buffer_load_dwordx4 v4, s[32:35], s46 offen offset:2048  lds
    buffer_load_dwordx4 v5, s[32:35], s46 offen offset:3072  lds
    s_mov_b32 m0, 96256
    s_nop 0
    buffer_load_dwordx4 v6, s[32:35], s46 offen offset:0  lds
    buffer_load_dwordx4 v7, s[32:35], s46 offen offset:1024  lds
    buffer_load_dwordx4 v8, s[32:35], s46 offen offset:2048  lds
    buffer_load_dwordx4 v9, s[32:35], s46 offen offset:3072  lds
    s_mov_b32 m0, 100352
    s_nop 0
    buffer_load_dwordx4 v10, s[32:35], s46 offen offset:0  lds
    buffer_load_dwordx4 v11, s[32:35], s46 offen offset:1024  lds
    buffer_load_dwordx4 v12, s[32:35], s46 offen offset:2048  lds
    buffer_load_dwordx4 v13, s[32:35], s46 offen offset:3072  lds
    s_mov_b32 m0, 104448
    s_nop 0
    buffer_load_dwordx4 v14, s[32:35], s46 offen offset:0  lds
    buffer_load_dwordx4 v15, s[32:35], s46 offen offset:1024  lds
    buffer_load_dwordx4 v16, s[32:35], s46 offen offset:2048  lds
    buffer_load_dwordx4 v17, s[32:35], s46 offen offset:3072  lds
    s_mov_b32 m0, 108544
    s_nop 0
    buffer_load_dwordx4 v18, s[32:35], s46 offen offset:0  lds
    buffer_load_dwordx4 v19, s[32:35], s46 offen offset:1024  lds
    s_add_u32 s46, s46, 294912
    s_cmp_ge_u32 s46, s47
    s_cselect_b32 s44, 5308416, 0
    s_sub_u32 s46, s46, s44
    s_waitcnt vmcnt(20)
    s_barrier
    s_mov_b32 m0, 160768
    s_nop 0
    buffer_load_dwordx4 v38, s[28:31], s48 offen sc1 lds
    s_mov_b32 m0, 161792
    s_nop 0
    buffer_load_dwordx4 v38, s[28:31], s48 offen offset:1024 sc1 lds
    s_add_u32 s48, s48, 2048
    s_cmp_ge_u32 s48, s49
    s_cselect_b32 s44, 36864, 0
    s_sub_u32 s48, s48, s44
    s_mov_b32 m0, 129024
    s_nop 0
    buffer_load_dwordx4 v2, s[32:35], s46 offen offset:0  lds
    buffer_load_dwordx4 v3, s[32:35], s46 offen offset:1024  lds
    buffer_load_dwordx4 v4, s[32:35], s46 offen offset:2048  lds
    buffer_load_dwordx4 v5, s[32:35], s46 offen offset:3072  lds
    s_mov_b32 m0, 133120
    s_nop 0
    buffer_load_dwordx4 v6, s[32:35], s46 offen offset:0  lds
    buffer_load_dwordx4 v7, s[32:35], s46 offen offset:1024  lds
    buffer_load_dwordx4 v8, s[32:35], s46 offen offset:2048  lds
    buffer_load_dwordx4 v9, s[32:35], s46 offen offset:3072  lds
    s_mov_b32 m0, 137216
    s_nop 0
    buffer_load_dwordx4 v10, s[32:35], s46 offen offset:0  lds
    buffer_load_dwordx4 v11, s[32:35], s46 offen offset:1024  lds
    buffer_load_dwordx4 v12, s[32:35], s46 offen offset:2048  lds
    buffer_load_dwordx4 v13, s[32:35], s46 offen offset:3072  lds
    s_mov_b32 m0, 141312
    s_nop 0
    buffer_load_dwordx4 v14, s[32:35], s46 offen offset:0  lds
    buffer_load_dwordx4 v15, s[32:35], s46 offen offset:1024  lds
    buffer_load_dwordx4 v16, s[32:35], s46 offen offset:2048  lds
    buffer_load_dwordx4 v17, s[32:35], s46 offen offset:3072  lds
    s_mov_b32 m0, 145408
    s_nop 0
    buffer_load_dwordx4 v18, s[32:35], s46 offen offset:0  lds
    buffer_load_dwordx4 v19, s[32:35], s46 offen offset:1024  lds
    s_add_u32 s46, s46, 294912
    s_cmp_ge_u32 s46, s47
    s_cselect_b32 s44, 5308416, 0
    s_sub_u32 s46, s46, s44
    s_waitcnt vmcnt(20)
    s_barrier
    s_mov_b32 m0, 148480
    s_nop 0
    buffer_load_dwordx4 v38, s[28:31], s48 offen sc1 lds
    s_mov_b32 m0, 149504
    s_nop 0
    buffer_load_dwordx4 v38, s[28:31], s48 offen offset:1024 sc1 lds
    s_add_u32 s48, s48, 2048
    s_cmp_ge_u32 s48, s49
    s_cselect_b32 s44, 36864, 0
    s_sub_u32 s48, s48, s44
    s_mov_b32 m0, 18432
    s_nop 0
    buffer_load_dwordx4 v2, s[32:35], s46 offen offset:0  lds
    buffer_load_dwordx4 v3, s[32:35], s46 offen offset:1024  lds
    buffer_load_dwordx4 v4, s[32:35], s46 offen offset:2048  lds
    buffer_load_dwordx4 v5, s[32:35], s46 offen offset:3072  lds
    s_mov_b32 m0, 22528
    s_nop 0
    buffer_load_dwordx4 v6, s[32:35], s46 offen offset:0  lds
    buffer_load_dwordx4 v7, s[32:35], s46 offen offset:1024  lds
    buffer_load_dwordx4 v8, s[32:35], s46 offen offset:2048  lds
    buffer_load_dwordx4 v9, s[32:35], s46 offen offset:3072  lds
    s_mov_b32 m0, 26624
    s_nop 0
    buffer_load_dwordx4 v10, s[32:35], s46 offen offset:0  lds
    buffer_load_dwordx4 v11, s[32:35], s46 offen offset:1024  lds
    buffer_load_dwordx4 v12, s[32:35], s46 offen offset:2048  lds
    buffer_load_dwordx4 v13, s[32:35], s46 offen offset:3072  lds
    s_mov_b32 m0, 30720
    s_nop 0
    buffer_load_dwordx4 v14, s[32:35], s46 offen offset:0  lds
    buffer_load_dwordx4 v15, s[32:35], s46 offen offset:1024  lds
    buffer_load_dwordx4 v16, s[32:35], s46 offen offset:2048  lds
    buffer_load_dwordx4 v17, s[32:35], s46 offen offset:3072  lds
    s_mov_b32 m0, 34816
    s_nop 0
    buffer_load_dwordx4 v18, s[32:35], s46 offen offset:0  lds
    buffer_load_dwordx4 v19, s[32:35], s46 offen offset:1024  lds
    s_add_u32 s46, s46, 294912
    s_cmp_ge_u32 s46, s47
    s_cselect_b32 s44, 5308416, 0
    s_sub_u32 s46, s46, s44
    s_waitcnt vmcnt(20)
    s_barrier
    s_mov_b32 m0, 152576
    s_nop 0
    buffer_load_dwordx4 v38, s[28:31], s48 offen sc1 lds
    s_mov_b32 m0, 153600
    s_nop 0
    buffer_load_dwordx4 v38, s[28:31], s48 offen offset:1024 sc1 lds
    s_add_u32 s48, s48, 2048
    s_cmp_ge_u32 s48, s49
    s_cselect_b32 s44, 36864, 0
    s_sub_u32 s48, s48, s44
    s_mov_b32 m0, 55296
    s_nop 0
    buffer_load_dwordx4 v2, s[32:35], s46 offen offset:0  lds
    buffer_load_dwordx4 v3, s[32:35], s46 offen offset:1024  lds
    buffer_load_dwordx4 v4, s[32:35], s46 offen offset:2048  lds
    buffer_load_dwordx4 v5, s[32:35], s46 offen offset:3072  lds
    s_mov_b32 m0, 59392
    s_nop 0
    buffer_load_dwordx4 v6, s[32:35], s46 offen offset:0  lds
    buffer_load_dwordx4 v7, s[32:35], s46 offen offset:1024  lds
    buffer_load_dwordx4 v8, s[32:35], s46 offen offset:2048  lds
    buffer_load_dwordx4 v9, s[32:35], s46 offen offset:3072  lds
    s_mov_b32 m0, 63488
    s_nop 0
    buffer_load_dwordx4 v10, s[32:35], s46 offen offset:0  lds
    buffer_load_dwordx4 v11, s[32:35], s46 offen offset:1024  lds
    buffer_load_dwordx4 v12, s[32:35], s46 offen offset:2048  lds
    buffer_load_dwordx4 v13, s[32:35], s46 offen offset:3072  lds
    s_mov_b32 m0, 67584
    s_nop 0
    buffer_load_dwordx4 v14, s[32:35], s46 offen offset:0  lds
    buffer_load_dwordx4 v15, s[32:35], s46 offen offset:1024  lds
    buffer_load_dwordx4 v16, s[32:35], s46 offen offset:2048  lds
    buffer_load_dwordx4 v17, s[32:35], s46 offen offset:3072  lds
    s_mov_b32 m0, 71680
    s_nop 0
    buffer_load_dwordx4 v18, s[32:35], s46 offen offset:0  lds
    buffer_load_dwordx4 v19, s[32:35], s46 offen offset:1024  lds
    s_add_u32 s46, s46, 294912
    s_cmp_ge_u32 s46, s47
    s_cselect_b32 s44, 5308416, 0
    s_sub_u32 s46, s46, s44
    s_waitcnt vmcnt(20)
    s_barrier
    s_waitcnt vmcnt(0)
    s_barrier
    v_lshrrev_b32 v40, 3, v1
    v_bfe_u32 v41, v1, 4, 1
    v_lshlrev_b32 v41, 2, v41
    v_and_b32 v42, 7, v1
    v_xor_b32 v42, v42, v41
    v_mul_u32_u24 v40, 1152, v40
    v_lshl_add_u32 v2, v42, 4, v40
    v_add_u32 v3, 8192, v2
    v_add_u32 v4, 16384, v2
    v_add_u32 v5, 24576, v2
    v_add_u32 v6, 36864, v2
    v_add_u32 v7, 45056, v2
    v_add_u32 v8, 53248, v2
    v_add_u32 v9, 61440, v2
    v_add_u32 v10, 73728, v2
    v_add_u32 v11, 81920, v2
    v_add_u32 v12, 90112, v2
    v_add_u32 v13, 98304, v2
    v_add_u32 v14, 110592, v2
    v_add_u32 v15, 118784, v2
    v_add_u32 v16, 126976, v2
    v_add_u32 v17, 135168, v2
    v_add_u32 v18, 147456, v2
    v_add_u32 v19, 155648, v2
    s_mov_b32 m0, 129024
    s_nop 0
    buffer_load_dwordx4 v2, s[36:39], s50 offen offset:0  lds
    buffer_load_dwordx4 v3, s[36:39], s50 offen offset:1024  lds
    buffer_load_dwordx4 v4, s[36:39], s50 offen offset:2048  lds
    buffer_load_dwordx4 v5, s[36:39], s50 offen offset:3072  lds
    s_mov_b32 m0, 133120
    s_nop 0
    buffer_load_dwordx4 v6, s[36:39], s50 offen offset:0  lds
    buffer_load_dwordx4 v7, s[36:39], s50 offen offset:1024  lds
    buffer_load_dwordx4 v8, s[36:39], s50 offen offset:2048  lds
    buffer_load_dwordx4 v9, s[36:39], s50 offen offset:3072  lds
    s_mov_b32 m0, 137216
    s_nop 0
    buffer_load_dwordx4 v10, s[36:39], s50 offen offset:0  lds
    buffer_load_dwordx4 v11, s[36:39], s50 offen offset:1024  lds
    buffer_load_dwordx4 v12, s[36:39], s50 offen offset:2048  lds
    buffer_load_dwordx4 v13, s[36:39], s50 offen offset:3072  lds
    s_mov_b32 m0, 141312
    s_nop 0
    buffer_load_dwordx4 v14, s[36:39], s50 offen offset:0  lds
    buffer_load_dwordx4 v15, s[36:39], s50 offen offset:1024  lds
    buffer_load_dwordx4 v16, s[36:39], s50 offen offset:2048  lds
    buffer_load_dwordx4 v17, s[36:39], s50 offen offset:3072  lds
    s_mov_b32 m0, 145408
    s_nop 0
    buffer_load_dwordx4 v18, s[36:39], s50 offen offset:0  lds
    buffer_load_dwordx4 v19, s[36:39], s50 offen offset:1024  lds
    s_barrier
    s_add_u32 s52, s50, 165888
    s_mov_b32 m0, 18432
    s_nop 0
    buffer_load_dwordx4 v2, s[36:39], s52 offen offset:0  lds
    buffer_load_dwordx4 v3, s[36:39], s52 offen offset:1024  lds
    buffer_load_dwordx4 v4, s[36:39], s52 offen offset:2048  lds
    buffer_load_dwordx4 v5, s[36:39], s52 offen offset:3072  lds
    s_mov_b32 m0, 22528
    s_nop 0
    buffer_load_dwordx4 v6, s[36:39], s52 offen offset:0  lds
    buffer_load_dwordx4 v7, s[36:39], s52 offen offset:1024  lds
    buffer_load_dwordx4 v8, s[36:39], s52 offen offset:2048  lds
    buffer_load_dwordx4 v9, s[36:39], s52 offen offset:3072  lds
    s_mov_b32 m0, 26624
    s_nop 0
    buffer_load_dwordx4 v10, s[36:39], s52 offen offset:0  lds
    buffer_load_dwordx4 v11, s[36:39], s52 offen offset:1024  lds
    buffer_load_dwordx4 v12, s[36:39], s52 offen offset:2048  lds
    buffer_load_dwordx4 v13, s[36:39], s52 offen offset:3072  lds
    s_mov_b32 m0, 30720
    s_nop 0
    buffer_load_dwordx4 v14, s[36:39], s52 offen offset:0  lds
    buffer_load_dwordx4 v15, s[36:39], s52 offen offset:1024  lds
    buffer_load_dwordx4 v16, s[36:39], s52 offen offset:2048  lds
    buffer_load_dwordx4 v17, s[36:39], s52 offen offset:3072  lds
    s_mov_b32 m0, 34816
    s_nop 0
    buffer_load_dwordx4 v18, s[36:39], s52 offen offset:0  lds
    buffer_load_dwordx4 v19, s[36:39], s52 offen offset:1024  lds
    s_add_u32 s50, s50, 128
    s_cmp_ge_u32 s50, s51
    s_cselect_b32 s44, 1152, 0
    s_sub_u32 s50, s50, s44
    s_barrier
    s_barrier
    s_waitcnt vmcnt(18)
    s_barrier
    s_waitcnt vmcnt(0)
    s_barrier
    s_mov_b32 m0, 55296
    s_nop 0
    buffer_load_dwordx4 v2, s[36:39], s50 offen offset:0  lds
    buffer_load_dwordx4 v3, s[36:39], s50 offen offset:1024  lds
    buffer_load_dwordx4 v4, s[36:39], s50 offen offset:2048  lds
    buffer_load_dwordx4 v5, s[36:39], s50 offen offset:3072  lds
    s_mov_b32 m0, 59392
    s_nop 0
    buffer_load_dwordx4 v6, s[36:39], s50 offen offset:0  lds
    buffer_load_dwordx4 v7, s[36:39], s50 offen offset:1024  lds
    buffer_load_dwordx4 v8, s[36:39], s50 offen offset:2048  lds
    buffer_load_dwordx4 v9, s[36:39], s50 offen offset:3072  lds
    s_mov_b32 m0, 63488
    s_nop 0
    buffer_load_dwordx4 v10, s[36:39], s50 offen offset:0  lds
    buffer_load_dwordx4 v11, s[36:39], s50 offen offset:1024  lds
    buffer_load_dwordx4 v12, s[36:39], s50 offen offset:2048  lds
    buffer_load_dwordx4 v13, s[36:39], s50 offen offset:3072  lds
    s_mov_b32 m0, 67584
    s_nop 0
    buffer_load_dwordx4 v14, s[36:39], s50 offen offset:0  lds
    buffer_load_dwordx4 v15, s[36:39], s50 offen offset:1024  lds
    buffer_load_dwordx4 v16, s[36:39], s50 offen offset:2048  lds
    buffer_load_dwordx4 v17, s[36:39], s50 offen offset:3072  lds
    s_mov_b32 m0, 71680
    s_nop 0
    buffer_load_dwordx4 v18, s[36:39], s50 offen offset:0  lds
    buffer_load_dwordx4 v19, s[36:39], s50 offen offset:1024  lds
    s_add_u32 s52, s50, 165888
    s_mov_b32 m0, 92160
    s_nop 0
    buffer_load_dwordx4 v2, s[36:39], s52 offen offset:0  lds
    buffer_load_dwordx4 v3, s[36:39], s52 offen offset:1024  lds
    buffer_load_dwordx4 v4, s[36:39], s52 offen offset:2048  lds
    buffer_load_dwordx4 v5, s[36:39], s52 offen offset:3072  lds
    s_mov_b32 m0, 96256
    s_nop 0
    buffer_load_dwordx4 v6, s[36:39], s52 offen offset:0  lds
    buffer_load_dwordx4 v7, s[36:39], s52 offen offset:1024  lds
    buffer_load_dwordx4 v8, s[36:39], s52 offen offset:2048  lds
    buffer_load_dwordx4 v9, s[36:39], s52 offen offset:3072  lds
    s_mov_b32 m0, 100352
    s_nop 0
    buffer_load_dwordx4 v10, s[36:39], s52 offen offset:0  lds
    buffer_load_dwordx4 v11, s[36:39], s52 offen offset:1024  lds
    buffer_load_dwordx4 v12, s[36:39], s52 offen offset:2048  lds
    buffer_load_dwordx4 v13, s[36:39], s52 offen offset:3072  lds
    s_mov_b32 m0, 104448
    s_nop 0
    buffer_load_dwordx4 v14, s[36:39], s52 offen offset:0  lds
    buffer_load_dwordx4 v15, s[36:39], s52 offen offset:1024  lds
    buffer_load_dwordx4 v16, s[36:39], s52 offen offset:2048  lds
    buffer_load_dwordx4 v17, s[36:39], s52 offen offset:3072  lds
    s_mov_b32 m0, 108544
    s_nop 0
    buffer_load_dwordx4 v18, s[36:39], s52 offen offset:0  lds
    buffer_load_dwordx4 v19, s[36:39], s52 offen offset:1024  lds
    s_add_u32 s50, s50, 128
    s_cmp_ge_u32 s50, s51
    s_cselect_b32 s44, 1152, 0
    s_sub_u32 s50, s50, s44
    s_waitcnt vmcnt(18)
    s_barrier
    s_mov_b32 m0, 129024
    s_nop 0
    buffer_load_dwordx4 v2, s[36:39], s50 offen offset:0  lds
    buffer_load_dwordx4 v3, s[36:39], s50 offen offset:1024  lds
    buffer_load_dwordx4 v4, s[36:39], s50 offen offset:2048  lds
    buffer_load_dwordx4 v5, s[36:39], s50 offen offset:3072  lds
    s_mov_b32 m0, 133120
    s_nop 0
    buffer_load_dwordx4 v6, s[36:39], s50 offen offset:0  lds
    buffer_load_dwordx4 v7, s[36:39], s50 offen offset:1024  lds
    buffer_load_dwordx4 v8, s[36:39], s50 offen offset:2048  lds
    buffer_load_dwordx4 v9, s[36:39], s50 offen offset:3072  lds
    s_mov_b32 m0, 137216
    s_nop 0
    buffer_load_dwordx4 v10, s[36:39], s50 offen offset:0  lds
    buffer_load_dwordx4 v11, s[36:39], s50 offen offset:1024  lds
    buffer_load_dwordx4 v12, s[36:39], s50 offen offset:2048  lds
    buffer_load_dwordx4 v13, s[36:39], s50 offen offset:3072  lds
    s_mov_b32 m0, 141312
    s_nop 0
    buffer_load_dwordx4 v14, s[36:39], s50 offen offset:0  lds
    buffer_load_dwordx4 v15, s[36:39], s50 offen offset:1024  lds
    buffer_load_dwordx4 v16, s[36:39], s50 offen offset:2048  lds
    buffer_load_dwordx4 v17, s[36:39], s50 offen offset:3072  lds
    s_mov_b32 m0, 145408
    s_nop 0
    buffer_load_dwordx4 v18, s[36:39], s50 offen offset:0  lds
    buffer_load_dwordx4 v19, s[36:39], s50 offen offset:1024  lds
    s_waitcnt vmcnt(18)
    s_barrier
    s_add_u32 s52, s50, 165888
    s_mov_b32 m0, 18432
    s_nop 0
    buffer_load_dwordx4 v2, s[36:39], s52 offen offset:0  lds
    buffer_load_dwordx4 v3, s[36:39], s52 offen offset:1024  lds
    buffer_load_dwordx4 v4, s[36:39], s52 offen offset:2048  lds
    buffer_load_dwordx4 v5, s[36:39], s52 offen offset:3072  lds
    s_mov_b32 m0, 22528
    s_nop 0
    buffer_load_dwordx4 v6, s[36:39], s52 offen offset:0  lds
    buffer_load_dwordx4 v7, s[36:39], s52 offen offset:1024  lds
    buffer_load_dwordx4 v8, s[36:39], s52 offen offset:2048  lds
    buffer_load_dwordx4 v9, s[36:39], s52 offen offset:3072  lds
    s_mov_b32 m0, 26624
    s_nop 0
    buffer_load_dwordx4 v10, s[36:39], s52 offen offset:0  lds
    buffer_load_dwordx4 v11, s[36:39], s52 offen offset:1024  lds
    buffer_load_dwordx4 v12, s[36:39], s52 offen offset:2048  lds
    buffer_load_dwordx4 v13, s[36:39], s52 offen offset:3072  lds
    s_mov_b32 m0, 30720
    s_nop 0
    buffer_load_dwordx4 v14, s[36:39], s52 offen offset:0  lds
    buffer_load_dwordx4 v15, s[36:39], s52 offen offset:1024  lds
    buffer_load_dwordx4 v16, s[36:39], s52 offen offset:2048  lds
    buffer_load_dwordx4 v17, s[36:39], s52 offen offset:3072  lds
    s_mov_b32 m0, 34816
    s_nop 0
    buffer_load_dwordx4 v18, s[36:39], s52 offen offset:0  lds
    buffer_load_dwordx4 v19, s[36:39], s52 offen offset:1024  lds
    s_add_u32 s50, s50, 128
    s_cmp_ge_u32 s50, s51
    s_cselect_b32 s44, 1152, 0
    s_sub_u32 s50, s50, s44
    s_waitcnt vmcnt(18)
    s_barrier
    s_mov_b32 m0, 55296
    s_nop 0
    buffer_load_dwordx4 v2, s[36:39], s50 offen offset:0  lds
    buffer_load_dwordx4 v3, s[36:39], s50 offen offset:1024  lds
    buffer_load_dwordx4 v4, s[36:39], s50 offen offset:2048  lds
    buffer_load_dwordx4 v5, s[36:39], s50 offen offset:3072  lds
    s_mov_b32 m0, 59392
    s_nop 0
    buffer_load_dwordx4 v6, s[36:39], s50 offen offset:0  lds
    buffer_load_dwordx4 v7, s[36:39], s50 offen offset:1024  lds
    buffer_load_dwordx4 v8, s[36:39], s50 offen offset:2048  lds
    buffer_load_dwordx4 v9, s[36:39], s50 offen offset:3072  lds
    s_mov_b32 m0, 63488
    s_nop 0
    buffer_load_dwordx4 v10, s[36:39], s50 offen offset:0  lds
    buffer_load_dwordx4 v11, s[36:39], s50 offen offset:1024  lds
    buffer_load_dwordx4 v12, s[36:39], s50 offen offset:2048  lds
    buffer_load_dwordx4 v13, s[36:39], s50 offen offset:3072  lds
    s_mov_b32 m0, 67584
    s_nop 0
    buffer_load_dwordx4 v14, s[36:39], s50 offen offset:0  lds
    buffer_load_dwordx4 v15, s[36:39], s50 offen offset:1024  lds
    buffer_load_dwordx4 v16, s[36:39], s50 offen offset:2048  lds
    buffer_load_dwordx4 v17, s[36:39], s50 offen offset:3072  lds
    s_mov_b32 m0, 71680
    s_nop 0
    buffer_load_dwordx4 v18, s[36:39], s50 offen offset:0  lds
    buffer_load_dwordx4 v19, s[36:39], s50 offen offset:1024  lds
    s_waitcnt vmcnt(18)
    s_barrier
    s_add_u32 s52, s50, 165888
    s_mov_b32 m0, 92160
    s_nop 0
    buffer_load_dwordx4 v2, s[36:39], s52 offen offset:0  lds
    buffer_load_dwordx4 v3, s[36:39], s52 offen offset:1024  lds
    buffer_load_dwordx4 v4, s[36:39], s52 offen offset:2048  lds
    buffer_load_dwordx4 v5, s[36:39], s52 offen offset:3072  lds
    s_mov_b32 m0, 96256
    s_nop 0
    buffer_load_dwordx4 v6, s[36:39], s52 offen offset:0  lds
    buffer_load_dwordx4 v7, s[36:39], s52 offen offset:1024  lds
    buffer_load_dwordx4 v8, s[36:39], s52 offen offset:2048  lds
    buffer_load_dwordx4 v9, s[36:39], s52 offen offset:3072  lds
    s_mov_b32 m0, 100352
    s_nop 0
    buffer_load_dwordx4 v10, s[36:39], s52 offen offset:0  lds
    buffer_load_dwordx4 v11, s[36:39], s52 offen offset:1024  lds
    buffer_load_dwordx4 v12, s[36:39], s52 offen offset:2048  lds
    buffer_load_dwordx4 v13, s[36:39], s52 offen offset:3072  lds
    s_mov_b32 m0, 104448
    s_nop 0
    buffer_load_dwordx4 v14, s[36:39], s52 offen offset:0  lds
    buffer_load_dwordx4 v15, s[36:39], s52 offen offset:1024  lds
    buffer_load_dwordx4 v16, s[36:39], s52 offen offset:2048  lds
    buffer_load_dwordx4 v17, s[36:39], s52 offen offset:3072  lds
    s_mov_b32 m0, 108544
    s_nop 0
    buffer_load_dwordx4 v18, s[36:39], s52 offen offset:0  lds
    buffer_load_dwordx4 v19, s[36:39], s52 offen offset:1024  lds
    s_add_u32 s50, s50, 128
    s_cmp_ge_u32 s50, s51
    s_cselect_b32 s44, 1152, 0
    s_sub_u32 s50, s50, s44
    s_waitcnt vmcnt(18)
    s_barrier
    s_mov_b32 m0, 129024
    s_nop 0
    buffer_load_dwordx4 v2, s[36:39], s50 offen offset:0  lds
    buffer_load_dwordx4 v3, s[36:39], s50 offen offset:1024  lds
    buffer_load_dwordx4 v4, s[36:39], s50 offen offset:2048  lds
    buffer_load_dwordx4 v5, s[36:39], s50 offen offset:3072  lds
    s_mov_b32 m0, 133120
    s_nop 0
    buffer_load_dwordx4 v6, s[36:39], s50 offen offset:0  lds
    buffer_load_dwordx4 v7, s[36:39], s50 offen offset:1024  lds
    buffer_load_dwordx4 v8, s[36:39], s50 offen offset:2048  lds
    buffer_load_dwordx4 v9, s[36:39], s50 offen offset:3072  lds
    s_mov_b32 m0, 137216
    s_nop 0
    buffer_load_dwordx4 v10, s[36:39], s50 offen offset:0  lds
    buffer_load_dwordx4 v11, s[36:39], s50 offen offset:1024  lds
    buffer_load_dwordx4 v12, s[36:39], s50 offen offset:2048  lds
    buffer_load_dwordx4 v13, s[36:39], s50 offen offset:3072  lds
    s_mov_b32 m0, 141312
    s_nop 0
    buffer_load_dwordx4 v14, s[36:39], s50 offen offset:0  lds
    buffer_load_dwordx4 v15, s[36:39], s50 offen offset:1024  lds
    buffer_load_dwordx4 v16, s[36:39], s50 offen offset:2048  lds
    buffer_load_dwordx4 v17, s[36:39], s50 offen offset:3072  lds
    s_mov_b32 m0, 145408
    s_nop 0
    buffer_load_dwordx4 v18, s[36:39], s50 offen offset:0  lds
    buffer_load_dwordx4 v19, s[36:39], s50 offen offset:1024  lds
    s_waitcnt vmcnt(18)
    s_barrier
    s_add_u32 s52, s50, 165888
    s_mov_b32 m0, 18432
    s_nop 0
    buffer_load_dwordx4 v2, s[36:39], s52 offen offset:0  lds
    buffer_load_dwordx4 v3, s[36:39], s52 offen offset:1024  lds
    buffer_load_dwordx4 v4, s[36:39], s52 offen offset:2048  lds
    buffer_load_dwordx4 v5, s[36:39], s52 offen offset:3072  lds
    s_mov_b32 m0, 22528
    s_nop 0
    buffer_load_dwordx4 v6, s[36:39], s52 offen offset:0  lds
    buffer_load_dwordx4 v7, s[36:39], s52 offen offset:1024  lds
    buffer_load_dwordx4 v8, s[36:39], s52 offen offset:2048  lds
    buffer_load_dwordx4 v9, s[36:39], s52 offen offset:3072  lds
    s_mov_b32 m0, 26624
    s_nop 0
    buffer_load_dwordx4 v10, s[36:39], s52 offen offset:0  lds
    buffer_load_dwordx4 v11, s[36:39], s52 offen offset:1024  lds
    buffer_load_dwordx4 v12, s[36:39], s52 offen offset:2048  lds
    buffer_load_dwordx4 v13, s[36:39], s52 offen offset:3072  lds
    s_mov_b32 m0, 30720
    s_nop 0
    buffer_load_dwordx4 v14, s[36:39], s52 offen offset:0  lds
    buffer_load_dwordx4 v15, s[36:39], s52 offen offset:1024  lds
    buffer_load_dwordx4 v16, s[36:39], s52 offen offset:2048  lds
    buffer_load_dwordx4 v17, s[36:39], s52 offen offset:3072  lds
    s_mov_b32 m0, 34816
    s_nop 0
    buffer_load_dwordx4 v18, s[36:39], s52 offen offset:0  lds
    buffer_load_dwordx4 v19, s[36:39], s52 offen offset:1024  lds
    s_add_u32 s50, s50, 128
    s_cmp_ge_u32 s50, s51
    s_cselect_b32 s44, 1152, 0
    s_sub_u32 s50, s50, s44
    s_waitcnt vmcnt(18)
    s_barrier
    s_mov_b32 m0, 55296
    s_nop 0
    buffer_load_dwordx4 v2, s[36:39], s50 offen offset:0  lds
    buffer_load_dwordx4 v3, s[36:39], s50 offen offset:1024  lds
    buffer_load_dwordx4 v4, s[36:39], s50 offen offset:2048  lds
    buffer_load_dwordx4 v5, s[36:39], s50 offen offset:3072  lds
    s_mov_b32 m0, 59392
    s_nop 0
    buffer_load_dwordx4 v6, s[36:39], s50 offen offset:0  lds
    buffer_load_dwordx4 v7, s[36:39], s50 offen offset:1024  lds
    buffer_load_dwordx4 v8, s[36:39], s50 offen offset:2048  lds
    buffer_load_dwordx4 v9, s[36:39], s50 offen offset:3072  lds
    s_mov_b32 m0, 63488
    s_nop 0
    buffer_load_dwordx4 v10, s[36:39], s50 offen offset:0  lds
    buffer_load_dwordx4 v11, s[36:39], s50 offen offset:1024  lds
    buffer_load_dwordx4 v12, s[36:39], s50 offen offset:2048  lds
    buffer_load_dwordx4 v13, s[36:39], s50 offen offset:3072  lds
    s_mov_b32 m0, 67584
    s_nop 0
    buffer_load_dwordx4 v14, s[36:39], s50 offen offset:0  lds
    buffer_load_dwordx4 v15, s[36:39], s50 offen offset:1024  lds
    buffer_load_dwordx4 v16, s[36:39], s50 offen offset:2048  lds
    buffer_load_dwordx4 v17, s[36:39], s50 offen offset:3072  lds
    s_mov_b32 m0, 71680
    s_nop 0
    buffer_load_dwordx4 v18, s[36:39], s50 offen offset:0  lds
    buffer_load_dwordx4 v19, s[36:39], s50 offen offset:1024  lds
    s_waitcnt vmcnt(18)
    s_barrier
    s_add_u32 s52, s50, 165888
    s_mov_b32 m0, 92160
    s_nop 0
    buffer_load_dwordx4 v2, s[36:39], s52 offen offset:0  lds
    buffer_load_dwordx4 v3, s[36:39], s52 offen offset:1024  lds
    buffer_load_dwordx4 v4, s[36:39], s52 offen offset:2048  lds
    buffer_load_dwordx4 v5, s[36:39], s52 offen offset:3072  lds
    s_mov_b32 m0, 96256
    s_nop 0
    buffer_load_dwordx4 v6, s[36:39], s52 offen offset:0  lds
    buffer_load_dwordx4 v7, s[36:39], s52 offen offset:1024  lds
    buffer_load_dwordx4 v8, s[36:39], s52 offen offset:2048  lds
    buffer_load_dwordx4 v9, s[36:39], s52 offen offset:3072  lds
    s_mov_b32 m0, 100352
    s_nop 0
    buffer_load_dwordx4 v10, s[36:39], s52 offen offset:0  lds
    buffer_load_dwordx4 v11, s[36:39], s52 offen offset:1024  lds
    buffer_load_dwordx4 v12, s[36:39], s52 offen offset:2048  lds
    buffer_load_dwordx4 v13, s[36:39], s52 offen offset:3072  lds
    s_mov_b32 m0, 104448
    s_nop 0
    buffer_load_dwordx4 v14, s[36:39], s52 offen offset:0  lds
    buffer_load_dwordx4 v15, s[36:39], s52 offen offset:1024  lds
    buffer_load_dwordx4 v16, s[36:39], s52 offen offset:2048  lds
    buffer_load_dwordx4 v17, s[36:39], s52 offen offset:3072  lds
    s_mov_b32 m0, 108544
    s_nop 0
    buffer_load_dwordx4 v18, s[36:39], s52 offen offset:0  lds
    buffer_load_dwordx4 v19, s[36:39], s52 offen offset:1024  lds
    s_add_u32 s50, s50, 128
    s_cmp_ge_u32 s50, s51
    s_cselect_b32 s44, 1152, 0
    s_sub_u32 s50, s50, s44
    s_waitcnt vmcnt(18)
    s_barrier
    s_mov_b32 m0, 129024
    s_nop 0
    buffer_load_dwordx4 v2, s[36:39], s50 offen offset:0  lds
    buffer_load_dwordx4 v3, s[36:39], s50 offen offset:1024  lds
    buffer_load_dwordx4 v4, s[36:39], s50 offen offset:2048  lds
    buffer_load_dwordx4 v5, s[36:39], s50 offen offset:3072  lds
    s_mov_b32 m0, 133120
    s_nop 0
    buffer_load_dwordx4 v6, s[36:39], s50 offen offset:0  lds
    buffer_load_dwordx4 v7, s[36:39], s50 offen offset:1024  lds
    buffer_load_dwordx4 v8, s[36:39], s50 offen offset:2048  lds
    buffer_load_dwordx4 v9, s[36:39], s50 offen offset:3072  lds
    s_mov_b32 m0, 137216
    s_nop 0
    buffer_load_dwordx4 v10, s[36:39], s50 offen offset:0  lds
    buffer_load_dwordx4 v11, s[36:39], s50 offen offset:1024  lds
    buffer_load_dwordx4 v12, s[36:39], s50 offen offset:2048  lds
    buffer_load_dwordx4 v13, s[36:39], s50 offen offset:3072  lds
    s_mov_b32 m0, 141312
    s_nop 0
    buffer_load_dwordx4 v14, s[36:39], s50 offen offset:0  lds
    buffer_load_dwordx4 v15, s[36:39], s50 offen offset:1024  lds
    buffer_load_dwordx4 v16, s[36:39], s50 offen offset:2048  lds
    buffer_load_dwordx4 v17, s[36:39], s50 offen offset:3072  lds
    s_mov_b32 m0, 145408
    s_nop 0
    buffer_load_dwordx4 v18, s[36:39], s50 offen offset:0  lds
    buffer_load_dwordx4 v19, s[36:39], s50 offen offset:1024  lds
    s_waitcnt vmcnt(18)
    s_barrier
    s_add_u32 s52, s50, 165888
    s_mov_b32 m0, 18432
    s_nop 0
    buffer_load_dwordx4 v2, s[36:39], s52 offen offset:0  lds
    buffer_load_dwordx4 v3, s[36:39], s52 offen offset:1024  lds
    buffer_load_dwordx4 v4, s[36:39], s52 offen offset:2048  lds
    buffer_load_dwordx4 v5, s[36:39], s52 offen offset:3072  lds
    s_mov_b32 m0, 22528
    s_nop 0
    buffer_load_dwordx4 v6, s[36:39], s52 offen offset:0  lds
    buffer_load_dwordx4 v7, s[36:39], s52 offen offset:1024  lds
    buffer_load_dwordx4 v8, s[36:39], s52 offen offset:2048  lds
    buffer_load_dwordx4 v9, s[36:39], s52 offen offset:3072  lds
    s_mov_b32 m0, 26624
    s_nop 0
    buffer_load_dwordx4 v10, s[36:39], s52 offen offset:0  lds
    buffer_load_dwordx4 v11, s[36:39], s52 offen offset:1024  lds
    buffer_load_dwordx4 v12, s[36:39], s52 offen offset:2048  lds
    buffer_load_dwordx4 v13, s[36:39], s52 offen offset:3072  lds
    s_mov_b32 m0, 30720
    s_nop 0
    buffer_load_dwordx4 v14, s[36:39], s52 offen offset:0  lds
    buffer_load_dwordx4 v15, s[36:39], s52 offen offset:1024  lds
    buffer_load_dwordx4 v16, s[36:39], s52 offen offset:2048  lds
    buffer_load_dwordx4 v17, s[36:39], s52 offen offset:3072  lds
    s_mov_b32 m0, 34816
    s_nop 0
    buffer_load_dwordx4 v18, s[36:39], s52 offen offset:0  lds
    buffer_load_dwordx4 v19, s[36:39], s52 offen offset:1024  lds
    s_add_u32 s50, s50, 128
    s_cmp_ge_u32 s50, s51
    s_cselect_b32 s44, 1152, 0
    s_sub_u32 s50, s50, s44
    s_waitcnt vmcnt(18)
    s_barrier
    s_mov_b32 m0, 55296
    s_nop 0
    buffer_load_dwordx4 v2, s[36:39], s50 offen offset:0  lds
    buffer_load_dwordx4 v3, s[36:39], s50 offen offset:1024  lds
    buffer_load_dwordx4 v4, s[36:39], s50 offen offset:2048  lds
    buffer_load_dwordx4 v5, s[36:39], s50 offen offset:3072  lds
    s_mov_b32 m0, 59392
    s_nop 0
    buffer_load_dwordx4 v6, s[36:39], s50 offen offset:0  lds
    buffer_load_dwordx4 v7, s[36:39], s50 offen offset:1024  lds
    buffer_load_dwordx4 v8, s[36:39], s50 offen offset:2048  lds
    buffer_load_dwordx4 v9, s[36:39], s50 offen offset:3072  lds
    s_mov_b32 m0, 63488
    s_nop 0
    buffer_load_dwordx4 v10, s[36:39], s50 offen offset:0  lds
    buffer_load_dwordx4 v11, s[36:39], s50 offen offset:1024  lds
    buffer_load_dwordx4 v12, s[36:39], s50 offen offset:2048  lds
    buffer_load_dwordx4 v13, s[36:39], s50 offen offset:3072  lds
    s_mov_b32 m0, 67584
    s_nop 0
    buffer_load_dwordx4 v14, s[36:39], s50 offen offset:0  lds
    buffer_load_dwordx4 v15, s[36:39], s50 offen offset:1024  lds
    buffer_load_dwordx4 v16, s[36:39], s50 offen offset:2048  lds
    buffer_load_dwordx4 v17, s[36:39], s50 offen offset:3072  lds
    s_mov_b32 m0, 71680
    s_nop 0
    buffer_load_dwordx4 v18, s[36:39], s50 offen offset:0  lds
    buffer_load_dwordx4 v19, s[36:39], s50 offen offset:1024  lds
    s_waitcnt vmcnt(18)
    s_barrier
    s_add_u32 s52, s50, 165888
    s_mov_b32 m0, 92160
    s_nop 0
    buffer_load_dwordx4 v2, s[36:39], s52 offen offset:0  lds
    buffer_load_dwordx4 v3, s[36:39], s52 offen offset:1024  lds
    buffer_load_dwordx4 v4, s[36:39], s52 offen offset:2048  lds
    buffer_load_dwordx4 v5, s[36:39], s52 offen offset:3072  lds
    s_mov_b32 m0, 96256
    s_nop 0
    buffer_load_dwordx4 v6, s[36:39], s52 offen offset:0  lds
    buffer_load_dwordx4 v7, s[36:39], s52 offen offset:1024  lds
    buffer_load_dwordx4 v8, s[36:39], s52 offen offset:2048  lds
    buffer_load_dwordx4 v9, s[36:39], s52 offen offset:3072  lds
    s_mov_b32 m0, 100352
    s_nop 0
    buffer_load_dwordx4 v10, s[36:39], s52 offen offset:0  lds
    buffer_load_dwordx4 v11, s[36:39], s52 offen offset:1024  lds
    buffer_load_dwordx4 v12, s[36:39], s52 offen offset:2048  lds
    buffer_load_dwordx4 v13, s[36:39], s52 offen offset:3072  lds
    s_mov_b32 m0, 104448
    s_nop 0
    buffer_load_dwordx4 v14, s[36:39], s52 offen offset:0  lds
    buffer_load_dwordx4 v15, s[36:39], s52 offen offset:1024  lds
    buffer_load_dwordx4 v16, s[36:39], s52 offen offset:2048  lds
    buffer_load_dwordx4 v17, s[36:39], s52 offen offset:3072  lds
    s_mov_b32 m0, 108544
    s_nop 0
    buffer_load_dwordx4 v18, s[36:39], s52 offen offset:0  lds
    buffer_load_dwordx4 v19, s[36:39], s52 offen offset:1024  lds
    s_add_u32 s50, s50, 128
    s_cmp_ge_u32 s50, s51
    s_cselect_b32 s44, 1152, 0
    s_sub_u32 s50, s50, s44
    s_waitcnt vmcnt(18)
    s_barrier
    s_mov_b32 m0, 129024
    s_nop 0
    buffer_load_dwordx4 v2, s[36:39], s50 offen offset:0  lds
    buffer_load_dwordx4 v3, s[36:39], s50 offen offset:1024  lds
    buffer_load_dwordx4 v4, s[36:39], s50 offen offset:2048  lds
    buffer_load_dwordx4 v5, s[36:39], s50 offen offset:3072  lds
    s_mov_b32 m0, 133120
    s_nop 0
    buffer_load_dwordx4 v6, s[36:39], s50 offen offset:0  lds
    buffer_load_dwordx4 v7, s[36:39], s50 offen offset:1024  lds
    buffer_load_dwordx4 v8, s[36:39], s50 offen offset:2048  lds
    buffer_load_dwordx4 v9, s[36:39], s50 offen offset:3072  lds
    s_mov_b32 m0, 137216
    s_nop 0
    buffer_load_dwordx4 v10, s[36:39], s50 offen offset:0  lds
    buffer_load_dwordx4 v11, s[36:39], s50 offen offset:1024  lds
    buffer_load_dwordx4 v12, s[36:39], s50 offen offset:2048  lds
    buffer_load_dwordx4 v13, s[36:39], s50 offen offset:3072  lds
    s_mov_b32 m0, 141312
    s_nop 0
    buffer_load_dwordx4 v14, s[36:39], s50 offen offset:0  lds
    buffer_load_dwordx4 v15, s[36:39], s50 offen offset:1024  lds
    buffer_load_dwordx4 v16, s[36:39], s50 offen offset:2048  lds
    buffer_load_dwordx4 v17, s[36:39], s50 offen offset:3072  lds
    s_mov_b32 m0, 145408
    s_nop 0
    buffer_load_dwordx4 v18, s[36:39], s50 offen offset:0  lds
    buffer_load_dwordx4 v19, s[36:39], s50 offen offset:1024  lds
    s_waitcnt vmcnt(18)
    s_barrier
    s_add_u32 s52, s50, 165888
    s_mov_b32 m0, 18432
    s_nop 0
    buffer_load_dwordx4 v2, s[36:39], s52 offen offset:0  lds
    buffer_load_dwordx4 v3, s[36:39], s52 offen offset:1024  lds
    buffer_load_dwordx4 v4, s[36:39], s52 offen offset:2048  lds
    buffer_load_dwordx4 v5, s[36:39], s52 offen offset:3072  lds
    s_mov_b32 m0, 22528
    s_nop 0
    buffer_load_dwordx4 v6, s[36:39], s52 offen offset:0  lds
    buffer_load_dwordx4 v7, s[36:39], s52 offen offset:1024  lds
    buffer_load_dwordx4 v8, s[36:39], s52 offen offset:2048  lds
    buffer_load_dwordx4 v9, s[36:39], s52 offen offset:3072  lds
    s_mov_b32 m0, 26624
    s_nop 0
    buffer_load_dwordx4 v10, s[36:39], s52 offen offset:0  lds
    buffer_load_dwordx4 v11, s[36:39], s52 offen offset:1024  lds
    buffer_load_dwordx4 v12, s[36:39], s52 offen offset:2048  lds
    buffer_load_dwordx4 v13, s[36:39], s52 offen offset:3072  lds
    s_mov_b32 m0, 30720
    s_nop 0
    buffer_load_dwordx4 v14, s[36:39], s52 offen offset:0  lds
    buffer_load_dwordx4 v15, s[36:39], s52 offen offset:1024  lds
    buffer_load_dwordx4 v16, s[36:39], s52 offen offset:2048  lds
    buffer_load_dwordx4 v17, s[36:39], s52 offen offset:3072  lds
    s_mov_b32 m0, 34816
    s_nop 0
    buffer_load_dwordx4 v18, s[36:39], s52 offen offset:0  lds
    buffer_load_dwordx4 v19, s[36:39], s52 offen offset:1024  lds
    s_add_u32 s50, s50, 128
    s_cmp_ge_u32 s50, s51
    s_cselect_b32 s44, 1152, 0
    s_sub_u32 s50, s50, s44
    s_waitcnt vmcnt(18)
    s_barrier
    s_waitcnt vmcnt(0)
    s_barrier
    s_endpgm
L_r6:
    v_mov_b32 v27, 2146435072
    v_mul_u32_u24 v20, 57, v1
    v_lshrrev_b32 v20, 9, v20
    v_mul_u32_u24 v21, 9, v20
    v_sub_u32 v21, v1, v21
    v_mul_u32_u24 v6, 9216, v20
    v_lshl_add_u32 v6, v21, 4, v6
    v_cmp_gt_u32 vcc, 7, v20
    s_nop 1
    v_cndmask_b32 v6, v27, v6, vcc
    v_cmp_gt_u32 vcc, 4, v20
    s_nop 1
    v_cndmask_b32 v7, v27, v6, vcc
    s_mul_i32 s46, s23, 1152
    s_and_b32 s44, s24, 7
    s_mul_i32 s44, s44, 144
    s_add_u32 s46, s46, s44
    s_lshr_b32 s44, s24, 3
    s_mul_i32 s47, s44, 1327104
    s_add_u32 s47, s47, s46
    s_mul_i32 s44, s44, 36864
    s_add_u32 s46, s46, s44
    s_add_u32 s46, s46, 6553600
    s_lshr_b32 s25, s23, 2
    s_lshl_b32 s25, s25, 3
    s_lshr_b32 s44, s24, 2
    s_add_u32 s25, s25, s44
    s_and_b32 s26, s23, 3
    s_lshl_b32 s26, s26, 2
    s_and_b32 s45, s24, 3
    s_add_u32 s26, s26, s45
    s_lshl_b32 s45, s45, 1
    s_add_u32 s27, s44, s45
    s_cmp_ge_u32 s27, 9
    s_cselect_b32 s44, 9, 0
    s_sub_u32 s27, s27, s44
    s_mov_b32 s44, 429496730
    s_mul_i32 s48, s26, 1296
    v_add_u32 v20, 0, v1
    v_mul_hi_u32 v21, v20, s44
    v_mul_u32_u24 v22, 10, v21
    v_sub_u32 v22, v20, v22
    v_add_u32 v23, -2, v21
    v_cmp_gt_u32 vcc, 18, v21
    s_nop 1
    v_cndmask_b32 v23, v23, v21, vcc
    v_mul_u32_u24 v23, 36, v23
    v_lshl_add_u32 v23, v22, 2, v23
    v_cmp_gt_u32 vcc, 9, v22
    s_nop 1
    v_cndmask_b32 v23, v27, v23, vcc
    v_cmp_gt_u32 vcc, 38, v21
    s_nop 1
    v_cndmask_b32 v23, v27, v23, vcc
    v_and_b32 v24, 62, v21
    v_cmp_ne_u32 vcc, 18, v24
    s_nop 1
    v_cndmask_b32 v32, v27, v23, vcc
    v_add_u32 v20, 64, v1
    v_mul_hi_u32 v21, v20, s44
    v_mul_u32_u24 v22, 10, v21
    v_sub_u32 v22, v20, v22
    v_add_u32 v23, -2, v21
    v_cmp_gt_u32 vcc, 18, v21
    s_nop 1
    v_cndmask_b32 v23, v23, v21, vcc
    v_mul_u32_u24 v23, 36, v23
    v_lshl_add_u32 v23, v22, 2, v23
    v_cmp_gt_u32 vcc, 9, v22
    s_nop 1
    v_cndmask_b32 v23, v27, v23, vcc
    v_cmp_gt_u32 vcc, 38, v21
    s_nop 1
    v_cndmask_b32 v23, v27, v23, vcc
    v_and_b32 v24, 62, v21
    v_cmp_ne_u32 vcc, 18, v24
    s_nop 1
    v_cndmask_b32 v33, v27, v23, vcc
    v_add_u32 v20, 128, v1
    v_mul_hi_u32 v21, v20, s44
    v_mul_u32_u24 v22, 10, v21
    v_sub_u32 v22, v20, v22
    v_add_u32 v23, -2, v21
    v_cmp_gt_u32 vcc, 18, v21
    s_nop 1
    v_cndmask_b32 v23, v23, v21, vcc
    v_mul_u32_u24 v23, 36, v23
    v_lshl_add_u32 v23, v22, 2, v23
    v_cmp_gt_u32 vcc, 9, v22
    s_nop 1
    v_cndmask_b32 v23, v27, v23, vcc
    v_cmp_gt_u32 vcc, 38, v21
    s_nop 1
    v_cndmask_b32 v23, v27, v23, vcc
    v_and_b32 v24, 62, v21
    v_cmp_ne_u32 vcc, 18, v24
    s_nop 1
    v_cndmask_b32 v34, v27, v23, vcc
    v_add_u32 v20, 192, v1
    v_mul_hi_u32 v21, v20, s44
    v_mul_u32_u24 v22, 10, v21
    v_sub_u32 v22, v20, v22
    v_add_u32 v23, -2, v21
    v_cmp_gt_u32 vcc, 18, v21
    s_nop 1
    v_cndmask_b32 v23, v23, v21, vcc
    v_mul_u32_u24 v23, 36, v23
    v_lshl_add_u32 v23, v22, 2, v23
    v_cmp_gt_u32 vcc, 9, v22
    s_nop 1
    v_cndmask_b32 v23, v27, v23, vcc
    v_cmp_gt_u32 vcc, 38, v21
    s_nop 1
    v_cndmask_b32 v23, v27, v23, vcc
    v_and_b32 v24, 62, v21
    v_cmp_ne_u32 vcc, 18, v24
    s_nop 1
    v_cndmask_b32 v35, v27, v23, vcc
    v_add_u32 v20, 256, v1
    v_mul_hi_u32 v21, v20, s44
    v_mul_u32_u24 v22, 10, v21
    v_sub_u32 v22, v20, v22
    v_add_u32 v23, -2, v21
    v_cmp_gt_u32 vcc, 18, v21
    s_nop 1
    v_cndmask_b32 v23, v23, v21, vcc
    v_mul_u32_u24 v23, 36, v23
    v_lshl_add_u32 v23, v22, 2, v23
    v_cmp_gt_u32 vcc, 9, v22
    s_nop 1
    v_cndmask_b32 v23, v27, v23, vcc
    v_cmp_gt_u32 vcc, 38, v21
    s_nop 1
    v_cndmask_b32 v23, v27, v23, vcc
    v_and_b32 v24, 62, v21
    v_cmp_ne_u32 vcc, 18, v24
    s_nop 1
    v_cndmask_b32 v36, v27, v23, vcc
    v_add_u32 v20, 320, v1
    v_mul_hi_u32 v21, v20, s44
    v_mul_u32_u24 v22, 10, v21
    v_sub_u32 v22, v20, v22
    v_add_u32 v23, -2, v21
    v_cmp_gt_u32 vcc, 18, v21
    s_nop 1
    v_cndmask_b32 v23, v23, v21, vcc
    v_mul_u32_u24 v23, 36, v23
    v_lshl_add_u32 v23, v22, 2, v23
    v_cmp_gt_u32 vcc, 9, v22
    s_nop 1
    v_cndmask_b32 v23, v27, v23, vcc
    v_cmp_gt_u32 vcc, 38, v21
    s_nop 1
    v_cndmask_b32 v23, v27, v23, vcc
    v_and_b32 v24, 62, v21
    v_cmp_ne_u32 vcc, 18, v24
    s_nop 1
    v_cndmask_b32 v37, v27, v23, vcc
    v_add_u32 v20, 384, v1
    v_mul_hi_u32 v21, v20, s44
    v_mul_u32_u24 v22, 10, v21
    v_sub_u32 v22, v20, v22
    v_add_u32 v23, -2, v21
    v_cmp_gt_u32 vcc, 18, v21
    s_nop 1
    v_cndmask_b32 v23, v23, v21, vcc
    v_mul_u32_u24 v23, 36, v23
    v_lshl_add_u32 v23, v22, 2, v23
    v_cmp_gt_u32 vcc, 9, v22
    s_nop 1
    v_cndmask_b32 v23, v27, v23, vcc
    v_cmp_gt_u32 vcc, 38, v21
    s_nop 1
    v_cndmask_b32 v23, v27, v23, vcc
    v_and_b32 v24, 62, v21
    v_cmp_ne_u32 vcc, 18, v24
    s_nop 1
    v_cndmask_b32 v38, v27, v23, vcc
    v_add_u32 v20, 448, v1
    v_mul_hi_u32 v21, v20, s44
    v_mul_u32_u24 v22, 10, v21
    v_sub_u32 v22, v20, v22
    v_add_u32 v23, -2, v21
    v_cmp_gt_u32 vcc, 18, v21
    s_nop 1
    v_cndmask_b32 v23, v23, v21, vcc
    v_mul_u32_u24 v23, 36, v23
    v_lshl_add_u32 v23, v22, 2, v23
    v_cmp_gt_u32 vcc, 9, v22
    s_nop 1
    v_cndmask_b32 v23, v27, v23, vcc
    v_cmp_gt_u32 vcc, 38, v21
    s_nop 1
    v_cndmask_b32 v23, v27, v23, vcc
    v_and_b32 v24, 62, v21
    v_cmp_ne_u32 vcc, 18, v24
    s_nop 1
    v_cndmask_b32 v39, v27, v23, vcc
    v_add_u32 v20, 512, v1
    v_mul_hi_u32 v21, v20, s44
    v_mul_u32_u24 v22, 10, v21
    v_sub_u32 v22, v20, v22
    v_add_u32 v23, -2, v21
    v_cmp_gt_u32 vcc, 18, v21
    s_nop 1
    v_cndmask_b32 v23, v23, v21, vcc
    v_mul_u32_u24 v23, 36, v23
    v_lshl_add_u32 v23, v22, 2, v23
    v_cmp_gt_u32 vcc, 9, v22
    s_nop 1
    v_cndmask_b32 v23, v27, v23, vcc
    v_cmp_gt_u32 vcc, 38, v21
    s_nop 1
    v_cndmask_b32 v23, v27, v23, vcc
    v_and_b32 v24, 62, v21
    v_cmp_ne_u32 vcc, 18, v24
    s_nop 1
    v_cndmask_b32 v40, v27, v23, vcc
    v_add_u32 v20, 576, v1
    v_mul_hi_u32 v21, v20, s44
    v_mul_u32_u24 v22, 10, v21
    v_sub_u32 v22, v20, v22
    v_add_u32 v23, -2, v21
    v_cmp_gt_u32 vcc, 18, v21
    s_nop 1
    v_cndmask_b32 v23, v23, v21, vcc
    v_mul_u32_u24 v23, 36, v23
    v_lshl_add_u32 v23, v22, 2, v23
    v_cmp_gt_u32 vcc, 9, v22
    s_nop 1
    v_cndmask_b32 v23, v27, v23, vcc
    v_cmp_gt_u32 vcc, 38, v21
    s_nop 1
    v_cndmask_b32 v23, v27, v23, vcc
    v_and_b32 v24, 62, v21
    v_cmp_ne_u32 vcc, 18, v24
    s_nop 1
    v_cndmask_b32 v41, v27, v23, vcc
    s_waitcnt lgkmcnt(0)
    s_mov_b32 s28, s20
    s_and_b32 s29, s21, 0xffff
    s_mov_b32 s30, 27262976
    s_mov_b32 s31, 0x20000
    s_mov_b32 s32, s12
    s_and_b32 s33, s13, 0xffff
    s_mov_b32 s34, 5308416
    s_mov_b32 s35, 0x20000
    s_mov_b32 s36, s18
    s_and_b32 s37, s19, 0xffff
    s_mov_b32 s38, 256
    s_mov_b32 s39, 0x20000
    s_mov_b32 s40, s8
    s_and_b32 s41, s9, 0xffff
    s_mov_b32 s42, 20736
    s_mov_b32 s43, 0x20000
    s_barrier
    s_mov_b32 m0, 131072
    s_nop 0
    buffer_load_dword v32, s[40:43], s48 offen lds
    s_mov_b32 m0, 131328
    s_nop 0
    buffer_load_dword v33, s[40:43], s48 offen lds
    s_mov_b32 m0, 131584
    s_nop 0
    buffer_load_dword v34, s[40:43], s48 offen lds
    s_mov_b32 m0, 131840
    s_nop 0
    buffer_load_dword v35, s[40:43], s48 offen lds
    s_mov_b32 m0, 132096
    s_nop 0
    buffer_load_dword v36, s[40:43], s48 offen lds
    s_mov_b32 m0, 132352
    s_nop 0
    buffer_load_dword v37, s[40:43], s48 offen lds
    s_mov_b32 m0, 132608
    s_nop 0
    buffer_load_dword v38, s[40:43], s48 offen lds
    s_mov_b32 m0, 132864
    s_nop 0
    buffer_load_dword v39, s[40:43], s48 offen lds
    s_mov_b32 m0, 133120
    s_nop 0
    buffer_load_dword v40, s[40:43], s48 offen lds
    s_mov_b32 m0, 133376
    s_nop 0
    buffer_load_dword v41, s[40:43], s48 offen lds
    s_barrier
    s_waitcnt vmcnt(0)
    s_barrier
    s_barrier
    v_mov_b32 v18, 0
    s_mov_b32 s56, 0
L_sequential_preLN__linear_kernel_hedgehog__dense_activation_relu__prompt_kernel_renonce_25:
    buffer_load_dword v19, v18, s[36:39], 0 offen sc1
    s_waitcnt vmcnt(0)
    v_readfirstlane_b32 s57, v19
    s_nop 0
    s_cmp_lg_u32 s57, 0
    s_cbranch_scc1 L_sequential_preLN__linear_kernel_hedgehog__dense_activation_relu__prompt_kernel_gotnonce_26
    s_add_u32 s56, s56, 1
    s_cmp_lt_u32 s56, 0x40000
    s_cbranch_scc1 L_sequential_preLN__linear_kernel_hedgehog__dense_activation_relu__prompt_kernel_renonce_25
L_sequential_preLN__linear_kernel_hedgehog__dense_activation_relu__prompt_kernel_gotnonce_26:
    s_barrier
    s_barrier
    s_barrier
    s_barrier
    s_barrier
    buffer_load_dwordx4 v[32:35], v6, s[32:35], s47 offen
    s_add_u32 s47, s47, 64512
    buffer_load_dwordx4 v[36:39], v6, s[32:35], s47 offen
    s_add_u32 s47, s47, 64512
    buffer_load_dwordx4 v[40:43], v6, s[32:35], s47 offen
    s_add_u32 s47, s47, 64512
    buffer_load_dwordx4 v[44:47], v6, s[32:35], s47 offen
    s_add_u32 s47, s47, 64512
    buffer_load_dwordx4 v[48:51], v6, s[32:35], s47 offen
    s_add_u32 s47, s47, 64512
    buffer_load_dwordx4 v[52:55], v6, s[32:35], s47 offen
    s_add_u32 s47, s47, 64512
    buffer_load_dwordx4 v[56:59], v6, s[32:35], s47 offen
    s_add_u32 s47, s47, 64512
    s_barrier
    buffer_load_dwordx4 v[60:63], v6, s[32:35], s47 offen
    s_add_u32 s47, s47, 64512
    buffer_load_dwordx4 v[64:67], v6, s[32:35], s47 offen
    s_add_u32 s47, s47, 64512
    buffer_load_dwordx4 v[68:71], v6, s[32:35], s47 offen
    s_add_u32 s47, s47, 64512
    buffer_load_dwordx4 v[72:75], v6, s[32:35], s47 offen
    s_add_u32 s47, s47, 64512
    buffer_load_dwordx4 v[76:79], v6, s[32:35], s47 offen
    s_add_u32 s47, s47, 64512
    buffer_load_dwordx4 v[80:83], v6, s[32:35], s47 offen
    s_add_u32 s47, s47, 64512
    buffer_load_dwordx4 v[84:87], v6, s[32:35], s47 offen
    s_add_u32 s47, s47, 64512
    buffer_load_dwordx4 v[88:91], v6, s[32:35], s47 offen
    s_add_u32 s47, s47, 64512
    buffer_load_dwordx4 v[92:95], v6, s[32:35], s47 offen
    s_add_u32 s47, s47, 64512
    buffer_load_dwordx4 v[96:99], v6, s[32:35], s47 offen
    s_add_u32 s47, s47, 64512
    buffer_load_dwordx4 v[100:103], v6, s[32:35], s47 offen
    s_add_u32 s47, s47, 64512
    buffer_load_dwordx4 v[104:107], v6, s[32:35], s47 offen
    s_add_u32 s47, s47, 64512
    buffer_load_dwordx4 v[108:111], v6, s[32:35], s47 offen
    s_add_u32 s47, s47, 64512
    buffer_load_dwordx4 v[112:115], v7, s[32:35], s47 offen
    s_barrier
    s_barrier
    s_barrier
    s_barrier
    s_barrier
    s_barrier
    s_barrier
    s_barrier
    s_barrier
    s_barrier
    s_barrier
    s_barrier
    s_barrier
    s_barrier
    s_waitcnt vmcnt(0)
    v_lshlrev_b32 v8, 16, v32
    v_and_b32 v9, 0xffff0000, v32
    v_lshlrev_b32 v10, 16, v33
    v_and_b32 v11, 0xffff0000, v33
    v_lshlrev_b32 v12, 16, v34
    v_and_b32 v13, 0xffff0000, v34
    v_lshlrev_b32 v14, 16, v35
    v_and_b32 v15, 0xffff0000, v35
    v_lshlrev_b32 v20, 16, v36
    v_and_b32 v21, 0xffff0000, v36
    v_pk_add_f32 v[8:9], v[8:9], v[20:21]
    v_lshlrev_b32 v20, 16, v37
    v_and_b32 v21, 0xffff0000, v37
    v_pk_add_f32 v[10:11], v[10:11], v[20:21]
    v_lshlrev_b32 v20, 16, v38
    v_and_b32 v21, 0xffff0000, v38
    v_pk_add_f32 v[12:13], v[12:13], v[20:21]
    v_lshlrev_b32 v20, 16, v39
    v_and_b32 v21, 0xffff0000, v39
    v_pk_add_f32 v[14:15], v[14:15], v[20:21]
    v_lshlrev_b32 v20, 16, v40
    v_and_b32 v21, 0xffff0000, v40
    v_pk_add_f32 v[8:9], v[8:9], v[20:21]
    v_lshlrev_b32 v20, 16, v41
    v_and_b32 v21, 0xffff0000, v41
    v_pk_add_f32 v[10:11], v[10:11], v[20:21]
    v_lshlrev_b32 v20, 16, v42
    v_and_b32 v21, 0xffff0000, v42
    v_pk_add_f32 v[12:13], v[12:13], v[20:21]
    v_lshlrev_b32 v20, 16, v43
    v_and_b32 v21, 0xffff0000, v43
    v_pk_add_f32 v[14:15], v[14:15], v[20:21]
    v_lshlrev_b32 v20, 16, v44
    v_and_b32 v21, 0xffff0000, v44
    v_pk_add_f32 v[8:9], v[8:9], v[20:21]
    v_lshlrev_b32 v20, 16, v45
    v_and_b32 v21, 0xffff0000, v45
    v_pk_add_f32 v[10:11], v[10:11], v[20:21]
    v_lshlrev_b32 v20, 16, v46
    v_and_b32 v21, 0xffff0000, v46
    v_pk_add_f32 v[12:13], v[12:13], v[20:21]
    v_lshlrev_b32 v20, 16, v47
    v_and_b32 v21, 0xffff0000, v47
    v_pk_add_f32 v[14:15], v[14:15], v[20:21]
    v_lshlrev_b32 v20, 16, v48
    v_and_b32 v21, 0xffff0000, v48
    v_pk_add_f32 v[8:9], v[8:9], v[20:21]
    v_lshlrev_b32 v20, 16, v49
    v_and_b32 v21, 0xffff0000, v49
    v_pk_add_f32 v[10:11], v[10:11], v[20:21]
    v_lshlrev_b32 v20, 16, v50
    v_and_b32 v21, 0xffff0000, v50
    v_pk_add_f32 v[12:13], v[12:13], v[20:21]
    v_lshlrev_b32 v20, 16, v51
    v_and_b32 v21, 0xffff0000, v51
    v_pk_add_f32 v[14:15], v[14:15], v[20:21]
    v_lshlrev_b32 v20, 16, v52
    v_and_b32 v21, 0xffff0000, v52
    v_pk_add_f32 v[8:9], v[8:9], v[20:21]
    v_lshlrev_b32 v20, 16, v53
    v_and_b32 v21, 0xffff0000, v53
    v_pk_add_f32 v[10:11], v[10:11], v[20:21]
    v_lshlrev_b32 v20, 16, v54
    v_and_b32 v21, 0xffff0000, v54
    v_pk_add_f32 v[12:13], v[12:13], v[20:21]
    v_lshlrev_b32 v20, 16, v55
    v_and_b32 v21, 0xffff0000, v55
    v_pk_add_f32 v[14:15], v[14:15], v[20:21]
    v_lshlrev_b32 v20, 16, v56
    v_and_b32 v21, 0xffff0000, v56
    v_pk_add_f32 v[8:9], v[8:9], v[20:21]
    v_lshlrev_b32 v20, 16, v57
    v_and_b32 v21, 0xffff0000, v57
    v_pk_add_f32 v[10:11], v[10:11], v[20:21]
    v_lshlrev_b32 v20, 16, v58
    v_and_b32 v21, 0xffff0000, v58
    v_pk_add_f32 v[12:13], v[12:13], v[20:21]
    v_lshlrev_b32 v20, 16, v59
    v_and_b32 v21, 0xffff0000, v59
    v_pk_add_f32 v[14:15], v[14:15], v[20:21]
    v_lshlrev_b32 v20, 16, v60
    v_and_b32 v21, 0xffff0000, v60
    v_pk_add_f32 v[8:9], v[8:9], v[20:21]
    v_lshlrev_b32 v20, 16, v61
    v_and_b32 v21, 0xffff0000, v61
    v_pk_add_f32 v[10:11], v[10:11], v[20:21]
    v_lshlrev_b32 v20, 16, v62
    v_and_b32 v21, 0xffff0000, v62
    v_pk_add_f32 v[12:13], v[12:13], v[20:21]
    v_lshlrev_b32 v20, 16, v63
    v_and_b32 v21, 0xffff0000, v63
    v_pk_add_f32 v[14:15], v[14:15], v[20:21]
    v_lshlrev_b32 v20, 16, v64
    v_and_b32 v21, 0xffff0000, v64
    v_pk_add_f32 v[8:9], v[8:9], v[20:21]
    v_lshlrev_b32 v20, 16, v65
    v_and_b32 v21, 0xffff0000, v65
    v_pk_add_f32 v[10:11], v[10:11], v[20:21]
    v_lshlrev_b32 v20, 16, v66
    v_and_b32 v21, 0xffff0000, v66
    v_pk_add_f32 v[12:13], v[12:13], v[20:21]
    v_lshlrev_b32 v20, 16, v67
    v_and_b32 v21, 0xffff0000, v67
    v_pk_add_f32 v[14:15], v[14:15], v[20:21]
    v_lshlrev_b32 v20, 16, v68
    v_and_b32 v21, 0xffff0000, v68
    v_pk_add_f32 v[8:9], v[8:9], v[20:21]
    v_lshlrev_b32 v20, 16, v69
    v_and_b32 v21, 0xffff0000, v69
    v_pk_add_f32 v[10:11], v[10:11], v[20:21]
    v_lshlrev_b32 v20, 16, v70
    v_and_b32 v21, 0xffff0000, v70
    v_pk_add_f32 v[12:13], v[12:13], v[20:21]
    v_lshlrev_b32 v20, 16, v71
    v_and_b32 v21, 0xffff0000, v71
    v_pk_add_f32 v[14:15], v[14:15], v[20:21]
    v_lshlrev_b32 v20, 16, v72
    v_and_b32 v21, 0xffff0000, v72
    v_pk_add_f32 v[8:9], v[8:9], v[20:21]
    v_lshlrev_b32 v20, 16, v73
    v_and_b32 v21, 0xffff0000, v73
    v_pk_add_f32 v[10:11], v[10:11], v[20:21]
    v_lshlrev_b32 v20, 16, v74
    v_and_b32 v21, 0xffff0000, v74
    v_pk_add_f32 v[12:13], v[12:13], v[20:21]
    v_lshlrev_b32 v20, 16, v75
    v_and_b32 v21, 0xffff0000, v75
    v_pk_add_f32 v[14:15], v[14:15], v[20:21]
    v_lshlrev_b32 v20, 16, v76
    v_and_b32 v21, 0xffff0000, v76
    v_pk_add_f32 v[8:9], v[8:9], v[20:21]
    v_lshlrev_b32 v20, 16, v77
    v_and_b32 v21, 0xffff0000, v77
    v_pk_add_f32 v[10:11], v[10:11], v[20:21]
    v_lshlrev_b32 v20, 16, v78
    v_and_b32 v21, 0xffff0000, v78
    v_pk_add_f32 v[12:13], v[12:13], v[20:21]
    v_lshlrev_b32 v20, 16, v79
    v_and_b32 v21, 0xffff0000, v79
    v_pk_add_f32 v[14:15], v[14:15], v[20:21]
    v_lshlrev_b32 v20, 16, v80
    v_and_b32 v21, 0xffff0000, v80
    v_pk_add_f32 v[8:9], v[8:9], v[20:21]
    v_lshlrev_b32 v20, 16, v81
    v_and_b32 v21, 0xffff0000, v81
    v_pk_add_f32 v[10:11], v[10:11], v[20:21]
    v_lshlrev_b32 v20, 16, v82
    v_and_b32 v21, 0xffff0000, v82
    v_pk_add_f32 v[12:13], v[12:13], v[20:21]
    v_lshlrev_b32 v20, 16, v83
    v_and_b32 v21, 0xffff0000, v83
    v_pk_add_f32 v[14:15], v[14:15], v[20:21]
    v_lshlrev_b32 v20, 16, v84
    v_and_b32 v21, 0xffff0000, v84
    v_pk_add_f32 v[8:9], v[8:9], v[20:21]
    v_lshlrev_b32 v20, 16, v85
    v_and_b32 v21, 0xffff0000, v85
    v_pk_add_f32 v[10:11], v[10:11], v[20:21]
    v_lshlrev_b32 v20, 16, v86
    v_and_b32 v21, 0xffff0000, v86
    v_pk_add_f32 v[12:13], v[12:13], v[20:21]
    v_lshlrev_b32 v20, 16, v87
    v_and_b32 v21, 0xffff0000, v87
    v_pk_add_f32 v[14:15], v[14:15], v[20:21]
    v_lshlrev_b32 v20, 16, v88
    v_and_b32 v21, 0xffff0000, v88
    v_pk_add_f32 v[8:9], v[8:9], v[20:21]
    v_lshlrev_b32 v20, 16, v89
    v_and_b32 v21, 0xffff0000, v89
    v_pk_add_f32 v[10:11], v[10:11], v[20:21]
    v_lshlrev_b32 v20, 16, v90
    v_and_b32 v21, 0xffff0000, v90
    v_pk_add_f32 v[12:13], v[12:13], v[20:21]
    v_lshlrev_b32 v20, 16, v91
    v_and_b32 v21, 0xffff0000, v91
    v_pk_add_f32 v[14:15], v[14:15], v[20:21]
    v_lshlrev_b32 v20, 16, v92
    v_and_b32 v21, 0xffff0000, v92
    v_pk_add_f32 v[8:9], v[8:9], v[20:21]
    v_lshlrev_b32 v20, 16, v93
    v_and_b32 v21, 0xffff0000, v93
    v_pk_add_f32 v[10:11], v[10:11], v[20:21]
    v_lshlrev_b32 v20, 16, v94
    v_and_b32 v21, 0xffff0000, v94
    v_pk_add_f32 v[12:13], v[12:13], v[20:21]
    v_lshlrev_b32 v20, 16, v95
    v_and_b32 v21, 0xffff0000, v95
    v_pk_add_f32 v[14:15], v[14:15], v[20:21]
    v_lshlrev_b32 v20, 16, v96
    v_and_b32 v21, 0xffff0000, v96
    v_pk_add_f32 v[8:9], v[8:9], v[20:21]
    v_lshlrev_b32 v20, 16, v97
    v_and_b32 v21, 0xffff0000, v97
    v_pk_add_f32 v[10:11], v[10:11], v[20:21]
    v_lshlrev_b32 v20, 16, v98
    v_and_b32 v21, 0xffff0000, v98
    v_pk_add_f32 v[12:13], v[12:13], v[20:21]
    v_lshlrev_b32 v20, 16, v99
    v_and_b32 v21, 0xffff0000, v99
    v_pk_add_f32 v[14:15], v[14:15], v[20:21]
    v_lshlrev_b32 v20, 16, v100
    v_and_b32 v21, 0xffff0000, v100
    v_pk_add_f32 v[8:9], v[8:9], v[20:21]
    v_lshlrev_b32 v20, 16, v101
    v_and_b32 v21, 0xffff0000, v101
    v_pk_add_f32 v[10:11], v[10:11], v[20:21]
    v_lshlrev_b32 v20, 16, v102
    v_and_b32 v21, 0xffff0000, v102
    v_pk_add_f32 v[12:13], v[12:13], v[20:21]
    v_lshlrev_b32 v20, 16, v103
    v_and_b32 v21, 0xffff0000, v103
    v_pk_add_f32 v[14:15], v[14:15], v[20:21]
    v_lshlrev_b32 v20, 16, v104
    v_and_b32 v21, 0xffff0000, v104
    v_pk_add_f32 v[8:9], v[8:9], v[20:21]
    v_lshlrev_b32 v20, 16, v105
    v_and_b32 v21, 0xffff0000, v105
    v_pk_add_f32 v[10:11], v[10:11], v[20:21]
    v_lshlrev_b32 v20, 16, v106
    v_and_b32 v21, 0xffff0000, v106
    v_pk_add_f32 v[12:13], v[12:13], v[20:21]
    v_lshlrev_b32 v20, 16, v107
    v_and_b32 v21, 0xffff0000, v107
    v_pk_add_f32 v[14:15], v[14:15], v[20:21]
    v_lshlrev_b32 v20, 16, v108
    v_and_b32 v21, 0xffff0000, v108
    v_pk_add_f32 v[8:9], v[8:9], v[20:21]
    v_lshlrev_b32 v20, 16, v109
    v_and_b32 v21, 0xffff0000, v109
    v_pk_add_f32 v[10:11], v[10:11], v[20:21]
    v_lshlrev_b32 v20, 16, v110
    v_and_b32 v21, 0xffff0000, v110
    v_pk_add_f32 v[12:13], v[12:13], v[20:21]
    v_lshlrev_b32 v20, 16, v111
    v_and_b32 v21, 0xffff0000, v111
    v_pk_add_f32 v[14:15], v[14:15], v[20:21]
    v_lshlrev_b32 v20, 16, v112
    v_and_b32 v21, 0xffff0000, v112
    v_pk_add_f32 v[8:9], v[8:9], v[20:21]
    v_lshlrev_b32 v20, 16, v113
    v_and_b32 v21, 0xffff0000, v113
    v_pk_add_f32 v[10:11], v[10:11], v[20:21]
    v_lshlrev_b32 v20, 16, v114
    v_and_b32 v21, 0xffff0000, v114
    v_pk_add_f32 v[12:13], v[12:13], v[20:21]
    v_lshlrev_b32 v20, 16, v115
    v_and_b32 v21, 0xffff0000, v115
    v_pk_add_f32 v[14:15], v[14:15], v[20:21]
    v_lshlrev_b32 v20, 5, v1
    v_add_u32 v20, 159744, v20
    ds_write_b128 v20, v[8:11]
    ds_write_b128 v20, v[12:15] offset:16
    v_min_u32 v21, 17, v1
    v_lshlrev_b32 v22, 4, v21
    v_add_u32 v22, 159744, v22
    s_waitcnt lgkmcnt(0)
    ds_read_b128 v[32:35], v22 offset:0
    ds_read_b128 v[36:39], v22 offset:288
    ds_read_b128 v[40:43], v22 offset:576
    ds_read_b128 v[44:47], v22 offset:864
    ds_read_b128 v[48:51], v22 offset:1152
    ds_read_b128 v[52:55], v22 offset:1440
    ds_read_b128 v[56:59], v22 offset:1728
    s_waitcnt lgkmcnt(0)
    v_pk_add_f32 v[32:33], v[32:33], v[36:37]
    v_pk_add_f32 v[34:35], v[34:35], v[38:39]
    v_pk_add_f32 v[32:33], v[32:33], v[40:41]
    v_pk_add_f32 v[34:35], v[34:35], v[42:43]
    v_pk_add_f32 v[32:33], v[32:33], v[44:45]
    v_pk_add_f32 v[34:35], v[34:35], v[46:47]
    v_pk_add_f32 v[32:33], v[32:33], v[48:49]
    v_pk_add_f32 v[34:35], v[34:35], v[50:51]
    v_pk_add_f32 v[32:33], v[32:33], v[52:53]
    v_pk_add_f32 v[34:35], v[34:35], v[54:55]
    v_pk_add_f32 v[32:33], v[32:33], v[56:57]
    v_pk_add_f32 v[34:35], v[34:35], v[58:59]
    v_cvt_pk_bf16_f32 v40, v32, v33
    v_cvt_pk_bf16_f32 v41, v34, v35
    v_lshlrev_b32 v36, 16, v40
    v_and_b32 v37, 0xffff0000, v40
    v_lshlrev_b32 v38, 16, v41
    v_and_b32 v39, 0xffff0000, v41
    v_sub_f32 v32, v32, v36
    v_sub_f32 v33, v33, v37
    v_sub_f32 v34, v34, v38
    v_sub_f32 v35, v35, v39
    v_cvt_pk_bf16_f32 v42, v32, v33
    v_cvt_pk_bf16_f32 v43, v34, v35
    v_mov_b32 v44, 0
    v_mov_b32 v45, 0
    v_lshlrev_b32 v21, 3, v1
    v_cmp_gt_u32 vcc, 18, v1
    s_nop 1
    v_cndmask_b32 v21, v27, v21, vcc
    buffer_store_dwordx2 v[40:41], v21, s[28:31], s46 offen sc1
    s_add_u32 s46, s46, 9216
    buffer_store_dwordx2 v[42:43], v21, s[28:31], s46 offen sc1
    s_add_u32 s46, s46, 9216
    buffer_store_dwordx2 v[40:41], v21, s[28:31], s46 offen sc1
    s_add_u32 s46, s46, 9216
    buffer_store_dwordx2 v[44:45], v21, s[28:31], s46 offen sc1
    v_mov_b32 v15, v19
    s_cmp_ge_u32 s24, 18
    s_cselect_b32 s26, 18, 0
    s_sub_u32 s26, s24, s26
    s_cmp_ge_u32 s26, 9
    s_cselect_b32 s27, 9, 0
    s_sub_u32 s27, s26, s27
    v_and_b32 v2, 7, v1
    v_bfe_u32 v3, v1, 3, 2
    v_lshrrev_b32 v4, 5, v1
    s_and_b32 s44, s23, 3
    s_lshl_b32 s44, s44, 3
    v_add_u32 v5, s44, v2
    v_lshlrev_b32 v6, 10, v3
    v_lshl_add_u32 v6, v4, 9, v6
    v_lshl_add_u32 v6, v5, 4, v6
    v_mul_u32_u24 v7, 1152, v2
    v_lshl_add_u32 v7, v3, 5, v7
    v_lshl_add_u32 v7, v4, 4, v7
    s_mov_b32 s32, s16
    s_and_b32 s33, s17, 0xffff
    s_mov_b32 s34, 2359296
    s_mov_b32 s35, 0x20000
    s_lshr_b32 s44, s23, 2
    s_lshl_b32 s45, s24, 1
    s_add_u32 s44, s44, s45
    s_mul_i32 s46, s44, 36864
    s_add_u32 s47, s46, 2359296
    s_add_u32 s46, s46, 8388608
    s_lshl_b32 s44, s24, 6
    s_lshl_b32 s45, s23, 3
    s_add_u32 s44, s44, s45
    s_mul_i32 s48, s44, 1152
    v_lshlrev_b32 v8, 3, v1
    v_lshlrev_b32 v9, 2, v2
    s_lshl_b32 s49, s24, 12
    s_add_u32 s49, s49, 4718592
    s_mul_i32 s50, s24, 1152
    s_add_u32 s50, s50, 6500352
    s_lshl_b32 s44, s23, 2
    v_mov_b32 v11, s44
    s_barrier
    s_barrier
    s_barrier
    s_waitcnt vmcnt(0)
    s_lshl_b32 s51, s23, 7
    s_add_u32 s51, s51, 6496256
    s_lshl_b32 s44, s24, 2
    v_mov_b32 v13, s44
    s_mov_b64 exec, 1
    buffer_store_dword v15, v13, s[28:31], s51 offen sc1
    s_mov_b64 exec, -1
    s_barrier
    s_barrier
    s_barrier
    s_barrier
    s_barrier
    s_barrier
    s_barrier
    s_barrier
    s_barrier
    s_barrier
    s_barrier
    s_barrier
    s_barrier
    s_barrier
    s_barrier
    s_barrier
    s_barrier
    s_barrier
    s_barrier
    s_barrier
    s_lshl_b32 s44, s23, 5
    s_add_u32 s44, s44, 147456
    v_add_u32 v10, s44, v9
    ds_read_b32 v14, v10
    s_waitcnt lgkmcnt(0)
    s_barrier
    s_barrier
    s_barrier
    s_barrier
    s_add_u32 s51, s50, 0
    s_mov_b64 exec, 1
    buffer_store_dword v15, v11, s[28:31], s51 offen sc1
    s_mov_b64 exec, -1
    s_barrier
    s_barrier
    s_add_u32 s51, s50, 0
    buffer_load_dword v12, v9, s[28:31], s51 offen sc1
    s_barrier
    s_barrier
    s_add_u32 s51, s50, 0
    s_mov_b32 s56, 0
    s_waitcnt vmcnt(0)
    v_cmp_ne_u32 vcc, v12, v15
    s_nop 0
    s_cmp_eq_u64 vcc, 0
    s_cbranch_scc1 L_sequential_preLN__linear_kernel_hedgehog__dense_activation_relu__prompt_kernel_polled_28
L_sequential_preLN__linear_kernel_hedgehog__dense_activation_relu__prompt_kernel_poll_27:
    buffer_load_dword v12, v9, s[28:31], s51 offen sc1
    s_waitcnt vmcnt(0)
    v_cmp_ne_u32 vcc, v12, v15
    s_nop 0
    s_cmp_eq_u64 vcc, 0
    s_cbranch_scc1 L_sequential_preLN__linear_kernel_hedgehog__dense_activation_relu__prompt_kernel_polled_28
    s_sleep 1
    s_add_u32 s56, s56, 1
    s_cmp_lt_u32 s56, 0x20000
    s_cbranch_scc1 L_sequential_preLN__linear_kernel_hedgehog__dense_activation_relu__prompt_kernel_poll_27
L_sequential_preLN__linear_kernel_hedgehog__dense_activation_relu__prompt_kernel_polled_28:
    s_add_u32 s52, s27, 0
    s_cmp_ge_u32 s52, 9
    s_cselect_b32 s44, 9, 0
    s_sub_u32 s52, s52, s44
    s_lshl_b32 s44, s52, 12
    s_add_u32 s54, s46, s44
    s_add_u32 s44, s47, s44
    buffer_load_dwordx4 v[32:35], v6, s[28:31], s54 offen sc1
    s_add_u32 s54, s54, 2359296
    buffer_load_dwordx4 v[36:39], v6, s[28:31], s54 offen sc1
    s_add_u32 s54, s54, 2359296
    buffer_load_dwordx4 v[40:43], v6, s[28:31], s54 offen sc1
    s_add_u32 s54, s54, 2359296
    buffer_load_dwordx4 v[44:47], v6, s[28:31], s54 offen sc1
    s_add_u32 s54, s54, 2359296
    buffer_load_dwordx4 v[64:67], v6, s[28:31], s44 offen sc1
    s_add_u32 s51, s50, 256
    s_mov_b64 exec, 1
    buffer_store_dword v15, v11, s[28:31], s51 offen sc1
    s_mov_b64 exec, -1
    s_barrier
    buffer_load_dwordx4 v[48:51], v6, s[28:31], s54 offen sc1
    s_add_u32 s54, s54, 2359296
    buffer_load_dwordx4 v[52:55], v6, s[28:31], s54 offen sc1
    s_add_u32 s54, s54, 2359296
    buffer_load_dwordx4 v[56:59], v6, s[28:31], s54 offen sc1
    s_add_u32 s54, s54, 2359296
    buffer_load_dwordx4 v[60:63], v6, s[28:31], s54 offen sc1
    s_barrier
    s_barrier
    s_waitcnt vmcnt(9)
    v_lshlrev_b32 v68, 16, v32
    v_and_b32 v69, 0xffff0000, v32
    v_lshlrev_b32 v70, 16, v33
    v_and_b32 v71, 0xffff0000, v33
    v_lshlrev_b32 v72, 16, v34
    v_and_b32 v73, 0xffff0000, v34
    v_lshlrev_b32 v74, 16, v35
    v_and_b32 v75, 0xffff0000, v35
    s_waitcnt vmcnt(8)
    v_lshlrev_b32 v24, 16, v36
    v_and_b32 v25, 0xffff0000, v36
    v_pk_add_f32 v[68:69], v[68:69], v[24:25]
    v_lshlrev_b32 v26, 16, v37
    v_and_b32 v27, 0xffff0000, v37
    v_pk_add_f32 v[70:71], v[70:71], v[26:27]
    v_lshlrev_b32 v24, 16, v38
    v_and_b32 v25, 0xffff0000, v38
    v_pk_add_f32 v[72:73], v[72:73], v[24:25]
    v_lshlrev_b32 v26, 16, v39
    v_and_b32 v27, 0xffff0000, v39
    v_pk_add_f32 v[74:75], v[74:75], v[26:27]
    s_waitcnt vmcnt(7)
    v_lshlrev_b32 v24, 16, v40
    v_and_b32 v25, 0xffff0000, v40
    v_pk_add_f32 v[68:69], v[68:69], v[24:25]
    v_lshlrev_b32 v26, 16, v41
    v_and_b32 v27, 0xffff0000, v41
    v_pk_add_f32 v[70:71], v[70:71], v[26:27]
    v_lshlrev_b32 v24, 16, v42
    v_and_b32 v25, 0xffff0000, v42
    v_pk_add_f32 v[72:73], v[72:73], v[24:25]
    v_lshlrev_b32 v26, 16, v43
    v_and_b32 v27, 0xffff0000, v43
    v_pk_add_f32 v[74:75], v[74:75], v[26:27]
    s_waitcnt vmcnt(6)
    v_lshlrev_b32 v24, 16, v44
    v_and_b32 v25, 0xffff0000, v44
    v_pk_add_f32 v[68:69], v[68:69], v[24:25]
    v_lshlrev_b32 v26, 16, v45
    v_and_b32 v27, 0xffff0000, v45
    v_pk_add_f32 v[70:71], v[70:71], v[26:27]
    v_lshlrev_b32 v24, 16, v46
    v_and_b32 v25, 0xffff0000, v46
    v_pk_add_f32 v[72:73], v[72:73], v[24:25]
    v_lshlrev_b32 v26, 16, v47
    v_and_b32 v27, 0xffff0000, v47
    v_pk_add_f32 v[74:75], v[74:75], v[26:27]
    s_barrier
    s_add_u32 s51, s50, 512
    s_mov_b64 exec, 1
    buffer_store_dword v15, v11, s[28:31], s51 offen sc1
    s_mov_b64 exec, -1
    s_barrier
    s_waitcnt vmcnt(4)
    v_lshlrev_b32 v24, 16, v48
    v_and_b32 v25, 0xffff0000, v48
    v_pk_add_f32 v[68:69], v[68:69], v[24:25]
    v_lshlrev_b32 v26, 16, v49
    v_and_b32 v27, 0xffff0000, v49
    v_pk_add_f32 v[70:71], v[70:71], v[26:27]
    v_lshlrev_b32 v24, 16, v50
    v_and_b32 v25, 0xffff0000, v50
    v_pk_add_f32 v[72:73], v[72:73], v[24:25]
    v_lshlrev_b32 v26, 16, v51
    v_and_b32 v27, 0xffff0000, v51
    v_pk_add_f32 v[74:75], v[74:75], v[26:27]
    s_waitcnt vmcnt(3)
    v_lshlrev_b32 v24, 16, v52
    v_and_b32 v25, 0xffff0000, v52
    v_pk_add_f32 v[68:69], v[68:69], v[24:25]
    v_lshlrev_b32 v26, 16, v53
    v_and_b32 v27, 0xffff0000, v53
    v_pk_add_f32 v[70:71], v[70:71], v[26:27]
    v_lshlrev_b32 v24, 16, v54
    v_and_b32 v25, 0xffff0000, v54
    v_pk_add_f32 v[72:73], v[72:73], v[24:25]
    v_lshlrev_b32 v26, 16, v55
    v_and_b32 v27, 0xffff0000, v55
    v_pk_add_f32 v[74:75], v[74:75], v[26:27]
    s_waitcnt vmcnt(2)
    v_lshlrev_b32 v24, 16, v56
    v_and_b32 v25, 0xffff0000, v56
    v_pk_add_f32 v[68:69], v[68:69], v[24:25]
    v_lshlrev_b32 v26, 16, v57
    v_and_b32 v27, 0xffff0000, v57
    v_pk_add_f32 v[70:71], v[70:71], v[26:27]
    v_lshlrev_b32 v24, 16, v58
    v_and_b32 v25, 0xffff0000, v58
    v_pk_add_f32 v[72:73], v[72:73], v[24:25]
    v_lshlrev_b32 v26, 16, v59
    v_and_b32 v27, 0xffff0000, v59
    v_pk_add_f32 v[74:75], v[74:75], v[26:27]
    s_waitcnt vmcnt(1)
    v_lshlrev_b32 v24, 16, v60
    v_and_b32 v25, 0xffff0000, v60
    v_pk_add_f32 v[68:69], v[68:69], v[24:25]
    v_lshlrev_b32 v26, 16, v61
    v_and_b32 v27, 0xffff0000, v61
    v_pk_add_f32 v[70:71], v[70:71], v[26:27]
    v_lshlrev_b32 v24, 16, v62
    v_and_b32 v25, 0xffff0000, v62
    v_pk_add_f32 v[72:73], v[72:73], v[24:25]
    v_lshlrev_b32 v26, 16, v63
    v_and_b32 v27, 0xffff0000, v63
    v_pk_add_f32 v[74:75], v[74:75], v[26:27]
    v_permlane32_swap_b32 v68, v72
    v_permlane32_swap_b32 v69, v73
    v_permlane32_swap_b32 v70, v74
    v_permlane32_swap_b32 v71, v75
    v_lshlrev_b32 v24, 16, v64
    v_and_b32 v25, 0xffff0000, v64
    v_fma_f32 v68, v68, v14, v24
    v_fma_f32 v69, v69, v14, v25
    v_lshlrev_b32 v24, 16, v65
    v_and_b32 v25, 0xffff0000, v65
    v_fma_f32 v70, v70, v14, v24
    v_fma_f32 v71, v71, v14, v25
    v_lshlrev_b32 v24, 16, v66
    v_and_b32 v25, 0xffff0000, v66
    v_fma_f32 v72, v72, v14, v24
    v_fma_f32 v73, v73, v14, v25
    v_lshlrev_b32 v24, 16, v67
    v_and_b32 v25, 0xffff0000, v67
    v_fma_f32 v74, v74, v14, v24
    v_fma_f32 v75, v75, v14, v25
    v_cvt_pk_bf16_f32 v28, v68, v69
    v_cvt_pk_bf16_f32 v29, v70, v71
    v_cvt_pk_bf16_f32 v30, v72, v73
    v_cvt_pk_bf16_f32 v31, v74, v75
    s_lshl_b32 s44, s52, 7
    s_add_u32 s44, s44, s48
    buffer_store_dwordx4 v[28:31], v7, s[32:35], s44 offen
    s_barrier
    s_barrier
    s_barrier
    s_add_u32 s51, s50, 768
    s_mov_b64 exec, 1
    buffer_store_dword v15, v11, s[28:31], s51 offen sc1
    s_mov_b64 exec, -1
    s_barrier
    s_barrier
    s_barrier
    s_add_u32 s51, s50, 1024
    s_mov_b64 exec, 1
    buffer_store_dword v15, v11, s[28:31], s51 offen sc1
    s_mov_b64 exec, -1
    s_add_u32 s51, s50, 768
    s_mov_b32 s56, 0
L_sequential_preLN__linear_kernel_hedgehog__dense_activation_relu__prompt_kernel_poll_29:
    buffer_load_dword v12, v9, s[28:31], s51 offen sc1
    s_waitcnt vmcnt(0)
    v_cmp_ne_u32 vcc, v12, v15
    s_nop 0
    s_cmp_eq_u64 vcc, 0
    s_cbranch_scc1 L_sequential_preLN__linear_kernel_hedgehog__dense_activation_relu__prompt_kernel_polled_30
    s_sleep 1
    s_add_u32 s56, s56, 1
    s_cmp_lt_u32 s56, 0x20000
    s_cbranch_scc1 L_sequential_preLN__linear_kernel_hedgehog__dense_activation_relu__prompt_kernel_poll_29
L_sequential_preLN__linear_kernel_hedgehog__dense_activation_relu__prompt_kernel_polled_30:
    s_add_u32 s53, s27, 6
    s_cmp_ge_u32 s53, 9
    s_cselect_b32 s44, 9, 0
    s_sub_u32 s53, s53, s44
    s_lshl_b32 s44, s53, 12
    s_add_u32 s54, s46, s44
    s_add_u32 s44, s47, s44
    buffer_load_dwordx4 v[80:83], v6, s[28:31], s54 offen sc1
    s_add_u32 s54, s54, 2359296
    buffer_load_dwordx4 v[84:87], v6, s[28:31], s54 offen sc1
    s_add_u32 s54, s54, 2359296
    buffer_load_dwordx4 v[88:91], v6, s[28:31], s54 offen sc1
    s_add_u32 s54, s54, 2359296
    buffer_load_dwordx4 v[92:95], v6, s[28:31], s54 offen sc1
    s_add_u32 s54, s54, 2359296
    buffer_load_dwordx4 v[112:115], v6, s[28:31], s44 offen sc1
    buffer_load_dwordx4 v[96:99], v6, s[28:31], s54 offen sc1
    s_add_u32 s54, s54, 2359296
    buffer_load_dwordx4 v[100:103], v6, s[28:31], s54 offen sc1
    s_add_u32 s54, s54, 2359296
    buffer_load_dwordx4 v[104:107], v6, s[28:31], s54 offen sc1
    s_add_u32 s54, s54, 2359296
    buffer_load_dwordx4 v[108:111], v6, s[28:31], s54 offen sc1
    s_add_u32 s51, s50, 1024
    s_mov_b32 s56, 0
L_sequential_preLN__linear_kernel_hedgehog__dense_activation_relu__prompt_kernel_poll_31:
    buffer_load_dword v12, v9, s[28:31], s51 offen sc1
    s_waitcnt vmcnt(0)
    v_cmp_ne_u32 vcc, v12, v15
    s_nop 0
    s_cmp_eq_u64 vcc, 0
    s_cbranch_scc1 L_sequential_preLN__linear_kernel_hedgehog__dense_activation_relu__prompt_kernel_polled_32
    s_sleep 1
    s_add_u32 s56, s56, 1
    s_cmp_lt_u32 s56, 0x20000
    s_cbranch_scc1 L_sequential_preLN__linear_kernel_hedgehog__dense_activation_relu__prompt_kernel_poll_31
L_sequential_preLN__linear_kernel_hedgehog__dense_activation_relu__prompt_kernel_polled_32:
    s_add_u32 s52, s27, 8
    s_cmp_ge_u32 s52, 9
    s_cselect_b32 s44, 9, 0
    s_sub_u32 s52, s52, s44
    s_lshl_b32 s44, s52, 12
    s_add_u32 s54, s46, s44
    s_add_u32 s44, s47, s44
    buffer_load_dwordx4 v[32:35], v6, s[28:31], s54 offen sc1
    s_add_u32 s54, s54, 2359296
    buffer_load_dwordx4 v[36:39], v6, s[28:31], s54 offen sc1
    s_add_u32 s54, s54, 2359296
    buffer_load_dwordx4 v[40:43], v6, s[28:31], s54 offen sc1
    s_add_u32 s54, s54, 2359296
    buffer_load_dwordx4 v[44:47], v6, s[28:31], s54 offen sc1
    s_add_u32 s54, s54, 2359296
    buffer_load_dwordx4 v[64:67], v6, s[28:31], s44 offen sc1
    buffer_load_dwordx4 v[48:51], v6, s[28:31], s54 offen sc1
    s_add_u32 s54, s54, 2359296
    buffer_load_dwordx4 v[52:55], v6, s[28:31], s54 offen sc1
    s_add_u32 s54, s54, 2359296
    buffer_load_dwordx4 v[56:59], v6, s[28:31], s54 offen sc1
    s_add_u32 s54, s54, 2359296
    buffer_load_dwordx4 v[60:63], v6, s[28:31], s54 offen sc1
    s_waitcnt vmcnt(17)
    v_lshlrev_b32 v116, 16, v80
    v_and_b32 v117, 0xffff0000, v80
    v_lshlrev_b32 v118, 16, v81
    v_and_b32 v119, 0xffff0000, v81
    v_lshlrev_b32 v120, 16, v82
    v_and_b32 v121, 0xffff0000, v82
    v_lshlrev_b32 v122, 16, v83
    v_and_b32 v123, 0xffff0000, v83
    s_waitcnt vmcnt(16)
    v_lshlrev_b32 v24, 16, v84
    v_and_b32 v25, 0xffff0000, v84
    v_pk_add_f32 v[116:117], v[116:117], v[24:25]
    v_lshlrev_b32 v26, 16, v85
    v_and_b32 v27, 0xffff0000, v85
    v_pk_add_f32 v[118:119], v[118:119], v[26:27]
    v_lshlrev_b32 v24, 16, v86
    v_and_b32 v25, 0xffff0000, v86
    v_pk_add_f32 v[120:121], v[120:121], v[24:25]
    v_lshlrev_b32 v26, 16, v87
    v_and_b32 v27, 0xffff0000, v87
    v_pk_add_f32 v[122:123], v[122:123], v[26:27]
    s_waitcnt vmcnt(15)
    v_lshlrev_b32 v24, 16, v88
    v_and_b32 v25, 0xffff0000, v88
    v_pk_add_f32 v[116:117], v[116:117], v[24:25]
    v_lshlrev_b32 v26, 16, v89
    v_and_b32 v27, 0xffff0000, v89
    v_pk_add_f32 v[118:119], v[118:119], v[26:27]
    v_lshlrev_b32 v24, 16, v90
    v_and_b32 v25, 0xffff0000, v90
    v_pk_add_f32 v[120:121], v[120:121], v[24:25]
    v_lshlrev_b32 v26, 16, v91
    v_and_b32 v27, 0xffff0000, v91
    v_pk_add_f32 v[122:123], v[122:123], v[26:27]
    s_waitcnt vmcnt(14)
    v_lshlrev_b32 v24, 16, v92
    v_and_b32 v25, 0xffff0000, v92
    v_pk_add_f32 v[116:117], v[116:117], v[24:25]
    v_lshlrev_b32 v26, 16, v93
    v_and_b32 v27, 0xffff0000, v93
    v_pk_add_f32 v[118:119], v[118:119], v[26:27]
    v_lshlrev_b32 v24, 16, v94
    v_and_b32 v25, 0xffff0000, v94
    v_pk_add_f32 v[120:121], v[120:121], v[24:25]
    v_lshlrev_b32 v26, 16, v95
    v_and_b32 v27, 0xffff0000, v95
    v_pk_add_f32 v[122:123], v[122:123], v[26:27]
    s_waitcnt vmcnt(12)
    v_lshlrev_b32 v24, 16, v96
    v_and_b32 v25, 0xffff0000, v96
    v_pk_add_f32 v[116:117], v[116:117], v[24:25]
    v_lshlrev_b32 v26, 16, v97
    v_and_b32 v27, 0xffff0000, v97
    v_pk_add_f32 v[118:119], v[118:119], v[26:27]
    v_lshlrev_b32 v24, 16, v98
    v_and_b32 v25, 0xffff0000, v98
    v_pk_add_f32 v[120:121], v[120:121], v[24:25]
    v_lshlrev_b32 v26, 16, v99
    v_and_b32 v27, 0xffff0000, v99
    v_pk_add_f32 v[122:123], v[122:123], v[26:27]
    s_waitcnt vmcnt(11)
    v_lshlrev_b32 v24, 16, v100
    v_and_b32 v25, 0xffff0000, v100
    v_pk_add_f32 v[116:117], v[116:117], v[24:25]
    v_lshlrev_b32 v26, 16, v101
    v_and_b32 v27, 0xffff0000, v101
    v_pk_add_f32 v[118:119], v[118:119], v[26:27]
    v_lshlrev_b32 v24, 16, v102
    v_and_b32 v25, 0xffff0000, v102
    v_pk_add_f32 v[120:121], v[120:121], v[24:25]
    v_lshlrev_b32 v26, 16, v103
    v_and_b32 v27, 0xffff0000, v103
    v_pk_add_f32 v[122:123], v[122:123], v[26:27]
    s_waitcnt vmcnt(10)
    v_lshlrev_b32 v24, 16, v104
    v_and_b32 v25, 0xffff0000, v104
    v_pk_add_f32 v[116:117], v[116:117], v[24:25]
    v_lshlrev_b32 v26, 16, v105
    v_and_b32 v27, 0xffff0000, v105
    v_pk_add_f32 v[118:119], v[118:119], v[26:27]
    v_lshlrev_b32 v24, 16, v106
    v_and_b32 v25, 0xffff0000, v106
    v_pk_add_f32 v[120:121], v[120:121], v[24:25]
    v_lshlrev_b32 v26, 16, v107
    v_and_b32 v27, 0xffff0000, v107
    v_pk_add_f32 v[122:123], v[122:123], v[26:27]
    s_waitcnt vmcnt(9)
    v_lshlrev_b32 v24, 16, v108
    v_and_b32 v25, 0xffff0000, v108
    v_pk_add_f32 v[116:117], v[116:117], v[24:25]
    v_lshlrev_b32 v26, 16, v109
    v_and_b32 v27, 0xffff0000, v109
    v_pk_add_f32 v[118:119], v[118:119], v[26:27]
    v_lshlrev_b32 v24, 16, v110
    v_and_b32 v25, 0xffff0000, v110
    v_pk_add_f32 v[120:121], v[120:121], v[24:25]
    v_lshlrev_b32 v26, 16, v111
    v_and_b32 v27, 0xffff0000, v111
    v_pk_add_f32 v[122:123], v[122:123], v[26:27]
    v_permlane32_swap_b32 v116, v120
    v_permlane32_swap_b32 v117, v121
    v_permlane32_swap_b32 v118, v122
    v_permlane32_swap_b32 v119, v123
    v_lshlrev_b32 v24, 16, v112
    v_and_b32 v25, 0xffff0000, v112
    v_fma_f32 v116, v116, v14, v24
    v_fma_f32 v117, v117, v14, v25
    v_lshlrev_b32 v24, 16, v113
    v_and_b32 v25, 0xffff0000, v113
    v_fma_f32 v118, v118, v14, v24
    v_fma_f32 v119, v119, v14, v25
    v_lshlrev_b32 v24, 16, v114
    v_and_b32 v25, 0xffff0000, v114
    v_fma_f32 v120, v120, v14, v24
    v_fma_f32 v121, v121, v14, v25
    v_lshlrev_b32 v24, 16, v115
    v_and_b32 v25, 0xffff0000, v115
    v_fma_f32 v122, v122, v14, v24
    v_fma_f32 v123, v123, v14, v25
    v_cvt_pk_bf16_f32 v28, v116, v117
    v_cvt_pk_bf16_f32 v29, v118, v119
    v_cvt_pk_bf16_f32 v30, v120, v121
    v_cvt_pk_bf16_f32 v31, v122, v123
    s_lshl_b32 s44, s53, 7
    s_add_u32 s44, s44, s48
    buffer_store_dwordx4 v[28:31], v7, s[32:35], s44 offen
    s_waitcnt vmcnt(9)
    v_lshlrev_b32 v68, 16, v32
    v_and_b32 v69, 0xffff0000, v32
    v_lshlrev_b32 v70, 16, v33
    v_and_b32 v71, 0xffff0000, v33
    v_lshlrev_b32 v72, 16, v34
    v_and_b32 v73, 0xffff0000, v34
    v_lshlrev_b32 v74, 16, v35
    v_and_b32 v75, 0xffff0000, v35
    s_waitcnt vmcnt(8)
    v_lshlrev_b32 v24, 16, v36
    v_and_b32 v25, 0xffff0000, v36
    v_pk_add_f32 v[68:69], v[68:69], v[24:25]
    v_lshlrev_b32 v26, 16, v37
    v_and_b32 v27, 0xffff0000, v37
    v_pk_add_f32 v[70:71], v[70:71], v[26:27]
    v_lshlrev_b32 v24, 16, v38
    v_and_b32 v25, 0xffff0000, v38
    v_pk_add_f32 v[72:73], v[72:73], v[24:25]
    v_lshlrev_b32 v26, 16, v39
    v_and_b32 v27, 0xffff0000, v39
    v_pk_add_f32 v[74:75], v[74:75], v[26:27]
    s_waitcnt vmcnt(7)
    v_lshlrev_b32 v24, 16, v40
    v_and_b32 v25, 0xffff0000, v40
    v_pk_add_f32 v[68:69], v[68:69], v[24:25]
    v_lshlrev_b32 v26, 16, v41
    v_and_b32 v27, 0xffff0000, v41
    v_pk_add_f32 v[70:71], v[70:71], v[26:27]
    v_lshlrev_b32 v24, 16, v42
    v_and_b32 v25, 0xffff0000, v42
    v_pk_add_f32 v[72:73], v[72:73], v[24:25]
    v_lshlrev_b32 v26, 16, v43
    v_and_b32 v27, 0xffff0000, v43
    v_pk_add_f32 v[74:75], v[74:75], v[26:27]
    s_waitcnt vmcnt(6)
    v_lshlrev_b32 v24, 16, v44
    v_and_b32 v25, 0xffff0000, v44
    v_pk_add_f32 v[68:69], v[68:69], v[24:25]
    v_lshlrev_b32 v26, 16, v45
    v_and_b32 v27, 0xffff0000, v45
    v_pk_add_f32 v[70:71], v[70:71], v[26:27]
    v_lshlrev_b32 v24, 16, v46
    v_and_b32 v25, 0xffff0000, v46
    v_pk_add_f32 v[72:73], v[72:73], v[24:25]
    v_lshlrev_b32 v26, 16, v47
    v_and_b32 v27, 0xffff0000, v47
    v_pk_add_f32 v[74:75], v[74:75], v[26:27]
    s_waitcnt vmcnt(4)
    v_lshlrev_b32 v24, 16, v48
    v_and_b32 v25, 0xffff0000, v48
    v_pk_add_f32 v[68:69], v[68:69], v[24:25]
    v_lshlrev_b32 v26, 16, v49
    v_and_b32 v27, 0xffff0000, v49
    v_pk_add_f32 v[70:71], v[70:71], v[26:27]
    v_lshlrev_b32 v24, 16, v50
    v_and_b32 v25, 0xffff0000, v50
    v_pk_add_f32 v[72:73], v[72:73], v[24:25]
    v_lshlrev_b32 v26, 16, v51
    v_and_b32 v27, 0xffff0000, v51
    v_pk_add_f32 v[74:75], v[74:75], v[26:27]
    s_waitcnt vmcnt(3)
    v_lshlrev_b32 v24, 16, v52
    v_and_b32 v25, 0xffff0000, v52
    v_pk_add_f32 v[68:69], v[68:69], v[24:25]
    v_lshlrev_b32 v26, 16, v53
    v_and_b32 v27, 0xffff0000, v53
    v_pk_add_f32 v[70:71], v[70:71], v[26:27]
    v_lshlrev_b32 v24, 16, v54
    v_and_b32 v25, 0xffff0000, v54
    v_pk_add_f32 v[72:73], v[72:73], v[24:25]
    v_lshlrev_b32 v26, 16, v55
    v_and_b32 v27, 0xffff0000, v55
    v_pk_add_f32 v[74:75], v[74:75], v[26:27]
    s_waitcnt vmcnt(2)
    v_lshlrev_b32 v24, 16, v56
    v_and_b32 v25, 0xffff0000, v56
    v_pk_add_f32 v[68:69], v[68:69], v[24:25]
    v_lshlrev_b32 v26, 16, v57
    v_and_b32 v27, 0xffff0000, v57
    v_pk_add_f32 v[70:71], v[70:71], v[26:27]
    v_lshlrev_b32 v24, 16, v58
    v_and_b32 v25, 0xffff0000, v58
    v_pk_add_f32 v[72:73], v[72:73], v[24:25]
    v_lshlrev_b32 v26, 16, v59
    v_and_b32 v27, 0xffff0000, v59
    v_pk_add_f32 v[74:75], v[74:75], v[26:27]
    s_waitcnt vmcnt(1)
    v_lshlrev_b32 v24, 16, v60
    v_and_b32 v25, 0xffff0000, v60
    v_pk_add_f32 v[68:69], v[68:69], v[24:25]
    v_lshlrev_b32 v26, 16, v61
    v_and_b32 v27, 0xffff0000, v61
    v_pk_add_f32 v[70:71], v[70:71], v[26:27]
    v_lshlrev_b32 v24, 16, v62
    v_and_b32 v25, 0xffff0000, v62
    v_pk_add_f32 v[72:73], v[72:73], v[24:25]
    v_lshlrev_b32 v26, 16, v63
    v_and_b32 v27, 0xffff0000, v63
    v_pk_add_f32 v[74:75], v[74:75], v[26:27]
    v_permlane32_swap_b32 v68, v72
    v_permlane32_swap_b32 v69, v73
    v_permlane32_swap_b32 v70, v74
    v_permlane32_swap_b32 v71, v75
    v_lshlrev_b32 v24, 16, v64
    v_and_b32 v25, 0xffff0000, v64
    v_fma_f32 v68, v68, v14, v24
    v_fma_f32 v69, v69, v14, v25
    v_lshlrev_b32 v24, 16, v65
    v_and_b32 v25, 0xffff0000, v65
    v_fma_f32 v70, v70, v14, v24
    v_fma_f32 v71, v71, v14, v25
    v_lshlrev_b32 v24, 16, v66
    v_and_b32 v25, 0xffff0000, v66
    v_fma_f32 v72, v72, v14, v24
    v_fma_f32 v73, v73, v14, v25
    v_lshlrev_b32 v24, 16, v67
    v_and_b32 v25, 0xffff0000, v67
    v_fma_f32 v74, v74, v14, v24
    v_fma_f32 v75, v75, v14, v25
    v_cvt_pk_bf16_f32 v28, v68, v69
    v_cvt_pk_bf16_f32 v29, v70, v71
    v_cvt_pk_bf16_f32 v30, v72, v73
    v_cvt_pk_bf16_f32 v31, v74, v75
    s_lshl_b32 s44, s52, 7
    s_add_u32 s44, s44, s48
    buffer_store_dwordx4 v[28:31], v7, s[32:35], s44 offen
    s_endpgm
L_r7:
    s_getpc_b64 s[46:47]
L_sequential_preLN__linear_kernel_hedgehog__dense_activation_relu__prompt_kernel_pc_33:
    s_sub_u32 s46, s46, L_sequential_preLN__linear_kernel_hedgehog__dense_activation_relu__prompt_kernel_pc_33-sequential_preLN__linear_kernel_hedgehog__dense_activation_relu__prompt_kernel
    s_subb_u32 s47, s47, 0
    s_lshl_b32 s44, s24, 12
    v_and_b32 v20, 31, v1
    v_lshlrev_b32 v20, 7, v20
    v_add_u32 v20, s44, v20
    v_min_u32 v20, L_code_end-sequential_preLN__linear_kernel_hedgehog__dense_activation_relu__prompt_kernel-4, v20
    global_load_dword v30, v20, s[46:47]
    s_lshr_b32 s25, s23, 2
    s_lshl_b32 s25, s25, 3
    s_lshr_b32 s44, s24, 2
    s_add_u32 s25, s25, s44
    s_and_b32 s26, s23, 3
    s_lshl_b32 s26, s26, 2
    s_and_b32 s45, s24, 3
    s_add_u32 s26, s26, s45
    s_lshl_b32 s45, s45, 1
    s_add_u32 s27, s44, s45
    s_cmp_ge_u32 s27, 9
    s_cselect_b32 s44, 9, 0
    s_sub_u32 s27, s27, s44
    v_mov_b32 v27, 2146435072
    v_lshlrev_b32 v12, 7, v1
    v_cmp_gt_u32 vcc, 34, v1
    s_nop 1
    v_cndmask_b32 v13, v27, v12, vcc
    s_mul_i32 s48, s24, 20736
    s_mul_i32 s49, s23, 663552
    s_add_u32 s49, s49, s48
    s_lshl_b32 s50, s26, 7
    s_add_u32 s50, s50, 6488064
    s_lshl_b32 s44, s25, 2
    v_mov_b32 v16, s44
    v_and_b32 v17, 15, v1
    v_lshlrev_b32 v17, 2, v17
    v_mov_b32 v18, 0
    s_waitcnt lgkmcnt(0)
    s_mov_b32 s28, s20
    s_and_b32 s29, s21, 0xffff
    s_mov_b32 s30, 27262976
    s_mov_b32 s31, 0x20000
    s_mov_b32 s32, s14
    s_and_b32 s33, s15, 0xffff
    s_mov_b32 s34, 5308416
    s_mov_b32 s35, 0x20000
    s_mov_b32 s36, s18
    s_and_b32 s37, s19, 0xffff
    s_mov_b32 s38, 256
    s_mov_b32 s39, 0x20000
    s_mov_b32 s40, s10
    s_and_b32 s41, s11, 0xffff
    s_mov_b32 s42, 663552
    s_mov_b32 s43, 0x20000
    s_cmp_lg_u32 s2, 0
    s_cbranch_scc1 L_sequential_preLN__linear_kernel_hedgehog__dense_activation_relu__prompt_kernel_nononce_34
    s_memrealtime s[44:45]
    s_waitcnt lgkmcnt(0)
    s_or_b32 s44, s44, 1
    v_mov_b32 v20, s44
    s_mov_b64 exec, 1
    buffer_store_dword v20, v18, s[36:39], 0 offen sc1
    s_mov_b64 exec, -1
L_sequential_preLN__linear_kernel_hedgehog__dense_activation_relu__prompt_kernel_nononce_34:
    s_lshr_b32 s48, s24, 1
    s_mul_i32 s48, s48, 41472
    s_lshr_b32 s52, s23, 1
    s_xor_b32 s52, s52, s24
    s_and_b32 s52, s52, 1
    v_cmp_gt_u32 vcc, 4, v1
    s_nop 1
    v_cndmask_b32 v13, v27, v12, vcc
    s_barrier
    s_barrier
    s_barrier
    s_mov_b32 s56, 0
L_sequential_preLN__linear_kernel_hedgehog__dense_activation_relu__prompt_kernel_renonce_35:
    buffer_load_dword v15, v18, s[36:39], 0 offen sc1
    s_waitcnt vmcnt(0)
    v_readfirstlane_b32 s57, v15
    s_nop 0
    s_cmp_lg_u32 s57, 0
    s_cbranch_scc1 L_sequential_preLN__linear_kernel_hedgehog__dense_activation_relu__prompt_kernel_gotnonce_36
    s_add_u32 s56, s56, 1
    s_cmp_lt_u32 s56, 0x40000
    s_cbranch_scc1 L_sequential_preLN__linear_kernel_hedgehog__dense_activation_relu__prompt_kernel_renonce_35
L_sequential_preLN__linear_kernel_hedgehog__dense_activation_relu__prompt_kernel_gotnonce_36:
    v_mov_b32 v19, 137968
    ds_write_b32 v19, v15
    s_waitcnt lgkmcnt(0)
    s_barrier
    s_barrier
    s_cmp_lg_u32 s52, 0
    s_cbranch_scc1 L_sequential_preLN__linear_kernel_hedgehog__dense_activation_relu__prompt_kernel_notouch_37
    buffer_load_dword v30, v12, s[40:43], s48 offen
    s_add_u32 s48, s48, 8192
    buffer_load_dword v30, v12, s[40:43], s48 offen
    s_add_u32 s48, s48, 8192
L_sequential_preLN__linear_kernel_hedgehog__dense_activation_relu__prompt_kernel_notouch_37:
    s_barrier
    s_cmp_lg_u32 s52, 0
    s_cbranch_scc1 L_sequential_preLN__linear_kernel_hedgehog__dense_activation_relu__prompt_kernel_notouch_38
    buffer_load_dword v30, v12, s[40:43], s48 offen
    s_add_u32 s48, s48, 8192
    buffer_load_dword v30, v12, s[40:43], s48 offen
    s_add_u32 s48, s48, 8192
L_sequential_preLN__linear_kernel_hedgehog__dense_activation_relu__prompt_kernel_notouch_38:
    s_barrier
    s_cmp_lg_u32 s52, 0
    s_cbranch_scc1 L_sequential_preLN__linear_kernel_hedgehog__dense_activation_relu__prompt_kernel_notouch_39
    buffer_load_dword v30, v12, s[40:43], s48 offen
    s_add_u32 s48, s48, 8192
    buffer_load_dword v30, v13, s[40:43], s48 offen
    s_add_u32 s48, s48, 8192
L_sequential_preLN__linear_kernel_hedgehog__dense_activation_relu__prompt_kernel_notouch_39:
    s_barrier
    s_barrier
    s_barrier
    s_barrier
    s_barrier
    s_barrier
    s_barrier
    s_barrier
    s_barrier
    s_barrier
    s_barrier
    s_barrier
    s_barrier
    s_barrier
    s_barrier
    s_lshl_b32 s25, s23, 2
    s_lshr_b32 s44, s24, 3
    s_add_u32 s25, s25, s44
    s_and_b32 s26, s24, 7
    s_and_b32 s27, s24, 1
    s_lshl_b32 s50, s25, 7
    s_add_u32 s50, s50, 6492160
    s_lshl_b32 s44, s26, 2
    v_mov_b32 v16, s44
    s_lshl_b32 s54, s24, 7
    s_add_u32 s54, s54, 6492160
    v_and_b32 v17, 7, v1
    v_lshlrev_b32 v17, 2, v17
    v_lshlrev_b32 v20, 4, v1
    s_barrier
    s_barrier
    s_mov_b64 exec, 1
    buffer_store_dword v15, v16, s[28:31], s50 offen sc1
    s_mov_b64 exec, -1
    s_cmp_ge_u32 s24, 18
    s_cselect_b32 s26, 18, 0
    s_sub_u32 s26, s24, s26
    s_cmp_ge_u32 s26, 9
    s_cselect_b32 s27, 9, 0
    s_sub_u32 s27, s26, s27
    s_mul_i32 s48, s24, 73728
    s_add_u32 s48, s48, 2359296
    s_add_u32 s49, s48, 36864
    s_lshl_b32 s44, s26, 11
    s_add_u32 s48, s48, s44
    s_mov_b32 s56, 0
L_sequential_preLN__linear_kernel_hedgehog__dense_activation_relu__prompt_kernel_poll_40:
    buffer_load_dword v19, v17, s[28:31], s54 offen sc1
    s_waitcnt vmcnt(0)
    v_cmp_ne_u32 vcc, v19, v15
    s_nop 0
    s_cmp_eq_u64 vcc, 0
    s_cbranch_scc1 L_sequential_preLN__linear_kernel_hedgehog__dense_activation_relu__prompt_kernel_polled_41
    s_sleep 1
    s_add_u32 s56, s56, 1
    s_cmp_lt_u32 s56, 0x20000
    s_cbranch_scc1 L_sequential_preLN__linear_kernel_hedgehog__dense_activation_relu__prompt_kernel_poll_40
L_sequential_preLN__linear_kernel_hedgehog__dense_activation_relu__prompt_kernel_polled_41:
    s_add_u32 s45, s48, 0
    s_mov_b32 m0, 147456
    s_nop 0
    buffer_load_dwordx4 v20, s[28:31], s45 offen sc1 lds
    s_mov_b32 m0, 148480
    s_nop 0
    buffer_load_dwordx4 v20, s[28:31], s45 offen offset:1024 sc1 lds
    s_add_u32 s45, s48, 36864
    s_mov_b32 m0, 148480
    s_nop 0
    buffer_load_dwordx4 v20, s[28:31], s45 offen sc1 lds
    s_mov_b32 m0, 149504
    s_nop 0
    buffer_load_dwordx4 v20, s[28:31], s45 offen offset:1024 sc1 lds
    s_add_u32 s48, s48, 2048
    s_cmp_ge_u32 s48, s49
    s_cselect_b32 s44, 36864, 0
    s_sub_u32 s48, s48, s44
    s_add_u32 s45, s48, 0
    s_mov_b32 m0, 151552
    s_nop 0
    buffer_load_dwordx4 v20, s[28:31], s45 offen sc1 lds
    s_mov_b32 m0, 152576
    s_nop 0
    buffer_load_dwordx4 v20, s[28:31], s45 offen offset:1024 sc1 lds
    s_add_u32 s45, s48, 36864
    s_mov_b32 m0, 152576
    s_nop 0
    buffer_load_dwordx4 v20, s[28:31], s45 offen sc1 lds
    s_mov_b32 m0, 153600
    s_nop 0
    buffer_load_dwordx4 v20, s[28:31], s45 offen offset:1024 sc1 lds
    s_add_u32 s48, s48, 2048
    s_cmp_ge_u32 s48, s49
    s_cselect_b32 s44, 36864, 0
    s_sub_u32 s48, s48, s44
    s_add_u32 s45, s48, 0
    s_mov_b32 m0, 155648
    s_nop 0
    buffer_load_dwordx4 v20, s[28:31], s45 offen sc1 lds
    s_mov_b32 m0, 156672
    s_nop 0
    buffer_load_dwordx4 v20, s[28:31], s45 offen offset:1024 sc1 lds
    s_add_u32 s45, s48, 36864
    s_mov_b32 m0, 156672
    s_nop 0
    buffer_load_dwordx4 v20, s[28:31], s45 offen sc1 lds
    s_mov_b32 m0, 157696
    s_nop 0
    buffer_load_dwordx4 v20, s[28:31], s45 offen offset:1024 sc1 lds
    s_add_u32 s48, s48, 2048
    s_cmp_ge_u32 s48, s49
    s_cselect_b32 s44, 36864, 0
    s_sub_u32 s48, s48, s44
    s_cmp_ge_u32 s24, 18
    s_cselect_b32 s26, 18, 0
    s_sub_u32 s26, s24, s26
    s_cmp_ge_u32 s26, 9
    s_cselect_b32 s27, 9, 0
    s_sub_u32 s27, s26, s27
    v_and_b32 v2, 7, v1
    v_bfe_u32 v3, v1, 3, 2
    v_lshrrev_b32 v4, 5, v1
    s_and_b32 s44, s23, 3
    s_lshl_b32 s44, s44, 3
    v_add_u32 v5, s44, v2
    v_lshlrev_b32 v6, 10, v3
    v_lshl_add_u32 v6, v4, 9, v6
    v_lshl_add_u32 v6, v5, 4, v6
    v_mul_u32_u24 v7, 1152, v2
    v_lshl_add_u32 v7, v3, 5, v7
    v_lshl_add_u32 v7, v4, 4, v7
    s_mov_b32 s32, s16
    s_and_b32 s33, s17, 0xffff
    s_mov_b32 s34, 2359296
    s_mov_b32 s35, 0x20000
    s_lshr_b32 s44, s23, 2
    s_lshl_b32 s45, s24, 1
    s_add_u32 s44, s44, s45
    s_mul_i32 s46, s44, 36864
    s_add_u32 s47, s46, 2359296
    s_add_u32 s46, s46, 8388608
    s_lshl_b32 s44, s24, 6
    s_lshl_b32 s45, s23, 3
    s_add_u32 s44, s44, s45
    s_mul_i32 s48, s44, 1152
    v_lshlrev_b32 v8, 3, v1
    v_lshlrev_b32 v9, 2, v2
    s_lshl_b32 s49, s24, 12
    s_add_u32 s49, s49, 4718592
    s_mul_i32 s50, s24, 1152
    s_add_u32 s50, s50, 6500352
    s_lshl_b32 s44, s23, 2
    v_mov_b32 v11, s44
    s_waitcnt vmcnt(8)
    s_barrier
    s_waitcnt vmcnt(4)
    s_barrier
    s_waitcnt vmcnt(0)
    s_barrier
    s_barrier
    buffer_load_dwordx2 v[16:17], v8, s[28:31], s49 offen offset:0 sc1
    buffer_load_dwordx2 v[18:19], v8, s[28:31], s49 offen offset:512 sc1
    buffer_load_dwordx2 v[20:21], v8, s[28:31], s49 offen offset:1024 sc1
    buffer_load_dwordx2 v[22:23], v8, s[28:31], s49 offen offset:1536 sc1
    buffer_load_dwordx2 v[24:25], v8, s[28:31], s49 offen offset:2048 sc1
    buffer_load_dwordx2 v[26:27], v8, s[28:31], s49 offen offset:2560 sc1
    buffer_load_dwordx2 v[28:29], v8, s[28:31], s49 offen offset:3072 sc1
    buffer_load_dwordx2 v[30:31], v8, s[28:31], s49 offen offset:3584 sc1
    s_barrier
    s_barrier
    s_barrier
    s_barrier
    s_waitcnt vmcnt(0)
    v_pk_add_f32 v[16:17], v[16:17], v[18:19]
    v_pk_add_f32 v[16:17], v[16:17], v[20:21]
    v_pk_add_f32 v[16:17], v[16:17], v[22:23]
    v_pk_add_f32 v[16:17], v[16:17], v[24:25]
    v_pk_add_f32 v[16:17], v[16:17], v[26:27]
    v_pk_add_f32 v[16:17], v[16:17], v[28:29]
    v_pk_add_f32 v[16:17], v[16:17], v[30:31]
    v_mul_f32 v16, -0.001736111111111111, v16
    v_mul_f32 v17, 0.001736111111111111, v17
    v_fma_f32 v17, -v16, v16, v17
    v_max_f32 v17, 0, v17
    v_add_f32 v17, 0x3727c5ac, v17
    v_rsq_f32 v20, v17
    v_cvt_pk_bf16_f32 v18, v16, v16
    v_and_b32 v17, 0xffff0000, v18
    v_sub_f32 v17, v16, v17
    v_mov_b32 v16, 0
    v_cvt_pk_bf16_f32 v19, v17, v16
    s_barrier
    s_barrier
    v_and_b32 v13, 31, v1
    v_lshlrev_b32 v13, 2, v13
    s_lshl_b32 s51, s23, 7
    s_add_u32 s51, s51, 6496256
    buffer_load_dword v12, v13, s[28:31], s51 offen sc1
    s_barrier
    s_barrier
    s_barrier
    s_mov_b32 s56, 0
    s_waitcnt vmcnt(0)
    v_cmp_ne_u32 vcc, v12, v15
    s_nop 0
    s_cmp_eq_u64 vcc, 0
    s_cbranch_scc1 L_sequential_preLN__linear_kernel_hedgehog__dense_activation_relu__prompt_kernel_polled_43
L_sequential_preLN__linear_kernel_hedgehog__dense_activation_relu__prompt_kernel_poll_42:
    buffer_load_dword v12, v13, s[28:31], s51 offen sc1
    s_waitcnt vmcnt(0)
    v_cmp_ne_u32 vcc, v12, v15
    s_nop 0
    s_cmp_eq_u64 vcc, 0
    s_cbranch_scc1 L_sequential_preLN__linear_kernel_hedgehog__dense_activation_relu__prompt_kernel_polled_43
    s_sleep 1
    s_add_u32 s56, s56, 1
    s_cmp_lt_u32 s56, 0x20000
    s_cbranch_scc1 L_sequential_preLN__linear_kernel_hedgehog__dense_activation_relu__prompt_kernel_poll_42
L_sequential_preLN__linear_kernel_hedgehog__dense_activation_relu__prompt_kernel_polled_43:
    s_barrier
    s_barrier
    s_barrier
    s_barrier
    v_add_u32 v10, 92160, v8
    ds_write_b64 v10, v[18:19]
    s_waitcnt lgkmcnt(0)
    s_barrier
    s_barrier
    s_barrier
    s_barrier
    s_barrier
    v_lshlrev_b32 v10, 2, v1
    v_add_u32 v10, 147456, v10
    ds_write_b32 v10, v20
    s_waitcnt lgkmcnt(0)
    s_barrier
    s_lshl_b32 s44, s23, 5
    s_add_u32 s44, s44, 147456
    v_add_u32 v10, s44, v9
    ds_read_b32 v14, v10
    s_waitcnt lgkmcnt(0)
    s_barrier
    s_barrier
    s_barrier
    s_barrier
    s_barrier
    s_barrier
    s_add_u32 s51, s50, 128
    s_mov_b64 exec, 1
    buffer_store_dword v15, v11, s[28:31], s51 offen sc1
    s_mov_b64 exec, -1
    s_barrier
    s_barrier
    s_add_u32 s51, s50, 128
    buffer_load_dword v12, v9, s[28:31], s51 offen sc1
    s_barrier
    s_barrier
    s_add_u32 s51, s50, 128
    s_mov_b32 s56, 0
    s_waitcnt vmcnt(0)
    v_cmp_ne_u32 vcc, v12, v15
    s_nop 0
    s_cmp_eq_u64 vcc, 0
    s_cbranch_scc1 L_sequential_preLN__linear_kernel_hedgehog__dense_activation_relu__prompt_kernel_polled_45
L_sequential_preLN__linear_kernel_hedgehog__dense_activation_relu__prompt_kernel_poll_44:
    buffer_load_dword v12, v9, s[28:31], s51 offen sc1
    s_waitcnt vmcnt(0)
    v_cmp_ne_u32 vcc, v12, v15
    s_nop 0
    s_cmp_eq_u64 vcc, 0
    s_cbranch_scc1 L_sequential_preLN__linear_kernel_hedgehog__dense_activation_relu__prompt_kernel_polled_45
    s_sleep 1
    s_add_u32 s56, s56, 1
    s_cmp_lt_u32 s56, 0x20000
    s_cbranch_scc1 L_sequential_preLN__linear_kernel_hedgehog__dense_activation_relu__prompt_kernel_poll_44
L_sequential_preLN__linear_kernel_hedgehog__dense_activation_relu__prompt_kernel_polled_45:
    s_add_u32 s52, s27, 1
    s_cmp_ge_u32 s52, 9
    s_cselect_b32 s44, 9, 0
    s_sub_u32 s52, s52, s44
    s_lshl_b32 s44, s52, 12
    s_add_u32 s54, s46, s44
    s_add_u32 s44, s47, s44
    buffer_load_dwordx4 v[32:35], v6, s[28:31], s54 offen sc1
    s_add_u32 s54, s54, 2359296
    buffer_load_dwordx4 v[36:39], v6, s[28:31], s54 offen sc1
    s_add_u32 s54, s54, 2359296
    buffer_load_dwordx4 v[40:43], v6, s[28:31], s54 offen sc1
    s_add_u32 s54, s54, 2359296
    buffer_load_dwordx4 v[44:47], v6, s[28:31], s54 offen sc1
    s_add_u32 s54, s54, 2359296
    buffer_load_dwordx4 v[64:67], v6, s[28:31], s44 offen sc1
    s_add_u32 s51, s50, 384
    s_mov_b64 exec, 1
    buffer_store_dword v15, v11, s[28:31], s51 offen sc1
    s_mov_b64 exec, -1
    s_barrier
    buffer_load_dwordx4 v[48:51], v6, s[28:31], s54 offen sc1
    s_add_u32 s54, s54, 2359296
    buffer_load_dwordx4 v[52:55], v6, s[28:31], s54 offen sc1
    s_add_u32 s54, s54, 2359296
    buffer_load_dwordx4 v[56:59], v6, s[28:31], s54 offen sc1
    s_add_u32 s54, s54, 2359296
    buffer_load_dwordx4 v[60:63], v6, s[28:31], s54 offen sc1
    s_barrier
    s_barrier
    s_waitcnt vmcnt(9)
    v_lshlrev_b32 v68, 16, v32
    v_and_b32 v69, 0xffff0000, v32
    v_lshlrev_b32 v70, 16, v33
    v_and_b32 v71, 0xffff0000, v33
    v_lshlrev_b32 v72, 16, v34
    v_and_b32 v73, 0xffff0000, v34
    v_lshlrev_b32 v74, 16, v35
    v_and_b32 v75, 0xffff0000, v35
    s_waitcnt vmcnt(8)
    v_lshlrev_b32 v24, 16, v36
    v_and_b32 v25, 0xffff0000, v36
    v_pk_add_f32 v[68:69], v[68:69], v[24:25]
    v_lshlrev_b32 v26, 16, v37
    v_and_b32 v27, 0xffff0000, v37
    v_pk_add_f32 v[70:71], v[70:71], v[26:27]
    v_lshlrev_b32 v24, 16, v38
    v_and_b32 v25, 0xffff0000, v38
    v_pk_add_f32 v[72:73], v[72:73], v[24:25]
    v_lshlrev_b32 v26, 16, v39
    v_and_b32 v27, 0xffff0000, v39
    v_pk_add_f32 v[74:75], v[74:75], v[26:27]
    s_waitcnt vmcnt(7)
    v_lshlrev_b32 v24, 16, v40
    v_and_b32 v25, 0xffff0000, v40
    v_pk_add_f32 v[68:69], v[68:69], v[24:25]
    v_lshlrev_b32 v26, 16, v41
    v_and_b32 v27, 0xffff0000, v41
    v_pk_add_f32 v[70:71], v[70:71], v[26:27]
    v_lshlrev_b32 v24, 16, v42
    v_and_b32 v25, 0xffff0000, v42
    v_pk_add_f32 v[72:73], v[72:73], v[24:25]
    v_lshlrev_b32 v26, 16, v43
    v_and_b32 v27, 0xffff0000, v43
    v_pk_add_f32 v[74:75], v[74:75], v[26:27]
    s_waitcnt vmcnt(6)
    v_lshlrev_b32 v24, 16, v44
    v_and_b32 v25, 0xffff0000, v44
    v_pk_add_f32 v[68:69], v[68:69], v[24:25]
    v_lshlrev_b32 v26, 16, v45
    v_and_b32 v27, 0xffff0000, v45
    v_pk_add_f32 v[70:71], v[70:71], v[26:27]
    v_lshlrev_b32 v24, 16, v46
    v_and_b32 v25, 0xffff0000, v46
    v_pk_add_f32 v[72:73], v[72:73], v[24:25]
    v_lshlrev_b32 v26, 16, v47
    v_and_b32 v27, 0xffff0000, v47
    v_pk_add_f32 v[74:75], v[74:75], v[26:27]
    s_barrier
    s_add_u32 s51, s50, 640
    s_mov_b64 exec, 1
    buffer_store_dword v15, v11, s[28:31], s51 offen sc1
    s_mov_b64 exec, -1
    s_barrier
    s_waitcnt vmcnt(4)
    v_lshlrev_b32 v24, 16, v48
    v_and_b32 v25, 0xffff0000, v48
    v_pk_add_f32 v[68:69], v[68:69], v[24:25]
    v_lshlrev_b32 v26, 16, v49
    v_and_b32 v27, 0xffff0000, v49
    v_pk_add_f32 v[70:71], v[70:71], v[26:27]
    v_lshlrev_b32 v24, 16, v50
    v_and_b32 v25, 0xffff0000, v50
    v_pk_add_f32 v[72:73], v[72:73], v[24:25]
    v_lshlrev_b32 v26, 16, v51
    v_and_b32 v27, 0xffff0000, v51
    v_pk_add_f32 v[74:75], v[74:75], v[26:27]
    s_waitcnt vmcnt(3)
    v_lshlrev_b32 v24, 16, v52
    v_and_b32 v25, 0xffff0000, v52
    v_pk_add_f32 v[68:69], v[68:69], v[24:25]
    v_lshlrev_b32 v26, 16, v53
    v_and_b32 v27, 0xffff0000, v53
    v_pk_add_f32 v[70:71], v[70:71], v[26:27]
    v_lshlrev_b32 v24, 16, v54
    v_and_b32 v25, 0xffff0000, v54
    v_pk_add_f32 v[72:73], v[72:73], v[24:25]
    v_lshlrev_b32 v26, 16, v55
    v_and_b32 v27, 0xffff0000, v55
    v_pk_add_f32 v[74:75], v[74:75], v[26:27]
    s_waitcnt vmcnt(2)
    v_lshlrev_b32 v24, 16, v56
    v_and_b32 v25, 0xffff0000, v56
    v_pk_add_f32 v[68:69], v[68:69], v[24:25]
    v_lshlrev_b32 v26, 16, v57
    v_and_b32 v27, 0xffff0000, v57
    v_pk_add_f32 v[70:71], v[70:71], v[26:27]
    v_lshlrev_b32 v24, 16, v58
    v_and_b32 v25, 0xffff0000, v58
    v_pk_add_f32 v[72:73], v[72:73], v[24:25]
    v_lshlrev_b32 v26, 16, v59
    v_and_b32 v27, 0xffff0000, v59
    v_pk_add_f32 v[74:75], v[74:75], v[26:27]
    s_waitcnt vmcnt(1)
    v_lshlrev_b32 v24, 16, v60
    v_and_b32 v25, 0xffff0000, v60
    v_pk_add_f32 v[68:69], v[68:69], v[24:25]
    v_lshlrev_b32 v26, 16, v61
    v_and_b32 v27, 0xffff0000, v61
    v_pk_add_f32 v[70:71], v[70:71], v[26:27]
    v_lshlrev_b32 v24, 16, v62
    v_and_b32 v25, 0xffff0000, v62
    v_pk_add_f32 v[72:73], v[72:73], v[24:25]
    v_lshlrev_b32 v26, 16, v63
    v_and_b32 v27, 0xffff0000, v63
    v_pk_add_f32 v[74:75], v[74:75], v[26:27]
    v_permlane32_swap_b32 v68, v72
    v_permlane32_swap_b32 v69, v73
    v_permlane32_swap_b32 v70, v74
    v_permlane32_swap_b32 v71, v75
    v_lshlrev_b32 v24, 16, v64
    v_and_b32 v25, 0xffff0000, v64
    v_fma_f32 v68, v68, v14, v24
    v_fma_f32 v69, v69, v14, v25
    v_lshlrev_b32 v24, 16, v65
    v_and_b32 v25, 0xffff0000, v65
    v_fma_f32 v70, v70, v14, v24
    v_fma_f32 v71, v71, v14, v25
    v_lshlrev_b32 v24, 16, v66
    v_and_b32 v25, 0xffff0000, v66
    v_fma_f32 v72, v72, v14, v24
    v_fma_f32 v73, v73, v14, v25
    v_lshlrev_b32 v24, 16, v67
    v_and_b32 v25, 0xffff0000, v67
    v_fma_f32 v74, v74, v14, v24
    v_fma_f32 v75, v75, v14, v25
    v_cvt_pk_bf16_f32 v28, v68, v69
    v_cvt_pk_bf16_f32 v29, v70, v71
    v_cvt_pk_bf16_f32 v30, v72, v73
    v_cvt_pk_bf16_f32 v31, v74, v75
    s_lshl_b32 s44, s52, 7
    s_add_u32 s44, s44, s48
    buffer_store_dwordx4 v[28:31], v7, s[32:35], s44 offen
    s_barrier
    s_barrier
    s_add_u32 s51, s50, 640
    buffer_load_dword v12, v9, s[28:31], s51 offen sc1
    s_add_u32 s51, s50, 640
    s_mov_b32 s56, 0
    s_waitcnt vmcnt(0)
    v_cmp_ne_u32 vcc, v12, v15
    s_nop 0
    s_cmp_eq_u64 vcc, 0
    s_cbranch_scc1 L_sequential_preLN__linear_kernel_hedgehog__dense_activation_relu__prompt_kernel_polled_47
L_sequential_preLN__linear_kernel_hedgehog__dense_activation_relu__prompt_kernel_poll_46:
    buffer_load_dword v12, v9, s[28:31], s51 offen sc1
    s_waitcnt vmcnt(0)
    v_cmp_ne_u32 vcc, v12, v15
    s_nop 0
    s_cmp_eq_u64 vcc, 0
    s_cbranch_scc1 L_sequential_preLN__linear_kernel_hedgehog__dense_activation_relu__prompt_kernel_polled_47
    s_sleep 1
    s_add_u32 s56, s56, 1
    s_cmp_lt_u32 s56, 0x20000
    s_cbranch_scc1 L_sequential_preLN__linear_kernel_hedgehog__dense_activation_relu__prompt_kernel_poll_46
L_sequential_preLN__linear_kernel_hedgehog__dense_activation_relu__prompt_kernel_polled_47:
    s_barrier
    s_add_u32 s51, s50, 896
    s_mov_b64 exec, 1
    buffer_store_dword v15, v11, s[28:31], s51 offen sc1
    s_mov_b64 exec, -1
    s_barrier
    s_add_u32 s51, s50, 896
    s_mov_b32 s56, 0
L_sequential_preLN__linear_kernel_hedgehog__dense_activation_relu__prompt_kernel_poll_48:
    buffer_load_dword v12, v9, s[28:31], s51 offen sc1
    s_waitcnt vmcnt(0)
    v_cmp_ne_u32 vcc, v12, v15
    s_nop 0
    s_cmp_eq_u64 vcc, 0
    s_cbranch_scc1 L_sequential_preLN__linear_kernel_hedgehog__dense_activation_relu__prompt_kernel_polled_49
    s_sleep 1
    s_add_u32 s56, s56, 1
    s_cmp_lt_u32 s56, 0x20000
    s_cbranch_scc1 L_sequential_preLN__linear_kernel_hedgehog__dense_activation_relu__prompt_kernel_poll_48
L_sequential_preLN__linear_kernel_hedgehog__dense_activation_relu__prompt_kernel_polled_49:
    s_add_u32 s53, s27, 7
    s_cmp_ge_u32 s53, 9
    s_cselect_b32 s44, 9, 0
    s_sub_u32 s53, s53, s44
    s_lshl_b32 s44, s53, 12
    s_add_u32 s54, s46, s44
    s_add_u32 s44, s47, s44
    buffer_load_dwordx4 v[80:83], v6, s[28:31], s54 offen sc1
    s_add_u32 s54, s54, 2359296
    buffer_load_dwordx4 v[84:87], v6, s[28:31], s54 offen sc1
    s_add_u32 s54, s54, 2359296
    buffer_load_dwordx4 v[88:91], v6, s[28:31], s54 offen sc1
    s_add_u32 s54, s54, 2359296
    buffer_load_dwordx4 v[92:95], v6, s[28:31], s54 offen sc1
    s_add_u32 s54, s54, 2359296
    buffer_load_dwordx4 v[112:115], v6, s[28:31], s44 offen sc1
    buffer_load_dwordx4 v[96:99], v6, s[28:31], s54 offen sc1
    s_add_u32 s54, s54, 2359296
    buffer_load_dwordx4 v[100:103], v6, s[28:31], s54 offen sc1
    s_add_u32 s54, s54, 2359296
    buffer_load_dwordx4 v[104:107], v6, s[28:31], s54 offen sc1
    s_add_u32 s54, s54, 2359296
    buffer_load_dwordx4 v[108:111], v6, s[28:31], s54 offen sc1
    s_waitcnt vmcnt(8)
    v_lshlrev_b32 v116, 16, v80
    v_and_b32 v117, 0xffff0000, v80
    v_lshlrev_b32 v118, 16, v81
    v_and_b32 v119, 0xffff0000, v81
    v_lshlrev_b32 v120, 16, v82
    v_and_b32 v121, 0xffff0000, v82
    v_lshlrev_b32 v122, 16, v83
    v_and_b32 v123, 0xffff0000, v83
    s_waitcnt vmcnt(7)
    v_lshlrev_b32 v24, 16, v84
    v_and_b32 v25, 0xffff0000, v84
    v_pk_add_f32 v[116:117], v[116:117], v[24:25]
    v_lshlrev_b32 v26, 16, v85
    v_and_b32 v27, 0xffff0000, v85
    v_pk_add_f32 v[118:119], v[118:119], v[26:27]
    v_lshlrev_b32 v24, 16, v86
    v_and_b32 v25, 0xffff0000, v86
    v_pk_add_f32 v[120:121], v[120:121], v[24:25]
    v_lshlrev_b32 v26, 16, v87
    v_and_b32 v27, 0xffff0000, v87
    v_pk_add_f32 v[122:123], v[122:123], v[26:27]
    s_waitcnt vmcnt(6)
    v_lshlrev_b32 v24, 16, v88
    v_and_b32 v25, 0xffff0000, v88
    v_pk_add_f32 v[116:117], v[116:117], v[24:25]
    v_lshlrev_b32 v26, 16, v89
    v_and_b32 v27, 0xffff0000, v89
    v_pk_add_f32 v[118:119], v[118:119], v[26:27]
    v_lshlrev_b32 v24, 16, v90
    v_and_b32 v25, 0xffff0000, v90
    v_pk_add_f32 v[120:121], v[120:121], v[24:25]
    v_lshlrev_b32 v26, 16, v91
    v_and_b32 v27, 0xffff0000, v91
    v_pk_add_f32 v[122:123], v[122:123], v[26:27]
    s_waitcnt vmcnt(5)
    v_lshlrev_b32 v24, 16, v92
    v_and_b32 v25, 0xffff0000, v92
    v_pk_add_f32 v[116:117], v[116:117], v[24:25]
    v_lshlrev_b32 v26, 16, v93
    v_and_b32 v27, 0xffff0000, v93
    v_pk_add_f32 v[118:119], v[118:119], v[26:27]
    v_lshlrev_b32 v24, 16, v94
    v_and_b32 v25, 0xffff0000, v94
    v_pk_add_f32 v[120:121], v[120:121], v[24:25]
    v_lshlrev_b32 v26, 16, v95
    v_and_b32 v27, 0xffff0000, v95
    v_pk_add_f32 v[122:123], v[122:123], v[26:27]
    s_waitcnt vmcnt(3)
    v_lshlrev_b32 v24, 16, v96
    v_and_b32 v25, 0xffff0000, v96
    v_pk_add_f32 v[116:117], v[116:117], v[24:25]
    v_lshlrev_b32 v26, 16, v97
    v_and_b32 v27, 0xffff0000, v97
    v_pk_add_f32 v[118:119], v[118:119], v[26:27]
    v_lshlrev_b32 v24, 16, v98
    v_and_b32 v25, 0xffff0000, v98
    v_pk_add_f32 v[120:121], v[120:121], v[24:25]
    v_lshlrev_b32 v26, 16, v99
    v_and_b32 v27, 0xffff0000, v99
    v_pk_add_f32 v[122:123], v[122:123], v[26:27]
    s_waitcnt vmcnt(2)
    v_lshlrev_b32 v24, 16, v100
    v_and_b32 v25, 0xffff0000, v100
    v_pk_add_f32 v[116:117], v[116:117], v[24:25]
    v_lshlrev_b32 v26, 16, v101
    v_and_b32 v27, 0xffff0000, v101
    v_pk_add_f32 v[118:119], v[118:119], v[26:27]
    v_lshlrev_b32 v24, 16, v102
    v_and_b32 v25, 0xffff0000, v102
    v_pk_add_f32 v[120:121], v[120:121], v[24:25]
    v_lshlrev_b32 v26, 16, v103
    v_and_b32 v27, 0xffff0000, v103
    v_pk_add_f32 v[122:123], v[122:123], v[26:27]
    s_waitcnt vmcnt(1)
    v_lshlrev_b32 v24, 16, v104
    v_and_b32 v25, 0xffff0000, v104
    v_pk_add_f32 v[116:117], v[116:117], v[24:25]
    v_lshlrev_b32 v26, 16, v105
    v_and_b32 v27, 0xffff0000, v105
    v_pk_add_f32 v[118:119], v[118:119], v[26:27]
    v_lshlrev_b32 v24, 16, v106
    v_and_b32 v25, 0xffff0000, v106
    v_pk_add_f32 v[120:121], v[120:121], v[24:25]
    v_lshlrev_b32 v26, 16, v107
    v_and_b32 v27, 0xffff0000, v107
    v_pk_add_f32 v[122:123], v[122:123], v[26:27]
    s_waitcnt vmcnt(0)
    v_lshlrev_b32 v24, 16, v108
    v_and_b32 v25, 0xffff0000, v108
    v_pk_add_f32 v[116:117], v[116:117], v[24:25]
    v_lshlrev_b32 v26, 16, v109
    v_and_b32 v27, 0xffff0000, v109
    v_pk_add_f32 v[118:119], v[118:119], v[26:27]
    v_lshlrev_b32 v24, 16, v110
    v_and_b32 v25, 0xffff0000, v110
    v_pk_add_f32 v[120:121], v[120:121], v[24:25]
    v_lshlrev_b32 v26, 16, v111
    v_and_b32 v27, 0xffff0000, v111
    v_pk_add_f32 v[122:123], v[122:123], v[26:27]
    v_permlane32_swap_b32 v116, v120
    v_permlane32_swap_b32 v117, v121
    v_permlane32_swap_b32 v118, v122
    v_permlane32_swap_b32 v119, v123
    v_lshlrev_b32 v24, 16, v112
    v_and_b32 v25, 0xffff0000, v112
    v_fma_f32 v116, v116, v14, v24
    v_fma_f32 v117, v117, v14, v25
    v_lshlrev_b32 v24, 16, v113
    v_and_b32 v25, 0xffff0000, v113
    v_fma_f32 v118, v118, v14, v24
    v_fma_f32 v119, v119, v14, v25
    v_lshlrev_b32 v24, 16, v114
    v_and_b32 v25, 0xffff0000, v114
    v_fma_f32 v120, v120, v14, v24
    v_fma_f32 v121, v121, v14, v25
    v_lshlrev_b32 v24, 16, v115
    v_and_b32 v25, 0xffff0000, v115
    v_fma_f32 v122, v122, v14, v24
    v_fma_f32 v123, v123, v14, v25
    v_cvt_pk_bf16_f32 v28, v116, v117
    v_cvt_pk_bf16_f32 v29, v118, v119
    v_cvt_pk_bf16_f32 v30, v120, v121
    v_cvt_pk_bf16_f32 v31, v122, v123
    s_lshl_b32 s44, s53, 7
    s_add_u32 s44, s44, s48
    buffer_store_dwordx4 v[28:31], v7, s[32:35], s44 offen
    s_endpgm
L_done:
    s_endpgm
.section .rodata,"a"
.p2align 6
.amdhsa_kernel sequential_preLN__linear_kernel_hedgehog__dense_activation_relu__prompt_kernel
  .amdhsa_next_free_vgpr 256
  .amdhsa_next_free_sgpr 102
  .amdhsa_accum_offset 256
  .amdhsa_group_segment_fixed_size 0
  .amdhsa_kernarg_size 80
  .amdhsa_user_sgpr_count 2
  .amdhsa_user_sgpr_kernarg_segment_ptr 1
  .amdhsa_system_sgpr_workgroup_id_x 1
  .amdhsa_float_denorm_mode_32 3
.end_amdhsa_kernel
.text
L_code_end:
    s_endpgm
```
